```python
import torch

def _softmax(x, axis=-1):
    return torch.softmax(x, dim=axis)
def _gelu(x):
    return torch.nn.functional.gelu(x, approximate="tanh")
def _silu(x):
    return torch.nn.functional.silu(x)
def _sigmoid(x):
    return torch.sigmoid(x)
def _layernorm(x, axis=-1, eps=1e-5):
    m = x.mean(dim=axis, keepdim=True)
    v = x.var(dim=axis, keepdim=True, unbiased=False)
    return (x - m) / torch.sqrt(v + eps)
def _scatter_add(tgt, idx, src, axis=0):
    return tgt.clone().index_add_(axis, idx, src)
def _segment_sum(src, seg, n):
    out = torch.zeros((n,) + src.shape[1:], dtype=src.dtype)
    return out.index_add_(0, seg, src)
def _pad(x, pw):
    flat = tuple(v for pair in reversed(pw) for v in pair)
    return torch.nn.functional.pad(x, flat)

kernel_name = 'interleave_layers__linear_attn_block__glu_gated_bilinear__prompt'

def setup_inputs():

    _w = (lambda a: (lambda t: t.to(torch.bfloat16) if t.is_floating_point() else t)(torch.as_tensor(a)))
    def _A_setup():
        B, S, D = 1, 2048, 1024
        return {
            "x": _w((lambda *s: torch.randn(*s, dtype=torch.bfloat16) * 0.05)(B, S, D)),
            "wqkv": _w((lambda *s: torch.randn(*s, dtype=torch.bfloat16) * 0.05)(D, 3 * D)),
            "wo": _w((lambda *s: torch.randn(*s, dtype=torch.bfloat16) * 0.05)(D, D)),
        }
    _A_in = _A_setup()

    def _B_setup():
        B, S, D, F = 1, 2048, 1024, 3584
        return {
            "x": _w((lambda *s: torch.randn(*s, dtype=torch.bfloat16) * 0.05)(B, S, D)),
            "w_gate": _w((lambda *s: torch.randn(*s, dtype=torch.bfloat16) * 0.8)(D, F) * (D ** -0.5)),
            "w_up": _w((lambda *s: torch.randn(*s, dtype=torch.bfloat16) * 0.8)(D, F) * (D ** -0.5)),
            "w_down": _w((lambda *s: torch.randn(*s, dtype=torch.bfloat16) * 0.8)(F, D) * (F ** -0.5)),
        }
    _B_in = _B_setup()

    return {
        "A_x": _A_in["x"],
        "A_wqkv": _A_in["wqkv"],
        "A_wo": _A_in["wo"],
        "B_x": _B_in["x"],
        "B_w_gate": _B_in["w_gate"],
        "B_w_up": _B_in["w_up"],
        "B_w_down": _B_in["w_down"],
    }

def reference(A_x, A_wqkv, A_wo, B_x, B_w_gate, B_w_up, B_w_down):
    def _A_ref(x, wqkv, wo):
        B, S, D = x.shape
        H = 32; Dh = D // H
        qkv = (lambda x, *d: x.permute(*d))((x @ wqkv).reshape(B, S, 3, H, Dh), 2, 0, 3, 1, 4)
        q, k, v = qkv[0], qkv[1], qkv[2]
        phi = lambda t: torch.where(t > 0, t + 1, torch.exp(t)) + 1e-6
        pq, pk = phi(q), phi(k)
        kv = torch.einsum("bhsd,bhse->bhde", pk, v)
        z = torch.einsum("bhsd->bhd", pk)
        num = torch.einsum("bhqd,bhde->bhqe", pq, kv)
        den = torch.einsum("bhqd,bhd->bhq", pq, z)[..., None] + 1e-6
        o = num / den
        return (lambda x, *d: x.permute(*d))(o, 0, 2, 1, 3).reshape(B, S, D) @ wo

    def _B_ref(x, w_gate, w_up, w_down):
        g = torch.einsum("bsd,df->bsf", x, w_gate)
        u = torch.einsum("bsd,df->bsf", x, w_up)
        h = g * u
        return torch.einsum("bsf,fd->bsd", h, w_down)

    x = A_x
    x = x + _A_ref(_layernorm(x, axis=-1), A_wqkv, A_wo)
    x = x + _B_ref(_layernorm(x, axis=-1), B_w_gate, B_w_up, B_w_down)
    x = x + _A_ref(_layernorm(x, axis=-1), A_wqkv, A_wo)
    x = x + _B_ref(_layernorm(x, axis=-1), B_w_gate, B_w_up, B_w_down)
    return x
```

```asm
; @launch grid=(256,1,1) block=(256,1,1) lds=163840
.amdgcn_target "amdgcn-amd-amdhsa--gfx950"
.text
.globl interleave_layers__linear_attn_block__glu_gated_bilinear__prompt_kernel
.p2align 8
.type interleave_layers__linear_attn_block__glu_gated_bilinear__prompt_kernel,@function
interleave_layers__linear_attn_block__glu_gated_bilinear__prompt_kernel:
s_mov_b64 vcc, 0
s_cmp_ge_u32 s2, 256
s_cbranch_scc1 L_main_end
s_load_dwordx16 s[40:55], s[0:1], 0
s_load_dwordx4 s[56:59], s[0:1], 64
v_mov_b32 v1, v0
v_lshrrev_b32 v2, 6, v0
s_nop 1
v_readfirstlane_b32 s20, v2
v_and_b32 v2, 63, v0
s_nop 3
s_mov_b32 s30, 0
s_waitcnt lgkmcnt(0)
s_mov_b32 s8, s58
s_and_b32 s9, s59, 0xffff
s_mov_b32 s10, 0x3000000
s_mov_b32 s11, 0x20000
v_mbcnt_lo_u32_b32 v63, -1, 0
v_mbcnt_hi_u32_b32 v63, -1, v63
s_lshl_b32 s29, s20, 6
v_add_u32 v62, s29, v63
s_mov_b32 s4, s56
s_and_b32 s5, s57, 0xffff
s_mov_b32 s6, 0x100
s_mov_b32 s7, 0x20000
s_mov_b32 s57, 0
s_add_u32 s26, s2, s20
s_cmp_lg_u32 s26, 0
s_cbranch_scc1 L_p0_nt
s_memrealtime s[32:33]
s_waitcnt lgkmcnt(0)
s_or_b32 s32, s32, 1
v_mov_b32 v1, s32
s_mov_b64 exec, 1
buffer_store_dword v1, off, s[4:7], 0 sc1
s_mov_b64 exec, -1
L_p0_nt:
s_mov_b32 s16, s40
s_and_b32 s17, s41, 0xffff
s_mov_b32 s18, 0x400000
s_mov_b32 s19, 0x20000
s_lshl_b32 s26, s2, 2
s_add_u32 s26, s26, s20
s_lshr_b32 s21, s26, 3
s_and_b32 s22, s26, 7
s_lshl_b32 s27, s21, 15
s_lshl_b32 s28, s22, 8
s_add_u32 s27, s27, s28
v_and_b32 v1, 15, v63
v_lshlrev_b32 v2, 11, v1
v_lshrrev_b32 v3, 4, v63
v_lshl_add_u32 v2, v3, 4, v2
buffer_load_dwordx4 v[4:7], v2, s[16:19], s27 offen offset:0
buffer_load_dwordx4 v[8:11], v2, s[16:19], s27 offen offset:64
buffer_load_dwordx4 v[12:15], v2, s[16:19], s27 offen offset:128
buffer_load_dwordx4 v[16:19], v2, s[16:19], s27 offen offset:192
s_cmp_ge_u32 s2, 192
s_cbranch_scc1 L_p0_pf
s_and_b32 s33, s2, 3
s_lshr_b32 s32, s2, 2
s_mov_b32 s12, s42
s_and_b32 s13, s43, 0xffff
s_mov_b32 s14, 0x600000
s_mov_b32 s15, 0x20000
v_lshrrev_b32 v144, 3, v62
v_mul_u32_u24 v144, 6144, v144
v_and_b32 v145, 7, v62
v_lshl_add_u32 v144, v145, 4, v144
s_mul_i32 s29, s33, 1572864
s_mul_i32 s28, s32, 128
s_add_u32 s29, s29, s28
buffer_load_dwordx4 v[160:163], v144, s[12:15], s29 offen
s_add_u32 s29, s29, 196608
buffer_load_dwordx4 v[164:167], v144, s[12:15], s29 offen
s_add_u32 s29, s29, 196608
buffer_load_dwordx4 v[168:171], v144, s[12:15], s29 offen
s_add_u32 s29, s29, 196608
buffer_load_dwordx4 v[172:175], v144, s[12:15], s29 offen
s_add_u32 s29, s29, 196608
buffer_load_dwordx4 v[176:179], v144, s[12:15], s29 offen
s_add_u32 s29, s29, 196608
buffer_load_dwordx4 v[180:183], v144, s[12:15], s29 offen
s_add_u32 s29, s29, 196608
buffer_load_dwordx4 v[184:187], v144, s[12:15], s29 offen
s_add_u32 s29, s29, 196608
buffer_load_dwordx4 v[188:191], v144, s[12:15], s29 offen
s_add_u32 s29, s29, 196608
s_waitcnt vmcnt(8)
s_branch L_p0_x
L_p0_pf:
s_getpc_b64 s[34:35]
s_sub_u32 s32, s2, 192
s_lshr_b32 s33, s32, 3
s_lshl_b32 s33, s33, 2
s_add_u32 s33, s33, s20
s_lshl_b32 s33, s33, 13
s_mov_b32 s12, s34
s_and_b32 s13, s35, 0xffff
s_mov_b32 s14, 0xe000
s_mov_b32 s15, 0x20000
s_mov_b32 s14, L_main_end-L_p0_x
v_lshlrev_b32 v3, 7, v63
buffer_load_dword v0, v3, s[12:15], s33 offen
s_mov_b32 s12, s44
s_and_b32 s13, s45, 0xffff
s_mov_b32 s14, 0x200000
s_mov_b32 s15, 0x20000
s_lshl_b32 s32, s32, 2
s_add_u32 s32, s32, s20
s_lshl_b32 s32, s32, 13
buffer_load_dword v0, v3, s[12:15], s32 offen
s_waitcnt vmcnt(2)
L_p0_x:
s_cmp_ge_u32 s2, 68
s_cbranch_scc1 L_p0_nz
v_mov_b32 v56, 0
v_mov_b32 v57, 0
v_mov_b32 v58, 0
v_mov_b32 v59, 0
s_and_b32 s25, s2, 1
s_mul_i32 s25, s25, 0x100000
s_lshr_b32 s29, s2, 1
s_lshl_b32 s29, s29, 12
s_add_u32 s29, s29, s25
s_add_u32 s29, s29, 0x1d00000
v_lshlrev_b32 v3, 4, v62
buffer_store_dwordx4 v[56:59], v3, s[8:11], s29 offen sc1
L_p0_nz:
s_lshl_b32 s27, s26, 12
s_add_u32 s27, s27, 0x0
s_lshl_b32 s23, s21, 11
s_lshr_b32 s28, s22, 1
s_lshl_b32 s28, s28, 9
s_add_u32 s23, s23, s28
s_and_b32 s28, s22, 1
s_lshl_b32 s28, s28, 4
s_add_u32 s23, s23, s28
s_add_u32 s23, s23, 0x1a00000
v_lshlrev_b32 v2, 4, v63
v_lshlrev_b32 v3, 5, v1
v_permlane16_swap_b32 v4, v6
v_permlane16_swap_b32 v5, v7
v_permlane16_swap_b32 v8, v10
v_permlane16_swap_b32 v9, v11
v_permlane16_swap_b32 v12, v14
v_permlane16_swap_b32 v13, v15
v_permlane16_swap_b32 v16, v18
v_permlane16_swap_b32 v17, v19
v_permlane32_swap_b32 v4, v6
v_permlane32_swap_b32 v5, v7
v_permlane32_swap_b32 v8, v10
v_permlane32_swap_b32 v9, v11
v_permlane32_swap_b32 v12, v14
v_permlane32_swap_b32 v13, v15
v_permlane32_swap_b32 v16, v18
v_permlane32_swap_b32 v17, v19
buffer_store_dwordx4 v[4:7], v2, s[8:11], s27 offen offset:0 sc1
buffer_store_dwordx4 v[8:11], v2, s[8:11], s27 offen offset:1024 sc1
buffer_store_dwordx4 v[12:15], v2, s[8:11], s27 offen offset:2048 sc1
buffer_store_dwordx4 v[16:19], v2, s[8:11], s27 offen offset:3072 sc1
buffer_load_dword v64, off, s[4:7], 0 sc1
v_lshlrev_b32 v20, 16, v4
v_lshlrev_b32 v36, 16, v12
v_and_b32 v21, 0xffff0000, v4
v_and_b32 v37, 0xffff0000, v12
v_lshlrev_b32 v22, 16, v5
v_lshlrev_b32 v38, 16, v13
v_and_b32 v23, 0xffff0000, v5
v_and_b32 v39, 0xffff0000, v13
v_lshlrev_b32 v24, 16, v6
v_lshlrev_b32 v40, 16, v14
v_and_b32 v25, 0xffff0000, v6
v_and_b32 v41, 0xffff0000, v14
v_lshlrev_b32 v26, 16, v7
v_lshlrev_b32 v42, 16, v15
v_and_b32 v27, 0xffff0000, v7
v_and_b32 v43, 0xffff0000, v15
v_lshlrev_b32 v28, 16, v8
v_lshlrev_b32 v44, 16, v16
v_and_b32 v29, 0xffff0000, v8
v_and_b32 v45, 0xffff0000, v16
v_lshlrev_b32 v30, 16, v9
v_lshlrev_b32 v46, 16, v17
v_and_b32 v31, 0xffff0000, v9
v_and_b32 v47, 0xffff0000, v17
v_lshlrev_b32 v32, 16, v10
v_lshlrev_b32 v48, 16, v18
v_and_b32 v33, 0xffff0000, v10
v_and_b32 v49, 0xffff0000, v18
v_lshlrev_b32 v34, 16, v11
v_lshlrev_b32 v50, 16, v19
v_and_b32 v35, 0xffff0000, v11
v_and_b32 v51, 0xffff0000, v19
v_pk_add_f32 v[52:53], v[20:21], v[22:23]
v_pk_add_f32 v[54:55], v[36:37], v[38:39]
v_pk_add_f32 v[52:53], v[52:53], v[24:25]
v_pk_add_f32 v[54:55], v[54:55], v[40:41]
v_pk_add_f32 v[52:53], v[52:53], v[26:27]
v_pk_add_f32 v[54:55], v[54:55], v[42:43]
v_pk_add_f32 v[52:53], v[52:53], v[28:29]
v_pk_add_f32 v[54:55], v[54:55], v[44:45]
v_pk_add_f32 v[52:53], v[52:53], v[30:31]
v_pk_add_f32 v[54:55], v[54:55], v[46:47]
v_pk_add_f32 v[52:53], v[52:53], v[32:33]
v_pk_add_f32 v[54:55], v[54:55], v[48:49]
v_pk_add_f32 v[52:53], v[52:53], v[34:35]
v_pk_add_f32 v[54:55], v[54:55], v[50:51]
v_add_f32 v52, v52, v53
v_add_f32 v54, v54, v55
v_mov_b32 v60, v52
v_mov_b32 v61, v54
s_nop 0
v_permlane16_swap_b32 v52, v60
v_permlane16_swap_b32 v54, v61
v_add_f32 v52, v52, v60
v_add_f32 v54, v54, v61
v_mov_b32 v60, v52
v_mov_b32 v61, v54
s_nop 0
v_permlane32_swap_b32 v52, v60
v_permlane32_swap_b32 v54, v61
v_add_f32 v52, v52, v60
v_add_f32 v54, v54, v61
v_mul_f32 v53, 0x3c800000, v52
v_mul_f32 v55, 0x3c800000, v54
v_pk_add_f32 v[20:21], v[20:21], v[52:53] op_sel:[0,1] op_sel_hi:[1,1] neg_lo:[0,1] neg_hi:[0,1]
v_pk_add_f32 v[36:37], v[36:37], v[54:55] op_sel:[0,1] op_sel_hi:[1,1] neg_lo:[0,1] neg_hi:[0,1]
v_pk_add_f32 v[22:23], v[22:23], v[52:53] op_sel:[0,1] op_sel_hi:[1,1] neg_lo:[0,1] neg_hi:[0,1]
v_pk_add_f32 v[38:39], v[38:39], v[54:55] op_sel:[0,1] op_sel_hi:[1,1] neg_lo:[0,1] neg_hi:[0,1]
v_pk_add_f32 v[24:25], v[24:25], v[52:53] op_sel:[0,1] op_sel_hi:[1,1] neg_lo:[0,1] neg_hi:[0,1]
v_pk_add_f32 v[40:41], v[40:41], v[54:55] op_sel:[0,1] op_sel_hi:[1,1] neg_lo:[0,1] neg_hi:[0,1]
v_pk_add_f32 v[26:27], v[26:27], v[52:53] op_sel:[0,1] op_sel_hi:[1,1] neg_lo:[0,1] neg_hi:[0,1]
v_pk_add_f32 v[42:43], v[42:43], v[54:55] op_sel:[0,1] op_sel_hi:[1,1] neg_lo:[0,1] neg_hi:[0,1]
v_pk_add_f32 v[28:29], v[28:29], v[52:53] op_sel:[0,1] op_sel_hi:[1,1] neg_lo:[0,1] neg_hi:[0,1]
v_pk_add_f32 v[44:45], v[44:45], v[54:55] op_sel:[0,1] op_sel_hi:[1,1] neg_lo:[0,1] neg_hi:[0,1]
v_pk_add_f32 v[30:31], v[30:31], v[52:53] op_sel:[0,1] op_sel_hi:[1,1] neg_lo:[0,1] neg_hi:[0,1]
v_pk_add_f32 v[46:47], v[46:47], v[54:55] op_sel:[0,1] op_sel_hi:[1,1] neg_lo:[0,1] neg_hi:[0,1]
v_pk_add_f32 v[32:33], v[32:33], v[52:53] op_sel:[0,1] op_sel_hi:[1,1] neg_lo:[0,1] neg_hi:[0,1]
v_pk_add_f32 v[48:49], v[48:49], v[54:55] op_sel:[0,1] op_sel_hi:[1,1] neg_lo:[0,1] neg_hi:[0,1]
v_pk_add_f32 v[34:35], v[34:35], v[52:53] op_sel:[0,1] op_sel_hi:[1,1] neg_lo:[0,1] neg_hi:[0,1]
v_pk_add_f32 v[50:51], v[50:51], v[54:55] op_sel:[0,1] op_sel_hi:[1,1] neg_lo:[0,1] neg_hi:[0,1]
v_pk_mul_f32 v[20:21], v[20:21], v[20:21]
v_pk_mul_f32 v[36:37], v[36:37], v[36:37]
v_pk_fma_f32 v[20:21], v[22:23], v[22:23], v[20:21]
v_pk_fma_f32 v[36:37], v[38:39], v[38:39], v[36:37]
v_pk_fma_f32 v[20:21], v[24:25], v[24:25], v[20:21]
v_pk_fma_f32 v[36:37], v[40:41], v[40:41], v[36:37]
v_pk_fma_f32 v[20:21], v[26:27], v[26:27], v[20:21]
v_pk_fma_f32 v[36:37], v[42:43], v[42:43], v[36:37]
v_pk_fma_f32 v[20:21], v[28:29], v[28:29], v[20:21]
v_pk_fma_f32 v[36:37], v[44:45], v[44:45], v[36:37]
v_pk_fma_f32 v[20:21], v[30:31], v[30:31], v[20:21]
v_pk_fma_f32 v[36:37], v[46:47], v[46:47], v[36:37]
v_pk_fma_f32 v[20:21], v[32:33], v[32:33], v[20:21]
v_pk_fma_f32 v[36:37], v[48:49], v[48:49], v[36:37]
v_pk_fma_f32 v[20:21], v[34:35], v[34:35], v[20:21]
v_pk_fma_f32 v[36:37], v[50:51], v[50:51], v[36:37]
v_add_f32 v53, v20, v21
v_add_f32 v55, v36, v37
v_mov_b32 v60, v53
v_mov_b32 v61, v55
s_nop 0
v_permlane16_swap_b32 v53, v60
v_permlane16_swap_b32 v55, v61
v_add_f32 v53, v53, v60
v_add_f32 v55, v55, v61
v_mov_b32 v60, v53
v_mov_b32 v61, v55
s_nop 0
v_permlane32_swap_b32 v53, v60
v_permlane32_swap_b32 v55, v61
v_add_f32 v53, v53, v60
v_add_f32 v55, v55, v61
buffer_store_dwordx2 v[52:53], v3, s[8:11], s23 offen offset:0 sc1
buffer_store_dwordx2 v[54:55], v3, s[8:11], s23 offen offset:8 sc1
s_waitcnt vmcnt(2)
s_mov_b32 s56, 0x100000
L_p0_tag:
v_readfirstlane_b32 s58, v64
s_nop 3
s_cmp_lg_u32 s58, 0
s_cbranch_scc1 L_p0_go
buffer_load_dword v64, off, s[4:7], 0 sc1
s_sub_u32 s56, s56, 1
s_waitcnt vmcnt(0)
s_cbranch_scc0 L_p0_tag
L_p0_go:
s_lshl_b32 s100, s2, 7
s_add_u32 s100, s100, 0x1d58000
L_layer:
v_mbcnt_lo_u32_b32 v97, -1, 0
v_mbcnt_hi_u32_b32 v97, -1, v97
s_lshl_b32 s29, s20, 6
v_add_u32 v96, s29, v97
s_and_b32 s27, s2, 7
s_lshr_b32 s28, s2, 3
s_and_b32 s26, s27, 1
s_lshl_b32 s26, s26, 3
s_and_b32 s29, s28, 7
s_add_u32 s26, s26, s29
s_lshr_b32 s22, s27, 1
s_lshl_b32 s22, s22, 2
s_lshr_b32 s29, s28, 3
s_add_u32 s22, s22, s29
s_lshr_b32 s98, s26, 1
s_lshl_b32 s98, s98, 12
s_add_u32 s98, s98, 0x1d58000
s_add_u32 s98, s98, s57
s_lshl_b32 s99, s26, 4
s_add_u32 s99, s99, s22
s_lshl_b32 s99, s99, 7
s_add_u32 s99, s99, 0x1d40000
s_add_u32 s99, s99, s57
s_lshl_b32 s37, s22, 11
s_add_u32 s37, s37, 0x1dd8000
s_add_u32 s37, s37, s57
s_lshl_b32 s39, s26, 7
s_add_u32 s39, s39, s37
s_lshl_b32 s21, s26, 3
s_lshl_b32 s27, s20, 1
s_add_u32 s21, s21, s27
v_lshrrev_b32 v116, 3, v97
v_mul_u32_u24 v116, 6144, v116
v_bfe_u32 v117, v97, 4, 2
v_lshlrev_b32 v117, 1, v117
v_and_b32 v118, 7, v97
v_xor_b32 v117, v117, v118
v_lshl_add_u32 v98, v117, 4, v116
v_lshlrev_b32 v100, 4, v97
v_add_u32 v101, 0x8000, v100
s_lshl_b32 s26, s22, 7
s_mul_i32 s27, s20, 98304
s_add_u32 s26, s26, s27
s_sub_u32 s3, s27, 5898240
s_lshl_b32 s24, s20, 12
s_mov_b32 s32, 2048
s_mov_b32 s4, 0
s_mov_b32 s33, 50176
s_mov_b32 s5, 48128
s_mov_b32 s34, 2048
s_mov_b32 s6, 96256
s_mov_b32 s35, 50176
s_mov_b32 s7, 144384
s_lshl_b32 s23, s21, 15
s_lshl_b32 s41, s22, 11
s_add_u32 s41, s41, s23
s_add_u32 s41, s41, 0x400000
s_add_u32 s23, s23, 0x0
s_mul_i32 s36, s22, 8704
s_add_u32 s36, s36, 0x1d00000
s_add_u32 s36, s36, s57
s_mov_b32 m0, s24
s_mov_b32 s12, s42
s_and_b32 s13, s43, 0xffff
s_mov_b32 s14, 0x600000
s_mov_b32 s15, 0x20000
s_add_u32 s12, s12, s26
s_addc_u32 s13, s13, 0
s_sub_u32 s14, s14, s26
buffer_load_dwordx4 v98, s[12:15], s32 offen offset:0 lds
buffer_load_dwordx4 v98, s[12:15], s33 offen offset:1024 lds
buffer_load_dwordx4 v98, s[12:15], s34 offen offset:2048 lds
buffer_load_dwordx4 v98, s[12:15], s35 offen offset:3072 lds
s_add_u32 m0, s24, 0x4000
v_add_u32 v98, 0x60000, v98
buffer_load_dwordx4 v98, s[12:15], s32 offen offset:0 lds
buffer_load_dwordx4 v98, s[12:15], s33 offen offset:1024 lds
buffer_load_dwordx4 v98, s[12:15], s34 offen offset:2048 lds
buffer_load_dwordx4 v98, s[12:15], s35 offen offset:3072 lds
s_add_u32 m0, s24, 0x8000
v_add_u32 v98, 0x60000, v98
v_lshrrev_b32 v116, 2, v97
v_lshlrev_b32 v116, 7, v116
v_and_b32 v117, 3, v97
v_lshl_add_u32 v116, v117, 3, v116
v_bfe_u32 v117, v97, 3, 2
v_xor_b32 v118, 0, v117
v_lshl_add_u32 v106, v118, 5, v116
v_add_u32 v110, 0x10000, v106
v_add_u32 v252, 0x20000, v106
v_xor_b32 v118, 1, v117
v_lshl_add_u32 v107, v118, 5, v116
v_add_u32 v111, 0x10000, v107
v_add_u32 v253, 0x20000, v107
v_xor_b32 v118, 2, v117
v_lshl_add_u32 v108, v118, 5, v116
v_add_u32 v112, 0x10000, v108
v_add_u32 v254, 0x20000, v108
v_xor_b32 v118, 3, v117
v_lshl_add_u32 v109, v118, 5, v116
v_add_u32 v113, 0x10000, v109
v_add_u32 v255, 0x20000, v109
s_lshl_b32 s38, s20, 13
s_add_u32 s38, s38, 0x1dc0000
v_lshlrev_b32 v115, 7, v97
s_lshr_b32 s28, s2, 2
s_cmp_lt_u32 s28, 28
s_cselect_b32 s26, s48, s50
s_cselect_b32 s27, s49, s51
s_cselect_b32 s29, 0, 28
s_sub_u32 s28, s28, s29
s_mov_b32 s16, s26
s_and_b32 s17, s27, 0xffff
s_mov_b32 s18, 0x700000
s_mov_b32 s19, 0x20000
s_lshl_b32 s97, s28, 8
s_and_b32 s29, s2, 3
s_lshl_b32 s29, s29, 2
s_add_u32 s29, s29, s20
s_mul_i32 s29, s29, 458752
s_add_u32 s97, s97, s29
s_cmp_ge_u32 s2, 224
s_cselect_b32 s97, 0x80000000, s97
s_cmp_lg_u32 s30, 0
s_cselect_b32 s97, 0x80000000, s97
v_lshrrev_b32 v99, 1, v97
v_min_u32 v99, 31, v99
v_mul_u32_u24 v99, 7168, v99
v_and_b32 v116, 1, v97
v_lshl_add_u32 v99, v116, 7, v99
v_lshlrev_b32 v116, 5, v97
s_lshl_b32 s92, s21, 11
s_add_u32 s92, s92, 0x1a00000
v_min_u32 v118, 191, v96
v_lshrrev_b32 v119, 6, v118
v_lshlrev_b32 v119, 12, v119
v_and_b32 v120, 63, v118
v_lshl_add_u32 v119, v120, 2, v119
v_lshlrev_b32 v118, 2, v118
v_add_u32 v118, 0x24000, v118
s_lshl_b32 s93, s22, 8
s_add_u32 s93, s93, 0x1a80000
s_add_u32 s94, s93, 40960
s_add_u32 s95, s93, 81920
s_add_u32 s96, s93, 122880
v_and_b32 v117, 15, v97
v_lshlrev_b32 v117, 2, v117
s_lshl_b32 s31, s20, 8
s_add_u32 s31, s31, 0x24400
v_add_u32 v117, s31, v117
s_mov_b32 s60, 0x3fb8aa3b
s_mov_b32 s61, 0xb5c1a2a0
s_mov_b32 s62, 0x358637bd
s_mov_b32 s63, 0x358637bd
v_mov_b32 v125, s58
v_and_b32 v126, 31, v97
v_lshlrev_b32 v126, 7, v126
s_waitcnt vmcnt(8)
s_barrier
s_cmp_lg_u32 s20, 3
s_cbranch_scc1 L_k1_ns
s_mov_b64 exec, 1
buffer_store_dword v125, off, s[8:11], s100 sc1
s_mov_b64 exec, -1
L_k1_ns:
buffer_load_dwordx4 v98, s[12:15], s32 offen offset:0 lds
buffer_load_dwordx4 v98, s[12:15], s33 offen offset:1024 lds
buffer_load_dwordx4 v98, s[12:15], s34 offen offset:2048 lds
buffer_load_dwordx4 v98, s[12:15], s35 offen offset:3072 lds
s_add_u32 m0, s24, 0xc000
v_add_u32 v98, 0x60000, v98
buffer_load_dwordx4 v98, s[12:15], s32 offen offset:0 lds
buffer_load_dwordx4 v98, s[12:15], s33 offen offset:1024 lds
buffer_load_dwordx4 v98, s[12:15], s34 offen offset:2048 lds
buffer_load_dwordx4 v98, s[12:15], s35 offen offset:3072 lds
s_add_u32 m0, s24, 0x10000
v_add_u32 v98, 0x60000, v98
buffer_load_dwordx4 v98, s[12:15], s32 offen offset:0 lds
buffer_load_dwordx4 v98, s[12:15], s33 offen offset:1024 lds
buffer_load_dwordx4 v98, s[12:15], s34 offen offset:2048 lds
buffer_load_dwordx4 v98, s[12:15], s35 offen offset:3072 lds
s_add_u32 m0, s24, 0x14000
v_add_u32 v98, 0x60000, v98
buffer_load_dwordx4 v98, s[12:15], s32 offen offset:0 lds
buffer_load_dwordx4 v98, s[12:15], s33 offen offset:1024 lds
buffer_load_dwordx4 v98, s[12:15], s34 offen offset:2048 lds
buffer_load_dwordx4 v98, s[12:15], s35 offen offset:3072 lds
s_add_u32 m0, s24, 0x18000
v_add_u32 v98, 0x60000, v98
buffer_load_dwordx4 v98, s[12:15], s32 offen offset:0 lds
buffer_load_dwordx4 v98, s[12:15], s33 offen offset:1024 lds
buffer_load_dwordx4 v98, s[12:15], s34 offen offset:2048 lds
buffer_load_dwordx4 v98, s[12:15], s35 offen offset:3072 lds
s_add_u32 m0, s24, 0x1c000
v_add_u32 v98, 0x60000, v98
buffer_load_dwordx4 v98, s[12:15], s32 offen offset:0 lds
buffer_load_dwordx4 v98, s[12:15], s33 offen offset:1024 lds
buffer_load_dwordx4 v98, s[12:15], s34 offen offset:2048 lds
buffer_load_dwordx4 v98, s[12:15], s35 offen offset:3072 lds
s_add_u32 m0, s24, 0x20000
v_add_u32 v98, 0x60000, v98
buffer_load_dwordx4 v98, s[12:15], s32 offen offset:0 lds
buffer_load_dwordx4 v98, s[12:15], s33 offen offset:1024 lds
buffer_load_dwordx4 v98, s[12:15], s34 offen offset:2048 lds
buffer_load_dwordx4 v98, s[12:15], s35 offen offset:3072 lds
s_add_u32 m0, s24, 0x0
v_add_u32 v98, 0x60000, v98
s_cmp_lg_u32 s30, 0
s_cbranch_scc1 L_k1_nj
s_cmp_ge_u32 s2, 192
s_cbranch_scc1 L_k1_nc
s_and_b32 s27, s2, 3
s_lshr_b32 s26, s2, 2
v_lshlrev_b32 v146, 16, v160
v_and_b32 v147, 0xffff0000, v160
v_lshlrev_b32 v148, 16, v161
v_and_b32 v149, 0xffff0000, v161
v_lshlrev_b32 v150, 16, v162
v_and_b32 v151, 0xffff0000, v162
v_lshlrev_b32 v152, 16, v163
v_and_b32 v153, 0xffff0000, v163
v_lshlrev_b32 v154, 16, v164
v_and_b32 v155, 0xffff0000, v164
v_pk_add_f32 v[146:147], v[146:147], v[154:155]
v_lshlrev_b32 v156, 16, v165
v_and_b32 v157, 0xffff0000, v165
v_pk_add_f32 v[148:149], v[148:149], v[156:157]
v_lshlrev_b32 v154, 16, v166
v_and_b32 v155, 0xffff0000, v166
v_pk_add_f32 v[150:151], v[150:151], v[154:155]
v_lshlrev_b32 v156, 16, v167
v_and_b32 v157, 0xffff0000, v167
v_pk_add_f32 v[152:153], v[152:153], v[156:157]
v_lshlrev_b32 v154, 16, v168
v_and_b32 v155, 0xffff0000, v168
v_pk_add_f32 v[146:147], v[146:147], v[154:155]
v_lshlrev_b32 v156, 16, v169
v_and_b32 v157, 0xffff0000, v169
v_pk_add_f32 v[148:149], v[148:149], v[156:157]
v_lshlrev_b32 v154, 16, v170
v_and_b32 v155, 0xffff0000, v170
v_pk_add_f32 v[150:151], v[150:151], v[154:155]
v_lshlrev_b32 v156, 16, v171
v_and_b32 v157, 0xffff0000, v171
v_pk_add_f32 v[152:153], v[152:153], v[156:157]
v_lshlrev_b32 v154, 16, v172
v_and_b32 v155, 0xffff0000, v172
v_pk_add_f32 v[146:147], v[146:147], v[154:155]
v_lshlrev_b32 v156, 16, v173
v_and_b32 v157, 0xffff0000, v173
v_pk_add_f32 v[148:149], v[148:149], v[156:157]
v_lshlrev_b32 v154, 16, v174
v_and_b32 v155, 0xffff0000, v174
v_pk_add_f32 v[150:151], v[150:151], v[154:155]
v_lshlrev_b32 v156, 16, v175
v_and_b32 v157, 0xffff0000, v175
v_pk_add_f32 v[152:153], v[152:153], v[156:157]
v_lshlrev_b32 v154, 16, v176
v_and_b32 v155, 0xffff0000, v176
v_pk_add_f32 v[146:147], v[146:147], v[154:155]
v_lshlrev_b32 v156, 16, v177
v_and_b32 v157, 0xffff0000, v177
v_pk_add_f32 v[148:149], v[148:149], v[156:157]
v_lshlrev_b32 v154, 16, v178
v_and_b32 v155, 0xffff0000, v178
v_pk_add_f32 v[150:151], v[150:151], v[154:155]
v_lshlrev_b32 v156, 16, v179
v_and_b32 v157, 0xffff0000, v179
v_pk_add_f32 v[152:153], v[152:153], v[156:157]
v_lshlrev_b32 v154, 16, v180
v_and_b32 v155, 0xffff0000, v180
v_pk_add_f32 v[146:147], v[146:147], v[154:155]
v_lshlrev_b32 v156, 16, v181
v_and_b32 v157, 0xffff0000, v181
v_pk_add_f32 v[148:149], v[148:149], v[156:157]
v_lshlrev_b32 v154, 16, v182
v_and_b32 v155, 0xffff0000, v182
v_pk_add_f32 v[150:151], v[150:151], v[154:155]
v_lshlrev_b32 v156, 16, v183
v_and_b32 v157, 0xffff0000, v183
v_pk_add_f32 v[152:153], v[152:153], v[156:157]
v_lshlrev_b32 v154, 16, v184
v_and_b32 v155, 0xffff0000, v184
v_pk_add_f32 v[146:147], v[146:147], v[154:155]
v_lshlrev_b32 v156, 16, v185
v_and_b32 v157, 0xffff0000, v185
v_pk_add_f32 v[148:149], v[148:149], v[156:157]
v_lshlrev_b32 v154, 16, v186
v_and_b32 v155, 0xffff0000, v186
v_pk_add_f32 v[150:151], v[150:151], v[154:155]
v_lshlrev_b32 v156, 16, v187
v_and_b32 v157, 0xffff0000, v187
v_pk_add_f32 v[152:153], v[152:153], v[156:157]
v_lshlrev_b32 v154, 16, v188
v_and_b32 v155, 0xffff0000, v188
v_pk_add_f32 v[146:147], v[146:147], v[154:155]
v_lshlrev_b32 v156, 16, v189
v_and_b32 v157, 0xffff0000, v189
v_pk_add_f32 v[148:149], v[148:149], v[156:157]
v_lshlrev_b32 v154, 16, v190
v_and_b32 v155, 0xffff0000, v190
v_pk_add_f32 v[150:151], v[150:151], v[154:155]
v_lshlrev_b32 v156, 16, v191
v_and_b32 v157, 0xffff0000, v191
v_pk_add_f32 v[152:153], v[152:153], v[156:157]
v_lshlrev_b32 v144, 5, v96
v_add_u32 v144, 0x26000, v144
ds_write_b128 v144, v[146:149]
ds_write_b128 v144, v[150:153] offset:16
v_and_b32 v145, 63, v96
v_lshlrev_b32 v145, 2, v145
v_add_u32 v144, 0x26000, v145
s_waitcnt lgkmcnt(0)
s_barrier
ds_read2st64_b32 v[160:161], v144 offset0:0 offset1:1
ds_read2st64_b32 v[162:163], v144 offset0:2 offset1:3
ds_read2st64_b32 v[164:165], v144 offset0:4 offset1:5
ds_read2st64_b32 v[166:167], v144 offset0:6 offset1:7
ds_read2st64_b32 v[168:169], v144 offset0:8 offset1:9
ds_read2st64_b32 v[170:171], v144 offset0:10 offset1:11
ds_read2st64_b32 v[172:173], v144 offset0:12 offset1:13
ds_read2st64_b32 v[174:175], v144 offset0:14 offset1:15
ds_read2st64_b32 v[176:177], v144 offset0:16 offset1:17
ds_read2st64_b32 v[178:179], v144 offset0:18 offset1:19
ds_read2st64_b32 v[180:181], v144 offset0:20 offset1:21
ds_read2st64_b32 v[182:183], v144 offset0:22 offset1:23
ds_read2st64_b32 v[184:185], v144 offset0:24 offset1:25
ds_read2st64_b32 v[186:187], v144 offset0:26 offset1:27
ds_read2st64_b32 v[188:189], v144 offset0:28 offset1:29
ds_read2st64_b32 v[190:191], v144 offset0:30 offset1:31
s_mul_i32 s29, s27, 40960
s_mul_i32 s28, s26, 256
s_add_u32 s29, s29, s28
s_add_u32 s29, s29, 0x1a80000
s_waitcnt lgkmcnt(0)
v_pk_add_f32 v[160:161], v[160:161], v[162:163]
v_pk_add_f32 v[160:161], v[160:161], v[164:165]
v_pk_add_f32 v[160:161], v[160:161], v[166:167]
v_pk_add_f32 v[160:161], v[160:161], v[168:169]
v_pk_add_f32 v[160:161], v[160:161], v[170:171]
v_pk_add_f32 v[160:161], v[160:161], v[172:173]
v_pk_add_f32 v[160:161], v[160:161], v[174:175]
v_pk_add_f32 v[160:161], v[160:161], v[176:177]
v_pk_add_f32 v[160:161], v[160:161], v[178:179]
v_pk_add_f32 v[160:161], v[160:161], v[180:181]
v_pk_add_f32 v[160:161], v[160:161], v[182:183]
v_pk_add_f32 v[160:161], v[160:161], v[184:185]
v_pk_add_f32 v[160:161], v[160:161], v[186:187]
v_pk_add_f32 v[160:161], v[160:161], v[188:189]
v_pk_add_f32 v[160:161], v[160:161], v[190:191]
v_add_f32 v160, v160, v161
buffer_store_dword v160, v145, s[8:11], s29 offen sc1
L_k1_nc:
s_cmp_lg_u32 s20, 3
s_cbranch_scc1 L_k1_nj
s_waitcnt vmcnt(0)
s_lshl_b32 s26, s2, 7
s_add_u32 s26, s26, 0x1dc0000
s_mov_b64 exec, 1
buffer_store_dword v125, off, s[8:11], s26 sc1
s_mov_b64 exec, -1
L_k1_nj:
s_cmp_lg_u32 s20, 0
s_cbranch_scc1 L_k1_go
s_mov_b32 s56, 0x100000
L_k1_poll:
buffer_load_dword v124, v126, s[8:11], s98 offen sc1
s_waitcnt vmcnt(0)
v_cmp_ne_u32 s[46:47], s58, v124
s_nop 4
s_cmp_eq_u64 s[46:47], 0
s_cbranch_scc1 L_k1_go
s_sleep 1
s_sub_u32 s56, s56, 1
s_cbranch_scc0 L_k1_poll
L_k1_go:
s_barrier
s_mov_b32 s100, s39
buffer_load_dwordx4 a[0:3], v100, s[8:11], s23 offen offset:0 sc1
buffer_load_dwordx4 a[4:7], v101, s[8:11], s23 offen offset:0 sc1
buffer_load_dwordx4 a[8:11], v100, s[8:11], s23 offen offset:1024 sc1
buffer_load_dwordx4 a[12:15], v101, s[8:11], s23 offen offset:1024 sc1
buffer_load_dwordx4 a[16:19], v100, s[8:11], s23 offen offset:2048 sc1
buffer_load_dwordx4 a[20:23], v101, s[8:11], s23 offen offset:2048 sc1
buffer_load_dwordx4 a[24:27], v100, s[8:11], s23 offen offset:3072 sc1
buffer_load_dwordx4 a[28:31], v101, s[8:11], s23 offen offset:3072 sc1
s_waitcnt vmcnt(40)
s_barrier
ds_read_b64_tr_b16 v[188:189], v106 offset:0
ds_read_b64_tr_b16 v[190:191], v106 offset:4096
ds_read_b64_tr_b16 v[192:193], v106 offset:8192
ds_read_b64_tr_b16 v[194:195], v106 offset:12288
ds_read_b64_tr_b16 v[196:197], v107 offset:0
ds_read_b64_tr_b16 v[198:199], v107 offset:4096
ds_read_b64_tr_b16 v[200:201], v107 offset:8192
ds_read_b64_tr_b16 v[202:203], v107 offset:12288
ds_read_b64_tr_b16 v[204:205], v108 offset:0
ds_read_b64_tr_b16 v[206:207], v108 offset:4096
ds_read_b64_tr_b16 v[208:209], v108 offset:8192
ds_read_b64_tr_b16 v[210:211], v108 offset:12288
s_add_u32 s23, s23, 4096
s_waitcnt vmcnt(7) lgkmcnt(10)
v_mfma_f32_16x16x32_bf16 v[16:19], a[0:3], v[188:191], 0
s_waitcnt vmcnt(5) lgkmcnt(8)
buffer_load_dwordx4 a[32:35], v100, s[8:11], s23 offen offset:0 sc1
ds_read_b64_tr_b16 v[212:213], v109 offset:0
v_mfma_f32_16x16x32_bf16 v[16:19], a[8:11], v[192:195], v[16:19]
s_waitcnt vmcnt(5)
buffer_load_dwordx4 a[36:39], v101, s[8:11], s23 offen offset:0 sc1
ds_read_b64_tr_b16 v[214:215], v109 offset:4096
v_mfma_f32_16x16x32_bf16 v[64:67], a[12:15], v[192:195], 0
buffer_load_dwordx4 a[40:43], v100, s[8:11], s23 offen offset:1024 sc1
ds_read_b64_tr_b16 v[216:217], v109 offset:8192
v_mfma_f32_16x16x32_bf16 v[64:67], a[4:7], v[188:191], v[64:67]
s_waitcnt lgkmcnt(9)
buffer_load_dwordx4 a[44:47], v101, s[8:11], s23 offen offset:1024 sc1
ds_read_b64_tr_b16 v[218:219], v109 offset:12288
v_mfma_f32_16x16x32_bf16 v[68:71], a[4:7], v[196:199], 0
s_waitcnt lgkmcnt(8)
ds_read_b64_tr_b16 v[220:221], v106 offset:2048
v_mfma_f32_16x16x32_bf16 v[68:71], a[12:15], v[200:203], v[68:71]
ds_read_b64_tr_b16 v[222:223], v106 offset:6144
v_mfma_f32_16x16x32_bf16 v[20:23], a[8:11], v[200:203], 0
ds_read_b64_tr_b16 v[224:225], v106 offset:10240
v_mfma_f32_16x16x32_bf16 v[20:23], a[0:3], v[196:199], v[20:23]
s_waitcnt lgkmcnt(9)
ds_read_b64_tr_b16 v[226:227], v106 offset:14336
v_mfma_f32_16x16x32_bf16 v[24:27], a[0:3], v[204:207], 0
s_waitcnt lgkmcnt(8)
ds_read_b64_tr_b16 v[228:229], v107 offset:2048
v_mfma_f32_16x16x32_bf16 v[24:27], a[8:11], v[208:211], v[24:27]
ds_read_b64_tr_b16 v[230:231], v107 offset:6144
v_mfma_f32_16x16x32_bf16 v[72:75], a[12:15], v[208:211], 0
ds_read_b64_tr_b16 v[232:233], v107 offset:10240
v_mfma_f32_16x16x32_bf16 v[72:75], a[4:7], v[204:207], v[72:75]
s_waitcnt lgkmcnt(9)
ds_read_b64_tr_b16 v[234:235], v107 offset:14336
v_mfma_f32_16x16x32_bf16 v[76:79], a[4:7], v[212:215], 0
s_waitcnt lgkmcnt(8)
ds_read_b64_tr_b16 v[236:237], v108 offset:2048
v_mfma_f32_16x16x32_bf16 v[76:79], a[12:15], v[216:219], v[76:79]
ds_read_b64_tr_b16 v[238:239], v108 offset:6144
v_mfma_f32_16x16x32_bf16 v[28:31], a[8:11], v[216:219], 0
ds_read_b64_tr_b16 v[240:241], v108 offset:10240
v_mfma_f32_16x16x32_bf16 v[28:31], a[0:3], v[212:215], v[28:31]
s_waitcnt lgkmcnt(9)
ds_read_b64_tr_b16 v[242:243], v108 offset:14336
v_mfma_f32_16x16x32_bf16 v[32:35], a[0:3], v[220:223], 0
s_waitcnt lgkmcnt(8)
ds_read_b64_tr_b16 v[244:245], v109 offset:2048
v_mfma_f32_16x16x32_bf16 v[32:35], a[8:11], v[224:227], v[32:35]
ds_read_b64_tr_b16 v[246:247], v109 offset:6144
v_mfma_f32_16x16x32_bf16 v[80:83], a[12:15], v[224:227], 0
buffer_load_dwordx4 a[48:51], v100, s[8:11], s23 offen offset:2048 sc1
ds_read_b64_tr_b16 v[248:249], v109 offset:10240
v_mfma_f32_16x16x32_bf16 v[80:83], a[4:7], v[220:223], v[80:83]
s_waitcnt lgkmcnt(9)
ds_read_b64_tr_b16 v[250:251], v109 offset:14336
v_mfma_f32_16x16x32_bf16 v[84:87], a[4:7], v[228:231], 0
s_waitcnt lgkmcnt(8)
v_mfma_f32_16x16x32_bf16 v[84:87], a[12:15], v[232:235], v[84:87]
v_mfma_f32_16x16x32_bf16 v[36:39], a[8:11], v[232:235], 0
s_barrier
ds_read_b64_tr_b16 v[188:189], v106 offset:16384
v_mfma_f32_16x16x32_bf16 v[36:39], a[0:3], v[228:231], v[36:39]
s_waitcnt lgkmcnt(7)
buffer_load_dwordx4 a[52:55], v101, s[8:11], s23 offen offset:2048 sc1
ds_read_b64_tr_b16 v[190:191], v106 offset:20480
v_mfma_f32_16x16x32_bf16 v[40:43], a[0:3], v[236:239], 0
s_waitcnt lgkmcnt(6)
ds_read_b64_tr_b16 v[192:193], v106 offset:24576
v_mfma_f32_16x16x32_bf16 v[40:43], a[8:11], v[240:243], v[40:43]
ds_read_b64_tr_b16 v[194:195], v106 offset:28672
v_mfma_f32_16x16x32_bf16 v[88:91], a[12:15], v[240:243], 0
ds_read_b64_tr_b16 v[196:197], v107 offset:16384
v_mfma_f32_16x16x32_bf16 v[88:91], a[4:7], v[236:239], v[88:91]
s_waitcnt lgkmcnt(7)
buffer_load_dwordx4 a[56:59], v100, s[8:11], s23 offen offset:3072 sc1
ds_read_b64_tr_b16 v[198:199], v107 offset:20480
v_mfma_f32_16x16x32_bf16 v[92:95], a[4:7], v[244:247], 0
s_waitcnt lgkmcnt(6)
ds_read_b64_tr_b16 v[200:201], v107 offset:24576
ds_read_b64_tr_b16 v[202:203], v107 offset:28672
v_mfma_f32_16x16x32_bf16 v[92:95], a[12:15], v[248:251], v[92:95]
ds_read_b64_tr_b16 v[204:205], v108 offset:16384
ds_read_b64_tr_b16 v[206:207], v108 offset:20480
v_mfma_f32_16x16x32_bf16 v[44:47], a[8:11], v[248:251], 0
ds_read_b64_tr_b16 v[208:209], v108 offset:24576
ds_read_b64_tr_b16 v[210:211], v108 offset:28672
v_mfma_f32_16x16x32_bf16 v[44:47], a[0:3], v[244:247], v[44:47]
s_waitcnt vmcnt(10) lgkmcnt(10)
ds_read_b64_tr_b16 v[212:213], v109 offset:16384
ds_read_b64_tr_b16 v[214:215], v109 offset:20480
v_mfma_f32_16x16x32_bf16 v[16:19], a[16:19], v[188:191], v[16:19]
s_waitcnt vmcnt(8) lgkmcnt(10)
buffer_load_dwordx4 a[60:63], v101, s[8:11], s23 offen offset:3072 sc1
ds_read_b64_tr_b16 v[216:217], v109 offset:24576
v_mfma_f32_16x16x32_bf16 v[16:19], a[24:27], v[192:195], v[16:19]
s_waitcnt vmcnt(8)
s_add_u32 s23, s23, 4096
ds_read_b64_tr_b16 v[218:219], v109 offset:28672
ds_read_b64_tr_b16 v[220:221], v106 offset:18432
v_mfma_f32_16x16x32_bf16 v[64:67], a[28:31], v[192:195], v[64:67]
ds_read_b64_tr_b16 v[222:223], v106 offset:22528
ds_read_b64_tr_b16 v[224:225], v106 offset:26624
v_mfma_f32_16x16x32_bf16 v[64:67], a[20:23], v[188:191], v[64:67]
s_barrier
s_waitcnt lgkmcnt(13)
ds_read_b64_tr_b16 v[226:227], v106 offset:30720
ds_read_b64_tr_b16 v[228:229], v107 offset:18432
v_mfma_f32_16x16x32_bf16 v[68:71], a[20:23], v[196:199], v[68:71]
s_waitcnt lgkmcnt(13)
buffer_load_dwordx4 a[64:67], v100, s[8:11], s23 offen offset:0 sc1
ds_read_b64_tr_b16 v[230:231], v107 offset:22528
v_mfma_f32_16x16x32_bf16 v[68:71], a[28:31], v[200:203], v[68:71]
ds_read_b64_tr_b16 v[232:233], v107 offset:26624
ds_read_b64_tr_b16 v[234:235], v107 offset:30720
v_mfma_f32_16x16x32_bf16 v[20:23], a[24:27], v[200:203], v[20:23]
ds_read_b64_tr_b16 v[236:237], v108 offset:18432
ds_read_b64_tr_b16 v[238:239], v108 offset:22528
v_mfma_f32_16x16x32_bf16 v[20:23], a[16:19], v[196:199], v[20:23]
s_waitcnt lgkmcnt(15)
ds_read_b64_tr_b16 v[240:241], v108 offset:26624
ds_read_b64_tr_b16 v[242:243], v108 offset:30720
v_mfma_f32_16x16x32_bf16 v[24:27], a[16:19], v[204:207], v[24:27]
s_waitcnt lgkmcnt(15)
ds_read_b64_tr_b16 v[244:245], v109 offset:18432
ds_read_b64_tr_b16 v[246:247], v109 offset:22528
v_mfma_f32_16x16x32_bf16 v[24:27], a[24:27], v[208:211], v[24:27]
buffer_load_dwordx4 a[68:71], v101, s[8:11], s23 offen offset:0 sc1
ds_read_b64_tr_b16 v[248:249], v109 offset:26624
v_mfma_f32_16x16x32_bf16 v[72:75], a[28:31], v[208:211], v[72:75]
ds_read_b64_tr_b16 v[250:251], v109 offset:30720
ds_read_b64_tr_b16 v[188:189], v106 offset:32768
v_mfma_f32_16x16x32_bf16 v[72:75], a[20:23], v[204:207], v[72:75]
s_waitcnt lgkmcnt(15)
ds_read_b64_tr_b16 v[190:191], v106 offset:36864
ds_read_b64_tr_b16 v[192:193], v106 offset:40960
v_mfma_f32_16x16x32_bf16 v[76:79], a[20:23], v[212:215], v[76:79]
ds_read_b64_tr_b16 v[194:195], v106 offset:45056
ds_read_b64_tr_b16 v[196:197], v107 offset:32768
v_mfma_f32_16x16x32_bf16 v[76:79], a[28:31], v[216:219], v[76:79]
buffer_load_dwordx4 a[72:75], v100, s[8:11], s23 offen offset:1024 sc1
ds_read_b64_tr_b16 v[198:199], v107 offset:36864
v_mfma_f32_16x16x32_bf16 v[28:31], a[24:27], v[216:219], v[28:31]
ds_read_b64_tr_b16 v[200:201], v107 offset:40960
ds_read_b64_tr_b16 v[202:203], v107 offset:45056
v_mfma_f32_16x16x32_bf16 v[28:31], a[16:19], v[212:215], v[28:31]
ds_read_b64_tr_b16 v[204:205], v108 offset:32768
v_mfma_f32_16x16x32_bf16 v[32:35], a[16:19], v[220:223], v[32:35]
s_waitcnt lgkmcnt(15)
ds_read_b64_tr_b16 v[206:207], v108 offset:36864
v_mfma_f32_16x16x32_bf16 v[32:35], a[24:27], v[224:227], v[32:35]
ds_read_b64_tr_b16 v[208:209], v108 offset:40960
ds_read_b64_tr_b16 v[210:211], v108 offset:45056
v_mfma_f32_16x16x32_bf16 v[80:83], a[28:31], v[224:227], v[80:83]
buffer_load_dwordx4 a[76:79], v101, s[8:11], s23 offen offset:1024 sc1
ds_read_b64_tr_b16 v[212:213], v109 offset:32768
v_mfma_f32_16x16x32_bf16 v[80:83], a[20:23], v[220:223], v[80:83]
ds_read_b64_tr_b16 v[214:215], v109 offset:36864
v_mfma_f32_16x16x32_bf16 v[84:87], a[20:23], v[228:231], v[84:87]
ds_read_b64_tr_b16 v[216:217], v109 offset:40960
v_mfma_f32_16x16x32_bf16 v[84:87], a[28:31], v[232:235], v[84:87]
ds_read_b64_tr_b16 v[218:219], v109 offset:45056
ds_read_b64_tr_b16 v[220:221], v106 offset:34816
v_mfma_f32_16x16x32_bf16 v[36:39], a[24:27], v[232:235], v[36:39]
buffer_load_dwordx4 a[80:83], v100, s[8:11], s23 offen offset:2048 sc1
ds_read_b64_tr_b16 v[222:223], v106 offset:38912
v_mfma_f32_16x16x32_bf16 v[36:39], a[16:19], v[228:231], v[36:39]
ds_read_b64_tr_b16 v[224:225], v106 offset:43008
v_mfma_f32_16x16x32_bf16 v[40:43], a[16:19], v[236:239], v[40:43]
s_waitcnt lgkmcnt(11)
ds_read_b64_tr_b16 v[226:227], v106 offset:47104
v_mfma_f32_16x16x32_bf16 v[40:43], a[24:27], v[240:243], v[40:43]
ds_read_b64_tr_b16 v[228:229], v107 offset:34816
v_mfma_f32_16x16x32_bf16 v[88:91], a[28:31], v[240:243], v[88:91]
ds_read_b64_tr_b16 v[230:231], v107 offset:38912
v_mfma_f32_16x16x32_bf16 v[88:91], a[20:23], v[236:239], v[88:91]
buffer_load_dwordx4 a[84:87], v101, s[8:11], s23 offen offset:2048 sc1
ds_read_b64_tr_b16 v[232:233], v107 offset:43008
v_mfma_f32_16x16x32_bf16 v[92:95], a[20:23], v[244:247], v[92:95]
ds_read_b64_tr_b16 v[234:235], v107 offset:47104
v_mfma_f32_16x16x32_bf16 v[92:95], a[28:31], v[248:251], v[92:95]
ds_read_b64_tr_b16 v[236:237], v108 offset:34816
v_mfma_f32_16x16x32_bf16 v[44:47], a[24:27], v[248:251], v[44:47]
ds_read_b64_tr_b16 v[238:239], v108 offset:38912
v_mfma_f32_16x16x32_bf16 v[44:47], a[16:19], v[244:247], v[44:47]
s_waitcnt vmcnt(13)
buffer_load_dwordx4 a[88:91], v100, s[8:11], s23 offen offset:3072 sc1
ds_read_b64_tr_b16 v[240:241], v108 offset:43008
v_mfma_f32_16x16x32_bf16 v[16:19], a[32:35], v[188:191], v[16:19]
s_waitcnt vmcnt(12)
ds_read_b64_tr_b16 v[242:243], v108 offset:47104
v_mfma_f32_16x16x32_bf16 v[16:19], a[40:43], v[192:195], v[16:19]
s_waitcnt vmcnt(11)
ds_read_b64_tr_b16 v[244:245], v109 offset:34816
v_mfma_f32_16x16x32_bf16 v[64:67], a[44:47], v[192:195], v[64:67]
ds_read_b64_tr_b16 v[246:247], v109 offset:38912
v_mfma_f32_16x16x32_bf16 v[64:67], a[36:39], v[188:191], v[64:67]
s_barrier
ds_read_b64_tr_b16 v[248:249], v109 offset:43008
v_mfma_f32_16x16x32_bf16 v[68:71], a[36:39], v[196:199], v[68:71]
buffer_load_dwordx4 a[92:95], v101, s[8:11], s23 offen offset:3072 sc1
ds_read_b64_tr_b16 v[250:251], v109 offset:47104
v_mfma_f32_16x16x32_bf16 v[68:71], a[44:47], v[200:203], v[68:71]
s_add_u32 s23, s23, 4096
ds_read_b64_tr_b16 v[188:189], v106 offset:49152
v_mfma_f32_16x16x32_bf16 v[20:23], a[40:43], v[200:203], v[20:23]
ds_read_b64_tr_b16 v[190:191], v106 offset:53248
v_mfma_f32_16x16x32_bf16 v[20:23], a[32:35], v[196:199], v[20:23]
s_waitcnt lgkmcnt(9)
ds_read_b64_tr_b16 v[192:193], v106 offset:57344
v_mfma_f32_16x16x32_bf16 v[24:27], a[32:35], v[204:207], v[24:27]
buffer_load_dwordx4 a[96:99], v100, s[8:11], s23 offen offset:0 sc1
ds_read_b64_tr_b16 v[194:195], v106 offset:61440
v_mfma_f32_16x16x32_bf16 v[24:27], a[40:43], v[208:211], v[24:27]
ds_read_b64_tr_b16 v[196:197], v107 offset:49152
v_mfma_f32_16x16x32_bf16 v[72:75], a[44:47], v[208:211], v[72:75]
ds_read_b64_tr_b16 v[198:199], v107 offset:53248
v_mfma_f32_16x16x32_bf16 v[72:75], a[36:39], v[204:207], v[72:75]
ds_read_b64_tr_b16 v[200:201], v107 offset:57344
v_mfma_f32_16x16x32_bf16 v[76:79], a[36:39], v[212:215], v[76:79]
ds_read_b64_tr_b16 v[202:203], v107 offset:61440
v_mfma_f32_16x16x32_bf16 v[76:79], a[44:47], v[216:219], v[76:79]
buffer_load_dwordx4 a[100:103], v101, s[8:11], s23 offen offset:0 sc1
ds_read_b64_tr_b16 v[204:205], v108 offset:49152
v_mfma_f32_16x16x32_bf16 v[28:31], a[40:43], v[216:219], v[28:31]
ds_read_b64_tr_b16 v[206:207], v108 offset:53248
v_mfma_f32_16x16x32_bf16 v[28:31], a[32:35], v[212:215], v[28:31]
ds_read_b64_tr_b16 v[208:209], v108 offset:57344
v_mfma_f32_16x16x32_bf16 v[32:35], a[32:35], v[220:223], v[32:35]
ds_read_b64_tr_b16 v[210:211], v108 offset:61440
v_mfma_f32_16x16x32_bf16 v[32:35], a[40:43], v[224:227], v[32:35]
buffer_load_dwordx4 a[104:107], v100, s[8:11], s23 offen offset:1024 sc1
ds_read_b64_tr_b16 v[212:213], v109 offset:49152
v_mfma_f32_16x16x32_bf16 v[80:83], a[44:47], v[224:227], v[80:83]
ds_read_b64_tr_b16 v[214:215], v109 offset:53248
v_mfma_f32_16x16x32_bf16 v[80:83], a[36:39], v[220:223], v[80:83]
ds_read_b64_tr_b16 v[216:217], v109 offset:57344
v_mfma_f32_16x16x32_bf16 v[84:87], a[36:39], v[228:231], v[84:87]
ds_read_b64_tr_b16 v[218:219], v109 offset:61440
v_mfma_f32_16x16x32_bf16 v[84:87], a[44:47], v[232:235], v[84:87]
ds_read_b64_tr_b16 v[220:221], v106 offset:51200
v_mfma_f32_16x16x32_bf16 v[36:39], a[40:43], v[232:235], v[36:39]
buffer_load_dwordx4 a[108:111], v101, s[8:11], s23 offen offset:1024 sc1
ds_read_b64_tr_b16 v[222:223], v106 offset:55296
v_mfma_f32_16x16x32_bf16 v[36:39], a[32:35], v[228:231], v[36:39]
s_waitcnt lgkmcnt(9)
ds_read_b64_tr_b16 v[224:225], v106 offset:59392
v_mfma_f32_16x16x32_bf16 v[40:43], a[32:35], v[236:239], v[40:43]
ds_read_b64_tr_b16 v[226:227], v106 offset:63488
v_mfma_f32_16x16x32_bf16 v[40:43], a[40:43], v[240:243], v[40:43]
ds_read_b64_tr_b16 v[228:229], v107 offset:51200
v_mfma_f32_16x16x32_bf16 v[88:91], a[44:47], v[240:243], v[88:91]
buffer_load_dwordx4 a[112:115], v100, s[8:11], s23 offen offset:2048 sc1
ds_read_b64_tr_b16 v[230:231], v107 offset:55296
v_mfma_f32_16x16x32_bf16 v[88:91], a[36:39], v[236:239], v[88:91]
ds_read_b64_tr_b16 v[232:233], v107 offset:59392
v_mfma_f32_16x16x32_bf16 v[92:95], a[36:39], v[244:247], v[92:95]
ds_read_b64_tr_b16 v[234:235], v107 offset:63488
v_mfma_f32_16x16x32_bf16 v[92:95], a[44:47], v[248:251], v[92:95]
ds_read_b64_tr_b16 v[236:237], v108 offset:51200
v_mfma_f32_16x16x32_bf16 v[44:47], a[40:43], v[248:251], v[44:47]
ds_read_b64_tr_b16 v[238:239], v108 offset:55296
v_mfma_f32_16x16x32_bf16 v[44:47], a[32:35], v[244:247], v[44:47]
s_waitcnt vmcnt(16)
buffer_load_dwordx4 a[116:119], v101, s[8:11], s23 offen offset:2048 sc1
ds_read_b64_tr_b16 v[240:241], v108 offset:59392
v_mfma_f32_16x16x32_bf16 v[16:19], a[48:51], v[188:191], v[16:19]
s_waitcnt vmcnt(15)
ds_read_b64_tr_b16 v[242:243], v108 offset:63488
v_mfma_f32_16x16x32_bf16 v[16:19], a[56:59], v[192:195], v[16:19]
s_waitcnt vmcnt(14)
ds_read_b64_tr_b16 v[244:245], v109 offset:51200
v_mfma_f32_16x16x32_bf16 v[64:67], a[60:63], v[192:195], v[64:67]
ds_read_b64_tr_b16 v[246:247], v109 offset:55296
v_mfma_f32_16x16x32_bf16 v[64:67], a[52:55], v[188:191], v[64:67]
s_barrier
buffer_load_dwordx4 a[120:123], v100, s[8:11], s23 offen offset:3072 sc1
ds_read_b64_tr_b16 v[248:249], v109 offset:59392
v_mfma_f32_16x16x32_bf16 v[68:71], a[52:55], v[196:199], v[68:71]
ds_read_b64_tr_b16 v[250:251], v109 offset:63488
v_mfma_f32_16x16x32_bf16 v[68:71], a[60:63], v[200:203], v[68:71]
ds_read_b64_tr_b16 v[188:189], v110 offset:0
v_mfma_f32_16x16x32_bf16 v[20:23], a[56:59], v[200:203], v[20:23]
ds_read_b64_tr_b16 v[190:191], v110 offset:4096
v_mfma_f32_16x16x32_bf16 v[20:23], a[48:51], v[196:199], v[20:23]
s_waitcnt lgkmcnt(9)
ds_read_b64_tr_b16 v[192:193], v110 offset:8192
v_mfma_f32_16x16x32_bf16 v[24:27], a[48:51], v[204:207], v[24:27]
buffer_load_dwordx4 a[124:127], v101, s[8:11], s23 offen offset:3072 sc1
ds_read_b64_tr_b16 v[194:195], v110 offset:12288
v_mfma_f32_16x16x32_bf16 v[24:27], a[56:59], v[208:211], v[24:27]
s_add_u32 s23, s23, 4096
ds_read_b64_tr_b16 v[196:197], v111 offset:0
v_mfma_f32_16x16x32_bf16 v[72:75], a[60:63], v[208:211], v[72:75]
ds_read_b64_tr_b16 v[198:199], v111 offset:4096
v_mfma_f32_16x16x32_bf16 v[72:75], a[52:55], v[204:207], v[72:75]
ds_read_b64_tr_b16 v[200:201], v111 offset:8192
v_mfma_f32_16x16x32_bf16 v[76:79], a[52:55], v[212:215], v[76:79]
buffer_load_dwordx4 a[128:131], v100, s[8:11], s23 offen offset:0 sc1
ds_read_b64_tr_b16 v[202:203], v111 offset:12288
v_mfma_f32_16x16x32_bf16 v[76:79], a[60:63], v[216:219], v[76:79]
ds_read_b64_tr_b16 v[204:205], v112 offset:0
v_mfma_f32_16x16x32_bf16 v[28:31], a[56:59], v[216:219], v[28:31]
ds_read_b64_tr_b16 v[206:207], v112 offset:4096
v_mfma_f32_16x16x32_bf16 v[28:31], a[48:51], v[212:215], v[28:31]
ds_read_b64_tr_b16 v[208:209], v112 offset:8192
v_mfma_f32_16x16x32_bf16 v[32:35], a[48:51], v[220:223], v[32:35]
ds_read_b64_tr_b16 v[210:211], v112 offset:12288
v_mfma_f32_16x16x32_bf16 v[32:35], a[56:59], v[224:227], v[32:35]
buffer_load_dwordx4 a[132:135], v101, s[8:11], s23 offen offset:0 sc1
ds_read_b64_tr_b16 v[212:213], v113 offset:0
v_mfma_f32_16x16x32_bf16 v[80:83], a[60:63], v[224:227], v[80:83]
ds_read_b64_tr_b16 v[214:215], v113 offset:4096
v_mfma_f32_16x16x32_bf16 v[80:83], a[52:55], v[220:223], v[80:83]
ds_read_b64_tr_b16 v[216:217], v113 offset:8192
v_mfma_f32_16x16x32_bf16 v[84:87], a[52:55], v[228:231], v[84:87]
ds_read_b64_tr_b16 v[218:219], v113 offset:12288
v_mfma_f32_16x16x32_bf16 v[84:87], a[60:63], v[232:235], v[84:87]
buffer_load_dwordx4 a[136:139], v100, s[8:11], s23 offen offset:1024 sc1
ds_read_b64_tr_b16 v[220:221], v110 offset:2048
v_mfma_f32_16x16x32_bf16 v[36:39], a[56:59], v[232:235], v[36:39]
ds_read_b64_tr_b16 v[222:223], v110 offset:6144
v_mfma_f32_16x16x32_bf16 v[36:39], a[48:51], v[228:231], v[36:39]
s_waitcnt lgkmcnt(9)
ds_read_b64_tr_b16 v[224:225], v110 offset:10240
v_mfma_f32_16x16x32_bf16 v[40:43], a[48:51], v[236:239], v[40:43]
ds_read_b64_tr_b16 v[226:227], v110 offset:14336
v_mfma_f32_16x16x32_bf16 v[40:43], a[56:59], v[240:243], v[40:43]
ds_read_b64_tr_b16 v[228:229], v111 offset:2048
v_mfma_f32_16x16x32_bf16 v[88:91], a[60:63], v[240:243], v[88:91]
buffer_load_dwordx4 v[124:127], v116, s[8:11], s92 offen offset:0 sc1
ds_read_b64_tr_b16 v[230:231], v111 offset:6144
v_mfma_f32_16x16x32_bf16 v[88:91], a[52:55], v[236:239], v[88:91]
ds_read_b64_tr_b16 v[232:233], v111 offset:10240
v_mfma_f32_16x16x32_bf16 v[92:95], a[52:55], v[244:247], v[92:95]
ds_read_b64_tr_b16 v[234:235], v111 offset:14336
v_mfma_f32_16x16x32_bf16 v[92:95], a[60:63], v[248:251], v[92:95]
ds_read_b64_tr_b16 v[236:237], v112 offset:2048
v_mfma_f32_16x16x32_bf16 v[44:47], a[56:59], v[248:251], v[44:47]
buffer_load_dwordx4 v[128:131], v116, s[8:11], s92 offen offset:16 sc1
ds_read_b64_tr_b16 v[238:239], v112 offset:6144
v_mfma_f32_16x16x32_bf16 v[44:47], a[48:51], v[244:247], v[44:47]
s_waitcnt vmcnt(20)
ds_read_b64_tr_b16 v[240:241], v112 offset:10240
v_mfma_f32_16x16x32_bf16 v[16:19], a[64:67], v[188:191], v[16:19]
s_waitcnt vmcnt(18)
ds_read_b64_tr_b16 v[242:243], v112 offset:14336
v_mfma_f32_16x16x32_bf16 v[16:19], a[72:75], v[192:195], v[16:19]
s_waitcnt vmcnt(17)
ds_read_b64_tr_b16 v[244:245], v113 offset:2048
v_mfma_f32_16x16x32_bf16 v[64:67], a[76:79], v[192:195], v[64:67]
ds_read_b64_tr_b16 v[246:247], v113 offset:6144
v_mfma_f32_16x16x32_bf16 v[64:67], a[68:71], v[188:191], v[64:67]
s_barrier
buffer_load_dwordx4 v[132:135], v116, s[8:11], s92 offen offset:2048 sc1
ds_read_b64_tr_b16 v[248:249], v113 offset:10240
v_mfma_f32_16x16x32_bf16 v[68:71], a[68:71], v[196:199], v[68:71]
ds_read_b64_tr_b16 v[250:251], v113 offset:14336
v_mfma_f32_16x16x32_bf16 v[68:71], a[76:79], v[200:203], v[68:71]
ds_read_b64_tr_b16 v[188:189], v110 offset:16384
v_mfma_f32_16x16x32_bf16 v[20:23], a[72:75], v[200:203], v[20:23]
ds_read_b64_tr_b16 v[190:191], v110 offset:20480
v_mfma_f32_16x16x32_bf16 v[20:23], a[64:67], v[196:199], v[20:23]
s_waitcnt lgkmcnt(9)
buffer_load_dwordx4 v[136:139], v116, s[8:11], s92 offen offset:2064 sc1
ds_read_b64_tr_b16 v[192:193], v110 offset:24576
v_mfma_f32_16x16x32_bf16 v[24:27], a[64:67], v[204:207], v[24:27]
ds_read_b64_tr_b16 v[194:195], v110 offset:28672
v_mfma_f32_16x16x32_bf16 v[24:27], a[72:75], v[208:211], v[24:27]
ds_read_b64_tr_b16 v[196:197], v111 offset:16384
v_mfma_f32_16x16x32_bf16 v[72:75], a[76:79], v[208:211], v[72:75]
ds_read_b64_tr_b16 v[198:199], v111 offset:20480
v_mfma_f32_16x16x32_bf16 v[72:75], a[68:71], v[204:207], v[72:75]
ds_read_b64_tr_b16 v[200:201], v111 offset:24576
v_mfma_f32_16x16x32_bf16 v[76:79], a[68:71], v[212:215], v[76:79]
buffer_load_dwordx4 a[140:143], v101, s[8:11], s23 offen offset:1024 sc1
ds_read_b64_tr_b16 v[202:203], v111 offset:28672
v_mfma_f32_16x16x32_bf16 v[76:79], a[76:79], v[216:219], v[76:79]
ds_read_b64_tr_b16 v[204:205], v112 offset:16384
v_mfma_f32_16x16x32_bf16 v[28:31], a[72:75], v[216:219], v[28:31]
ds_read_b64_tr_b16 v[206:207], v112 offset:20480
v_mfma_f32_16x16x32_bf16 v[28:31], a[64:67], v[212:215], v[28:31]
ds_read_b64_tr_b16 v[208:209], v112 offset:24576
v_mfma_f32_16x16x32_bf16 v[32:35], a[64:67], v[220:223], v[32:35]
buffer_load_dwordx4 a[144:147], v100, s[8:11], s23 offen offset:2048 sc1
ds_read_b64_tr_b16 v[210:211], v112 offset:28672
v_mfma_f32_16x16x32_bf16 v[32:35], a[72:75], v[224:227], v[32:35]
ds_read_b64_tr_b16 v[212:213], v113 offset:16384
v_mfma_f32_16x16x32_bf16 v[80:83], a[76:79], v[224:227], v[80:83]
ds_read_b64_tr_b16 v[214:215], v113 offset:20480
v_mfma_f32_16x16x32_bf16 v[80:83], a[68:71], v[220:223], v[80:83]
ds_read_b64_tr_b16 v[216:217], v113 offset:24576
v_mfma_f32_16x16x32_bf16 v[84:87], a[68:71], v[228:231], v[84:87]
ds_read_b64_tr_b16 v[218:219], v113 offset:28672
v_mfma_f32_16x16x32_bf16 v[84:87], a[76:79], v[232:235], v[84:87]
buffer_load_dwordx4 a[148:151], v101, s[8:11], s23 offen offset:2048 sc1
ds_read_b64_tr_b16 v[220:221], v110 offset:18432
v_mfma_f32_16x16x32_bf16 v[36:39], a[72:75], v[232:235], v[36:39]
ds_read_b64_tr_b16 v[222:223], v110 offset:22528
v_mfma_f32_16x16x32_bf16 v[36:39], a[64:67], v[228:231], v[36:39]
s_waitcnt lgkmcnt(9)
ds_read_b64_tr_b16 v[224:225], v110 offset:26624
v_mfma_f32_16x16x32_bf16 v[40:43], a[64:67], v[236:239], v[40:43]
ds_read_b64_tr_b16 v[226:227], v110 offset:30720
v_mfma_f32_16x16x32_bf16 v[40:43], a[72:75], v[240:243], v[40:43]
buffer_load_dwordx4 a[152:155], v100, s[8:11], s23 offen offset:3072 sc1
ds_read_b64_tr_b16 v[228:229], v111 offset:18432
v_mfma_f32_16x16x32_bf16 v[88:91], a[76:79], v[240:243], v[88:91]
ds_read_b64_tr_b16 v[230:231], v111 offset:22528
v_mfma_f32_16x16x32_bf16 v[88:91], a[68:71], v[236:239], v[88:91]
ds_read_b64_tr_b16 v[232:233], v111 offset:26624
v_mfma_f32_16x16x32_bf16 v[92:95], a[68:71], v[244:247], v[92:95]
ds_read_b64_tr_b16 v[234:235], v111 offset:30720
v_mfma_f32_16x16x32_bf16 v[92:95], a[76:79], v[248:251], v[92:95]
ds_read_b64_tr_b16 v[236:237], v112 offset:18432
v_mfma_f32_16x16x32_bf16 v[44:47], a[72:75], v[248:251], v[44:47]
buffer_load_dwordx4 a[156:159], v101, s[8:11], s23 offen offset:3072 sc1
ds_read_b64_tr_b16 v[238:239], v112 offset:22528
v_mfma_f32_16x16x32_bf16 v[44:47], a[64:67], v[244:247], v[44:47]
s_waitcnt vmcnt(23)
s_add_u32 s23, s23, 4096
ds_read_b64_tr_b16 v[240:241], v112 offset:26624
v_mfma_f32_16x16x32_bf16 v[16:19], a[80:83], v[188:191], v[16:19]
s_waitcnt vmcnt(21)
ds_read_b64_tr_b16 v[242:243], v112 offset:30720
v_mfma_f32_16x16x32_bf16 v[16:19], a[88:91], v[192:195], v[16:19]
s_waitcnt vmcnt(20)
ds_read_b64_tr_b16 v[244:245], v113 offset:18432
v_mfma_f32_16x16x32_bf16 v[64:67], a[92:95], v[192:195], v[64:67]
buffer_load_dwordx4 v98, s[12:15], s32 offen offset:0 lds
ds_read_b64_tr_b16 v[246:247], v113 offset:22528
v_mfma_f32_16x16x32_bf16 v[64:67], a[84:87], v[188:191], v[64:67]
s_barrier
ds_read_b64_tr_b16 v[248:249], v113 offset:26624
v_mfma_f32_16x16x32_bf16 v[68:71], a[84:87], v[196:199], v[68:71]
ds_read_b64_tr_b16 v[250:251], v113 offset:30720
v_mfma_f32_16x16x32_bf16 v[68:71], a[92:95], v[200:203], v[68:71]
ds_read_b64_tr_b16 v[188:189], v110 offset:32768
v_mfma_f32_16x16x32_bf16 v[20:23], a[88:91], v[200:203], v[20:23]
ds_read_b64_tr_b16 v[190:191], v110 offset:36864
v_mfma_f32_16x16x32_bf16 v[20:23], a[80:83], v[196:199], v[20:23]
s_waitcnt lgkmcnt(9)
buffer_load_dwordx4 v98, s[12:15], s33 offen offset:1024 lds
ds_read_b64_tr_b16 v[192:193], v110 offset:40960
v_mfma_f32_16x16x32_bf16 v[24:27], a[80:83], v[204:207], v[24:27]
ds_read_b64_tr_b16 v[194:195], v110 offset:45056
v_mfma_f32_16x16x32_bf16 v[24:27], a[88:91], v[208:211], v[24:27]
ds_read_b64_tr_b16 v[196:197], v111 offset:32768
v_mfma_f32_16x16x32_bf16 v[72:75], a[92:95], v[208:211], v[72:75]
ds_read_b64_tr_b16 v[198:199], v111 offset:36864
v_mfma_f32_16x16x32_bf16 v[72:75], a[84:87], v[204:207], v[72:75]
buffer_load_dwordx4 v98, s[12:15], s34 offen offset:2048 lds
ds_read_b64_tr_b16 v[200:201], v111 offset:40960
v_mfma_f32_16x16x32_bf16 v[76:79], a[84:87], v[212:215], v[76:79]
ds_read_b64_tr_b16 v[202:203], v111 offset:45056
v_mfma_f32_16x16x32_bf16 v[76:79], a[92:95], v[216:219], v[76:79]
ds_read_b64_tr_b16 v[204:205], v112 offset:32768
v_mfma_f32_16x16x32_bf16 v[28:31], a[88:91], v[216:219], v[28:31]
ds_read_b64_tr_b16 v[206:207], v112 offset:36864
v_mfma_f32_16x16x32_bf16 v[28:31], a[80:83], v[212:215], v[28:31]
ds_read_b64_tr_b16 v[208:209], v112 offset:40960
v_mfma_f32_16x16x32_bf16 v[32:35], a[80:83], v[220:223], v[32:35]
buffer_load_dword v114, v115, s[8:11], s38 offen sc1
ds_read_b64_tr_b16 v[210:211], v112 offset:45056
v_mfma_f32_16x16x32_bf16 v[32:35], a[88:91], v[224:227], v[32:35]
ds_read_b64_tr_b16 v[212:213], v113 offset:32768
v_mfma_f32_16x16x32_bf16 v[80:83], a[92:95], v[224:227], v[80:83]
ds_read_b64_tr_b16 v[214:215], v113 offset:36864
v_mfma_f32_16x16x32_bf16 v[80:83], a[84:87], v[220:223], v[80:83]
ds_read_b64_tr_b16 v[216:217], v113 offset:40960
v_mfma_f32_16x16x32_bf16 v[84:87], a[84:87], v[228:231], v[84:87]
buffer_load_dwordx4 v98, s[12:15], s35 offen offset:3072 lds
ds_read_b64_tr_b16 v[218:219], v113 offset:45056
v_add_u32 v98, 0x60000, v98
v_mfma_f32_16x16x32_bf16 v[84:87], a[92:95], v[232:235], v[84:87]
s_add_u32 m0, s24, 0x4000
ds_read_b64_tr_b16 v[220:221], v110 offset:34816
v_mfma_f32_16x16x32_bf16 v[36:39], a[88:91], v[232:235], v[36:39]
ds_read_b64_tr_b16 v[222:223], v110 offset:38912
v_mfma_f32_16x16x32_bf16 v[36:39], a[80:83], v[228:231], v[36:39]
s_waitcnt lgkmcnt(9)
ds_read_b64_tr_b16 v[224:225], v110 offset:43008
v_mfma_f32_16x16x32_bf16 v[40:43], a[80:83], v[236:239], v[40:43]
ds_read_b64_tr_b16 v[226:227], v110 offset:47104
v_mfma_f32_16x16x32_bf16 v[40:43], a[88:91], v[240:243], v[40:43]
buffer_load_dwordx4 a[160:163], v100, s[8:11], s23 offen offset:0 sc1
ds_read_b64_tr_b16 v[228:229], v111 offset:34816
v_mfma_f32_16x16x32_bf16 v[88:91], a[92:95], v[240:243], v[88:91]
ds_read_b64_tr_b16 v[230:231], v111 offset:38912
v_mfma_f32_16x16x32_bf16 v[88:91], a[84:87], v[236:239], v[88:91]
ds_read_b64_tr_b16 v[232:233], v111 offset:43008
v_mfma_f32_16x16x32_bf16 v[92:95], a[84:87], v[244:247], v[92:95]
ds_read_b64_tr_b16 v[234:235], v111 offset:47104
v_mfma_f32_16x16x32_bf16 v[92:95], a[92:95], v[248:251], v[92:95]
buffer_load_dwordx4 a[164:167], v101, s[8:11], s23 offen offset:0 sc1
ds_read_b64_tr_b16 v[236:237], v112 offset:34816
v_mfma_f32_16x16x32_bf16 v[44:47], a[88:91], v[248:251], v[44:47]
ds_read_b64_tr_b16 v[238:239], v112 offset:38912
v_mfma_f32_16x16x32_bf16 v[44:47], a[80:83], v[244:247], v[44:47]
s_waitcnt vmcnt(26)
ds_read_b64_tr_b16 v[240:241], v112 offset:43008
v_mfma_f32_16x16x32_bf16 v[16:19], a[96:99], v[188:191], v[16:19]
s_waitcnt vmcnt(24)
ds_read_b64_tr_b16 v[242:243], v112 offset:47104
v_mfma_f32_16x16x32_bf16 v[16:19], a[104:107], v[192:195], v[16:19]
s_waitcnt vmcnt(23)
ds_read_b64_tr_b16 v[244:245], v113 offset:34816
v_mfma_f32_16x16x32_bf16 v[64:67], a[108:111], v[192:195], v[64:67]
buffer_load_dwordx4 a[168:171], v100, s[8:11], s23 offen offset:1024 sc1
ds_read_b64_tr_b16 v[246:247], v113 offset:38912
v_mfma_f32_16x16x32_bf16 v[64:67], a[100:103], v[188:191], v[64:67]
s_barrier
ds_read_b64_tr_b16 v[248:249], v113 offset:43008
v_mfma_f32_16x16x32_bf16 v[68:71], a[100:103], v[196:199], v[68:71]
ds_read_b64_tr_b16 v[250:251], v113 offset:47104
v_mfma_f32_16x16x32_bf16 v[68:71], a[108:111], v[200:203], v[68:71]
ds_read_b64_tr_b16 v[188:189], v110 offset:49152
v_mfma_f32_16x16x32_bf16 v[20:23], a[104:107], v[200:203], v[20:23]
buffer_load_dwordx4 a[172:175], v101, s[8:11], s23 offen offset:1024 sc1
ds_read_b64_tr_b16 v[190:191], v110 offset:53248
v_mfma_f32_16x16x32_bf16 v[20:23], a[96:99], v[196:199], v[20:23]
s_waitcnt lgkmcnt(9)
ds_read_b64_tr_b16 v[192:193], v110 offset:57344
v_mfma_f32_16x16x32_bf16 v[24:27], a[96:99], v[204:207], v[24:27]
ds_read_b64_tr_b16 v[194:195], v110 offset:61440
v_mfma_f32_16x16x32_bf16 v[24:27], a[104:107], v[208:211], v[24:27]
ds_read_b64_tr_b16 v[196:197], v111 offset:49152
v_mfma_f32_16x16x32_bf16 v[72:75], a[108:111], v[208:211], v[72:75]
ds_read_b64_tr_b16 v[198:199], v111 offset:53248
v_mfma_f32_16x16x32_bf16 v[72:75], a[100:103], v[204:207], v[72:75]
buffer_load_dwordx4 v98, s[12:15], s32 offen offset:0 lds
ds_read_b64_tr_b16 v[200:201], v111 offset:57344
v_mfma_f32_16x16x32_bf16 v[76:79], a[100:103], v[212:215], v[76:79]
ds_read_b64_tr_b16 v[202:203], v111 offset:61440
v_mfma_f32_16x16x32_bf16 v[76:79], a[108:111], v[216:219], v[76:79]
ds_read_b64_tr_b16 v[204:205], v112 offset:49152
v_mfma_f32_16x16x32_bf16 v[28:31], a[104:107], v[216:219], v[28:31]
ds_read_b64_tr_b16 v[206:207], v112 offset:53248
v_mfma_f32_16x16x32_bf16 v[28:31], a[96:99], v[212:215], v[28:31]
buffer_load_dwordx4 v98, s[12:15], s33 offen offset:1024 lds
ds_read_b64_tr_b16 v[208:209], v112 offset:57344
v_mfma_f32_16x16x32_bf16 v[32:35], a[96:99], v[220:223], v[32:35]
ds_read_b64_tr_b16 v[210:211], v112 offset:61440
v_mfma_f32_16x16x32_bf16 v[32:35], a[104:107], v[224:227], v[32:35]
ds_read_b64_tr_b16 v[212:213], v113 offset:49152
v_mfma_f32_16x16x32_bf16 v[80:83], a[108:111], v[224:227], v[80:83]
ds_read_b64_tr_b16 v[214:215], v113 offset:53248
s_waitcnt vmcnt(16)
v_mfma_f32_16x16x32_bf16 v[80:83], a[100:103], v[220:223], v[80:83]
ds_read_b64_tr_b16 v[216:217], v113 offset:57344
v_add_f32 v102, v124, v126
v_mfma_f32_16x16x32_bf16 v[84:87], a[100:103], v[228:231], v[84:87]
buffer_load_dwordx4 v98, s[12:15], s34 offen offset:2048 lds
ds_read_b64_tr_b16 v[218:219], v113 offset:61440
v_mfma_f32_16x16x32_bf16 v[84:87], a[108:111], v[232:235], v[84:87]
ds_read_b64_tr_b16 v[220:221], v110 offset:51200
v_add_f32 v104, v132, v134
v_mfma_f32_16x16x32_bf16 v[36:39], a[104:107], v[232:235], v[36:39]
ds_read_b64_tr_b16 v[222:223], v110 offset:55296
v_add_f32 v120, v128, v130
v_mfma_f32_16x16x32_bf16 v[36:39], a[96:99], v[228:231], v[36:39]
s_waitcnt lgkmcnt(9)
ds_read_b64_tr_b16 v[224:225], v110 offset:59392
v_add_f32 v122, v136, v138
v_mfma_f32_16x16x32_bf16 v[40:43], a[96:99], v[236:239], v[40:43]
buffer_load_dwordx4 v98, s[12:15], s35 offen offset:3072 lds
ds_read_b64_tr_b16 v[226:227], v110 offset:63488
v_add_u32 v98, 0x60000, v98
v_mfma_f32_16x16x32_bf16 v[40:43], a[104:107], v[240:243], v[40:43]
s_add_u32 m0, s24, 0x8000
ds_read_b64_tr_b16 v[228:229], v111 offset:51200
v_add_f32 v102, v102, v120
v_mfma_f32_16x16x32_bf16 v[88:91], a[108:111], v[240:243], v[88:91]
ds_read_b64_tr_b16 v[230:231], v111 offset:55296
v_add_f32 v104, v104, v122
v_mfma_f32_16x16x32_bf16 v[88:91], a[100:103], v[236:239], v[88:91]
ds_read_b64_tr_b16 v[232:233], v111 offset:59392
v_mov_b32 v120, v102
v_mfma_f32_16x16x32_bf16 v[92:95], a[100:103], v[244:247], v[92:95]
ds_read_b64_tr_b16 v[234:235], v111 offset:63488
v_mov_b32 v122, v104
v_mfma_f32_16x16x32_bf16 v[92:95], a[108:111], v[248:251], v[92:95]
buffer_load_dwordx4 a[176:179], v100, s[8:11], s23 offen offset:2048 sc1
ds_read_b64_tr_b16 v[236:237], v112 offset:51200
v_mfma_f32_16x16x32_bf16 v[44:47], a[104:107], v[248:251], v[44:47]
ds_read_b64_tr_b16 v[238:239], v112 offset:55296
v_permlane16_swap_b32 v102, v120
v_mfma_f32_16x16x32_bf16 v[44:47], a[96:99], v[244:247], v[44:47]
ds_read_b64_tr_b16 v[240:241], v112 offset:59392
v_permlane16_swap_b32 v104, v122
v_mfma_f32_16x16x32_bf16 v[16:19], a[112:115], v[188:191], v[16:19]
ds_read_b64_tr_b16 v[242:243], v112 offset:63488
v_add_f32 v102, v102, v120
v_mfma_f32_16x16x32_bf16 v[16:19], a[120:123], v[192:195], v[16:19]
buffer_load_dwordx4 a[180:183], v101, s[8:11], s23 offen offset:2048 sc1
ds_read_b64_tr_b16 v[244:245], v113 offset:51200
v_mfma_f32_16x16x32_bf16 v[64:67], a[124:127], v[192:195], v[64:67]
s_waitcnt vmcnt(11)
v_cmp_ne_u32 s[46:47], s58, v114
s_nop 4
s_cmp_eq_u64 s[46:47], 0
s_cbranch_scc1 L_k1cs_go
s_cmp_lg_u32 s30, 0
s_cbranch_scc1 L_k1cs_go
s_mov_b32 s56, 0x100000
L_k1cs_poll:
buffer_load_dword v114, v115, s[8:11], s38 offen sc1
s_waitcnt vmcnt(0)
v_cmp_ne_u32 s[46:47], s58, v114
s_nop 4
s_cmp_eq_u64 s[46:47], 0
s_cbranch_scc1 L_k1cs_go
s_sleep 1
s_sub_u32 s56, s56, 1
s_cbranch_scc0 L_k1cs_poll
L_k1cs_go:
ds_read_b64_tr_b16 v[246:247], v113 offset:55296
v_mfma_f32_16x16x32_bf16 v[64:67], a[116:119], v[188:191], v[64:67]
s_barrier
ds_read_b64_tr_b16 v[248:249], v113 offset:59392
v_add_f32 v104, v104, v122
v_mfma_f32_16x16x32_bf16 v[68:71], a[116:119], v[196:199], v[68:71]
ds_read_b64_tr_b16 v[250:251], v113 offset:63488
v_mov_b32 v120, v102
v_mfma_f32_16x16x32_bf16 v[68:71], a[124:127], v[200:203], v[68:71]
ds_read_b64_tr_b16 v[188:189], v252 offset:0
v_mov_b32 v122, v104
v_mfma_f32_16x16x32_bf16 v[20:23], a[120:123], v[200:203], v[20:23]
buffer_load_dword v140, v119, s[8:11], s93 offen sc1
ds_read_b64_tr_b16 v[190:191], v252 offset:4096
v_mfma_f32_16x16x32_bf16 v[20:23], a[112:115], v[196:199], v[20:23]
s_waitcnt lgkmcnt(9)
ds_read_b64_tr_b16 v[192:193], v252 offset:8192
v_permlane32_swap_b32 v102, v120
v_mfma_f32_16x16x32_bf16 v[24:27], a[112:115], v[204:207], v[24:27]
ds_read_b64_tr_b16 v[194:195], v252 offset:12288
v_permlane32_swap_b32 v104, v122
v_mfma_f32_16x16x32_bf16 v[24:27], a[120:123], v[208:211], v[24:27]
ds_read_b64_tr_b16 v[196:197], v253 offset:0
v_add_f32 v102, v102, v120
v_mfma_f32_16x16x32_bf16 v[72:75], a[124:127], v[208:211], v[72:75]
buffer_load_dword v141, v119, s[8:11], s94 offen sc1
ds_read_b64_tr_b16 v[198:199], v253 offset:4096
v_mfma_f32_16x16x32_bf16 v[72:75], a[116:119], v[204:207], v[72:75]
ds_read_b64_tr_b16 v[200:201], v253 offset:8192
v_add_f32 v104, v104, v122
v_mfma_f32_16x16x32_bf16 v[76:79], a[116:119], v[212:215], v[76:79]
ds_read_b64_tr_b16 v[202:203], v253 offset:12288
v_mul_f32 v102, 0x3a800000, v102
v_mfma_f32_16x16x32_bf16 v[76:79], a[124:127], v[216:219], v[76:79]
ds_read_b64_tr_b16 v[204:205], v254 offset:0
v_mul_f32 v104, 0x3a800000, v104
v_mfma_f32_16x16x32_bf16 v[28:31], a[120:123], v[216:219], v[28:31]
ds_read_b64_tr_b16 v[206:207], v254 offset:4096
v_add_f32 v103, v125, v127
v_mfma_f32_16x16x32_bf16 v[28:31], a[112:115], v[212:215], v[28:31]
buffer_load_dword v142, v119, s[8:11], s95 offen sc1
ds_read_b64_tr_b16 v[208:209], v254 offset:8192
v_mfma_f32_16x16x32_bf16 v[32:35], a[112:115], v[220:223], v[32:35]
ds_read_b64_tr_b16 v[210:211], v254 offset:12288
v_add_f32 v105, v133, v135
v_mfma_f32_16x16x32_bf16 v[32:35], a[120:123], v[224:227], v[32:35]
ds_read_b64_tr_b16 v[212:213], v255 offset:0
v_add_f32 v120, v129, v131
v_mfma_f32_16x16x32_bf16 v[80:83], a[124:127], v[224:227], v[80:83]
ds_read_b64_tr_b16 v[214:215], v255 offset:4096
v_add_f32 v122, v137, v139
v_mfma_f32_16x16x32_bf16 v[80:83], a[116:119], v[220:223], v[80:83]
buffer_load_dword v143, v119, s[8:11], s96 offen sc1
ds_read_b64_tr_b16 v[216:217], v255 offset:8192
v_mfma_f32_16x16x32_bf16 v[84:87], a[116:119], v[228:231], v[84:87]
ds_read_b64_tr_b16 v[218:219], v255 offset:12288
v_add_f32 v103, v103, v120
v_mfma_f32_16x16x32_bf16 v[84:87], a[124:127], v[232:235], v[84:87]
ds_read_b64_tr_b16 v[220:221], v252 offset:2048
v_add_f32 v105, v105, v122
v_mfma_f32_16x16x32_bf16 v[36:39], a[120:123], v[232:235], v[36:39]
ds_read_b64_tr_b16 v[222:223], v252 offset:6144
v_mul_f32 v120, 0x3c800000, v124
v_mfma_f32_16x16x32_bf16 v[36:39], a[112:115], v[228:231], v[36:39]
s_waitcnt lgkmcnt(9)
ds_read_b64_tr_b16 v[224:225], v252 offset:10240
v_mul_f32 v122, 0x3c800000, v132
v_mfma_f32_16x16x32_bf16 v[40:43], a[112:115], v[236:239], v[40:43]
buffer_load_dwordx4 a[184:187], v100, s[8:11], s23 offen offset:3072 sc1
ds_read_b64_tr_b16 v[226:227], v252 offset:14336
v_mfma_f32_16x16x32_bf16 v[40:43], a[120:123], v[240:243], v[40:43]
ds_read_b64_tr_b16 v[228:229], v253 offset:2048
v_sub_f32 v120, v120, v102
v_mfma_f32_16x16x32_bf16 v[88:91], a[124:127], v[240:243], v[88:91]
ds_read_b64_tr_b16 v[230:231], v253 offset:6144
v_sub_f32 v122, v122, v104
v_mfma_f32_16x16x32_bf16 v[88:91], a[116:119], v[236:239], v[88:91]
ds_read_b64_tr_b16 v[232:233], v253 offset:10240
v_mul_f32 v121, v120, v120
v_mfma_f32_16x16x32_bf16 v[92:95], a[116:119], v[244:247], v[92:95]
buffer_load_dwordx4 a[188:191], v101, s[8:11], s23 offen offset:3072 sc1
ds_read_b64_tr_b16 v[234:235], v253 offset:14336
v_mfma_f32_16x16x32_bf16 v[92:95], a[124:127], v[248:251], v[92:95]
s_add_u32 s23, s23, 4096
ds_read_b64_tr_b16 v[236:237], v254 offset:2048
v_mul_f32 v123, v122, v122
v_mfma_f32_16x16x32_bf16 v[44:47], a[120:123], v[248:251], v[44:47]
ds_read_b64_tr_b16 v[238:239], v254 offset:6144
v_mul_f32 v120, 0x3c800000, v126
v_mfma_f32_16x16x32_bf16 v[44:47], a[112:115], v[244:247], v[44:47]
ds_read_b64_tr_b16 v[240:241], v254 offset:10240
v_mul_f32 v122, 0x3c800000, v134
v_mfma_f32_16x16x32_bf16 v[16:19], a[128:131], v[188:191], v[16:19]
ds_read_b64_tr_b16 v[242:243], v254 offset:14336
v_sub_f32 v120, v120, v102
v_mfma_f32_16x16x32_bf16 v[16:19], a[136:139], v[192:195], v[16:19]
buffer_load_dwordx4 v98, s[12:15], s32 offen offset:0 lds
ds_read_b64_tr_b16 v[244:245], v255 offset:2048
v_mfma_f32_16x16x32_bf16 v[64:67], a[140:143], v[192:195], v[64:67]
ds_read_b64_tr_b16 v[246:247], v255 offset:6144
v_sub_f32 v122, v122, v104
v_mfma_f32_16x16x32_bf16 v[64:67], a[132:135], v[188:191], v[64:67]
s_waitcnt vmcnt(17)
s_barrier
ds_read_b64_tr_b16 v[248:249], v255 offset:10240
v_mfma_f32_16x16x32_bf16 v[68:71], a[132:135], v[196:199], v[68:71]
ds_read_b64_tr_b16 v[250:251], v255 offset:14336
v_fmac_f32 v121, v120, v120
v_mfma_f32_16x16x32_bf16 v[68:71], a[140:143], v[200:203], v[68:71]
buffer_load_dwordx4 v98, s[12:15], s33 offen offset:1024 lds
ds_read_b64_tr_b16 v[188:189], v106 offset:0
v_mfma_f32_16x16x32_bf16 v[20:23], a[136:139], v[200:203], v[20:23]
ds_read_b64_tr_b16 v[190:191], v106 offset:4096
v_fmac_f32 v123, v122, v122
v_mfma_f32_16x16x32_bf16 v[20:23], a[128:131], v[196:199], v[20:23]
s_waitcnt lgkmcnt(9)
ds_read_b64_tr_b16 v[192:193], v106 offset:8192
v_mul_f32 v120, 0x3c800000, v128
v_mfma_f32_16x16x32_bf16 v[24:27], a[128:131], v[204:207], v[24:27]
ds_read_b64_tr_b16 v[194:195], v106 offset:12288
v_mul_f32 v122, 0x3c800000, v136
v_mfma_f32_16x16x32_bf16 v[24:27], a[136:139], v[208:211], v[24:27]
ds_read_b64_tr_b16 v[196:197], v107 offset:0
v_sub_f32 v120, v120, v102
v_mfma_f32_16x16x32_bf16 v[72:75], a[140:143], v[208:211], v[72:75]
buffer_load_dwordx4 v98, s[12:15], s34 offen offset:2048 lds
ds_read_b64_tr_b16 v[198:199], v107 offset:4096
v_mfma_f32_16x16x32_bf16 v[72:75], a[132:135], v[204:207], v[72:75]
ds_read_b64_tr_b16 v[200:201], v107 offset:8192
v_sub_f32 v122, v122, v104
v_mfma_f32_16x16x32_bf16 v[76:79], a[132:135], v[212:215], v[76:79]
ds_read_b64_tr_b16 v[202:203], v107 offset:12288
v_fmac_f32 v121, v120, v120
v_mfma_f32_16x16x32_bf16 v[76:79], a[140:143], v[216:219], v[76:79]
ds_read_b64_tr_b16 v[204:205], v108 offset:0
v_fmac_f32 v123, v122, v122
v_mfma_f32_16x16x32_bf16 v[28:31], a[136:139], v[216:219], v[28:31]
buffer_load_dwordx4 v98, s[12:15], s35 offen offset:3072 lds
ds_read_b64_tr_b16 v[206:207], v108 offset:4096
v_add_u32 v98, 0x60000, v98
v_mfma_f32_16x16x32_bf16 v[28:31], a[128:131], v[212:215], v[28:31]
s_add_u32 m0, s24, 0xc000
ds_read_b64_tr_b16 v[208:209], v108 offset:8192
v_mul_f32 v120, 0x3c800000, v130
v_mfma_f32_16x16x32_bf16 v[32:35], a[128:131], v[220:223], v[32:35]
ds_read_b64_tr_b16 v[210:211], v108 offset:12288
v_mul_f32 v122, 0x3c800000, v138
v_mfma_f32_16x16x32_bf16 v[32:35], a[136:139], v[224:227], v[32:35]
ds_read_b64_tr_b16 v[212:213], v109 offset:0
v_sub_f32 v120, v120, v102
v_mfma_f32_16x16x32_bf16 v[80:83], a[140:143], v[224:227], v[80:83]
ds_read_b64_tr_b16 v[214:215], v109 offset:4096
v_sub_f32 v122, v122, v104
v_mfma_f32_16x16x32_bf16 v[80:83], a[132:135], v[220:223], v[80:83]
buffer_load_dwordx4 a[192:195], v100, s[8:11], s23 offen offset:0 sc1
ds_read_b64_tr_b16 v[216:217], v109 offset:8192
v_mfma_f32_16x16x32_bf16 v[84:87], a[132:135], v[228:231], v[84:87]
ds_read_b64_tr_b16 v[218:219], v109 offset:12288
v_fmac_f32 v121, v120, v120
v_mfma_f32_16x16x32_bf16 v[84:87], a[140:143], v[232:235], v[84:87]
ds_read_b64_tr_b16 v[220:221], v106 offset:2048
v_fmac_f32 v123, v122, v122
v_mfma_f32_16x16x32_bf16 v[36:39], a[136:139], v[232:235], v[36:39]
ds_read_b64_tr_b16 v[222:223], v106 offset:6144
v_fmamk_f32 v103, v121, 0x42800000, v103
v_mfma_f32_16x16x32_bf16 v[36:39], a[128:131], v[228:231], v[36:39]
s_waitcnt lgkmcnt(9)
buffer_load_dwordx4 a[196:199], v101, s[8:11], s23 offen offset:0 sc1
ds_read_b64_tr_b16 v[224:225], v106 offset:10240
v_mfma_f32_16x16x32_bf16 v[40:43], a[128:131], v[236:239], v[40:43]
ds_read_b64_tr_b16 v[226:227], v106 offset:14336
v_fmamk_f32 v105, v123, 0x42800000, v105
v_mfma_f32_16x16x32_bf16 v[40:43], a[136:139], v[240:243], v[40:43]
ds_read_b64_tr_b16 v[228:229], v107 offset:2048
v_mov_b32 v120, v103
v_mfma_f32_16x16x32_bf16 v[88:91], a[140:143], v[240:243], v[88:91]
ds_read_b64_tr_b16 v[230:231], v107 offset:6144
v_mov_b32 v122, v105
v_mfma_f32_16x16x32_bf16 v[88:91], a[132:135], v[236:239], v[88:91]
ds_read_b64_tr_b16 v[232:233], v107 offset:10240
v_permlane16_swap_b32 v103, v120
v_mfma_f32_16x16x32_bf16 v[92:95], a[132:135], v[244:247], v[92:95]
buffer_load_dwordx4 a[200:203], v100, s[8:11], s23 offen offset:1024 sc1
ds_read_b64_tr_b16 v[234:235], v107 offset:14336
v_mfma_f32_16x16x32_bf16 v[92:95], a[140:143], v[248:251], v[92:95]
ds_read_b64_tr_b16 v[236:237], v108 offset:2048
v_permlane16_swap_b32 v105, v122
v_mfma_f32_16x16x32_bf16 v[44:47], a[136:139], v[248:251], v[44:47]
ds_read_b64_tr_b16 v[238:239], v108 offset:6144
v_add_f32 v103, v103, v120
v_mfma_f32_16x16x32_bf16 v[44:47], a[128:131], v[244:247], v[44:47]
ds_read_b64_tr_b16 v[240:241], v108 offset:10240
v_add_f32 v105, v105, v122
v_mfma_f32_16x16x32_bf16 v[16:19], a[144:147], v[188:191], v[16:19]
buffer_load_dwordx4 a[204:207], v101, s[8:11], s23 offen offset:1024 sc1
ds_read_b64_tr_b16 v[242:243], v108 offset:14336
v_mfma_f32_16x16x32_bf16 v[16:19], a[152:155], v[192:195], v[16:19]
ds_read_b64_tr_b16 v[244:245], v109 offset:2048
v_mov_b32 v120, v103
v_mfma_f32_16x16x32_bf16 v[64:67], a[156:159], v[192:195], v[64:67]
ds_read_b64_tr_b16 v[246:247], v109 offset:6144
v_mov_b32 v122, v105
v_mfma_f32_16x16x32_bf16 v[64:67], a[148:151], v[188:191], v[64:67]
s_waitcnt vmcnt(16)
s_barrier
ds_read_b64_tr_b16 v[248:249], v109 offset:10240
v_mfma_f32_16x16x32_bf16 v[68:71], a[148:151], v[196:199], v[68:71]
ds_read_b64_tr_b16 v[250:251], v109 offset:14336
v_permlane32_swap_b32 v103, v120
v_mfma_f32_16x16x32_bf16 v[68:71], a[156:159], v[200:203], v[68:71]
buffer_load_dwordx4 v98, s[12:15], s32 offen offset:0 lds
ds_read_b64_tr_b16 v[188:189], v106 offset:16384
v_mfma_f32_16x16x32_bf16 v[20:23], a[152:155], v[200:203], v[20:23]
ds_read_b64_tr_b16 v[190:191], v106 offset:20480
v_permlane32_swap_b32 v105, v122
v_mfma_f32_16x16x32_bf16 v[20:23], a[144:147], v[196:199], v[20:23]
s_waitcnt lgkmcnt(9)
ds_read_b64_tr_b16 v[192:193], v106 offset:24576
v_add_f32 v103, v103, v120
v_mfma_f32_16x16x32_bf16 v[24:27], a[144:147], v[204:207], v[24:27]
ds_read_b64_tr_b16 v[194:195], v106 offset:28672
v_add_f32 v105, v105, v122
v_mfma_f32_16x16x32_bf16 v[24:27], a[152:155], v[208:211], v[24:27]
buffer_load_dwordx4 v98, s[12:15], s33 offen offset:1024 lds
ds_read_b64_tr_b16 v[196:197], v107 offset:16384
v_mfma_f32_16x16x32_bf16 v[72:75], a[156:159], v[208:211], v[72:75]
ds_read_b64_tr_b16 v[198:199], v107 offset:20480
v_mov_b32 v120, 0x3727c5ac
v_mfma_f32_16x16x32_bf16 v[72:75], a[148:151], v[204:207], v[72:75]
ds_read_b64_tr_b16 v[200:201], v107 offset:24576
v_mov_b32 v122, 0x3727c5ac
v_mfma_f32_16x16x32_bf16 v[76:79], a[148:151], v[212:215], v[76:79]
ds_read_b64_tr_b16 v[202:203], v107 offset:28672
v_fmamk_f32 v103, v103, 0x3a800000, v120
v_mfma_f32_16x16x32_bf16 v[76:79], a[156:159], v[216:219], v[76:79]
ds_read_b64_tr_b16 v[204:205], v108 offset:16384
v_fmamk_f32 v105, v105, 0x3a800000, v122
v_mfma_f32_16x16x32_bf16 v[28:31], a[152:155], v[216:219], v[28:31]
buffer_load_dwordx4 v98, s[12:15], s34 offen offset:2048 lds
ds_read_b64_tr_b16 v[206:207], v108 offset:20480
v_mfma_f32_16x16x32_bf16 v[28:31], a[144:147], v[212:215], v[28:31]
ds_read_b64_tr_b16 v[208:209], v108 offset:24576
v_rsq_f32 v103, v103
v_mfma_f32_16x16x32_bf16 v[32:35], a[144:147], v[220:223], v[32:35]
ds_read_b64_tr_b16 v[210:211], v108 offset:28672
v_rsq_f32 v105, v105
v_mfma_f32_16x16x32_bf16 v[32:35], a[152:155], v[224:227], v[32:35]
ds_read_b64_tr_b16 v[212:213], v109 offset:16384
v_mul_f32 v102, v102, v103
v_mfma_f32_16x16x32_bf16 v[80:83], a[156:159], v[224:227], v[80:83]
buffer_load_dwordx4 v98, s[12:15], s35 offen offset:3072 lds
ds_read_b64_tr_b16 v[214:215], v109 offset:20480
v_add_u32 v98, 0x60000, v98
v_mfma_f32_16x16x32_bf16 v[80:83], a[148:151], v[220:223], v[80:83]
s_add_u32 m0, s24, 0x10000
ds_read_b64_tr_b16 v[216:217], v109 offset:24576
v_mul_f32 v104, v104, v105
v_mfma_f32_16x16x32_bf16 v[84:87], a[148:151], v[228:231], v[84:87]
ds_read_b64_tr_b16 v[218:219], v109 offset:28672
v_sub_f32 v102, 0, v102
v_mfma_f32_16x16x32_bf16 v[84:87], a[156:159], v[232:235], v[84:87]
ds_read_b64_tr_b16 v[220:221], v106 offset:18432
v_sub_f32 v104, 0, v104
v_mfma_f32_16x16x32_bf16 v[36:39], a[152:155], v[232:235], v[36:39]
ds_read_b64_tr_b16 v[222:223], v106 offset:22528
ds_write_b32 v117, v103 offset:0
v_mfma_f32_16x16x32_bf16 v[36:39], a[144:147], v[228:231], v[36:39]
s_waitcnt lgkmcnt(10)
buffer_load_dwordx4 a[208:211], v100, s[8:11], s23 offen offset:2048 sc1
ds_read_b64_tr_b16 v[224:225], v106 offset:26624
v_mfma_f32_16x16x32_bf16 v[40:43], a[144:147], v[236:239], v[40:43]
ds_read_b64_tr_b16 v[226:227], v106 offset:30720
ds_write_b32 v117, v105 offset:64
v_mfma_f32_16x16x32_bf16 v[40:43], a[152:155], v[240:243], v[40:43]
ds_read_b64_tr_b16 v[228:229], v107 offset:18432
ds_write_b32 v117, v102 offset:128
v_mfma_f32_16x16x32_bf16 v[88:91], a[156:159], v[240:243], v[88:91]
ds_read_b64_tr_b16 v[230:231], v107 offset:22528
ds_write_b32 v117, v104 offset:192
v_mfma_f32_16x16x32_bf16 v[88:91], a[148:151], v[236:239], v[88:91]
buffer_load_dwordx4 a[212:215], v101, s[8:11], s23 offen offset:2048 sc1
ds_read_b64_tr_b16 v[232:233], v107 offset:26624
v_mfma_f32_16x16x32_bf16 v[92:95], a[148:151], v[244:247], v[92:95]
ds_read_b64_tr_b16 v[234:235], v107 offset:30720
s_waitcnt vmcnt(16)
v_mfma_f32_16x16x32_bf16 v[92:95], a[156:159], v[248:251], v[92:95]
ds_read_b64_tr_b16 v[236:237], v108 offset:18432
v_add_f32 v140, v140, v141
v_mfma_f32_16x16x32_bf16 v[44:47], a[152:155], v[248:251], v[44:47]
ds_read_b64_tr_b16 v[238:239], v108 offset:22528
v_add_f32 v142, v142, v143
v_mfma_f32_16x16x32_bf16 v[44:47], a[144:147], v[244:247], v[44:47]
ds_read_b64_tr_b16 v[240:241], v108 offset:26624
v_add_f32 v140, v140, v142
v_mfma_f32_16x16x32_bf16 v[16:19], a[160:163], v[188:191], v[16:19]
buffer_load_dwordx4 a[216:219], v100, s[8:11], s23 offen offset:3072 sc1
ds_read_b64_tr_b16 v[242:243], v108 offset:30720
v_mfma_f32_16x16x32_bf16 v[16:19], a[168:171], v[192:195], v[16:19]
ds_read_b64_tr_b16 v[244:245], v109 offset:18432
ds_write_b32 v118, v140
v_mfma_f32_16x16x32_bf16 v[64:67], a[172:175], v[192:195], v[64:67]
ds_read_b64_tr_b16 v[246:247], v109 offset:22528
v_lshrrev_b32 v116, 4, v97
v_mfma_f32_16x16x32_bf16 v[64:67], a[164:167], v[188:191], v[64:67]
s_waitcnt vmcnt(11)
s_barrier
ds_read_b64_tr_b16 v[248:249], v109 offset:26624
v_mfma_f32_16x16x32_bf16 v[68:71], a[164:167], v[196:199], v[68:71]
buffer_load_dwordx4 a[220:223], v101, s[8:11], s23 offen offset:3072 sc1
ds_read_b64_tr_b16 v[250:251], v109 offset:30720
v_mfma_f32_16x16x32_bf16 v[68:71], a[172:175], v[200:203], v[68:71]
s_add_u32 s23, s23, 4096
ds_read_b64_tr_b16 v[188:189], v106 offset:32768
v_lshlrev_b32 v116, 4, v116
v_mfma_f32_16x16x32_bf16 v[20:23], a[168:171], v[200:203], v[20:23]
ds_read_b64_tr_b16 v[190:191], v106 offset:36864
v_add_u32 v117, s31, v116
v_mfma_f32_16x16x32_bf16 v[20:23], a[160:163], v[196:199], v[20:23]
s_waitcnt lgkmcnt(10)
ds_read_b64_tr_b16 v[192:193], v106 offset:40960
v_add_u32 v116, 0x24000, v116
v_mfma_f32_16x16x32_bf16 v[24:27], a[160:163], v[204:207], v[24:27]
ds_read_b64_tr_b16 v[194:195], v106 offset:45056
v_and_b32 v118, 15, v97
v_mfma_f32_16x16x32_bf16 v[24:27], a[168:171], v[208:211], v[24:27]
buffer_load_dwordx4 v98, s[12:15], s32 offen offset:0 lds
ds_read_b64_tr_b16 v[196:197], v107 offset:32768
v_mfma_f32_16x16x32_bf16 v[72:75], a[172:175], v[208:211], v[72:75]
ds_read_b64_tr_b16 v[198:199], v107 offset:36864
v_lshlrev_b32 v118, 2, v118
v_mfma_f32_16x16x32_bf16 v[72:75], a[164:167], v[204:207], v[72:75]
ds_read_b64_tr_b16 v[200:201], v107 offset:40960
v_add_u32 v118, 0x24000, v118
v_mfma_f32_16x16x32_bf16 v[76:79], a[164:167], v[212:215], v[76:79]
ds_read_b64_tr_b16 v[202:203], v107 offset:45056
v_mfma_f32_16x16x32_bf16 v[76:79], a[172:175], v[216:219], v[76:79]
buffer_load_dwordx4 v98, s[12:15], s33 offen offset:1024 lds
ds_read_b64_tr_b16 v[204:205], v108 offset:32768
v_mfma_f32_16x16x32_bf16 v[28:31], a[168:171], v[216:219], v[28:31]
ds_read_b64_tr_b16 v[206:207], v108 offset:36864
v_mfma_f32_16x16x32_bf16 v[28:31], a[160:163], v[212:215], v[28:31]
ds_read_b64_tr_b16 v[208:209], v108 offset:40960
v_mfma_f32_16x16x32_bf16 v[32:35], a[160:163], v[220:223], v[32:35]
ds_read_b64_tr_b16 v[210:211], v108 offset:45056
v_mfma_f32_16x16x32_bf16 v[32:35], a[168:171], v[224:227], v[32:35]
ds_read_b64_tr_b16 v[212:213], v109 offset:32768
v_mfma_f32_16x16x32_bf16 v[80:83], a[172:175], v[224:227], v[80:83]
buffer_load_dwordx4 v98, s[12:15], s34 offen offset:2048 lds
ds_read_b64_tr_b16 v[214:215], v109 offset:36864
v_mfma_f32_16x16x32_bf16 v[80:83], a[164:167], v[220:223], v[80:83]
ds_read_b64_tr_b16 v[216:217], v109 offset:40960
v_mfma_f32_16x16x32_bf16 v[84:87], a[164:167], v[228:231], v[84:87]
ds_read_b64_tr_b16 v[218:219], v109 offset:45056
v_mfma_f32_16x16x32_bf16 v[84:87], a[172:175], v[232:235], v[84:87]
ds_read_b64_tr_b16 v[220:221], v106 offset:34816
v_mfma_f32_16x16x32_bf16 v[36:39], a[168:171], v[232:235], v[36:39]
buffer_load_dwordx4 v98, s[12:15], s35 offen offset:3072 lds
ds_read_b64_tr_b16 v[222:223], v106 offset:38912
v_add_u32 v98, 0x60000, v98
v_mfma_f32_16x16x32_bf16 v[36:39], a[160:163], v[228:231], v[36:39]
s_waitcnt lgkmcnt(9)
s_add_u32 m0, s24, 0x14000
ds_read_b64_tr_b16 v[224:225], v106 offset:43008
v_mfma_f32_16x16x32_bf16 v[40:43], a[160:163], v[236:239], v[40:43]
ds_read_b64_tr_b16 v[226:227], v106 offset:47104
v_mfma_f32_16x16x32_bf16 v[40:43], a[168:171], v[240:243], v[40:43]
ds_read_b64_tr_b16 v[228:229], v107 offset:34816
v_mfma_f32_16x16x32_bf16 v[88:91], a[172:175], v[240:243], v[88:91]
ds_read_b64_tr_b16 v[230:231], v107 offset:38912
v_mfma_f32_16x16x32_bf16 v[88:91], a[164:167], v[236:239], v[88:91]
buffer_load_dwordx4 a[224:227], v100, s[8:11], s23 offen offset:0 sc1
ds_read_b64_tr_b16 v[232:233], v107 offset:43008
v_mfma_f32_16x16x32_bf16 v[92:95], a[164:167], v[244:247], v[92:95]
ds_read_b64_tr_b16 v[234:235], v107 offset:47104
v_mfma_f32_16x16x32_bf16 v[92:95], a[172:175], v[248:251], v[92:95]
ds_read_b64_tr_b16 v[236:237], v108 offset:34816
v_mfma_f32_16x16x32_bf16 v[44:47], a[168:171], v[248:251], v[44:47]
ds_read_b64_tr_b16 v[238:239], v108 offset:38912
v_mfma_f32_16x16x32_bf16 v[44:47], a[160:163], v[244:247], v[44:47]
buffer_load_dwordx4 a[228:231], v101, s[8:11], s23 offen offset:0 sc1
ds_read_b64_tr_b16 v[240:241], v108 offset:43008
v_mfma_f32_16x16x32_bf16 v[16:19], a[176:179], v[188:191], v[16:19]
ds_read_b64_tr_b16 v[242:243], v108 offset:47104
v_mfma_f32_16x16x32_bf16 v[16:19], a[184:187], v[192:195], v[16:19]
ds_read_b64_tr_b16 v[244:245], v109 offset:34816
v_mfma_f32_16x16x32_bf16 v[64:67], a[188:191], v[192:195], v[64:67]
ds_read_b64_tr_b16 v[246:247], v109 offset:38912
v_mfma_f32_16x16x32_bf16 v[64:67], a[180:183], v[188:191], v[64:67]
s_waitcnt vmcnt(10)
s_barrier
ds_read_b64_tr_b16 v[248:249], v109 offset:43008
v_mfma_f32_16x16x32_bf16 v[68:71], a[180:183], v[196:199], v[68:71]
buffer_load_dwordx4 a[232:235], v100, s[8:11], s23 offen offset:1024 sc1
ds_read_b64_tr_b16 v[250:251], v109 offset:47104
v_mfma_f32_16x16x32_bf16 v[68:71], a[188:191], v[200:203], v[68:71]
ds_read_b64_tr_b16 v[188:189], v106 offset:49152
ds_read_b128 v[148:151], v117 offset:0
v_mfma_f32_16x16x32_bf16 v[20:23], a[184:187], v[200:203], v[20:23]
ds_read_b64_tr_b16 v[190:191], v106 offset:53248
ds_read_b128 v[156:159], v117 offset:128
v_mfma_f32_16x16x32_bf16 v[20:23], a[176:179], v[196:199], v[20:23]
s_waitcnt lgkmcnt(11)
ds_read_b64_tr_b16 v[192:193], v106 offset:57344
ds_read_b128 v[152:155], v117 offset:64
v_mfma_f32_16x16x32_bf16 v[24:27], a[176:179], v[204:207], v[24:27]
buffer_load_dwordx4 a[236:239], v101, s[8:11], s23 offen offset:1024 sc1
ds_read_b64_tr_b16 v[194:195], v106 offset:61440
v_mfma_f32_16x16x32_bf16 v[24:27], a[184:187], v[208:211], v[24:27]
ds_read_b64_tr_b16 v[196:197], v107 offset:49152
ds_read_b128 v[160:163], v117 offset:192
v_mfma_f32_16x16x32_bf16 v[72:75], a[188:191], v[208:211], v[72:75]
ds_read_b64_tr_b16 v[198:199], v107 offset:53248
ds_read2_b32 v[164:165], v118 offset0:64 offset1:80
v_mfma_f32_16x16x32_bf16 v[72:75], a[180:183], v[204:207], v[72:75]
ds_read_b64_tr_b16 v[200:201], v107 offset:57344
ds_read2_b32 v[166:167], v118 offset0:96 offset1:112
v_mfma_f32_16x16x32_bf16 v[76:79], a[180:183], v[212:215], v[76:79]
ds_read_b64_tr_b16 v[202:203], v107 offset:61440
ds_read2_b32 v[168:169], v118 offset0:128 offset1:144
v_mfma_f32_16x16x32_bf16 v[76:79], a[188:191], v[216:219], v[76:79]
buffer_load_dwordx4 v98, s[12:15], s32 offen offset:0 lds
ds_read_b64_tr_b16 v[204:205], v108 offset:49152
v_mfma_f32_16x16x32_bf16 v[28:31], a[184:187], v[216:219], v[28:31]
ds_read_b64_tr_b16 v[206:207], v108 offset:53248
ds_read2_b32 v[170:171], v118 offset0:160 offset1:176
v_mfma_f32_16x16x32_bf16 v[28:31], a[176:179], v[212:215], v[28:31]
ds_read_b64_tr_b16 v[208:209], v108 offset:57344
ds_read_b128 v[172:175], v116 offset:0
v_mfma_f32_16x16x32_bf16 v[32:35], a[176:179], v[220:223], v[32:35]
ds_read_b64_tr_b16 v[210:211], v108 offset:61440
ds_read_b128 v[176:179], v116 offset:64
v_mfma_f32_16x16x32_bf16 v[32:35], a[184:187], v[224:227], v[32:35]
buffer_load_dwordx4 v98, s[12:15], s33 offen offset:1024 lds
ds_read_b64_tr_b16 v[212:213], v109 offset:49152
v_mfma_f32_16x16x32_bf16 v[80:83], a[188:191], v[224:227], v[80:83]
ds_read_b64_tr_b16 v[214:215], v109 offset:53248
ds_read_b128 v[180:183], v116 offset:128
v_mfma_f32_16x16x32_bf16 v[80:83], a[180:183], v[220:223], v[80:83]
ds_read_b64_tr_b16 v[216:217], v109 offset:57344
ds_read_b128 v[184:187], v116 offset:192
v_mfma_f32_16x16x32_bf16 v[84:87], a[180:183], v[228:231], v[84:87]
ds_read_b64_tr_b16 v[218:219], v109 offset:61440
v_mfma_f32_16x16x32_bf16 v[84:87], a[188:191], v[232:235], v[84:87]
ds_read_b64_tr_b16 v[220:221], v106 offset:51200
v_mfma_f32_16x16x32_bf16 v[36:39], a[184:187], v[232:235], v[36:39]
buffer_load_dwordx4 v98, s[12:15], s34 offen offset:2048 lds
ds_read_b64_tr_b16 v[222:223], v106 offset:55296
v_mfma_f32_16x16x32_bf16 v[36:39], a[176:179], v[228:231], v[36:39]
s_waitcnt lgkmcnt(14)
ds_read_b64_tr_b16 v[224:225], v106 offset:59392
v_mfma_f32_16x16x32_bf16 v[40:43], a[176:179], v[236:239], v[40:43]
ds_read_b64_tr_b16 v[226:227], v106 offset:63488
v_mfma_f32_16x16x32_bf16 v[40:43], a[184:187], v[240:243], v[40:43]
ds_read_b64_tr_b16 v[228:229], v107 offset:51200
v_mfma_f32_16x16x32_bf16 v[88:91], a[188:191], v[240:243], v[88:91]
buffer_load_dwordx4 v98, s[12:15], s35 offen offset:3072 lds
ds_read_b64_tr_b16 v[230:231], v107 offset:55296
v_add_u32 v98, 0x60000, v98
v_mfma_f32_16x16x32_bf16 v[88:91], a[180:183], v[236:239], v[88:91]
s_add_u32 m0, s24, 0x18000
ds_read_b64_tr_b16 v[232:233], v107 offset:59392
v_mfma_f32_16x16x32_bf16 v[92:95], a[180:183], v[244:247], v[92:95]
ds_read_b64_tr_b16 v[234:235], v107 offset:63488
v_mfma_f32_16x16x32_bf16 v[92:95], a[188:191], v[248:251], v[92:95]
ds_read_b64_tr_b16 v[236:237], v108 offset:51200
v_mfma_f32_16x16x32_bf16 v[44:47], a[184:187], v[248:251], v[44:47]
ds_read_b64_tr_b16 v[238:239], v108 offset:55296
v_mfma_f32_16x16x32_bf16 v[44:47], a[176:179], v[244:247], v[44:47]
buffer_load_dwordx4 a[240:243], v100, s[8:11], s23 offen offset:2048 sc1
ds_read_b64_tr_b16 v[240:241], v108 offset:59392
v_mfma_f32_16x16x32_bf16 v[16:19], a[192:195], v[188:191], v[16:19]
ds_read_b64_tr_b16 v[242:243], v108 offset:63488
v_mfma_f32_16x16x32_bf16 v[16:19], a[200:203], v[192:195], v[16:19]
ds_read_b64_tr_b16 v[244:245], v109 offset:51200
v_mfma_f32_16x16x32_bf16 v[64:67], a[204:207], v[192:195], v[64:67]
ds_read_b64_tr_b16 v[246:247], v109 offset:55296
v_mfma_f32_16x16x32_bf16 v[64:67], a[196:199], v[188:191], v[64:67]
s_waitcnt vmcnt(9)
s_barrier
buffer_load_dwordx4 a[244:247], v101, s[8:11], s23 offen offset:2048 sc1
ds_read_b64_tr_b16 v[248:249], v109 offset:59392
v_mfma_f32_16x16x32_bf16 v[68:71], a[196:199], v[196:199], v[68:71]
ds_read_b64_tr_b16 v[250:251], v109 offset:63488
v_mfma_f32_16x16x32_bf16 v[68:71], a[204:207], v[200:203], v[68:71]
ds_read_b64_tr_b16 v[188:189], v110 offset:0
v_mfma_f32_16x16x32_bf16 v[20:23], a[200:203], v[200:203], v[20:23]
ds_read_b64_tr_b16 v[190:191], v110 offset:4096
v_mfma_f32_16x16x32_bf16 v[20:23], a[192:195], v[196:199], v[20:23]
s_waitcnt lgkmcnt(9)
ds_read_b64_tr_b16 v[192:193], v110 offset:8192
v_mfma_f32_16x16x32_bf16 v[24:27], a[192:195], v[204:207], v[24:27]
buffer_load_dwordx4 a[248:251], v100, s[8:11], s23 offen offset:3072 sc1
ds_read_b64_tr_b16 v[194:195], v110 offset:12288
v_mfma_f32_16x16x32_bf16 v[24:27], a[200:203], v[208:211], v[24:27]
ds_read_b64_tr_b16 v[196:197], v111 offset:0
v_mfma_f32_16x16x32_bf16 v[72:75], a[204:207], v[208:211], v[72:75]
ds_read_b64_tr_b16 v[198:199], v111 offset:4096
v_mfma_f32_16x16x32_bf16 v[72:75], a[196:199], v[204:207], v[72:75]
ds_read_b64_tr_b16 v[200:201], v111 offset:8192
v_mfma_f32_16x16x32_bf16 v[76:79], a[196:199], v[212:215], v[76:79]
buffer_load_dwordx4 a[252:255], v101, s[8:11], s23 offen offset:3072 sc1
ds_read_b64_tr_b16 v[202:203], v111 offset:12288
v_mfma_f32_16x16x32_bf16 v[76:79], a[204:207], v[216:219], v[76:79]
ds_read_b64_tr_b16 v[204:205], v112 offset:0
v_mfma_f32_16x16x32_bf16 v[28:31], a[200:203], v[216:219], v[28:31]
ds_read_b64_tr_b16 v[206:207], v112 offset:4096
v_mfma_f32_16x16x32_bf16 v[28:31], a[192:195], v[212:215], v[28:31]
ds_read_b64_tr_b16 v[208:209], v112 offset:8192
v_mfma_f32_16x16x32_bf16 v[32:35], a[192:195], v[220:223], v[32:35]
ds_read_b64_tr_b16 v[210:211], v112 offset:12288
v_mfma_f32_16x16x32_bf16 v[32:35], a[200:203], v[224:227], v[32:35]
buffer_load_dwordx4 v98, s[12:15], s32 offen offset:0 lds
ds_read_b64_tr_b16 v[212:213], v113 offset:0
v_mfma_f32_16x16x32_bf16 v[80:83], a[204:207], v[224:227], v[80:83]
ds_read_b64_tr_b16 v[214:215], v113 offset:4096
v_mfma_f32_16x16x32_bf16 v[80:83], a[196:199], v[220:223], v[80:83]
ds_read_b64_tr_b16 v[216:217], v113 offset:8192
v_mfma_f32_16x16x32_bf16 v[84:87], a[196:199], v[228:231], v[84:87]
ds_read_b64_tr_b16 v[218:219], v113 offset:12288
v_mfma_f32_16x16x32_bf16 v[84:87], a[204:207], v[232:235], v[84:87]
buffer_load_dwordx4 v98, s[12:15], s33 offen offset:1024 lds
ds_read_b64_tr_b16 v[220:221], v110 offset:2048
v_mfma_f32_16x16x32_bf16 v[36:39], a[200:203], v[232:235], v[36:39]
ds_read_b64_tr_b16 v[222:223], v110 offset:6144
v_mfma_f32_16x16x32_bf16 v[36:39], a[192:195], v[228:231], v[36:39]
s_waitcnt lgkmcnt(9)
ds_read_b64_tr_b16 v[224:225], v110 offset:10240
v_mfma_f32_16x16x32_bf16 v[40:43], a[192:195], v[236:239], v[40:43]
ds_read_b64_tr_b16 v[226:227], v110 offset:14336
v_mfma_f32_16x16x32_bf16 v[40:43], a[200:203], v[240:243], v[40:43]
ds_read_b64_tr_b16 v[228:229], v111 offset:2048
v_mfma_f32_16x16x32_bf16 v[88:91], a[204:207], v[240:243], v[88:91]
buffer_load_dwordx4 v98, s[12:15], s34 offen offset:2048 lds
ds_read_b64_tr_b16 v[230:231], v111 offset:6144
v_mfma_f32_16x16x32_bf16 v[88:91], a[196:199], v[236:239], v[88:91]
ds_read_b64_tr_b16 v[232:233], v111 offset:10240
v_mfma_f32_16x16x32_bf16 v[92:95], a[196:199], v[244:247], v[92:95]
ds_read_b64_tr_b16 v[234:235], v111 offset:14336
v_mfma_f32_16x16x32_bf16 v[92:95], a[204:207], v[248:251], v[92:95]
ds_read_b64_tr_b16 v[236:237], v112 offset:2048
v_mfma_f32_16x16x32_bf16 v[44:47], a[200:203], v[248:251], v[44:47]
buffer_load_dwordx4 v98, s[12:15], s35 offen offset:3072 lds
ds_read_b64_tr_b16 v[238:239], v112 offset:6144
v_add_u32 v98, s3, v98
v_mfma_f32_16x16x32_bf16 v[44:47], a[192:195], v[244:247], v[44:47]
s_add_u32 m0, s24, 0x1c000
ds_read_b64_tr_b16 v[240:241], v112 offset:10240
v_mfma_f32_16x16x32_bf16 v[16:19], a[208:211], v[188:191], v[16:19]
ds_read_b64_tr_b16 v[242:243], v112 offset:14336
v_mfma_f32_16x16x32_bf16 v[16:19], a[216:219], v[192:195], v[16:19]
ds_read_b64_tr_b16 v[244:245], v113 offset:2048
v_mfma_f32_16x16x32_bf16 v[64:67], a[220:223], v[192:195], v[64:67]
ds_read_b64_tr_b16 v[246:247], v113 offset:6144
v_mfma_f32_16x16x32_bf16 v[64:67], a[212:215], v[188:191], v[64:67]
s_waitcnt vmcnt(8)
s_barrier
ds_read_b64_tr_b16 v[248:249], v113 offset:10240
v_mfma_f32_16x16x32_bf16 v[68:71], a[212:215], v[196:199], v[68:71]
ds_read_b64_tr_b16 v[250:251], v113 offset:14336
v_mfma_f32_16x16x32_bf16 v[68:71], a[220:223], v[200:203], v[68:71]
ds_read_b64_tr_b16 v[188:189], v110 offset:16384
v_mfma_f32_16x16x32_bf16 v[20:23], a[216:219], v[200:203], v[20:23]
ds_read_b64_tr_b16 v[190:191], v110 offset:20480
v_mfma_f32_16x16x32_bf16 v[20:23], a[208:211], v[196:199], v[20:23]
s_waitcnt lgkmcnt(9)
ds_read_b64_tr_b16 v[192:193], v110 offset:24576
v_mfma_f32_16x16x32_bf16 v[24:27], a[208:211], v[204:207], v[24:27]
ds_read_b64_tr_b16 v[194:195], v110 offset:28672
v_mfma_f32_16x16x32_bf16 v[24:27], a[216:219], v[208:211], v[24:27]
ds_read_b64_tr_b16 v[196:197], v111 offset:16384
v_mfma_f32_16x16x32_bf16 v[72:75], a[220:223], v[208:211], v[72:75]
ds_read_b64_tr_b16 v[198:199], v111 offset:20480
v_mfma_f32_16x16x32_bf16 v[72:75], a[212:215], v[204:207], v[72:75]
ds_read_b64_tr_b16 v[200:201], v111 offset:24576
v_mfma_f32_16x16x32_bf16 v[76:79], a[212:215], v[212:215], v[76:79]
ds_read_b64_tr_b16 v[202:203], v111 offset:28672
v_mfma_f32_16x16x32_bf16 v[76:79], a[220:223], v[216:219], v[76:79]
ds_read_b64_tr_b16 v[204:205], v112 offset:16384
v_mfma_f32_16x16x32_bf16 v[28:31], a[216:219], v[216:219], v[28:31]
ds_read_b64_tr_b16 v[206:207], v112 offset:20480
v_mfma_f32_16x16x32_bf16 v[28:31], a[208:211], v[212:215], v[28:31]
ds_read_b64_tr_b16 v[208:209], v112 offset:24576
v_mfma_f32_16x16x32_bf16 v[32:35], a[208:211], v[220:223], v[32:35]
ds_read_b64_tr_b16 v[210:211], v112 offset:28672
v_mfma_f32_16x16x32_bf16 v[32:35], a[216:219], v[224:227], v[32:35]
ds_read_b64_tr_b16 v[212:213], v113 offset:16384
v_mfma_f32_16x16x32_bf16 v[80:83], a[220:223], v[224:227], v[80:83]
ds_read_b64_tr_b16 v[214:215], v113 offset:20480
v_mfma_f32_16x16x32_bf16 v[80:83], a[212:215], v[220:223], v[80:83]
ds_read_b64_tr_b16 v[216:217], v113 offset:24576
v_mfma_f32_16x16x32_bf16 v[84:87], a[212:215], v[228:231], v[84:87]
ds_read_b64_tr_b16 v[218:219], v113 offset:28672
v_mfma_f32_16x16x32_bf16 v[84:87], a[220:223], v[232:235], v[84:87]
ds_read_b64_tr_b16 v[220:221], v110 offset:18432
v_mfma_f32_16x16x32_bf16 v[36:39], a[216:219], v[232:235], v[36:39]
ds_read_b64_tr_b16 v[222:223], v110 offset:22528
v_mfma_f32_16x16x32_bf16 v[36:39], a[208:211], v[228:231], v[36:39]
s_waitcnt lgkmcnt(9)
ds_read_b64_tr_b16 v[224:225], v110 offset:26624
v_mfma_f32_16x16x32_bf16 v[40:43], a[208:211], v[236:239], v[40:43]
buffer_load_dwordx4 v98, s[12:15], s4 offen offset:0 lds
ds_read_b64_tr_b16 v[226:227], v110 offset:30720
v_mfma_f32_16x16x32_bf16 v[40:43], a[216:219], v[240:243], v[40:43]
ds_read_b64_tr_b16 v[228:229], v111 offset:18432
v_mfma_f32_16x16x32_bf16 v[88:91], a[220:223], v[240:243], v[88:91]
ds_read_b64_tr_b16 v[230:231], v111 offset:22528
v_mfma_f32_16x16x32_bf16 v[88:91], a[212:215], v[236:239], v[88:91]
ds_read_b64_tr_b16 v[232:233], v111 offset:26624
v_mfma_f32_16x16x32_bf16 v[92:95], a[212:215], v[244:247], v[92:95]
buffer_load_dwordx4 v98, s[12:15], s5 offen offset:1024 lds
ds_read_b64_tr_b16 v[234:235], v111 offset:30720
v_mfma_f32_16x16x32_bf16 v[92:95], a[220:223], v[248:251], v[92:95]
ds_read_b64_tr_b16 v[236:237], v112 offset:18432
v_mfma_f32_16x16x32_bf16 v[44:47], a[216:219], v[248:251], v[44:47]
ds_read_b64_tr_b16 v[238:239], v112 offset:22528
v_mfma_f32_16x16x32_bf16 v[44:47], a[208:211], v[244:247], v[44:47]
ds_read_b64_tr_b16 v[240:241], v112 offset:26624
v_mfma_f32_16x16x32_bf16 v[16:19], a[224:227], v[188:191], v[16:19]
ds_read_b64_tr_b16 v[242:243], v112 offset:30720
v_mfma_f32_16x16x32_bf16 v[16:19], a[232:235], v[192:195], v[16:19]
buffer_load_dwordx4 v98, s[12:15], s6 offen offset:2048 lds
ds_read_b64_tr_b16 v[244:245], v113 offset:18432
v_mfma_f32_16x16x32_bf16 v[64:67], a[236:239], v[192:195], v[64:67]
ds_read_b64_tr_b16 v[246:247], v113 offset:22528
v_mfma_f32_16x16x32_bf16 v[64:67], a[228:231], v[188:191], v[64:67]
s_waitcnt vmcnt(3)
s_barrier
buffer_load_dwordx4 v98, s[12:15], s7 offen offset:3072 lds
ds_read_b64_tr_b16 v[248:249], v113 offset:26624
v_add_u32 v98, 0xc0000, v98
v_mfma_f32_16x16x32_bf16 v[68:71], a[228:231], v[196:199], v[68:71]
s_add_u32 m0, s24, 0x20000
s_nop 0
buffer_load_dwordx4 v98, s[12:15], s4 offen offset:0 lds
ds_read_b64_tr_b16 v[250:251], v113 offset:30720
v_mfma_f32_16x16x32_bf16 v[68:71], a[236:239], v[200:203], v[68:71]
buffer_load_dwordx4 v98, s[12:15], s5 offen offset:1024 lds
ds_read_b64_tr_b16 v[188:189], v110 offset:32768
v_mfma_f32_16x16x32_bf16 v[20:23], a[232:235], v[200:203], v[20:23]
buffer_load_dwordx4 v98, s[12:15], s6 offen offset:2048 lds
ds_read_b64_tr_b16 v[190:191], v110 offset:36864
v_mfma_f32_16x16x32_bf16 v[20:23], a[224:227], v[196:199], v[20:23]
s_waitcnt lgkmcnt(9)
buffer_load_dwordx4 v98, s[12:15], s7 offen offset:3072 lds
ds_read_b64_tr_b16 v[192:193], v110 offset:40960
v_add_u32 v98, 0xc0000, v98
v_mfma_f32_16x16x32_bf16 v[24:27], a[224:227], v[204:207], v[24:27]
s_add_u32 m0, s24, 0x0
ds_read_b64_tr_b16 v[194:195], v110 offset:45056
v_mfma_f32_16x16x32_bf16 v[24:27], a[232:235], v[208:211], v[24:27]
ds_read_b64_tr_b16 v[196:197], v111 offset:32768
v_mfma_f32_16x16x32_bf16 v[72:75], a[236:239], v[208:211], v[72:75]
ds_read_b64_tr_b16 v[198:199], v111 offset:36864
v_mfma_f32_16x16x32_bf16 v[72:75], a[228:231], v[204:207], v[72:75]
ds_read_b64_tr_b16 v[200:201], v111 offset:40960
v_mfma_f32_16x16x32_bf16 v[76:79], a[228:231], v[212:215], v[76:79]
ds_read_b64_tr_b16 v[202:203], v111 offset:45056
v_mfma_f32_16x16x32_bf16 v[76:79], a[236:239], v[216:219], v[76:79]
ds_read_b64_tr_b16 v[204:205], v112 offset:32768
v_mfma_f32_16x16x32_bf16 v[28:31], a[232:235], v[216:219], v[28:31]
ds_read_b64_tr_b16 v[206:207], v112 offset:36864
v_mfma_f32_16x16x32_bf16 v[28:31], a[224:227], v[212:215], v[28:31]
ds_read_b64_tr_b16 v[208:209], v112 offset:40960
v_mfma_f32_16x16x32_bf16 v[32:35], a[224:227], v[220:223], v[32:35]
ds_read_b64_tr_b16 v[210:211], v112 offset:45056
v_mfma_f32_16x16x32_bf16 v[32:35], a[232:235], v[224:227], v[32:35]
ds_read_b64_tr_b16 v[212:213], v113 offset:32768
v_mfma_f32_16x16x32_bf16 v[80:83], a[236:239], v[224:227], v[80:83]
ds_read_b64_tr_b16 v[214:215], v113 offset:36864
v_mfma_f32_16x16x32_bf16 v[80:83], a[228:231], v[220:223], v[80:83]
ds_read_b64_tr_b16 v[216:217], v113 offset:40960
v_mfma_f32_16x16x32_bf16 v[84:87], a[228:231], v[228:231], v[84:87]
ds_read_b64_tr_b16 v[218:219], v113 offset:45056
v_mfma_f32_16x16x32_bf16 v[84:87], a[236:239], v[232:235], v[84:87]
ds_read_b64_tr_b16 v[220:221], v110 offset:34816
v_mfma_f32_16x16x32_bf16 v[36:39], a[232:235], v[232:235], v[36:39]
ds_read_b64_tr_b16 v[222:223], v110 offset:38912
v_mfma_f32_16x16x32_bf16 v[36:39], a[224:227], v[228:231], v[36:39]
s_waitcnt lgkmcnt(9)
ds_read_b64_tr_b16 v[224:225], v110 offset:43008
v_mfma_f32_16x16x32_bf16 v[40:43], a[224:227], v[236:239], v[40:43]
ds_read_b64_tr_b16 v[226:227], v110 offset:47104
v_mfma_f32_16x16x32_bf16 v[40:43], a[232:235], v[240:243], v[40:43]
ds_read_b64_tr_b16 v[228:229], v111 offset:34816
v_mfma_f32_16x16x32_bf16 v[88:91], a[236:239], v[240:243], v[88:91]
ds_read_b64_tr_b16 v[230:231], v111 offset:38912
v_mfma_f32_16x16x32_bf16 v[88:91], a[228:231], v[236:239], v[88:91]
ds_read_b64_tr_b16 v[232:233], v111 offset:43008
v_mfma_f32_16x16x32_bf16 v[92:95], a[228:231], v[244:247], v[92:95]
buffer_load_dwordx4 v98, s[12:15], s4 offen offset:0 lds
ds_read_b64_tr_b16 v[234:235], v111 offset:47104
v_mfma_f32_16x16x32_bf16 v[92:95], a[236:239], v[248:251], v[92:95]
ds_read_b64_tr_b16 v[236:237], v112 offset:34816
v_mfma_f32_16x16x32_bf16 v[44:47], a[232:235], v[248:251], v[44:47]
ds_read_b64_tr_b16 v[238:239], v112 offset:38912
v_mfma_f32_16x16x32_bf16 v[44:47], a[224:227], v[244:247], v[44:47]
ds_read_b64_tr_b16 v[240:241], v112 offset:43008
v_mfma_f32_16x16x32_bf16 v[16:19], a[240:243], v[188:191], v[16:19]
buffer_load_dwordx4 v98, s[12:15], s5 offen offset:1024 lds
ds_read_b64_tr_b16 v[242:243], v112 offset:47104
v_mfma_f32_16x16x32_bf16 v[16:19], a[248:251], v[192:195], v[16:19]
ds_read_b64_tr_b16 v[244:245], v113 offset:34816
v_mfma_f32_16x16x32_bf16 v[64:67], a[252:255], v[192:195], v[64:67]
ds_read_b64_tr_b16 v[246:247], v113 offset:38912
v_mfma_f32_16x16x32_bf16 v[64:67], a[244:247], v[188:191], v[64:67]
ds_read_b64_tr_b16 v[248:249], v113 offset:43008
v_mfma_f32_16x16x32_bf16 v[68:71], a[244:247], v[196:199], v[68:71]
ds_read_b64_tr_b16 v[250:251], v113 offset:47104
v_mfma_f32_16x16x32_bf16 v[68:71], a[252:255], v[200:203], v[68:71]
buffer_load_dwordx4 v98, s[12:15], s6 offen offset:2048 lds
v_mfma_f32_16x16x32_bf16 v[20:23], a[248:251], v[200:203], v[20:23]
v_mfma_f32_16x16x32_bf16 v[20:23], a[240:243], v[196:199], v[20:23]
s_waitcnt lgkmcnt(7)
v_mfma_f32_16x16x32_bf16 v[24:27], a[240:243], v[204:207], v[24:27]
v_mfma_f32_16x16x32_bf16 v[24:27], a[248:251], v[208:211], v[24:27]
buffer_load_dwordx4 v98, s[12:15], s7 offen offset:3072 lds
v_add_u32 v98, 0xc0000, v98
v_mfma_f32_16x16x32_bf16 v[72:75], a[252:255], v[208:211], v[72:75]
s_add_u32 m0, s24, 0x4000
v_mfma_f32_16x16x32_bf16 v[72:75], a[244:247], v[204:207], v[72:75]
v_mfma_f32_16x16x32_bf16 v[76:79], a[244:247], v[212:215], v[76:79]
v_mfma_f32_16x16x32_bf16 v[76:79], a[252:255], v[216:219], v[76:79]
v_mfma_f32_16x16x32_bf16 v[28:31], a[248:251], v[216:219], v[28:31]
buffer_load_dwordx4 v98, s[12:15], s4 offen offset:0 lds
v_mfma_f32_16x16x32_bf16 v[28:31], a[240:243], v[212:215], v[28:31]
v_mfma_f32_16x16x32_bf16 v[32:35], a[240:243], v[220:223], v[32:35]
v_mfma_f32_16x16x32_bf16 v[32:35], a[248:251], v[224:227], v[32:35]
v_mfma_f32_16x16x32_bf16 v[80:83], a[252:255], v[224:227], v[80:83]
buffer_load_dwordx4 v98, s[12:15], s5 offen offset:1024 lds
v_mfma_f32_16x16x32_bf16 v[80:83], a[244:247], v[220:223], v[80:83]
v_mfma_f32_16x16x32_bf16 v[84:87], a[244:247], v[228:231], v[84:87]
v_mfma_f32_16x16x32_bf16 v[84:87], a[252:255], v[232:235], v[84:87]
v_mfma_f32_16x16x32_bf16 v[36:39], a[248:251], v[232:235], v[36:39]
v_mfma_f32_16x16x32_bf16 v[36:39], a[240:243], v[228:231], v[36:39]
s_waitcnt lgkmcnt(0)
buffer_load_dwordx4 v98, s[12:15], s6 offen offset:2048 lds
v_mfma_f32_16x16x32_bf16 v[40:43], a[240:243], v[236:239], v[40:43]
v_mfma_f32_16x16x32_bf16 v[40:43], a[248:251], v[240:243], v[40:43]
v_mfma_f32_16x16x32_bf16 v[88:91], a[252:255], v[240:243], v[88:91]
v_mfma_f32_16x16x32_bf16 v[88:91], a[244:247], v[236:239], v[88:91]
buffer_load_dword v96, v99, s[16:19], s97 offen
v_mfma_f32_16x16x32_bf16 v[92:95], a[244:247], v[244:247], v[92:95]
s_add_u32 s97, s97, 229376
v_mfma_f32_16x16x32_bf16 v[92:95], a[252:255], v[248:251], v[92:95]
v_mfma_f32_16x16x32_bf16 v[44:47], a[248:251], v[248:251], v[44:47]
v_mfma_f32_16x16x32_bf16 v[44:47], a[240:243], v[244:247], v[44:47]
s_waitcnt lgkmcnt(0)
v_lshrrev_b32 v234, 5, v97
v_mul_u32_u24 v234, 4352, v234
v_and_b32 v235, 31, v97
v_lshl_add_u32 v234, v235, 2, v234
s_add_u32 s29, s36, 4096
s_lshl_b32 s27, s20, 13
s_add_u32 s27, s27, 0xc000
v_add_u32 v232, s27, v100
s_lshl_b32 s27, s20, 11
s_add_u32 s27, s27, 0xc000
v_lshlrev_b32 v235, 2, v97
v_add_u32 v233, s27, v235
s_lshr_b32 s27, s20, 1
s_mul_i32 s27, s27, 4352
s_and_b32 s28, s20, 1
s_lshl_b32 s28, s28, 11
s_add_u32 s26, s36, s27
s_add_u32 s26, s26, s28
v_pk_fma_f32 v[120:121], v[156:157], v[164:165], s[62:63] op_sel:[0,0,0] op_sel_hi:[1,0,1]
v_pk_fma_f32 v[16:17], v[148:149], v[16:17], v[120:121]
buffer_load_dwordx4 v98, s[12:15], s7 offen offset:3072 lds
s_add_u32 m0, s24, 0x8000
v_add_u32 v98, 0xc0000, v98
v_pk_fma_f32 v[124:125], v[16:17], s[60:61], s[60:61] op_sel:[0,0,1] op_sel_hi:[1,0,1]
v_max_f32 v16, s62, v16
v_exp_f32_e64 v124, v124 clamp
v_exp_f32_e64 v125, v125 clamp
v_max_f32 v17, s62, v17
v_pk_add_f32 v[16:17], v[16:17], v[124:125]
v_cvt_pk_bf16_f32 v128, v16, v17
v_pk_fma_f32 v[122:123], v[158:159], v[164:165], s[62:63] op_sel:[0,0,0] op_sel_hi:[1,0,1]
v_pk_fma_f32 v[18:19], v[150:151], v[18:19], v[122:123]
v_pk_fma_f32 v[126:127], v[18:19], s[60:61], s[60:61] op_sel:[0,0,1] op_sel_hi:[1,0,1]
v_max_f32 v18, s62, v18
v_exp_f32_e64 v126, v126 clamp
v_exp_f32_e64 v127, v127 clamp
v_max_f32 v19, s62, v19
v_pk_add_f32 v[18:19], v[18:19], v[126:127]
v_cvt_pk_bf16_f32 v129, v18, v19
v_pk_fma_f32 v[120:121], v[160:161], v[164:165], s[62:63] op_sel:[0,0,0] op_sel_hi:[1,0,1]
v_pk_fma_f32 v[64:65], v[152:153], v[64:65], v[120:121]
v_pk_fma_f32 v[124:125], v[64:65], s[60:61], s[60:61] op_sel:[0,0,1] op_sel_hi:[1,0,1]
buffer_load_dwordx4 v98, s[12:15], s4 offen offset:0 lds
v_max_f32 v64, s62, v64
v_exp_f32_e64 v124, v124 clamp
v_exp_f32_e64 v125, v125 clamp
v_max_f32 v65, s62, v65
v_pk_add_f32 v[64:65], v[64:65], v[124:125]
v_cvt_pk_bf16_f32 v130, v64, v65
v_pk_fma_f32 v[122:123], v[162:163], v[164:165], s[62:63] op_sel:[0,0,0] op_sel_hi:[1,0,1]
v_pk_fma_f32 v[66:67], v[154:155], v[66:67], v[122:123]
v_pk_fma_f32 v[126:127], v[66:67], s[60:61], s[60:61] op_sel:[0,0,1] op_sel_hi:[1,0,1]
v_max_f32 v66, s62, v66
v_exp_f32_e64 v126, v126 clamp
v_exp_f32_e64 v127, v127 clamp
v_max_f32 v67, s62, v67
v_pk_add_f32 v[66:67], v[66:67], v[126:127]
v_cvt_pk_bf16_f32 v131, v66, v67
v_pk_fma_f32 v[120:121], v[156:157], v[164:165], s[62:63] op_sel:[0,1,0] op_sel_hi:[1,1,1]
v_pk_fma_f32 v[20:21], v[148:149], v[20:21], v[120:121]
v_pk_fma_f32 v[124:125], v[20:21], s[60:61], s[60:61] op_sel:[0,0,1] op_sel_hi:[1,0,1]
v_max_f32 v20, s62, v20
buffer_load_dwordx4 v98, s[12:15], s5 offen offset:1024 lds
v_exp_f32_e64 v124, v124 clamp
v_exp_f32_e64 v125, v125 clamp
v_max_f32 v21, s62, v21
v_pk_add_f32 v[20:21], v[20:21], v[124:125]
v_cvt_pk_bf16_f32 v132, v20, v21
v_pk_fma_f32 v[122:123], v[158:159], v[164:165], s[62:63] op_sel:[0,1,0] op_sel_hi:[1,1,1]
v_pk_fma_f32 v[22:23], v[150:151], v[22:23], v[122:123]
v_pk_fma_f32 v[126:127], v[22:23], s[60:61], s[60:61] op_sel:[0,0,1] op_sel_hi:[1,0,1]
v_max_f32 v22, s62, v22
v_exp_f32_e64 v126, v126 clamp
v_exp_f32_e64 v127, v127 clamp
v_max_f32 v23, s62, v23
v_pk_add_f32 v[22:23], v[22:23], v[126:127]
v_cvt_pk_bf16_f32 v133, v22, v23
v_pk_fma_f32 v[120:121], v[160:161], v[164:165], s[62:63] op_sel:[0,1,0] op_sel_hi:[1,1,1]
v_pk_fma_f32 v[68:69], v[152:153], v[68:69], v[120:121]
v_pk_fma_f32 v[124:125], v[68:69], s[60:61], s[60:61] op_sel:[0,0,1] op_sel_hi:[1,0,1]
v_max_f32 v68, s62, v68
v_exp_f32_e64 v124, v124 clamp
buffer_load_dwordx4 v98, s[12:15], s6 offen offset:2048 lds
v_exp_f32_e64 v125, v125 clamp
v_max_f32 v69, s62, v69
v_pk_add_f32 v[68:69], v[68:69], v[124:125]
v_cvt_pk_bf16_f32 v134, v68, v69
v_pk_fma_f32 v[122:123], v[162:163], v[164:165], s[62:63] op_sel:[0,1,0] op_sel_hi:[1,1,1]
v_pk_fma_f32 v[70:71], v[154:155], v[70:71], v[122:123]
v_pk_fma_f32 v[126:127], v[70:71], s[60:61], s[60:61] op_sel:[0,0,1] op_sel_hi:[1,0,1]
v_max_f32 v70, s62, v70
v_exp_f32_e64 v126, v126 clamp
v_exp_f32_e64 v127, v127 clamp
v_max_f32 v71, s62, v71
v_pk_add_f32 v[70:71], v[70:71], v[126:127]
v_cvt_pk_bf16_f32 v135, v70, v71
v_pk_mul_f32 v[120:121], v[156:157], v[168:169] op_sel:[0,0] op_sel_hi:[1,0]
v_pk_fma_f32 v[32:33], v[148:149], v[32:33], v[120:121]
v_cvt_pk_bf16_f32 v136, v32, v33
v_pk_mul_f32 v[122:123], v[158:159], v[168:169] op_sel:[0,0] op_sel_hi:[1,0]
v_pk_fma_f32 v[34:35], v[150:151], v[34:35], v[122:123]
v_cvt_pk_bf16_f32 v137, v34, v35
buffer_load_dwordx4 v98, s[12:15], s7 offen offset:3072 lds
s_add_u32 m0, s24, 0xc000
v_add_u32 v98, 0xc0000, v98
v_pk_mul_f32 v[120:121], v[160:161], v[168:169] op_sel:[0,0] op_sel_hi:[1,0]
v_pk_fma_f32 v[80:81], v[152:153], v[80:81], v[120:121]
v_cvt_pk_bf16_f32 v138, v80, v81
v_pk_mul_f32 v[122:123], v[162:163], v[168:169] op_sel:[0,0] op_sel_hi:[1,0]
v_pk_fma_f32 v[82:83], v[154:155], v[82:83], v[122:123]
v_cvt_pk_bf16_f32 v139, v82, v83
v_pk_mul_f32 v[120:121], v[156:157], v[168:169] op_sel:[0,1] op_sel_hi:[1,1]
v_pk_fma_f32 v[36:37], v[148:149], v[36:37], v[120:121]
v_cvt_pk_bf16_f32 v140, v36, v37
v_pk_mul_f32 v[122:123], v[158:159], v[168:169] op_sel:[0,1] op_sel_hi:[1,1]
v_pk_fma_f32 v[38:39], v[150:151], v[38:39], v[122:123]
v_cvt_pk_bf16_f32 v141, v38, v39
v_pk_mul_f32 v[120:121], v[160:161], v[168:169] op_sel:[0,1] op_sel_hi:[1,1]
v_pk_fma_f32 v[84:85], v[152:153], v[84:85], v[120:121]
v_cvt_pk_bf16_f32 v142, v84, v85
v_pk_mul_f32 v[122:123], v[162:163], v[168:169] op_sel:[0,1] op_sel_hi:[1,1]
v_pk_fma_f32 v[86:87], v[154:155], v[86:87], v[122:123]
v_cvt_pk_bf16_f32 v143, v86, v87
v_mfma_f32_16x16x32_bf16 v[200:203], v[128:131], v[136:139], 0
v_mfma_f32_16x16x32_bf16 v[204:207], v[132:135], v[136:139], 0
v_mfma_f32_16x16x32_bf16 v[208:211], v[128:131], v[140:143], 0
v_mfma_f32_16x16x32_bf16 v[212:215], v[132:135], v[140:143], 0
v_pk_fma_f32 v[120:121], v[156:157], v[166:167], s[62:63] op_sel:[0,0,0] op_sel_hi:[1,0,1]
v_pk_fma_f32 v[24:25], v[148:149], v[24:25], v[120:121]
v_pk_fma_f32 v[124:125], v[24:25], s[60:61], s[60:61] op_sel:[0,0,1] op_sel_hi:[1,0,1]
v_max_f32 v24, s62, v24
v_exp_f32_e64 v124, v124 clamp
v_exp_f32_e64 v125, v125 clamp
v_max_f32 v25, s62, v25
v_pk_add_f32 v[24:25], v[24:25], v[124:125]
v_cvt_pk_bf16_f32 v128, v24, v25
v_pk_fma_f32 v[122:123], v[158:159], v[166:167], s[62:63] op_sel:[0,0,0] op_sel_hi:[1,0,1]
v_pk_fma_f32 v[26:27], v[150:151], v[26:27], v[122:123]
v_pk_fma_f32 v[126:127], v[26:27], s[60:61], s[60:61] op_sel:[0,0,1] op_sel_hi:[1,0,1]
v_max_f32 v26, s62, v26
v_exp_f32_e64 v126, v126 clamp
v_exp_f32_e64 v127, v127 clamp
v_max_f32 v27, s62, v27
v_pk_add_f32 v[26:27], v[26:27], v[126:127]
v_cvt_pk_bf16_f32 v129, v26, v27
v_pk_fma_f32 v[120:121], v[160:161], v[166:167], s[62:63] op_sel:[0,0,0] op_sel_hi:[1,0,1]
v_pk_fma_f32 v[72:73], v[152:153], v[72:73], v[120:121]
v_pk_fma_f32 v[124:125], v[72:73], s[60:61], s[60:61] op_sel:[0,0,1] op_sel_hi:[1,0,1]
v_max_f32 v72, s62, v72
v_exp_f32_e64 v124, v124 clamp
ds_write_b128 v232, v[200:203] offset:0
v_exp_f32_e64 v125, v125 clamp
v_max_f32 v73, s62, v73
v_pk_add_f32 v[72:73], v[72:73], v[124:125]
v_cvt_pk_bf16_f32 v130, v72, v73
v_pk_fma_f32 v[122:123], v[162:163], v[166:167], s[62:63] op_sel:[0,0,0] op_sel_hi:[1,0,1]
v_pk_fma_f32 v[74:75], v[154:155], v[74:75], v[122:123]
v_pk_fma_f32 v[126:127], v[74:75], s[60:61], s[60:61] op_sel:[0,0,1] op_sel_hi:[1,0,1]
v_max_f32 v74, s62, v74
v_exp_f32_e64 v126, v126 clamp
v_exp_f32_e64 v127, v127 clamp
v_max_f32 v75, s62, v75
v_pk_add_f32 v[74:75], v[74:75], v[126:127]
v_cvt_pk_bf16_f32 v131, v74, v75
v_pk_fma_f32 v[120:121], v[156:157], v[166:167], s[62:63] op_sel:[0,1,0] op_sel_hi:[1,1,1]
v_pk_fma_f32 v[28:29], v[148:149], v[28:29], v[120:121]
v_pk_fma_f32 v[124:125], v[28:29], s[60:61], s[60:61] op_sel:[0,0,1] op_sel_hi:[1,0,1]
v_max_f32 v28, s62, v28
v_exp_f32_e64 v124, v124 clamp
v_exp_f32_e64 v125, v125 clamp
v_max_f32 v29, s62, v29
v_pk_add_f32 v[28:29], v[28:29], v[124:125]
v_cvt_pk_bf16_f32 v132, v28, v29
ds_write_b128 v232, v[204:207] offset:1024
v_pk_fma_f32 v[122:123], v[158:159], v[166:167], s[62:63] op_sel:[0,1,0] op_sel_hi:[1,1,1]
v_pk_fma_f32 v[30:31], v[150:151], v[30:31], v[122:123]
v_pk_fma_f32 v[126:127], v[30:31], s[60:61], s[60:61] op_sel:[0,0,1] op_sel_hi:[1,0,1]
v_max_f32 v30, s62, v30
v_exp_f32_e64 v126, v126 clamp
v_exp_f32_e64 v127, v127 clamp
v_max_f32 v31, s62, v31
v_pk_add_f32 v[30:31], v[30:31], v[126:127]
v_cvt_pk_bf16_f32 v133, v30, v31
v_pk_fma_f32 v[120:121], v[160:161], v[166:167], s[62:63] op_sel:[0,1,0] op_sel_hi:[1,1,1]
v_pk_fma_f32 v[76:77], v[152:153], v[76:77], v[120:121]
v_pk_fma_f32 v[124:125], v[76:77], s[60:61], s[60:61] op_sel:[0,0,1] op_sel_hi:[1,0,1]
v_max_f32 v76, s62, v76
v_exp_f32_e64 v124, v124 clamp
v_exp_f32_e64 v125, v125 clamp
v_max_f32 v77, s62, v77
v_pk_add_f32 v[76:77], v[76:77], v[124:125]
v_cvt_pk_bf16_f32 v134, v76, v77
v_pk_fma_f32 v[122:123], v[162:163], v[166:167], s[62:63] op_sel:[0,1,0] op_sel_hi:[1,1,1]
v_pk_fma_f32 v[78:79], v[154:155], v[78:79], v[122:123]
v_pk_fma_f32 v[126:127], v[78:79], s[60:61], s[60:61] op_sel:[0,0,1] op_sel_hi:[1,0,1]
v_max_f32 v78, s62, v78
ds_write_b128 v232, v[208:211] offset:2048
v_exp_f32_e64 v126, v126 clamp
v_exp_f32_e64 v127, v127 clamp
v_max_f32 v79, s62, v79
v_pk_add_f32 v[78:79], v[78:79], v[126:127]
v_cvt_pk_bf16_f32 v135, v78, v79
v_pk_mul_f32 v[120:121], v[156:157], v[170:171] op_sel:[0,0] op_sel_hi:[1,0]
v_pk_fma_f32 v[40:41], v[148:149], v[40:41], v[120:121]
v_cvt_pk_bf16_f32 v136, v40, v41
v_pk_mul_f32 v[122:123], v[158:159], v[170:171] op_sel:[0,0] op_sel_hi:[1,0]
v_pk_fma_f32 v[42:43], v[150:151], v[42:43], v[122:123]
v_cvt_pk_bf16_f32 v137, v42, v43
v_pk_mul_f32 v[120:121], v[160:161], v[170:171] op_sel:[0,0] op_sel_hi:[1,0]
v_pk_fma_f32 v[88:89], v[152:153], v[88:89], v[120:121]
v_cvt_pk_bf16_f32 v138, v88, v89
v_pk_mul_f32 v[122:123], v[162:163], v[170:171] op_sel:[0,0] op_sel_hi:[1,0]
v_pk_fma_f32 v[90:91], v[154:155], v[90:91], v[122:123]
v_cvt_pk_bf16_f32 v139, v90, v91
v_pk_mul_f32 v[120:121], v[156:157], v[170:171] op_sel:[0,1] op_sel_hi:[1,1]
v_pk_fma_f32 v[44:45], v[148:149], v[44:45], v[120:121]
v_cvt_pk_bf16_f32 v140, v44, v45
v_pk_mul_f32 v[122:123], v[158:159], v[170:171] op_sel:[0,1] op_sel_hi:[1,1]
v_pk_fma_f32 v[46:47], v[150:151], v[46:47], v[122:123]
ds_write_b128 v232, v[212:215] offset:3072
v_cvt_pk_bf16_f32 v141, v46, v47
v_pk_mul_f32 v[120:121], v[160:161], v[170:171] op_sel:[0,1] op_sel_hi:[1,1]
v_pk_fma_f32 v[92:93], v[152:153], v[92:93], v[120:121]
v_cvt_pk_bf16_f32 v142, v92, v93
v_pk_mul_f32 v[122:123], v[162:163], v[170:171] op_sel:[0,1] op_sel_hi:[1,1]
v_pk_fma_f32 v[94:95], v[154:155], v[94:95], v[122:123]
v_cvt_pk_bf16_f32 v143, v94, v95
v_mfma_f32_16x16x32_bf16 v[216:219], v[128:131], v[136:139], 0
v_mfma_f32_16x16x32_bf16 v[220:223], v[132:135], v[136:139], 0
v_mfma_f32_16x16x32_bf16 v[224:227], v[128:131], v[140:143], 0
v_mfma_f32_16x16x32_bf16 v[228:231], v[132:135], v[140:143], 0
s_waitcnt vmcnt(17)
v_pk_add_f32 v[16:17], v[16:17], v[18:19]
v_pk_add_f32 v[64:65], v[64:65], v[66:67]
v_pk_add_f32 v[16:17], v[16:17], v[64:65]
v_add_f32 v144, v16, v17
v_pk_add_f32 v[20:21], v[20:21], v[22:23]
v_pk_add_f32 v[68:69], v[68:69], v[70:71]
v_pk_add_f32 v[20:21], v[20:21], v[68:69]
v_add_f32 v145, v20, v21
ds_write_b128 v232, v[216:219] offset:4096
v_pk_add_f32 v[24:25], v[24:25], v[26:27]
v_pk_add_f32 v[72:73], v[72:73], v[74:75]
v_pk_add_f32 v[24:25], v[24:25], v[72:73]
ds_write_b128 v232, v[220:223] offset:5120
v_add_f32 v146, v24, v25
v_pk_add_f32 v[28:29], v[28:29], v[30:31]
v_pk_add_f32 v[76:77], v[76:77], v[78:79]
ds_write_b128 v232, v[224:227] offset:6144
v_pk_add_f32 v[28:29], v[28:29], v[76:77]
v_add_f32 v147, v28, v29
v_permlane16_swap_b32 v144, v145
ds_write_b128 v232, v[228:231] offset:7168
v_permlane16_swap_b32 v146, v147
v_add_f32 v144, v144, v145
v_add_f32 v146, v146, v147
s_nop 1
v_permlane32_swap_b32 v144, v146
v_add_f32 v144, v144, v146
buffer_atomic_add_f32 v144, v234, s[8:11], s29 offen
s_waitcnt lgkmcnt(0)
s_barrier
ds_read2st64_b32 v[200:201], v233 offset0:0 offset1:1
ds_read2st64_b32 v[202:203], v233 offset0:2 offset1:3
ds_read2st64_b32 v[204:205], v233 offset0:4 offset1:5
ds_read2st64_b32 v[206:207], v233 offset0:6 offset1:7
ds_read2st64_b32 v[208:209], v233 offset0:32 offset1:33
ds_read2st64_b32 v[210:211], v233 offset0:34 offset1:35
ds_read2st64_b32 v[212:213], v233 offset0:36 offset1:37
ds_read2st64_b32 v[214:215], v233 offset0:38 offset1:39
ds_read2st64_b32 v[216:217], v233 offset0:64 offset1:65
ds_read2st64_b32 v[218:219], v233 offset0:66 offset1:67
ds_read2st64_b32 v[220:221], v233 offset0:68 offset1:69
ds_read2st64_b32 v[222:223], v233 offset0:70 offset1:71
ds_read2st64_b32 v[224:225], v233 offset0:96 offset1:97
ds_read2st64_b32 v[226:227], v233 offset0:98 offset1:99
ds_read2st64_b32 v[228:229], v233 offset0:100 offset1:101
ds_read2st64_b32 v[230:231], v233 offset0:102 offset1:103
v_and_b32 v115, 15, v97
v_lshlrev_b32 v115, 7, v115
v_lshrrev_b32 v117, 4, v97
v_lshlrev_b32 v117, 4, v117
v_add_u32 v117, 4096, v117
v_mov_b32 v118, s58
v_mov_b32 v148, 0x358637bd
v_mov_b32 v149, 0x358637bd
v_mov_b32 v150, 0x358637bd
v_mov_b32 v151, 0x358637bd
s_add_u32 s40, s36, 4352
s_waitcnt lgkmcnt(0)
v_pk_add_f32 v[200:201], v[200:201], v[208:209]
v_pk_add_f32 v[216:217], v[216:217], v[224:225]
v_pk_add_f32 v[202:203], v[202:203], v[210:211]
v_pk_add_f32 v[218:219], v[218:219], v[226:227]
v_pk_add_f32 v[204:205], v[204:205], v[212:213]
v_pk_add_f32 v[220:221], v[220:221], v[228:229]
v_pk_add_f32 v[206:207], v[206:207], v[214:215]
v_pk_add_f32 v[222:223], v[222:223], v[230:231]
v_pk_add_f32 v[128:129], v[200:201], v[216:217]
v_pk_add_f32 v[130:131], v[202:203], v[218:219]
v_pk_add_f32 v[132:133], v[204:205], v[220:221]
v_pk_add_f32 v[134:135], v[206:207], v[222:223]
ds_read_b64_tr_b16 v[188:189], v110 offset:49152
ds_read_b64_tr_b16 v[190:191], v110 offset:51200
ds_read_b64_tr_b16 v[192:193], v110 offset:53248
ds_read_b64_tr_b16 v[194:195], v110 offset:55296
ds_read_b64_tr_b16 v[196:197], v110 offset:57344
ds_read_b64_tr_b16 v[198:199], v110 offset:59392
ds_read_b64_tr_b16 v[200:201], v110 offset:61440
ds_read_b64_tr_b16 v[202:203], v110 offset:63488
ds_read_b64_tr_b16 v[204:205], v111 offset:49152
ds_read_b64_tr_b16 v[206:207], v111 offset:51200
ds_read_b64_tr_b16 v[208:209], v111 offset:53248
ds_read_b64_tr_b16 v[210:211], v111 offset:55296
ds_read_b64_tr_b16 v[212:213], v111 offset:57344
ds_read_b64_tr_b16 v[214:215], v111 offset:59392
ds_read_b64_tr_b16 v[216:217], v111 offset:61440
ds_read_b64_tr_b16 v[218:219], v111 offset:63488
buffer_atomic_add_f32 v128, v235, s[8:11], s26 offen offset:0
buffer_atomic_add_f32 v129, v235, s[8:11], s26 offen offset:256
buffer_atomic_add_f32 v130, v235, s[8:11], s26 offen offset:512
buffer_atomic_add_f32 v131, v235, s[8:11], s26 offen offset:768
buffer_atomic_add_f32 v132, v235, s[8:11], s26 offen offset:1024
buffer_atomic_add_f32 v133, v235, s[8:11], s26 offen offset:1280
buffer_atomic_add_f32 v134, v235, s[8:11], s26 offen offset:1536
buffer_atomic_add_f32 v135, v235, s[8:11], s26 offen offset:1792
s_waitcnt lgkmcnt(14)
ds_read_b64_tr_b16 v[220:221], v112 offset:49152
v_mfma_f32_16x16x32_bf16 v[0:3], v[188:191], a[0:3], 0
s_waitcnt lgkmcnt(13)
ds_read_b64_tr_b16 v[222:223], v112 offset:51200
v_mfma_f32_16x16x32_bf16 v[0:3], v[192:195], a[8:11], v[0:3]
s_waitcnt lgkmcnt(12)
ds_read_b64_tr_b16 v[224:225], v112 offset:53248
v_mfma_f32_16x16x32_bf16 v[0:3], v[196:199], a[16:19], v[0:3]
s_waitcnt lgkmcnt(11)
ds_read_b64_tr_b16 v[226:227], v112 offset:55296
v_mfma_f32_16x16x32_bf16 v[0:3], v[200:203], a[24:27], v[0:3]
ds_read_b64_tr_b16 v[228:229], v112 offset:57344
v_mfma_f32_16x16x32_bf16 v[48:51], v[200:203], a[28:31], 0
ds_read_b64_tr_b16 v[230:231], v112 offset:59392
v_mfma_f32_16x16x32_bf16 v[48:51], v[196:199], a[20:23], v[48:51]
ds_read_b64_tr_b16 v[232:233], v112 offset:61440
ds_read_b64_tr_b16 v[234:235], v112 offset:63488
v_mfma_f32_16x16x32_bf16 v[48:51], v[192:195], a[12:15], v[48:51]
ds_read_b64_tr_b16 v[236:237], v113 offset:49152
ds_read_b64_tr_b16 v[238:239], v113 offset:51200
v_mfma_f32_16x16x32_bf16 v[48:51], v[188:191], a[4:7], v[48:51]
s_waitcnt vmcnt(22)
s_barrier
s_waitcnt lgkmcnt(15)
buffer_load_dwordx4 v98, s[12:15], s4 offen offset:0 lds
ds_read_b64_tr_b16 v[240:241], v113 offset:53248
v_mfma_f32_16x16x32_bf16 v[52:55], v[204:207], a[4:7], 0
s_waitcnt lgkmcnt(15)
ds_read_b64_tr_b16 v[242:243], v113 offset:55296
ds_read_b64_tr_b16 v[244:245], v113 offset:57344
v_mfma_f32_16x16x32_bf16 v[52:55], v[208:211], a[12:15], v[52:55]
s_waitcnt lgkmcnt(12)
ds_read_b64_tr_b16 v[246:247], v113 offset:59392
ds_read_b64_tr_b16 v[248:249], v113 offset:61440
v_mfma_f32_16x16x32_bf16 v[52:55], v[212:215], a[20:23], v[52:55]
ds_read_b64_tr_b16 v[250:251], v113 offset:63488
ds_read_b64_tr_b16 v[188:189], v252 offset:0
v_mfma_f32_16x16x32_bf16 v[52:55], v[216:219], a[28:31], v[52:55]
buffer_load_dwordx4 v98, s[12:15], s5 offen offset:1024 lds
ds_read_b64_tr_b16 v[190:191], v252 offset:2048
v_mfma_f32_16x16x32_bf16 v[4:7], v[216:219], a[24:27], 0
ds_read_b64_tr_b16 v[192:193], v252 offset:4096
v_mfma_f32_16x16x32_bf16 v[4:7], v[212:215], a[16:19], v[4:7]
ds_read_b64_tr_b16 v[194:195], v252 offset:6144
ds_read_b64_tr_b16 v[196:197], v252 offset:8192
v_mfma_f32_16x16x32_bf16 v[4:7], v[208:211], a[8:11], v[4:7]
ds_read_b64_tr_b16 v[198:199], v252 offset:10240
ds_read_b64_tr_b16 v[200:201], v252 offset:12288
v_mfma_f32_16x16x32_bf16 v[4:7], v[204:207], a[0:3], v[4:7]
s_waitcnt lgkmcnt(15)
ds_read_b64_tr_b16 v[202:203], v252 offset:14336
ds_read_b64_tr_b16 v[204:205], v253 offset:0
v_mfma_f32_16x16x32_bf16 v[8:11], v[220:223], a[0:3], 0
buffer_load_dwordx4 v98, s[12:15], s6 offen offset:2048 lds
ds_read_b64_tr_b16 v[206:207], v253 offset:2048
v_mfma_f32_16x16x32_bf16 v[8:11], v[224:227], a[8:11], v[8:11]
ds_read_b64_tr_b16 v[208:209], v253 offset:4096
v_mfma_f32_16x16x32_bf16 v[8:11], v[228:231], a[16:19], v[8:11]
ds_read_b64_tr_b16 v[210:211], v253 offset:6144
v_mfma_f32_16x16x32_bf16 v[8:11], v[232:235], a[24:27], v[8:11]
ds_read_b64_tr_b16 v[212:213], v253 offset:8192
v_mfma_f32_16x16x32_bf16 v[56:59], v[232:235], a[28:31], 0
buffer_load_dwordx4 v98, s[12:15], s7 offen offset:3072 lds
ds_read_b64_tr_b16 v[214:215], v253 offset:10240
v_add_u32 v98, 0xc0000, v98
v_mfma_f32_16x16x32_bf16 v[56:59], v[228:231], a[20:23], v[56:59]
s_add_u32 m0, s24, 0x10000
ds_read_b64_tr_b16 v[216:217], v253 offset:12288
ds_read_b64_tr_b16 v[218:219], v253 offset:14336
v_mfma_f32_16x16x32_bf16 v[56:59], v[224:227], a[12:15], v[56:59]
v_mfma_f32_16x16x32_bf16 v[56:59], v[220:223], a[4:7], v[56:59]
s_waitcnt lgkmcnt(11)
ds_read_b64_tr_b16 v[220:221], v254 offset:0
v_mfma_f32_16x16x32_bf16 v[60:63], v[236:239], a[4:7], 0
ds_read_b64_tr_b16 v[222:223], v254 offset:2048
v_mfma_f32_16x16x32_bf16 v[60:63], v[240:243], a[12:15], v[60:63]
buffer_load_dwordx4 v98, s[12:15], s4 offen offset:0 lds
ds_read_b64_tr_b16 v[224:225], v254 offset:4096
v_mfma_f32_16x16x32_bf16 v[60:63], v[244:247], a[20:23], v[60:63]
ds_read_b64_tr_b16 v[226:227], v254 offset:6144
v_mfma_f32_16x16x32_bf16 v[60:63], v[248:251], a[28:31], v[60:63]
ds_read_b64_tr_b16 v[228:229], v254 offset:8192
v_mfma_f32_16x16x32_bf16 v[12:15], v[248:251], a[24:27], 0
ds_read_b64_tr_b16 v[230:231], v254 offset:10240
v_mfma_f32_16x16x32_bf16 v[12:15], v[244:247], a[16:19], v[12:15]
buffer_load_dwordx4 v98, s[12:15], s5 offen offset:1024 lds
ds_read_b64_tr_b16 v[232:233], v254 offset:12288
v_mfma_f32_16x16x32_bf16 v[12:15], v[240:243], a[8:11], v[12:15]
ds_read_b64_tr_b16 v[234:235], v254 offset:14336
v_mfma_f32_16x16x32_bf16 v[12:15], v[236:239], a[0:3], v[12:15]
ds_read_b64_tr_b16 v[236:237], v255 offset:0
v_mfma_f32_16x16x32_bf16 v[0:3], v[188:191], a[32:35], v[0:3]
ds_read_b64_tr_b16 v[238:239], v255 offset:2048
v_mfma_f32_16x16x32_bf16 v[0:3], v[192:195], a[40:43], v[0:3]
s_waitcnt lgkmcnt(9)
ds_read_b64_tr_b16 v[240:241], v255 offset:4096
v_mfma_f32_16x16x32_bf16 v[0:3], v[196:199], a[48:51], v[0:3]
buffer_load_dwordx4 v98, s[12:15], s6 offen offset:2048 lds
ds_read_b64_tr_b16 v[242:243], v255 offset:6144
v_mfma_f32_16x16x32_bf16 v[0:3], v[200:203], a[56:59], v[0:3]
ds_read_b64_tr_b16 v[244:245], v255 offset:8192
v_mfma_f32_16x16x32_bf16 v[48:51], v[200:203], a[60:63], v[48:51]
ds_read_b64_tr_b16 v[246:247], v255 offset:10240
v_mfma_f32_16x16x32_bf16 v[48:51], v[196:199], a[52:55], v[48:51]
ds_read_b64_tr_b16 v[248:249], v255 offset:12288
ds_read_b64_tr_b16 v[250:251], v255 offset:14336
v_mfma_f32_16x16x32_bf16 v[48:51], v[192:195], a[44:47], v[48:51]
buffer_load_dwordx4 v98, s[12:15], s7 offen offset:3072 lds
v_add_u32 v98, 0xc0000, v98
v_mfma_f32_16x16x32_bf16 v[48:51], v[188:191], a[36:39], v[48:51]
s_waitcnt vmcnt(26)
s_barrier
s_add_u32 m0, s24, 0x14000
ds_read_b64_tr_b16 v[188:189], v106 offset:0
v_mfma_f32_16x16x32_bf16 v[52:55], v[204:207], a[36:39], v[52:55]
ds_read_b64_tr_b16 v[190:191], v106 offset:2048
v_mfma_f32_16x16x32_bf16 v[52:55], v[208:211], a[44:47], v[52:55]
ds_read_b64_tr_b16 v[192:193], v106 offset:4096
v_mfma_f32_16x16x32_bf16 v[52:55], v[212:215], a[52:55], v[52:55]
ds_read_b64_tr_b16 v[194:195], v106 offset:6144
v_mfma_f32_16x16x32_bf16 v[52:55], v[216:219], a[60:63], v[52:55]
buffer_load_dwordx4 v98, s[12:15], s4 offen offset:0 lds
ds_read_b64_tr_b16 v[196:197], v106 offset:8192
v_mfma_f32_16x16x32_bf16 v[4:7], v[216:219], a[56:59], v[4:7]
ds_read_b64_tr_b16 v[198:199], v106 offset:10240
v_mfma_f32_16x16x32_bf16 v[4:7], v[212:215], a[48:51], v[4:7]
ds_read_b64_tr_b16 v[200:201], v106 offset:12288
ds_read_b64_tr_b16 v[202:203], v106 offset:14336
v_mfma_f32_16x16x32_bf16 v[4:7], v[208:211], a[40:43], v[4:7]
v_mfma_f32_16x16x32_bf16 v[4:7], v[204:207], a[32:35], v[4:7]
s_waitcnt lgkmcnt(8)
buffer_load_dwordx4 v98, s[12:15], s5 offen offset:1024 lds
ds_read_b64_tr_b16 v[204:205], v107 offset:0
v_mfma_f32_16x16x32_bf16 v[8:11], v[220:223], a[32:35], v[8:11]
ds_read_b64_tr_b16 v[206:207], v107 offset:2048
v_mfma_f32_16x16x32_bf16 v[8:11], v[224:227], a[40:43], v[8:11]
ds_read_b64_tr_b16 v[208:209], v107 offset:4096
v_mfma_f32_16x16x32_bf16 v[8:11], v[228:231], a[48:51], v[8:11]
ds_read_b64_tr_b16 v[210:211], v107 offset:6144
v_mfma_f32_16x16x32_bf16 v[8:11], v[232:235], a[56:59], v[8:11]
ds_read_b64_tr_b16 v[212:213], v107 offset:8192
v_mfma_f32_16x16x32_bf16 v[56:59], v[232:235], a[60:63], v[56:59]
buffer_load_dwordx4 v98, s[12:15], s6 offen offset:2048 lds
ds_read_b64_tr_b16 v[214:215], v107 offset:10240
v_mfma_f32_16x16x32_bf16 v[56:59], v[228:231], a[52:55], v[56:59]
ds_read_b64_tr_b16 v[216:217], v107 offset:12288
ds_read_b64_tr_b16 v[218:219], v107 offset:14336
v_mfma_f32_16x16x32_bf16 v[56:59], v[224:227], a[44:47], v[56:59]
v_mfma_f32_16x16x32_bf16 v[56:59], v[220:223], a[36:39], v[56:59]
ds_read_b64_tr_b16 v[220:221], v108 offset:0
v_mfma_f32_16x16x32_bf16 v[60:63], v[236:239], a[36:39], v[60:63]
buffer_load_dwordx4 v98, s[12:15], s7 offen offset:3072 lds
ds_read_b64_tr_b16 v[222:223], v108 offset:2048
v_mfma_f32_16x16x32_bf16 v[60:63], v[240:243], a[44:47], v[60:63]
ds_read_b64_tr_b16 v[224:225], v108 offset:4096
v_mfma_f32_16x16x32_bf16 v[60:63], v[244:247], a[52:55], v[60:63]
ds_read_b64_tr_b16 v[226:227], v108 offset:6144
v_mfma_f32_16x16x32_bf16 v[60:63], v[248:251], a[60:63], v[60:63]
ds_read_b64_tr_b16 v[228:229], v108 offset:8192
v_mfma_f32_16x16x32_bf16 v[12:15], v[248:251], a[56:59], v[12:15]
ds_read_b64_tr_b16 v[230:231], v108 offset:10240
v_mfma_f32_16x16x32_bf16 v[12:15], v[244:247], a[48:51], v[12:15]
ds_read_b64_tr_b16 v[232:233], v108 offset:12288
ds_read_b64_tr_b16 v[234:235], v108 offset:14336
v_mfma_f32_16x16x32_bf16 v[12:15], v[240:243], a[40:43], v[12:15]
v_mfma_f32_16x16x32_bf16 v[12:15], v[236:239], a[32:35], v[12:15]
s_waitcnt lgkmcnt(8)
s_bfe_u32 s28, s2, 0x10002
ds_read_b64_tr_b16 v[236:237], v109 offset:0
v_lshrrev_b32 v136, 3, v97
v_mul_u32_u24 v136, 2048, v136
v_bfe_u32 v137, v97, 4, 2
v_lshlrev_b32 v137, 1, v137
v_and_b32 v138, 7, v97
v_xor_b32 v137, v137, v138
v_lshl_add_u32 v98, v137, 4, v136
v_mfma_f32_16x16x32_bf16 v[0:3], v[188:191], a[64:67], v[0:3]
s_lshl_b32 s28, s28, 2
ds_read_b64_tr_b16 v[238:239], v109 offset:2048
v_mfma_f32_16x16x32_bf16 v[0:3], v[192:195], a[72:75], v[0:3]
s_lshr_b32 s29, s2, 6
ds_read_b64_tr_b16 v[240:241], v109 offset:4096
v_mfma_f32_16x16x32_bf16 v[0:3], v[196:199], a[80:83], v[0:3]
s_add_u32 s28, s28, s29
ds_read_b64_tr_b16 v[242:243], v109 offset:6144
v_mfma_f32_16x16x32_bf16 v[0:3], v[200:203], a[88:91], v[0:3]
s_lshl_b32 s28, s28, 8
ds_read_b64_tr_b16 v[244:245], v109 offset:8192
v_mfma_f32_16x16x32_bf16 v[48:51], v[200:203], a[92:95], v[48:51]
s_lshl_b32 s29, s20, 16
ds_read_b64_tr_b16 v[246:247], v109 offset:10240
v_mfma_f32_16x16x32_bf16 v[48:51], v[196:199], a[84:87], v[48:51]
s_add_u32 s28, s28, s29
ds_read_b64_tr_b16 v[248:249], v109 offset:12288
ds_read_b64_tr_b16 v[250:251], v109 offset:14336
v_mfma_f32_16x16x32_bf16 v[48:51], v[192:195], a[76:79], v[48:51]
s_mov_b32 s12, s44
v_mfma_f32_16x16x32_bf16 v[48:51], v[188:191], a[68:71], v[48:51]
s_waitcnt vmcnt(25)
s_barrier
s_and_b32 s13, s45, 0xffff
ds_read_b64_tr_b16 v[188:189], v106 offset:16384
v_mfma_f32_16x16x32_bf16 v[52:55], v[204:207], a[68:71], v[52:55]
s_mov_b32 s14, 0x200000
ds_read_b64_tr_b16 v[190:191], v106 offset:18432
v_mfma_f32_16x16x32_bf16 v[52:55], v[208:211], a[76:79], v[52:55]
s_mov_b32 s15, 0x20000
ds_read_b64_tr_b16 v[192:193], v106 offset:20480
v_mfma_f32_16x16x32_bf16 v[52:55], v[212:215], a[84:87], v[52:55]
s_add_u32 s12, s12, s28
ds_read_b64_tr_b16 v[194:195], v106 offset:22528
v_mfma_f32_16x16x32_bf16 v[52:55], v[216:219], a[92:95], v[52:55]
s_addc_u32 s13, s13, 0
ds_read_b64_tr_b16 v[196:197], v106 offset:24576
v_mfma_f32_16x16x32_bf16 v[4:7], v[216:219], a[88:91], v[4:7]
s_sub_u32 s14, s14, s28
ds_read_b64_tr_b16 v[198:199], v106 offset:26624
v_mfma_f32_16x16x32_bf16 v[4:7], v[212:215], a[80:83], v[4:7]
s_mov_b32 s32, 0
ds_read_b64_tr_b16 v[200:201], v106 offset:28672
ds_read_b64_tr_b16 v[202:203], v106 offset:30720
v_mfma_f32_16x16x32_bf16 v[4:7], v[208:211], a[72:75], v[4:7]
s_mov_b32 s33, 15360
v_mfma_f32_16x16x32_bf16 v[4:7], v[204:207], a[64:67], v[4:7]
s_waitcnt lgkmcnt(8)
s_mov_b32 s34, 30720
ds_read_b64_tr_b16 v[204:205], v107 offset:16384
v_mfma_f32_16x16x32_bf16 v[8:11], v[220:223], a[64:67], v[8:11]
s_mov_b32 s35, 46080
ds_read_b64_tr_b16 v[206:207], v107 offset:18432
v_mfma_f32_16x16x32_bf16 v[8:11], v[224:227], a[72:75], v[8:11]
s_add_u32 m0, s24, 0x18000
ds_read_b64_tr_b16 v[208:209], v107 offset:20480
v_mfma_f32_16x16x32_bf16 v[8:11], v[228:231], a[80:83], v[8:11]
ds_read_b64_tr_b16 v[210:211], v107 offset:22528
v_mfma_f32_16x16x32_bf16 v[8:11], v[232:235], a[88:91], v[8:11]
buffer_load_dwordx4 v98, s[12:15], s32 offen offset:0 lds
ds_read_b64_tr_b16 v[212:213], v107 offset:24576
v_mfma_f32_16x16x32_bf16 v[56:59], v[232:235], a[92:95], v[56:59]
ds_read_b64_tr_b16 v[214:215], v107 offset:26624
v_mfma_f32_16x16x32_bf16 v[56:59], v[228:231], a[84:87], v[56:59]
ds_read_b64_tr_b16 v[216:217], v107 offset:28672
ds_read_b64_tr_b16 v[218:219], v107 offset:30720
v_mfma_f32_16x16x32_bf16 v[56:59], v[224:227], a[76:79], v[56:59]
v_mfma_f32_16x16x32_bf16 v[56:59], v[220:223], a[68:71], v[56:59]
buffer_load_dwordx4 v98, s[12:15], s33 offen offset:1024 lds
ds_read_b64_tr_b16 v[220:221], v108 offset:16384
v_mfma_f32_16x16x32_bf16 v[60:63], v[236:239], a[68:71], v[60:63]
ds_read_b64_tr_b16 v[222:223], v108 offset:18432
v_mfma_f32_16x16x32_bf16 v[60:63], v[240:243], a[76:79], v[60:63]
ds_read_b64_tr_b16 v[224:225], v108 offset:20480
v_mfma_f32_16x16x32_bf16 v[60:63], v[244:247], a[84:87], v[60:63]
ds_read_b64_tr_b16 v[226:227], v108 offset:22528
v_mfma_f32_16x16x32_bf16 v[60:63], v[248:251], a[92:95], v[60:63]
ds_read_b64_tr_b16 v[228:229], v108 offset:24576
v_mfma_f32_16x16x32_bf16 v[12:15], v[248:251], a[88:91], v[12:15]
buffer_load_dwordx4 v98, s[12:15], s34 offen offset:2048 lds
ds_read_b64_tr_b16 v[230:231], v108 offset:26624
v_mfma_f32_16x16x32_bf16 v[12:15], v[244:247], a[80:83], v[12:15]
ds_read_b64_tr_b16 v[232:233], v108 offset:28672
ds_read_b64_tr_b16 v[234:235], v108 offset:30720
v_mfma_f32_16x16x32_bf16 v[12:15], v[240:243], a[72:75], v[12:15]
v_mfma_f32_16x16x32_bf16 v[12:15], v[236:239], a[64:67], v[12:15]
s_waitcnt lgkmcnt(8)
ds_read_b64_tr_b16 v[236:237], v109 offset:16384
v_mfma_f32_16x16x32_bf16 v[0:3], v[188:191], a[96:99], v[0:3]
buffer_load_dwordx4 v98, s[12:15], s35 offen offset:3072 lds
ds_read_b64_tr_b16 v[238:239], v109 offset:18432
v_add_u32 v98, 0x40000, v98
v_mfma_f32_16x16x32_bf16 v[0:3], v[192:195], a[104:107], v[0:3]
s_add_u32 m0, s24, 0x1c000
ds_read_b64_tr_b16 v[240:241], v109 offset:20480
v_mfma_f32_16x16x32_bf16 v[0:3], v[196:199], a[112:115], v[0:3]
ds_read_b64_tr_b16 v[242:243], v109 offset:22528
v_mfma_f32_16x16x32_bf16 v[0:3], v[200:203], a[120:123], v[0:3]
ds_read_b64_tr_b16 v[244:245], v109 offset:24576
v_mfma_f32_16x16x32_bf16 v[48:51], v[200:203], a[124:127], v[48:51]
ds_read_b64_tr_b16 v[246:247], v109 offset:26624
v_mfma_f32_16x16x32_bf16 v[48:51], v[196:199], a[116:119], v[48:51]
buffer_load_dwordx4 v98, s[12:15], s32 offen offset:0 lds
ds_read_b64_tr_b16 v[248:249], v109 offset:28672
v_mfma_f32_16x16x32_bf16 v[48:51], v[192:195], a[108:111], v[48:51]
s_waitcnt vmcnt(17)
ds_read_b64_tr_b16 v[250:251], v109 offset:30720
v_mfma_f32_16x16x32_bf16 v[48:51], v[188:191], a[100:103], v[48:51]
s_barrier
s_cmp_lg_u32 s20, 3
s_cbranch_scc1 L_kv_ns
s_mov_b64 exec, 1
buffer_store_dword v118, off, s[8:11], s100 sc1
s_mov_b64 exec, -1
L_kv_ns:
s_mov_b32 s100, s99
ds_read_b64_tr_b16 v[188:189], v106 offset:32768
v_mfma_f32_16x16x32_bf16 v[52:55], v[204:207], a[100:103], v[52:55]
ds_read_b64_tr_b16 v[190:191], v106 offset:34816
v_mfma_f32_16x16x32_bf16 v[52:55], v[208:211], a[108:111], v[52:55]
buffer_load_dwordx4 v98, s[12:15], s33 offen offset:1024 lds
ds_read_b64_tr_b16 v[192:193], v106 offset:36864
v_mfma_f32_16x16x32_bf16 v[52:55], v[212:215], a[116:119], v[52:55]
ds_read_b64_tr_b16 v[194:195], v106 offset:38912
v_mfma_f32_16x16x32_bf16 v[52:55], v[216:219], a[124:127], v[52:55]
ds_read_b64_tr_b16 v[196:197], v106 offset:40960
v_mfma_f32_16x16x32_bf16 v[4:7], v[216:219], a[120:123], v[4:7]
ds_read_b64_tr_b16 v[198:199], v106 offset:43008
v_mfma_f32_16x16x32_bf16 v[4:7], v[212:215], a[112:115], v[4:7]
ds_read_b64_tr_b16 v[200:201], v106 offset:45056
ds_read_b64_tr_b16 v[202:203], v106 offset:47104
v_mfma_f32_16x16x32_bf16 v[4:7], v[208:211], a[104:107], v[4:7]
buffer_load_dwordx4 v98, s[12:15], s34 offen offset:2048 lds
v_mfma_f32_16x16x32_bf16 v[4:7], v[204:207], a[96:99], v[4:7]
s_waitcnt lgkmcnt(9)
ds_read_b64_tr_b16 v[204:205], v107 offset:32768
v_mfma_f32_16x16x32_bf16 v[8:11], v[220:223], a[96:99], v[8:11]
ds_read_b64_tr_b16 v[206:207], v107 offset:34816
v_mfma_f32_16x16x32_bf16 v[8:11], v[224:227], a[104:107], v[8:11]
ds_read_b64_tr_b16 v[208:209], v107 offset:36864
v_mfma_f32_16x16x32_bf16 v[8:11], v[228:231], a[112:115], v[8:11]
buffer_load_dword v96, v99, s[16:19], s97 offen
ds_read_b64_tr_b16 v[210:211], v107 offset:38912
v_mfma_f32_16x16x32_bf16 v[8:11], v[232:235], a[120:123], v[8:11]
s_add_u32 s97, s97, 229376
ds_read_b64_tr_b16 v[212:213], v107 offset:40960
v_mfma_f32_16x16x32_bf16 v[56:59], v[232:235], a[124:127], v[56:59]
ds_read_b64_tr_b16 v[214:215], v107 offset:43008
v_mfma_f32_16x16x32_bf16 v[56:59], v[228:231], a[116:119], v[56:59]
ds_read_b64_tr_b16 v[216:217], v107 offset:45056
ds_read_b64_tr_b16 v[218:219], v107 offset:47104
v_mfma_f32_16x16x32_bf16 v[56:59], v[224:227], a[108:111], v[56:59]
v_mfma_f32_16x16x32_bf16 v[56:59], v[220:223], a[100:103], v[56:59]
buffer_load_dwordx4 v98, s[12:15], s35 offen offset:3072 lds
ds_read_b64_tr_b16 v[220:221], v108 offset:32768
v_add_u32 v98, 0x40000, v98
v_mfma_f32_16x16x32_bf16 v[60:63], v[236:239], a[100:103], v[60:63]
s_add_u32 m0, s24, 0x20000
ds_read_b64_tr_b16 v[222:223], v108 offset:34816
v_mfma_f32_16x16x32_bf16 v[60:63], v[240:243], a[108:111], v[60:63]
ds_read_b64_tr_b16 v[224:225], v108 offset:36864
v_mfma_f32_16x16x32_bf16 v[60:63], v[244:247], a[116:119], v[60:63]
s_waitcnt lgkmcnt(9)
ds_read_b64_tr_b16 v[226:227], v108 offset:38912
v_mfma_f32_16x16x32_bf16 v[60:63], v[248:251], a[124:127], v[60:63]
buffer_load_dwordx4 v98, s[12:15], s32 offen offset:0 lds
ds_read_b64_tr_b16 v[228:229], v108 offset:40960
v_mfma_f32_16x16x32_bf16 v[12:15], v[248:251], a[120:123], v[12:15]
ds_read_b64_tr_b16 v[230:231], v108 offset:43008
v_mfma_f32_16x16x32_bf16 v[12:15], v[244:247], a[112:115], v[12:15]
ds_read_b64_tr_b16 v[232:233], v108 offset:45056
ds_read_b64_tr_b16 v[234:235], v108 offset:47104
v_mfma_f32_16x16x32_bf16 v[12:15], v[240:243], a[104:107], v[12:15]
v_mfma_f32_16x16x32_bf16 v[12:15], v[236:239], a[96:99], v[12:15]
ds_read_b64_tr_b16 v[236:237], v109 offset:32768
v_mfma_f32_16x16x32_bf16 v[0:3], v[188:191], a[128:131], v[0:3]
buffer_load_dwordx4 v98, s[12:15], s33 offen offset:1024 lds
ds_read_b64_tr_b16 v[238:239], v109 offset:34816
v_mfma_f32_16x16x32_bf16 v[0:3], v[192:195], a[136:139], v[0:3]
ds_read_b64_tr_b16 v[240:241], v109 offset:36864
v_mfma_f32_16x16x32_bf16 v[0:3], v[196:199], a[144:147], v[0:3]
ds_read_b64_tr_b16 v[242:243], v109 offset:38912
v_mfma_f32_16x16x32_bf16 v[0:3], v[200:203], a[152:155], v[0:3]
ds_read_b64_tr_b16 v[244:245], v109 offset:40960
v_mfma_f32_16x16x32_bf16 v[48:51], v[200:203], a[156:159], v[48:51]
buffer_load_dwordx4 v98, s[12:15], s34 offen offset:2048 lds
ds_read_b64_tr_b16 v[246:247], v109 offset:43008
v_mfma_f32_16x16x32_bf16 v[48:51], v[196:199], a[148:151], v[48:51]
ds_read_b64_tr_b16 v[248:249], v109 offset:45056
ds_read_b64_tr_b16 v[250:251], v109 offset:47104
v_mfma_f32_16x16x32_bf16 v[48:51], v[192:195], a[140:143], v[48:51]
v_mfma_f32_16x16x32_bf16 v[48:51], v[188:191], a[132:135], v[48:51]
s_waitcnt vmcnt(20)
s_barrier
ds_read_b64_tr_b16 v[188:189], v106 offset:49152
v_mfma_f32_16x16x32_bf16 v[52:55], v[204:207], a[132:135], v[52:55]
s_waitcnt lgkmcnt(9)
ds_read_b64_tr_b16 v[190:191], v106 offset:51200
v_mfma_f32_16x16x32_bf16 v[52:55], v[208:211], a[140:143], v[52:55]
buffer_load_dwordx4 v98, s[12:15], s35 offen offset:3072 lds
ds_read_b64_tr_b16 v[192:193], v106 offset:53248
v_add_u32 v98, 0x40000, v98
v_mfma_f32_16x16x32_bf16 v[52:55], v[212:215], a[148:151], v[52:55]
s_add_u32 m0, s24, 0x0
ds_read_b64_tr_b16 v[194:195], v106 offset:55296
v_mfma_f32_16x16x32_bf16 v[52:55], v[216:219], a[156:159], v[52:55]
ds_read_b64_tr_b16 v[196:197], v106 offset:57344
v_mfma_f32_16x16x32_bf16 v[4:7], v[216:219], a[152:155], v[4:7]
ds_read_b64_tr_b16 v[198:199], v106 offset:59392
v_mfma_f32_16x16x32_bf16 v[4:7], v[212:215], a[144:147], v[4:7]
buffer_load_dwordx4 v98, s[12:15], s32 offen offset:0 lds
ds_read_b64_tr_b16 v[200:201], v106 offset:61440
v_mfma_f32_16x16x32_bf16 v[4:7], v[208:211], a[136:139], v[4:7]
ds_read_b64_tr_b16 v[202:203], v106 offset:63488
v_mfma_f32_16x16x32_bf16 v[4:7], v[204:207], a[128:131], v[4:7]
ds_read_b64_tr_b16 v[204:205], v107 offset:49152
v_mfma_f32_16x16x32_bf16 v[8:11], v[220:223], a[128:131], v[8:11]
ds_read_b64_tr_b16 v[206:207], v107 offset:51200
v_mfma_f32_16x16x32_bf16 v[8:11], v[224:227], a[136:139], v[8:11]
ds_read_b64_tr_b16 v[208:209], v107 offset:53248
v_mfma_f32_16x16x32_bf16 v[8:11], v[228:231], a[144:147], v[8:11]
buffer_load_dwordx4 v98, s[12:15], s33 offen offset:1024 lds
ds_read_b64_tr_b16 v[210:211], v107 offset:55296
v_mfma_f32_16x16x32_bf16 v[8:11], v[232:235], a[152:155], v[8:11]
ds_read_b64_tr_b16 v[212:213], v107 offset:57344
v_mfma_f32_16x16x32_bf16 v[56:59], v[232:235], a[156:159], v[56:59]
ds_read_b64_tr_b16 v[214:215], v107 offset:59392
v_mfma_f32_16x16x32_bf16 v[56:59], v[228:231], a[148:151], v[56:59]
ds_read_b64_tr_b16 v[216:217], v107 offset:61440
ds_read_b64_tr_b16 v[218:219], v107 offset:63488
v_mfma_f32_16x16x32_bf16 v[56:59], v[224:227], a[140:143], v[56:59]
buffer_load_dwordx4 v98, s[12:15], s34 offen offset:2048 lds
v_mfma_f32_16x16x32_bf16 v[56:59], v[220:223], a[132:135], v[56:59]
s_waitcnt lgkmcnt(9)
ds_read_b64_tr_b16 v[220:221], v108 offset:49152
v_mfma_f32_16x16x32_bf16 v[60:63], v[236:239], a[132:135], v[60:63]
ds_read_b64_tr_b16 v[222:223], v108 offset:51200
v_mfma_f32_16x16x32_bf16 v[60:63], v[240:243], a[140:143], v[60:63]
ds_read_b64_tr_b16 v[224:225], v108 offset:53248
v_mfma_f32_16x16x32_bf16 v[60:63], v[244:247], a[148:151], v[60:63]
ds_read_b64_tr_b16 v[226:227], v108 offset:55296
v_mfma_f32_16x16x32_bf16 v[60:63], v[248:251], a[156:159], v[60:63]
buffer_load_dwordx4 v98, s[12:15], s35 offen offset:3072 lds
ds_read_b64_tr_b16 v[228:229], v108 offset:57344
v_add_u32 v98, 0x40000, v98
v_mfma_f32_16x16x32_bf16 v[12:15], v[248:251], a[152:155], v[12:15]
s_add_u32 m0, s24, 0x4000
ds_read_b64_tr_b16 v[230:231], v108 offset:59392
v_mfma_f32_16x16x32_bf16 v[12:15], v[244:247], a[144:147], v[12:15]
ds_read_b64_tr_b16 v[232:233], v108 offset:61440
ds_read_b64_tr_b16 v[234:235], v108 offset:63488
v_mfma_f32_16x16x32_bf16 v[12:15], v[240:243], a[136:139], v[12:15]
v_mfma_f32_16x16x32_bf16 v[12:15], v[236:239], a[128:131], v[12:15]
buffer_load_dwordx4 v98, s[12:15], s32 offen offset:0 lds
ds_read_b64_tr_b16 v[236:237], v109 offset:49152
v_mfma_f32_16x16x32_bf16 v[0:3], v[188:191], a[160:163], v[0:3]
ds_read_b64_tr_b16 v[238:239], v109 offset:51200
v_mfma_f32_16x16x32_bf16 v[0:3], v[192:195], a[168:171], v[0:3]
ds_read_b64_tr_b16 v[240:241], v109 offset:53248
v_mfma_f32_16x16x32_bf16 v[0:3], v[196:199], a[176:179], v[0:3]
s_waitcnt lgkmcnt(9)
ds_read_b64_tr_b16 v[242:243], v109 offset:55296
v_mfma_f32_16x16x32_bf16 v[0:3], v[200:203], a[184:187], v[0:3]
ds_read_b64_tr_b16 v[244:245], v109 offset:57344
v_mfma_f32_16x16x32_bf16 v[48:51], v[200:203], a[188:191], v[48:51]
buffer_load_dwordx4 v98, s[12:15], s33 offen offset:1024 lds
ds_read_b64_tr_b16 v[246:247], v109 offset:59392
v_mfma_f32_16x16x32_bf16 v[48:51], v[196:199], a[180:183], v[48:51]
ds_read_b64_tr_b16 v[248:249], v109 offset:61440
ds_read_b64_tr_b16 v[250:251], v109 offset:63488
v_mfma_f32_16x16x32_bf16 v[48:51], v[192:195], a[172:175], v[48:51]
v_mfma_f32_16x16x32_bf16 v[48:51], v[188:191], a[164:167], v[48:51]
s_waitcnt vmcnt(23)
s_barrier
ds_read_b64_tr_b16 v[188:189], v110 offset:0
v_mfma_f32_16x16x32_bf16 v[52:55], v[204:207], a[164:167], v[52:55]
buffer_load_dwordx4 v98, s[12:15], s34 offen offset:2048 lds
ds_read_b64_tr_b16 v[190:191], v110 offset:2048
v_mfma_f32_16x16x32_bf16 v[52:55], v[208:211], a[172:175], v[52:55]
ds_read_b64_tr_b16 v[192:193], v110 offset:4096
v_mfma_f32_16x16x32_bf16 v[52:55], v[212:215], a[180:183], v[52:55]
ds_read_b64_tr_b16 v[194:195], v110 offset:6144
v_mfma_f32_16x16x32_bf16 v[52:55], v[216:219], a[188:191], v[52:55]
ds_read_b64_tr_b16 v[196:197], v110 offset:8192
v_mfma_f32_16x16x32_bf16 v[4:7], v[216:219], a[184:187], v[4:7]
ds_read_b64_tr_b16 v[198:199], v110 offset:10240
v_mfma_f32_16x16x32_bf16 v[4:7], v[212:215], a[176:179], v[4:7]
buffer_load_dwordx4 v98, s[12:15], s35 offen offset:3072 lds
ds_read_b64_tr_b16 v[200:201], v110 offset:12288
v_add_u32 v98, 0x40000, v98
v_mfma_f32_16x16x32_bf16 v[4:7], v[208:211], a[168:171], v[4:7]
s_add_u32 m0, s24, 0x8000
ds_read_b64_tr_b16 v[202:203], v110 offset:14336
v_mfma_f32_16x16x32_bf16 v[4:7], v[204:207], a[160:163], v[4:7]
ds_read_b64_tr_b16 v[204:205], v111 offset:0
v_mfma_f32_16x16x32_bf16 v[8:11], v[220:223], a[160:163], v[8:11]
s_waitcnt lgkmcnt(9)
ds_read_b64_tr_b16 v[206:207], v111 offset:2048
v_mfma_f32_16x16x32_bf16 v[8:11], v[224:227], a[168:171], v[8:11]
buffer_load_dwordx4 v98, s[12:15], s32 offen offset:0 lds
ds_read_b64_tr_b16 v[208:209], v111 offset:4096
v_mfma_f32_16x16x32_bf16 v[8:11], v[228:231], a[176:179], v[8:11]
ds_read_b64_tr_b16 v[210:211], v111 offset:6144
v_mfma_f32_16x16x32_bf16 v[8:11], v[232:235], a[184:187], v[8:11]
ds_read_b64_tr_b16 v[212:213], v111 offset:8192
v_mfma_f32_16x16x32_bf16 v[56:59], v[232:235], a[188:191], v[56:59]
ds_read_b64_tr_b16 v[214:215], v111 offset:10240
v_mfma_f32_16x16x32_bf16 v[56:59], v[228:231], a[180:183], v[56:59]
ds_read_b64_tr_b16 v[216:217], v111 offset:12288
ds_read_b64_tr_b16 v[218:219], v111 offset:14336
v_mfma_f32_16x16x32_bf16 v[56:59], v[224:227], a[172:175], v[56:59]
buffer_load_dwordx4 v98, s[12:15], s33 offen offset:1024 lds
v_mfma_f32_16x16x32_bf16 v[56:59], v[220:223], a[164:167], v[56:59]
ds_read_b64_tr_b16 v[220:221], v112 offset:0
v_mfma_f32_16x16x32_bf16 v[60:63], v[236:239], a[164:167], v[60:63]
ds_read_b64_tr_b16 v[222:223], v112 offset:2048
v_mfma_f32_16x16x32_bf16 v[60:63], v[240:243], a[172:175], v[60:63]
ds_read_b64_tr_b16 v[224:225], v112 offset:4096
v_mfma_f32_16x16x32_bf16 v[60:63], v[244:247], a[180:183], v[60:63]
buffer_load_dwordx4 v98, s[12:15], s34 offen offset:2048 lds
ds_read_b64_tr_b16 v[226:227], v112 offset:6144
v_mfma_f32_16x16x32_bf16 v[60:63], v[248:251], a[188:191], v[60:63]
ds_read_b64_tr_b16 v[228:229], v112 offset:8192
v_mfma_f32_16x16x32_bf16 v[12:15], v[248:251], a[184:187], v[12:15]
ds_read_b64_tr_b16 v[230:231], v112 offset:10240
v_mfma_f32_16x16x32_bf16 v[12:15], v[244:247], a[176:179], v[12:15]
ds_read_b64_tr_b16 v[232:233], v112 offset:12288
ds_read_b64_tr_b16 v[234:235], v112 offset:14336
v_mfma_f32_16x16x32_bf16 v[12:15], v[240:243], a[168:171], v[12:15]
v_mfma_f32_16x16x32_bf16 v[12:15], v[236:239], a[160:163], v[12:15]
s_waitcnt lgkmcnt(8)
buffer_load_dword v114, v115, s[8:11], s37 offen sc1
ds_read_b64_tr_b16 v[236:237], v113 offset:0
v_mfma_f32_16x16x32_bf16 v[0:3], v[188:191], a[192:195], v[0:3]
ds_read_b64_tr_b16 v[238:239], v113 offset:2048
v_mfma_f32_16x16x32_bf16 v[0:3], v[192:195], a[200:203], v[0:3]
ds_read_b64_tr_b16 v[240:241], v113 offset:4096
v_mfma_f32_16x16x32_bf16 v[0:3], v[196:199], a[208:211], v[0:3]
ds_read_b64_tr_b16 v[242:243], v113 offset:6144
v_mfma_f32_16x16x32_bf16 v[0:3], v[200:203], a[216:219], v[0:3]
buffer_load_dwordx4 v98, s[12:15], s35 offen offset:3072 lds
ds_read_b64_tr_b16 v[244:245], v113 offset:8192
v_add_u32 v98, 0x40000, v98
v_mfma_f32_16x16x32_bf16 v[48:51], v[200:203], a[220:223], v[48:51]
s_add_u32 m0, s24, 0xc000
ds_read_b64_tr_b16 v[246:247], v113 offset:10240
v_mfma_f32_16x16x32_bf16 v[48:51], v[196:199], a[212:215], v[48:51]
ds_read_b64_tr_b16 v[248:249], v113 offset:12288
ds_read_b64_tr_b16 v[250:251], v113 offset:14336
v_mfma_f32_16x16x32_bf16 v[48:51], v[192:195], a[204:207], v[48:51]
v_mfma_f32_16x16x32_bf16 v[48:51], v[188:191], a[196:199], v[48:51]
s_waitcnt vmcnt(26)
s_barrier
ds_read_b64_tr_b16 v[188:189], v110 offset:16384
v_mfma_f32_16x16x32_bf16 v[52:55], v[204:207], a[196:199], v[52:55]
ds_read_b64_tr_b16 v[190:191], v110 offset:18432
v_mfma_f32_16x16x32_bf16 v[52:55], v[208:211], a[204:207], v[52:55]
ds_read_b64_tr_b16 v[192:193], v110 offset:20480
v_mfma_f32_16x16x32_bf16 v[52:55], v[212:215], a[212:215], v[52:55]
ds_read_b64_tr_b16 v[194:195], v110 offset:22528
v_mfma_f32_16x16x32_bf16 v[52:55], v[216:219], a[220:223], v[52:55]
ds_read_b64_tr_b16 v[196:197], v110 offset:24576
v_mfma_f32_16x16x32_bf16 v[4:7], v[216:219], a[216:219], v[4:7]
ds_read_b64_tr_b16 v[198:199], v110 offset:26624
v_mfma_f32_16x16x32_bf16 v[4:7], v[212:215], a[208:211], v[4:7]
ds_read_b64_tr_b16 v[200:201], v110 offset:28672
ds_read_b64_tr_b16 v[202:203], v110 offset:30720
v_mfma_f32_16x16x32_bf16 v[4:7], v[208:211], a[200:203], v[4:7]
v_mfma_f32_16x16x32_bf16 v[4:7], v[204:207], a[192:195], v[4:7]
s_waitcnt lgkmcnt(8)
ds_read_b64_tr_b16 v[204:205], v111 offset:16384
v_mfma_f32_16x16x32_bf16 v[8:11], v[220:223], a[192:195], v[8:11]
ds_read_b64_tr_b16 v[206:207], v111 offset:18432
v_mfma_f32_16x16x32_bf16 v[8:11], v[224:227], a[200:203], v[8:11]
ds_read_b64_tr_b16 v[208:209], v111 offset:20480
v_mfma_f32_16x16x32_bf16 v[8:11], v[228:231], a[208:211], v[8:11]
ds_read_b64_tr_b16 v[210:211], v111 offset:22528
v_mfma_f32_16x16x32_bf16 v[8:11], v[232:235], a[216:219], v[8:11]
ds_read_b64_tr_b16 v[212:213], v111 offset:24576
v_mfma_f32_16x16x32_bf16 v[56:59], v[232:235], a[220:223], v[56:59]
ds_read_b64_tr_b16 v[214:215], v111 offset:26624
v_mfma_f32_16x16x32_bf16 v[56:59], v[228:231], a[212:215], v[56:59]
ds_read_b64_tr_b16 v[216:217], v111 offset:28672
ds_read_b64_tr_b16 v[218:219], v111 offset:30720
v_mfma_f32_16x16x32_bf16 v[56:59], v[224:227], a[204:207], v[56:59]
v_mfma_f32_16x16x32_bf16 v[56:59], v[220:223], a[196:199], v[56:59]
ds_read_b64_tr_b16 v[220:221], v112 offset:16384
v_mfma_f32_16x16x32_bf16 v[60:63], v[236:239], a[196:199], v[60:63]
ds_read_b64_tr_b16 v[222:223], v112 offset:18432
v_mfma_f32_16x16x32_bf16 v[60:63], v[240:243], a[204:207], v[60:63]
ds_read_b64_tr_b16 v[224:225], v112 offset:20480
v_mfma_f32_16x16x32_bf16 v[60:63], v[244:247], a[212:215], v[60:63]
ds_read_b64_tr_b16 v[226:227], v112 offset:22528
v_mfma_f32_16x16x32_bf16 v[60:63], v[248:251], a[220:223], v[60:63]
ds_read_b64_tr_b16 v[228:229], v112 offset:24576
v_mfma_f32_16x16x32_bf16 v[12:15], v[248:251], a[216:219], v[12:15]
ds_read_b64_tr_b16 v[230:231], v112 offset:26624
v_mfma_f32_16x16x32_bf16 v[12:15], v[244:247], a[208:211], v[12:15]
ds_read_b64_tr_b16 v[232:233], v112 offset:28672
ds_read_b64_tr_b16 v[234:235], v112 offset:30720
v_mfma_f32_16x16x32_bf16 v[12:15], v[240:243], a[200:203], v[12:15]
v_mfma_f32_16x16x32_bf16 v[12:15], v[236:239], a[192:195], v[12:15]
s_waitcnt lgkmcnt(8)
ds_read_b64_tr_b16 v[236:237], v113 offset:16384
v_mfma_f32_16x16x32_bf16 v[0:3], v[188:191], a[224:227], v[0:3]
ds_read_b64_tr_b16 v[238:239], v113 offset:18432
v_mfma_f32_16x16x32_bf16 v[0:3], v[192:195], a[232:235], v[0:3]
ds_read_b64_tr_b16 v[240:241], v113 offset:20480
v_mfma_f32_16x16x32_bf16 v[0:3], v[196:199], a[240:243], v[0:3]
ds_read_b64_tr_b16 v[242:243], v113 offset:22528
v_mfma_f32_16x16x32_bf16 v[0:3], v[200:203], a[248:251], v[0:3]
ds_read_b64_tr_b16 v[244:245], v113 offset:24576
v_mfma_f32_16x16x32_bf16 v[48:51], v[200:203], a[252:255], v[48:51]
ds_read_b64_tr_b16 v[246:247], v113 offset:26624
v_mfma_f32_16x16x32_bf16 v[48:51], v[196:199], a[244:247], v[48:51]
ds_read_b64_tr_b16 v[248:249], v113 offset:28672
ds_read_b64_tr_b16 v[250:251], v113 offset:30720
v_mfma_f32_16x16x32_bf16 v[48:51], v[192:195], a[236:239], v[48:51]
v_mfma_f32_16x16x32_bf16 v[48:51], v[188:191], a[228:231], v[48:51]
v_mfma_f32_16x16x32_bf16 v[52:55], v[204:207], a[228:231], v[52:55]
v_mfma_f32_16x16x32_bf16 v[52:55], v[208:211], a[236:239], v[52:55]
v_mfma_f32_16x16x32_bf16 v[52:55], v[212:215], a[244:247], v[52:55]
v_mfma_f32_16x16x32_bf16 v[52:55], v[216:219], a[252:255], v[52:55]
v_mfma_f32_16x16x32_bf16 v[4:7], v[216:219], a[248:251], v[4:7]
v_mfma_f32_16x16x32_bf16 v[4:7], v[212:215], a[240:243], v[4:7]
v_mfma_f32_16x16x32_bf16 v[4:7], v[208:211], a[232:235], v[4:7]
v_mfma_f32_16x16x32_bf16 v[4:7], v[204:207], a[224:227], v[4:7]
s_waitcnt lgkmcnt(0)
v_mfma_f32_16x16x32_bf16 v[8:11], v[220:223], a[224:227], v[8:11]
v_mfma_f32_16x16x32_bf16 v[8:11], v[224:227], a[232:235], v[8:11]
v_mfma_f32_16x16x32_bf16 v[8:11], v[228:231], a[240:243], v[8:11]
v_mfma_f32_16x16x32_bf16 v[8:11], v[232:235], a[248:251], v[8:11]
v_mfma_f32_16x16x32_bf16 v[56:59], v[232:235], a[252:255], v[56:59]
v_mfma_f32_16x16x32_bf16 v[56:59], v[228:231], a[244:247], v[56:59]
v_mfma_f32_16x16x32_bf16 v[56:59], v[224:227], a[236:239], v[56:59]
v_mfma_f32_16x16x32_bf16 v[56:59], v[220:223], a[228:231], v[56:59]
v_mfma_f32_16x16x32_bf16 v[60:63], v[236:239], a[228:231], v[60:63]
v_mfma_f32_16x16x32_bf16 v[60:63], v[240:243], a[236:239], v[60:63]
v_mfma_f32_16x16x32_bf16 v[60:63], v[244:247], a[244:247], v[60:63]
v_mfma_f32_16x16x32_bf16 v[60:63], v[248:251], a[252:255], v[60:63]
v_mfma_f32_16x16x32_bf16 v[12:15], v[248:251], a[248:251], v[12:15]
v_mfma_f32_16x16x32_bf16 v[12:15], v[244:247], a[240:243], v[12:15]
v_mfma_f32_16x16x32_bf16 v[12:15], v[240:243], a[232:235], v[12:15]
v_mfma_f32_16x16x32_bf16 v[12:15], v[236:239], a[224:227], v[12:15]
s_waitcnt vmcnt(1)
v_cmp_ne_u32 s[46:47], s58, v114
s_mov_b32 s25, 0
s_barrier
s_nop 2
s_cmp_eq_u64 s[46:47], 0
s_cbranch_scc0 L_k1_nx
s_mov_b32 s25, 1
buffer_load_dwordx4 v[16:19], v117, s[8:11], s36 offen offset:0 sc1
buffer_load_dwordx4 v[20:23], v117, s[8:11], s36 offen offset:64 sc1
buffer_load_dwordx4 v[64:67], v100, s[8:11], s36 offen offset:0 sc1
buffer_load_dwordx4 v[68:71], v100, s[8:11], s36 offen offset:1024 sc1
buffer_load_dwordx4 v[72:75], v100, s[8:11], s36 offen offset:2048 sc1
buffer_load_dwordx4 v[76:79], v100, s[8:11], s36 offen offset:3072 sc1
buffer_load_dwordx4 v[24:27], v117, s[8:11], s40 offen offset:0 sc1
buffer_load_dwordx4 v[28:31], v117, s[8:11], s40 offen offset:64 sc1
buffer_load_dwordx4 v[80:83], v100, s[8:11], s40 offen offset:0 sc1
buffer_load_dwordx4 v[84:87], v100, s[8:11], s40 offen offset:1024 sc1
buffer_load_dwordx4 v[88:91], v100, s[8:11], s40 offen offset:2048 sc1
buffer_load_dwordx4 v[92:95], v100, s[8:11], s40 offen offset:3072 sc1
L_k1_nx:
v_pk_fma_f32 v[120:121], v[172:173], v[102:103], s[62:63] op_sel:[0,0,0] op_sel_hi:[1,0,1]
v_pk_fma_f32 v[0:1], v[0:1], v[102:103], v[120:121] op_sel:[0,1,0] op_sel_hi:[1,1,1]
v_pk_fma_f32 v[124:125], v[0:1], s[60:61], s[60:61] op_sel:[0,0,1] op_sel_hi:[1,0,1]
v_max_f32 v0, s62, v0
v_exp_f32_e64 v124, v124 clamp
v_exp_f32_e64 v125, v125 clamp
v_max_f32 v1, s62, v1
v_pk_add_f32 v[0:1], v[0:1], v[124:125]
v_cvt_pk_bf16_f32 v32, v0, v1
v_pk_fma_f32 v[122:123], v[174:175], v[102:103], s[62:63] op_sel:[0,0,0] op_sel_hi:[1,0,1]
v_pk_fma_f32 v[2:3], v[2:3], v[102:103], v[122:123] op_sel:[0,1,0] op_sel_hi:[1,1,1]
v_pk_fma_f32 v[126:127], v[2:3], s[60:61], s[60:61] op_sel:[0,0,1] op_sel_hi:[1,0,1]
v_max_f32 v2, s62, v2
v_exp_f32_e64 v126, v126 clamp
v_exp_f32_e64 v127, v127 clamp
v_max_f32 v3, s62, v3
v_pk_add_f32 v[2:3], v[2:3], v[126:127]
v_cvt_pk_bf16_f32 v33, v2, v3
v_pk_fma_f32 v[120:121], v[176:177], v[102:103], s[62:63] op_sel:[0,0,0] op_sel_hi:[1,0,1]
v_pk_fma_f32 v[4:5], v[4:5], v[102:103], v[120:121] op_sel:[0,1,0] op_sel_hi:[1,1,1]
v_pk_fma_f32 v[124:125], v[4:5], s[60:61], s[60:61] op_sel:[0,0,1] op_sel_hi:[1,0,1]
v_max_f32 v4, s62, v4
v_exp_f32_e64 v124, v124 clamp
v_exp_f32_e64 v125, v125 clamp
v_max_f32 v5, s62, v5
v_pk_add_f32 v[4:5], v[4:5], v[124:125]
v_cvt_pk_bf16_f32 v34, v4, v5
v_pk_fma_f32 v[122:123], v[178:179], v[102:103], s[62:63] op_sel:[0,0,0] op_sel_hi:[1,0,1]
v_pk_fma_f32 v[6:7], v[6:7], v[102:103], v[122:123] op_sel:[0,1,0] op_sel_hi:[1,1,1]
v_pk_fma_f32 v[126:127], v[6:7], s[60:61], s[60:61] op_sel:[0,0,1] op_sel_hi:[1,0,1]
v_max_f32 v6, s62, v6
v_exp_f32_e64 v126, v126 clamp
v_exp_f32_e64 v127, v127 clamp
v_max_f32 v7, s62, v7
v_pk_add_f32 v[6:7], v[6:7], v[126:127]
v_cvt_pk_bf16_f32 v35, v6, v7
v_pk_fma_f32 v[120:121], v[180:181], v[102:103], s[62:63] op_sel:[0,0,0] op_sel_hi:[1,0,1]
v_pk_fma_f32 v[8:9], v[8:9], v[102:103], v[120:121] op_sel:[0,1,0] op_sel_hi:[1,1,1]
v_pk_fma_f32 v[124:125], v[8:9], s[60:61], s[60:61] op_sel:[0,0,1] op_sel_hi:[1,0,1]
v_max_f32 v8, s62, v8
v_exp_f32_e64 v124, v124 clamp
v_exp_f32_e64 v125, v125 clamp
v_max_f32 v9, s62, v9
v_pk_add_f32 v[8:9], v[8:9], v[124:125]
v_cvt_pk_bf16_f32 v36, v8, v9
v_pk_fma_f32 v[122:123], v[182:183], v[102:103], s[62:63] op_sel:[0,0,0] op_sel_hi:[1,0,1]
v_pk_fma_f32 v[10:11], v[10:11], v[102:103], v[122:123] op_sel:[0,1,0] op_sel_hi:[1,1,1]
v_pk_fma_f32 v[126:127], v[10:11], s[60:61], s[60:61] op_sel:[0,0,1] op_sel_hi:[1,0,1]
v_max_f32 v10, s62, v10
v_exp_f32_e64 v126, v126 clamp
v_exp_f32_e64 v127, v127 clamp
v_max_f32 v11, s62, v11
v_pk_add_f32 v[10:11], v[10:11], v[126:127]
v_cvt_pk_bf16_f32 v37, v10, v11
v_pk_fma_f32 v[120:121], v[184:185], v[102:103], s[62:63] op_sel:[0,0,0] op_sel_hi:[1,0,1]
v_pk_fma_f32 v[12:13], v[12:13], v[102:103], v[120:121] op_sel:[0,1,0] op_sel_hi:[1,1,1]
v_pk_fma_f32 v[124:125], v[12:13], s[60:61], s[60:61] op_sel:[0,0,1] op_sel_hi:[1,0,1]
v_max_f32 v12, s62, v12
v_exp_f32_e64 v124, v124 clamp
v_exp_f32_e64 v125, v125 clamp
v_max_f32 v13, s62, v13
v_pk_add_f32 v[12:13], v[12:13], v[124:125]
v_cvt_pk_bf16_f32 v38, v12, v13
v_pk_fma_f32 v[122:123], v[186:187], v[102:103], s[62:63] op_sel:[0,0,0] op_sel_hi:[1,0,1]
v_pk_fma_f32 v[14:15], v[14:15], v[102:103], v[122:123] op_sel:[0,1,0] op_sel_hi:[1,1,1]
v_pk_fma_f32 v[126:127], v[14:15], s[60:61], s[60:61] op_sel:[0,0,1] op_sel_hi:[1,0,1]
v_max_f32 v14, s62, v14
v_exp_f32_e64 v126, v126 clamp
v_exp_f32_e64 v127, v127 clamp
v_max_f32 v15, s62, v15
v_pk_add_f32 v[14:15], v[14:15], v[126:127]
v_cvt_pk_bf16_f32 v39, v14, v15
v_pk_fma_f32 v[120:121], v[172:173], v[104:105], s[62:63] op_sel:[0,0,0] op_sel_hi:[1,0,1]
v_pk_fma_f32 v[48:49], v[48:49], v[104:105], v[120:121] op_sel:[0,1,0] op_sel_hi:[1,1,1]
v_pk_fma_f32 v[124:125], v[48:49], s[60:61], s[60:61] op_sel:[0,0,1] op_sel_hi:[1,0,1]
v_max_f32 v48, s62, v48
v_exp_f32_e64 v124, v124 clamp
v_exp_f32_e64 v125, v125 clamp
v_max_f32 v49, s62, v49
v_pk_add_f32 v[48:49], v[48:49], v[124:125]
v_cvt_pk_bf16_f32 v40, v48, v49
v_pk_fma_f32 v[122:123], v[174:175], v[104:105], s[62:63] op_sel:[0,0,0] op_sel_hi:[1,0,1]
v_pk_fma_f32 v[50:51], v[50:51], v[104:105], v[122:123] op_sel:[0,1,0] op_sel_hi:[1,1,1]
v_pk_fma_f32 v[126:127], v[50:51], s[60:61], s[60:61] op_sel:[0,0,1] op_sel_hi:[1,0,1]
v_max_f32 v50, s62, v50
v_exp_f32_e64 v126, v126 clamp
v_exp_f32_e64 v127, v127 clamp
v_max_f32 v51, s62, v51
v_pk_add_f32 v[50:51], v[50:51], v[126:127]
v_cvt_pk_bf16_f32 v41, v50, v51
v_pk_fma_f32 v[120:121], v[176:177], v[104:105], s[62:63] op_sel:[0,0,0] op_sel_hi:[1,0,1]
v_pk_fma_f32 v[52:53], v[52:53], v[104:105], v[120:121] op_sel:[0,1,0] op_sel_hi:[1,1,1]
v_pk_fma_f32 v[124:125], v[52:53], s[60:61], s[60:61] op_sel:[0,0,1] op_sel_hi:[1,0,1]
v_max_f32 v52, s62, v52
v_exp_f32_e64 v124, v124 clamp
v_exp_f32_e64 v125, v125 clamp
v_max_f32 v53, s62, v53
v_pk_add_f32 v[52:53], v[52:53], v[124:125]
v_cvt_pk_bf16_f32 v42, v52, v53
v_pk_fma_f32 v[122:123], v[178:179], v[104:105], s[62:63] op_sel:[0,0,0] op_sel_hi:[1,0,1]
v_pk_fma_f32 v[54:55], v[54:55], v[104:105], v[122:123] op_sel:[0,1,0] op_sel_hi:[1,1,1]
v_pk_fma_f32 v[126:127], v[54:55], s[60:61], s[60:61] op_sel:[0,0,1] op_sel_hi:[1,0,1]
v_max_f32 v54, s62, v54
v_exp_f32_e64 v126, v126 clamp
v_exp_f32_e64 v127, v127 clamp
v_max_f32 v55, s62, v55
v_pk_add_f32 v[54:55], v[54:55], v[126:127]
v_cvt_pk_bf16_f32 v43, v54, v55
v_pk_fma_f32 v[120:121], v[180:181], v[104:105], s[62:63] op_sel:[0,0,0] op_sel_hi:[1,0,1]
v_pk_fma_f32 v[56:57], v[56:57], v[104:105], v[120:121] op_sel:[0,1,0] op_sel_hi:[1,1,1]
v_pk_fma_f32 v[124:125], v[56:57], s[60:61], s[60:61] op_sel:[0,0,1] op_sel_hi:[1,0,1]
v_max_f32 v56, s62, v56
v_exp_f32_e64 v124, v124 clamp
v_exp_f32_e64 v125, v125 clamp
v_max_f32 v57, s62, v57
v_pk_add_f32 v[56:57], v[56:57], v[124:125]
v_cvt_pk_bf16_f32 v44, v56, v57
v_pk_fma_f32 v[122:123], v[182:183], v[104:105], s[62:63] op_sel:[0,0,0] op_sel_hi:[1,0,1]
v_pk_fma_f32 v[58:59], v[58:59], v[104:105], v[122:123] op_sel:[0,1,0] op_sel_hi:[1,1,1]
v_pk_fma_f32 v[126:127], v[58:59], s[60:61], s[60:61] op_sel:[0,0,1] op_sel_hi:[1,0,1]
v_max_f32 v58, s62, v58
v_exp_f32_e64 v126, v126 clamp
v_exp_f32_e64 v127, v127 clamp
v_max_f32 v59, s62, v59
v_pk_add_f32 v[58:59], v[58:59], v[126:127]
v_cvt_pk_bf16_f32 v45, v58, v59
v_pk_fma_f32 v[120:121], v[184:185], v[104:105], s[62:63] op_sel:[0,0,0] op_sel_hi:[1,0,1]
v_pk_fma_f32 v[60:61], v[60:61], v[104:105], v[120:121] op_sel:[0,1,0] op_sel_hi:[1,1,1]
v_pk_fma_f32 v[124:125], v[60:61], s[60:61], s[60:61] op_sel:[0,0,1] op_sel_hi:[1,0,1]
v_max_f32 v60, s62, v60
v_exp_f32_e64 v124, v124 clamp
v_exp_f32_e64 v125, v125 clamp
v_max_f32 v61, s62, v61
v_pk_add_f32 v[60:61], v[60:61], v[124:125]
v_cvt_pk_bf16_f32 v46, v60, v61
v_pk_fma_f32 v[122:123], v[186:187], v[104:105], s[62:63] op_sel:[0,0,0] op_sel_hi:[1,0,1]
v_pk_fma_f32 v[62:63], v[62:63], v[104:105], v[122:123] op_sel:[0,1,0] op_sel_hi:[1,1,1]
v_pk_fma_f32 v[126:127], v[62:63], s[60:61], s[60:61] op_sel:[0,0,1] op_sel_hi:[1,0,1]
v_max_f32 v62, s62, v62
v_exp_f32_e64 v126, v126 clamp
v_exp_f32_e64 v127, v127 clamp
v_max_f32 v63, s62, v63
v_pk_add_f32 v[62:63], v[62:63], v[126:127]
v_cvt_pk_bf16_f32 v47, v62, v63
s_cmp_lg_u32 s25, 0
s_cbranch_scc1 L_k1_have
s_mov_b32 s56, 0x100000
L_kvx_poll:
buffer_load_dword v114, v115, s[8:11], s37 offen sc1
s_waitcnt vmcnt(0)
v_cmp_ne_u32 s[46:47], s58, v114
s_nop 4
s_cmp_eq_u64 s[46:47], 0
s_cbranch_scc1 L_kvx_go
s_sub_u32 s56, s56, 1
s_cbranch_scc0 L_kvx_poll
L_kvx_go:
buffer_load_dwordx4 v[16:19], v117, s[8:11], s36 offen offset:0 sc1
buffer_load_dwordx4 v[20:23], v117, s[8:11], s36 offen offset:64 sc1
buffer_load_dwordx4 v[64:67], v100, s[8:11], s36 offen offset:0 sc1
buffer_load_dwordx4 v[68:71], v100, s[8:11], s36 offen offset:1024 sc1
buffer_load_dwordx4 v[72:75], v100, s[8:11], s36 offen offset:2048 sc1
buffer_load_dwordx4 v[76:79], v100, s[8:11], s36 offen offset:3072 sc1
buffer_load_dwordx4 v[24:27], v117, s[8:11], s40 offen offset:0 sc1
buffer_load_dwordx4 v[28:31], v117, s[8:11], s40 offen offset:64 sc1
buffer_load_dwordx4 v[80:83], v100, s[8:11], s40 offen offset:0 sc1
buffer_load_dwordx4 v[84:87], v100, s[8:11], s40 offen offset:1024 sc1
buffer_load_dwordx4 v[88:91], v100, s[8:11], s40 offen offset:2048 sc1
buffer_load_dwordx4 v[92:95], v100, s[8:11], s40 offen offset:3072 sc1
L_k1_have:
s_waitcnt vmcnt(6)
v_cvt_pk_bf16_f32 v200, v16, v17
v_cvt_pk_bf16_f32 v201, v18, v19
v_cvt_pk_bf16_f32 v202, v20, v21
v_cvt_pk_bf16_f32 v203, v22, v23
v_cvt_pk_bf16_f32 v192, v64, v65
v_cvt_pk_bf16_f32 v193, v66, v67
v_cvt_pk_bf16_f32 v194, v68, v69
v_cvt_pk_bf16_f32 v195, v70, v71
v_cvt_pk_bf16_f32 v196, v72, v73
v_cvt_pk_bf16_f32 v197, v74, v75
v_cvt_pk_bf16_f32 v198, v76, v77
v_cvt_pk_bf16_f32 v199, v78, v79
v_mfma_f32_16x16x32_bf16 v[0:3], v[200:203], v[32:35], v[148:151]
v_mfma_f32_16x16x32_bf16 v[216:219], v[192:195], v[32:35], 0
v_mfma_f32_16x16x32_bf16 v[220:223], v[196:199], v[32:35], 0
v_mfma_f32_16x16x32_bf16 v[8:11], v[200:203], v[40:43], v[148:151]
v_mfma_f32_16x16x32_bf16 v[232:235], v[192:195], v[40:43], 0
v_mfma_f32_16x16x32_bf16 v[236:239], v[196:199], v[40:43], 0
s_waitcnt vmcnt(0)
v_cvt_pk_bf16_f32 v212, v24, v25
v_cvt_pk_bf16_f32 v213, v26, v27
v_cvt_pk_bf16_f32 v214, v28, v29
v_cvt_pk_bf16_f32 v215, v30, v31
v_cvt_pk_bf16_f32 v204, v80, v81
v_cvt_pk_bf16_f32 v205, v82, v83
v_cvt_pk_bf16_f32 v206, v84, v85
v_cvt_pk_bf16_f32 v207, v86, v87
v_cvt_pk_bf16_f32 v208, v88, v89
v_cvt_pk_bf16_f32 v209, v90, v91
v_cvt_pk_bf16_f32 v210, v92, v93
v_cvt_pk_bf16_f32 v211, v94, v95
v_mfma_f32_16x16x32_bf16 v[4:7], v[212:215], v[36:39], v[148:151]
v_mfma_f32_16x16x32_bf16 v[224:227], v[204:207], v[36:39], 0
v_mfma_f32_16x16x32_bf16 v[228:231], v[208:211], v[36:39], 0
v_mfma_f32_16x16x32_bf16 v[12:15], v[212:215], v[44:47], v[148:151]
v_mfma_f32_16x16x32_bf16 v[240:243], v[204:207], v[44:47], 0
v_mfma_f32_16x16x32_bf16 v[244:247], v[208:211], v[44:47], 0
v_rcp_f32 v0, v0
s_nop 0
v_pk_mul_f32 v[216:217], v[216:217], v[0:1] op_sel_hi:[1,0]
v_pk_mul_f32 v[218:219], v[218:219], v[0:1] op_sel_hi:[1,0]
v_pk_mul_f32 v[220:221], v[220:221], v[0:1] op_sel_hi:[1,0]
v_pk_mul_f32 v[222:223], v[222:223], v[0:1] op_sel_hi:[1,0]
v_cvt_pk_bf16_f32 v32, v216, v217
v_cvt_pk_bf16_f32 v33, v218, v219
v_cvt_pk_bf16_f32 v34, v220, v221
v_cvt_pk_bf16_f32 v35, v222, v223
buffer_store_dwordx4 v[32:35], v100, s[8:11], s41 offen offset:0 sc1
v_rcp_f32 v8, v8
s_nop 0
v_pk_mul_f32 v[232:233], v[232:233], v[8:9] op_sel_hi:[1,0]
v_pk_mul_f32 v[234:235], v[234:235], v[8:9] op_sel_hi:[1,0]
v_pk_mul_f32 v[236:237], v[236:237], v[8:9] op_sel_hi:[1,0]
v_pk_mul_f32 v[238:239], v[238:239], v[8:9] op_sel_hi:[1,0]
v_cvt_pk_bf16_f32 v40, v232, v233
v_cvt_pk_bf16_f32 v41, v234, v235
v_cvt_pk_bf16_f32 v42, v236, v237
v_cvt_pk_bf16_f32 v43, v238, v239
buffer_store_dwordx4 v[40:43], v101, s[8:11], s41 offen offset:0 sc1
v_rcp_f32 v4, v4
s_nop 0
v_pk_mul_f32 v[224:225], v[224:225], v[4:5] op_sel_hi:[1,0]
v_pk_mul_f32 v[226:227], v[226:227], v[4:5] op_sel_hi:[1,0]
v_pk_mul_f32 v[228:229], v[228:229], v[4:5] op_sel_hi:[1,0]
v_pk_mul_f32 v[230:231], v[230:231], v[4:5] op_sel_hi:[1,0]
v_cvt_pk_bf16_f32 v36, v224, v225
v_cvt_pk_bf16_f32 v37, v226, v227
v_cvt_pk_bf16_f32 v38, v228, v229
v_cvt_pk_bf16_f32 v39, v230, v231
buffer_store_dwordx4 v[36:39], v100, s[8:11], s41 offen offset:1024 sc1
v_rcp_f32 v12, v12
s_nop 0
v_pk_mul_f32 v[240:241], v[240:241], v[12:13] op_sel_hi:[1,0]
v_pk_mul_f32 v[242:243], v[242:243], v[12:13] op_sel_hi:[1,0]
v_pk_mul_f32 v[244:245], v[244:245], v[12:13] op_sel_hi:[1,0]
v_pk_mul_f32 v[246:247], v[246:247], v[12:13] op_sel_hi:[1,0]
v_cvt_pk_bf16_f32 v44, v240, v241
v_cvt_pk_bf16_f32 v45, v242, v243
v_cvt_pk_bf16_f32 v46, v244, v245
v_cvt_pk_bf16_f32 v47, v246, v247
buffer_store_dwordx4 v[44:47], v101, s[8:11], s41 offen offset:1024 sc1
v_mbcnt_lo_u32_b32 v105, -1, 0
v_mbcnt_hi_u32_b32 v105, -1, v105
s_lshl_b32 s29, s20, 6
v_add_u32 v104, s29, v105
s_and_b32 s27, s2, 7
s_lshr_b32 s28, s2, 3
s_and_b32 s26, s27, 3
s_lshl_b32 s26, s26, 3
s_and_b32 s29, s28, 7
s_add_u32 s26, s26, s29
s_lshr_b32 s22, s27, 2
s_lshl_b32 s22, s22, 2
s_lshr_b32 s29, s28, 3
s_add_u32 s22, s22, s29
s_lshr_b32 s98, s26, 1
s_lshl_b32 s98, s98, 11
s_add_u32 s98, s98, 0x1d40000
s_add_u32 s98, s98, s57
s_lshl_b32 s99, s26, 3
s_add_u32 s99, s99, s22
s_lshl_b32 s99, s99, 7
s_add_u32 s99, s99, 0x1d48000
s_add_u32 s99, s99, s57
s_lshl_b32 s21, s26, 2
s_add_u32 s21, s21, s20
v_lshlrev_b32 v109, 4, v105
s_lshl_b32 s23, s21, 15
s_lshl_b32 s27, s22, 12
s_add_u32 s31, s23, s27
s_add_u32 s23, s23, 0x400000
s_add_u32 s92, s31, 0x0
buffer_load_dwordx4 v98, s[12:15], s32 offen offset:0 lds
buffer_load_dwordx4 v98, s[12:15], s33 offen offset:1024 lds
buffer_load_dwordx4 v98, s[12:15], s34 offen offset:2048 lds
buffer_load_dwordx4 v98, s[12:15], s35 offen offset:3072 lds
s_add_u32 m0, s24, 0x10000
v_add_u32 v98, 0x40000, v98
buffer_load_dwordx4 v98, s[12:15], s32 offen offset:0 lds
buffer_load_dwordx4 v98, s[12:15], s33 offen offset:1024 lds
buffer_load_dwordx4 v98, s[12:15], s34 offen offset:2048 lds
buffer_load_dwordx4 v98, s[12:15], s35 offen offset:3072 lds
s_add_u32 m0, s24, 0x14000
v_add_u32 v98, 0xffe40080, v98
v_lshrrev_b32 v128, 2, v105
v_lshlrev_b32 v128, 7, v128
v_and_b32 v129, 3, v105
v_lshl_add_u32 v128, v129, 3, v128
v_bfe_u32 v129, v105, 3, 2
v_xor_b32 v130, 0, v129
v_lshl_add_u32 v116, v130, 5, v128
v_add_u32 v120, 0x10000, v116
v_add_u32 v112, 0x20000, v116
v_xor_b32 v130, 1, v129
v_lshl_add_u32 v117, v130, 5, v128
v_add_u32 v121, 0x10000, v117
v_add_u32 v113, 0x20000, v117
v_xor_b32 v130, 2, v129
v_lshl_add_u32 v118, v130, 5, v128
v_add_u32 v122, 0x10000, v118
v_add_u32 v114, 0x20000, v118
v_xor_b32 v130, 3, v129
v_lshl_add_u32 v119, v130, 5, v128
v_add_u32 v123, 0x10000, v119
v_add_u32 v115, 0x20000, v119
v_add_u32 v137, 0x1000, v109
v_add_u32 v138, 0x2000, v109
v_add_u32 v139, 0x3000, v109
v_add_u32 v140, 0x4000, v109
v_add_u32 v141, 0x5000, v109
v_add_u32 v142, 0x6000, v109
v_add_u32 v143, 0x7000, v109
v_mbcnt_lo_u32_b32 v224, -1, 0
v_mbcnt_hi_u32_b32 v224, -1, v224
s_lshl_b32 s29, s20, 6
v_add_u32 v239, s29, v224
s_bfe_u32 s28, s2, 0x10005
s_lshl_b32 s29, s28, 1
v_add_u32 v240, 0, v224
v_mul_u32_u24 v241, 4682, v240
v_lshrrev_b32 v241, 16, v241
v_mul_u32_u24 v242, 14, v241
v_sub_u32 v242, v240, v242
v_add_u32 v242, s29, v242
v_subrev_u32 v243, 14, v242
v_min_u32 v242, v242, v243
v_mul_u32_u24 v241, 7168, v241
v_lshl_add_u32 v232, v242, 4, v241
v_add_u32 v240, 64, v224
v_mul_u32_u24 v241, 4682, v240
v_lshrrev_b32 v241, 16, v241
v_mul_u32_u24 v242, 14, v241
v_sub_u32 v242, v240, v242
v_add_u32 v242, s29, v242
v_subrev_u32 v243, 14, v242
v_min_u32 v242, v242, v243
v_mul_u32_u24 v241, 7168, v241
v_lshl_add_u32 v233, v242, 4, v241
v_subrev_u32 v233, 1024, v233
v_add_u32 v240, 128, v224
v_mul_u32_u24 v241, 4682, v240
v_lshrrev_b32 v241, 16, v241
v_mul_u32_u24 v242, 14, v241
v_sub_u32 v242, v240, v242
v_add_u32 v242, s29, v242
v_subrev_u32 v243, 14, v242
v_min_u32 v242, v242, v243
v_mul_u32_u24 v241, 7168, v241
v_lshl_add_u32 v234, v242, 4, v241
v_subrev_u32 v234, 2048, v234
v_add_u32 v240, 192, v224
v_mul_u32_u24 v241, 4682, v240
v_lshrrev_b32 v241, 16, v241
v_mul_u32_u24 v242, 14, v241
v_sub_u32 v242, v240, v242
v_add_u32 v242, s29, v242
v_subrev_u32 v243, 14, v242
v_min_u32 v242, v242, v243
v_mul_u32_u24 v241, 7168, v241
v_lshl_add_u32 v235, v242, 4, v241
v_subrev_u32 v235, 3072, v235
v_add_u32 v240, 256, v224
v_mul_u32_u24 v241, 4682, v240
v_lshrrev_b32 v241, 16, v241
v_mul_u32_u24 v242, 14, v241
v_sub_u32 v242, v240, v242
v_add_u32 v242, s29, v242
v_subrev_u32 v243, 14, v242
v_min_u32 v242, v242, v243
v_mul_u32_u24 v241, 7168, v241
v_lshl_add_u32 v236, v242, 4, v241
v_add_u32 v240, 320, v224
v_mul_u32_u24 v241, 4682, v240
v_lshrrev_b32 v241, 16, v241
v_mul_u32_u24 v242, 14, v241
v_sub_u32 v242, v240, v242
v_add_u32 v242, s29, v242
v_subrev_u32 v243, 14, v242
v_min_u32 v242, v242, v243
v_mul_u32_u24 v241, 7168, v241
v_lshl_add_u32 v237, v242, 4, v241
v_subrev_u32 v237, 1024, v237
v_add_u32 v240, 384, v224
v_mul_u32_u24 v241, 4682, v240
v_lshrrev_b32 v241, 16, v241
v_mul_u32_u24 v242, 14, v241
v_sub_u32 v242, v240, v242
v_add_u32 v242, s29, v242
v_subrev_u32 v243, 14, v242
v_min_u32 v242, v242, v243
v_mul_u32_u24 v241, 7168, v241
v_lshl_add_u32 v238, v242, 4, v241
v_subrev_u32 v238, 2048, v238
v_lshlrev_b32 v225, 4, v224
v_add_u32 v226, 0x8000, v225
v_add_u32 v227, 0x10000, v225
v_add_u32 v228, 0x18000, v225
v_lshrrev_b32 v240, 2, v224
v_mul_u32_u24 v240, 224, v240
v_and_b32 v244, 3, v224
v_lshl_add_u32 v229, v244, 3, v240
v_add_u32 v229, 0x1a000, v229
v_min_u32 v242, 223, v239
v_lshrrev_b32 v243, 5, v242
v_add_u32 v243, s28, v243
v_subrev_u32 v244, 7, v243
v_min_u32 v243, v243, v244
v_lshlrev_b32 v243, 4, v243
v_and_b32 v244, 15, v242
v_add_u32 v243, v243, v244
v_bfe_u32 v244, v242, 4, 1
v_mul_u32_u24 v244, 3584, v244
v_add_lshl_u32 v243, v243, v244, 2
v_lshlrev_b32 v242, 2, v242
v_add_u32 v242, 0xbc00, v242
v_lshlrev_b32 v240, 5, v224
v_and_b32 v241, 7, v224
v_lshlrev_b32 v241, 7, v241
v_lshlrev_b32 v231, 7, v224
v_min_u32 v239, 13, v224
v_lshlrev_b32 v239, 7, v239
v_mov_b32 v248, s58
s_cmp_lg_u32 s30, 0
s_cbranch_scc1 L_k2_nl
s_cmp_ge_u32 s2, 224
s_cbranch_scc1 L_k2_nl
s_lshr_b32 s37, s2, 2
s_and_b32 s38, s2, 3
s_cmp_lt_u32 s37, 28
s_cselect_b32 s26, s48, s50
s_cselect_b32 s27, s49, s51
s_cselect_b32 s39, 0, 28
s_sub_u32 s39, s37, s39
s_add_u32 s37, s37, 24
s_mov_b32 s4, s26
s_and_b32 s5, s27, 0xffff
s_mov_b32 s6, 0x700000
s_mov_b32 s7, 0x20000
v_lshrrev_b32 v144, 4, v104
v_mul_u32_u24 v144, 7168, v144
v_and_b32 v145, 15, v104
v_lshl_add_u32 v144, v145, 4, v144
s_mul_i32 s29, s38, 1835008
s_mul_i32 s28, s39, 256
s_add_u32 s29, s29, s28
buffer_load_dwordx4 v[160:163], v144, s[4:7], s29 offen
s_add_u32 s29, s29, 114688
buffer_load_dwordx4 v[164:167], v144, s[4:7], s29 offen
s_add_u32 s29, s29, 114688
buffer_load_dwordx4 v[168:171], v144, s[4:7], s29 offen
s_add_u32 s29, s29, 114688
buffer_load_dwordx4 v[172:175], v144, s[4:7], s29 offen
s_add_u32 s29, s29, 114688
buffer_load_dwordx4 v[176:179], v144, s[4:7], s29 offen
s_add_u32 s29, s29, 114688
buffer_load_dwordx4 v[180:183], v144, s[4:7], s29 offen
s_add_u32 s29, s29, 114688
buffer_load_dwordx4 v[184:187], v144, s[4:7], s29 offen
s_add_u32 s29, s29, 114688
buffer_load_dwordx4 v[188:191], v144, s[4:7], s29 offen
s_add_u32 s29, s29, 114688
buffer_load_dwordx4 v[192:195], v144, s[4:7], s29 offen
s_add_u32 s29, s29, 114688
buffer_load_dwordx4 v[196:199], v144, s[4:7], s29 offen
s_add_u32 s29, s29, 114688
buffer_load_dwordx4 v[200:203], v144, s[4:7], s29 offen
s_add_u32 s29, s29, 114688
buffer_load_dwordx4 v[204:207], v144, s[4:7], s29 offen
s_add_u32 s29, s29, 114688
buffer_load_dwordx4 v[208:211], v144, s[4:7], s29 offen
s_add_u32 s29, s29, 114688
buffer_load_dwordx4 v[212:215], v144, s[4:7], s29 offen
s_add_u32 s29, s29, 114688
buffer_load_dwordx4 v[216:219], v144, s[4:7], s29 offen
s_add_u32 s29, s29, 114688
buffer_load_dwordx4 v[220:223], v144, s[4:7], s29 offen
s_add_u32 s29, s29, 114688
s_waitcnt vmcnt(24)
s_branch L_k2_pw
L_k2_nl:
s_waitcnt vmcnt(8)
L_k2_pw:
v_mov_b32 v133, s58
v_and_b32 v134, 15, v105
v_lshlrev_b32 v134, 7, v134
s_barrier
s_cmp_lg_u32 s20, 3
s_cbranch_scc1 L_k2_ns
s_mov_b64 exec, 1
buffer_store_dword v133, off, s[8:11], s100 sc1
s_mov_b64 exec, -1
L_k2_ns:
s_cmp_lg_u32 s30, 0
s_cbranch_scc1 L_k2_nj
s_cmp_ge_u32 s2, 224
s_cbranch_scc1 L_k2_nj
s_waitcnt vmcnt(15)
v_lshlrev_b32 v146, 16, v160
v_and_b32 v147, 0xffff0000, v160
v_lshlrev_b32 v148, 16, v161
v_and_b32 v149, 0xffff0000, v161
v_lshlrev_b32 v150, 16, v162
v_and_b32 v151, 0xffff0000, v162
v_lshlrev_b32 v152, 16, v163
v_and_b32 v153, 0xffff0000, v163
s_waitcnt vmcnt(14)
v_lshlrev_b32 v154, 16, v164
v_and_b32 v155, 0xffff0000, v164
v_pk_add_f32 v[146:147], v[146:147], v[154:155]
v_lshlrev_b32 v156, 16, v165
v_and_b32 v157, 0xffff0000, v165
v_pk_add_f32 v[148:149], v[148:149], v[156:157]
v_lshlrev_b32 v154, 16, v166
v_and_b32 v155, 0xffff0000, v166
v_pk_add_f32 v[150:151], v[150:151], v[154:155]
v_lshlrev_b32 v156, 16, v167
v_and_b32 v157, 0xffff0000, v167
v_pk_add_f32 v[152:153], v[152:153], v[156:157]
s_waitcnt vmcnt(13)
v_lshlrev_b32 v154, 16, v168
v_and_b32 v155, 0xffff0000, v168
v_pk_add_f32 v[146:147], v[146:147], v[154:155]
v_lshlrev_b32 v156, 16, v169
v_and_b32 v157, 0xffff0000, v169
v_pk_add_f32 v[148:149], v[148:149], v[156:157]
v_lshlrev_b32 v154, 16, v170
v_and_b32 v155, 0xffff0000, v170
v_pk_add_f32 v[150:151], v[150:151], v[154:155]
v_lshlrev_b32 v156, 16, v171
v_and_b32 v157, 0xffff0000, v171
v_pk_add_f32 v[152:153], v[152:153], v[156:157]
s_waitcnt vmcnt(12)
v_lshlrev_b32 v154, 16, v172
v_and_b32 v155, 0xffff0000, v172
v_pk_add_f32 v[146:147], v[146:147], v[154:155]
v_lshlrev_b32 v156, 16, v173
v_and_b32 v157, 0xffff0000, v173
v_pk_add_f32 v[148:149], v[148:149], v[156:157]
v_lshlrev_b32 v154, 16, v174
v_and_b32 v155, 0xffff0000, v174
v_pk_add_f32 v[150:151], v[150:151], v[154:155]
v_lshlrev_b32 v156, 16, v175
v_and_b32 v157, 0xffff0000, v175
v_pk_add_f32 v[152:153], v[152:153], v[156:157]
s_waitcnt vmcnt(11)
v_lshlrev_b32 v154, 16, v176
v_and_b32 v155, 0xffff0000, v176
v_pk_add_f32 v[146:147], v[146:147], v[154:155]
v_lshlrev_b32 v156, 16, v177
v_and_b32 v157, 0xffff0000, v177
v_pk_add_f32 v[148:149], v[148:149], v[156:157]
v_lshlrev_b32 v154, 16, v178
v_and_b32 v155, 0xffff0000, v178
v_pk_add_f32 v[150:151], v[150:151], v[154:155]
v_lshlrev_b32 v156, 16, v179
v_and_b32 v157, 0xffff0000, v179
v_pk_add_f32 v[152:153], v[152:153], v[156:157]
s_waitcnt vmcnt(10)
v_lshlrev_b32 v154, 16, v180
v_and_b32 v155, 0xffff0000, v180
v_pk_add_f32 v[146:147], v[146:147], v[154:155]
v_lshlrev_b32 v156, 16, v181
v_and_b32 v157, 0xffff0000, v181
v_pk_add_f32 v[148:149], v[148:149], v[156:157]
v_lshlrev_b32 v154, 16, v182
v_and_b32 v155, 0xffff0000, v182
v_pk_add_f32 v[150:151], v[150:151], v[154:155]
v_lshlrev_b32 v156, 16, v183
v_and_b32 v157, 0xffff0000, v183
v_pk_add_f32 v[152:153], v[152:153], v[156:157]
s_waitcnt vmcnt(9)
v_lshlrev_b32 v154, 16, v184
v_and_b32 v155, 0xffff0000, v184
v_pk_add_f32 v[146:147], v[146:147], v[154:155]
v_lshlrev_b32 v156, 16, v185
v_and_b32 v157, 0xffff0000, v185
v_pk_add_f32 v[148:149], v[148:149], v[156:157]
v_lshlrev_b32 v154, 16, v186
v_and_b32 v155, 0xffff0000, v186
v_pk_add_f32 v[150:151], v[150:151], v[154:155]
v_lshlrev_b32 v156, 16, v187
v_and_b32 v157, 0xffff0000, v187
v_pk_add_f32 v[152:153], v[152:153], v[156:157]
s_waitcnt vmcnt(8)
v_lshlrev_b32 v154, 16, v188
v_and_b32 v155, 0xffff0000, v188
v_pk_add_f32 v[146:147], v[146:147], v[154:155]
v_lshlrev_b32 v156, 16, v189
v_and_b32 v157, 0xffff0000, v189
v_pk_add_f32 v[148:149], v[148:149], v[156:157]
v_lshlrev_b32 v154, 16, v190
v_and_b32 v155, 0xffff0000, v190
v_pk_add_f32 v[150:151], v[150:151], v[154:155]
v_lshlrev_b32 v156, 16, v191
v_and_b32 v157, 0xffff0000, v191
v_pk_add_f32 v[152:153], v[152:153], v[156:157]
s_waitcnt vmcnt(7)
v_lshlrev_b32 v154, 16, v192
v_and_b32 v155, 0xffff0000, v192
v_pk_add_f32 v[146:147], v[146:147], v[154:155]
v_lshlrev_b32 v156, 16, v193
v_and_b32 v157, 0xffff0000, v193
v_pk_add_f32 v[148:149], v[148:149], v[156:157]
v_lshlrev_b32 v154, 16, v194
v_and_b32 v155, 0xffff0000, v194
v_pk_add_f32 v[150:151], v[150:151], v[154:155]
v_lshlrev_b32 v156, 16, v195
v_and_b32 v157, 0xffff0000, v195
v_pk_add_f32 v[152:153], v[152:153], v[156:157]
s_waitcnt vmcnt(6)
v_lshlrev_b32 v154, 16, v196
v_and_b32 v155, 0xffff0000, v196
v_pk_add_f32 v[146:147], v[146:147], v[154:155]
v_lshlrev_b32 v156, 16, v197
v_and_b32 v157, 0xffff0000, v197
v_pk_add_f32 v[148:149], v[148:149], v[156:157]
v_lshlrev_b32 v154, 16, v198
v_and_b32 v155, 0xffff0000, v198
v_pk_add_f32 v[150:151], v[150:151], v[154:155]
v_lshlrev_b32 v156, 16, v199
v_and_b32 v157, 0xffff0000, v199
v_pk_add_f32 v[152:153], v[152:153], v[156:157]
s_waitcnt vmcnt(5)
v_lshlrev_b32 v154, 16, v200
v_and_b32 v155, 0xffff0000, v200
v_pk_add_f32 v[146:147], v[146:147], v[154:155]
v_lshlrev_b32 v156, 16, v201
v_and_b32 v157, 0xffff0000, v201
v_pk_add_f32 v[148:149], v[148:149], v[156:157]
v_lshlrev_b32 v154, 16, v202
v_and_b32 v155, 0xffff0000, v202
v_pk_add_f32 v[150:151], v[150:151], v[154:155]
v_lshlrev_b32 v156, 16, v203
v_and_b32 v157, 0xffff0000, v203
v_pk_add_f32 v[152:153], v[152:153], v[156:157]
s_waitcnt vmcnt(4)
v_lshlrev_b32 v154, 16, v204
v_and_b32 v155, 0xffff0000, v204
v_pk_add_f32 v[146:147], v[146:147], v[154:155]
v_lshlrev_b32 v156, 16, v205
v_and_b32 v157, 0xffff0000, v205
v_pk_add_f32 v[148:149], v[148:149], v[156:157]
v_lshlrev_b32 v154, 16, v206
v_and_b32 v155, 0xffff0000, v206
v_pk_add_f32 v[150:151], v[150:151], v[154:155]
v_lshlrev_b32 v156, 16, v207
v_and_b32 v157, 0xffff0000, v207
v_pk_add_f32 v[152:153], v[152:153], v[156:157]
s_waitcnt vmcnt(3)
v_lshlrev_b32 v154, 16, v208
v_and_b32 v155, 0xffff0000, v208
v_pk_add_f32 v[146:147], v[146:147], v[154:155]
v_lshlrev_b32 v156, 16, v209
v_and_b32 v157, 0xffff0000, v209
v_pk_add_f32 v[148:149], v[148:149], v[156:157]
v_lshlrev_b32 v154, 16, v210
v_and_b32 v155, 0xffff0000, v210
v_pk_add_f32 v[150:151], v[150:151], v[154:155]
v_lshlrev_b32 v156, 16, v211
v_and_b32 v157, 0xffff0000, v211
v_pk_add_f32 v[152:153], v[152:153], v[156:157]
s_waitcnt vmcnt(2)
v_lshlrev_b32 v154, 16, v212
v_and_b32 v155, 0xffff0000, v212
v_pk_add_f32 v[146:147], v[146:147], v[154:155]
v_lshlrev_b32 v156, 16, v213
v_and_b32 v157, 0xffff0000, v213
v_pk_add_f32 v[148:149], v[148:149], v[156:157]
v_lshlrev_b32 v154, 16, v214
v_and_b32 v155, 0xffff0000, v214
v_pk_add_f32 v[150:151], v[150:151], v[154:155]
v_lshlrev_b32 v156, 16, v215
v_and_b32 v157, 0xffff0000, v215
v_pk_add_f32 v[152:153], v[152:153], v[156:157]
s_waitcnt vmcnt(1)
v_lshlrev_b32 v154, 16, v216
v_and_b32 v155, 0xffff0000, v216
v_pk_add_f32 v[146:147], v[146:147], v[154:155]
v_lshlrev_b32 v156, 16, v217
v_and_b32 v157, 0xffff0000, v217
v_pk_add_f32 v[148:149], v[148:149], v[156:157]
v_lshlrev_b32 v154, 16, v218
v_and_b32 v155, 0xffff0000, v218
v_pk_add_f32 v[150:151], v[150:151], v[154:155]
v_lshlrev_b32 v156, 16, v219
v_and_b32 v157, 0xffff0000, v219
v_pk_add_f32 v[152:153], v[152:153], v[156:157]
s_waitcnt vmcnt(0)
v_lshlrev_b32 v154, 16, v220
v_and_b32 v155, 0xffff0000, v220
v_pk_add_f32 v[146:147], v[146:147], v[154:155]
v_lshlrev_b32 v156, 16, v221
v_and_b32 v157, 0xffff0000, v221
v_pk_add_f32 v[148:149], v[148:149], v[156:157]
v_lshlrev_b32 v154, 16, v222
v_and_b32 v155, 0xffff0000, v222
v_pk_add_f32 v[150:151], v[150:151], v[154:155]
v_lshlrev_b32 v156, 16, v223
v_and_b32 v157, 0xffff0000, v223
v_pk_add_f32 v[152:153], v[152:153], v[156:157]
v_lshlrev_b32 v144, 5, v104
v_add_u32 v144, 0x26000, v144
ds_write_b128 v144, v[146:149]
ds_write_b128 v144, v[150:153] offset:16
v_and_b32 v145, 127, v104
v_lshlrev_b32 v145, 2, v145
v_add_u32 v144, 0x26000, v145
s_waitcnt lgkmcnt(0)
s_barrier
ds_read2st64_b32 v[160:161], v144 offset0:0 offset1:2
ds_read2st64_b32 v[162:163], v144 offset0:4 offset1:6
ds_read2st64_b32 v[164:165], v144 offset0:8 offset1:10
ds_read2st64_b32 v[166:167], v144 offset0:12 offset1:14
ds_read2st64_b32 v[168:169], v144 offset0:16 offset1:18
ds_read2st64_b32 v[170:171], v144 offset0:20 offset1:22
ds_read2st64_b32 v[172:173], v144 offset0:24 offset1:26
ds_read2st64_b32 v[174:175], v144 offset0:28 offset1:30
s_mul_i32 s29, s38, 40960
s_mul_i32 s28, s37, 512
s_add_u32 s29, s29, s28
s_add_u32 s29, s29, 0x1a80000
s_waitcnt lgkmcnt(0)
v_pk_add_f32 v[160:161], v[160:161], v[162:163]
v_pk_add_f32 v[160:161], v[160:161], v[164:165]
v_pk_add_f32 v[160:161], v[160:161], v[166:167]
v_pk_add_f32 v[160:161], v[160:161], v[168:169]
v_pk_add_f32 v[160:161], v[160:161], v[170:171]
v_pk_add_f32 v[160:161], v[160:161], v[172:173]
v_pk_add_f32 v[160:161], v[160:161], v[174:175]
v_add_f32 v160, v160, v161
buffer_store_dword v160, v145, s[8:11], s29 offen sc1
L_k2_nj:
buffer_load_dwordx4 v98, s[12:15], s32 offen offset:0 lds
buffer_load_dwordx4 v98, s[12:15], s33 offen offset:1024 lds
buffer_load_dwordx4 v98, s[12:15], s34 offen offset:2048 lds
buffer_load_dwordx4 v98, s[12:15], s35 offen offset:3072 lds
s_add_u32 m0, s24, 0x18000
v_add_u32 v98, 0x40000, v98
s_bfe_u32 s29, s2, 0x20001
s_lshl_b32 s29, s29, 3
s_lshr_b32 s28, s2, 5
s_add_u32 s29, s29, s28
s_and_b32 s28, s20, 1
s_mul_i32 s28, s28, 229376
s_mul_i32 s27, s29, 224
s_add_u32 s28, s28, s27
s_cmp_lt_u32 s20, 2
s_cselect_b32 s26, s48, s50
s_cselect_b32 s27, s49, s51
s_mov_b32 s16, s26
s_and_b32 s17, s27, 0xffff
s_mov_b32 s18, 0x700000
s_mov_b32 s19, 0x20000
s_add_u32 s16, s16, s28
s_addc_u32 s17, s17, 0
s_sub_u32 s18, s18, s28
s_mul_i32 s4, s20, 7168
s_mov_b32 s5, 917504
s_and_b32 s6, s2, 1
s_lshl_b32 s6, s6, 2
s_bfe_u32 s26, s2, 0x20003
s_add_u32 s6, s6, s26
s_lshl_b32 s6, s6, 2
s_add_u32 s6, s6, s20
s_lshl_b32 s6, s6, 10
s_add_u32 s6, s6, 0x1d48000
s_add_u32 s6, s6, s57
s_cmp_lg_u32 s20, 0
s_cbranch_scc1 L_k2_go
s_mov_b32 s56, 0x100000
L_k2_poll:
buffer_load_dword v132, v134, s[8:11], s98 offen sc1
s_waitcnt vmcnt(0)
v_cmp_ne_u32 s[46:47], s58, v132
s_nop 4
s_cmp_eq_u64 s[46:47], 0
s_cbranch_scc1 L_k2_go
s_sleep 1
s_sub_u32 s56, s56, 1
s_cbranch_scc0 L_k2_poll
L_k2_go:
s_barrier
s_mov_b32 s100, s99
buffer_load_dwordx4 a[0:3], v109, s[8:11], s23 offen offset:0 sc1
buffer_load_dwordx4 a[4:7], v109, s[8:11], s23 offen offset:1024 sc1
buffer_load_dwordx4 a[8:11], v109, s[8:11], s23 offen offset:2048 sc1
buffer_load_dwordx4 a[12:15], v109, s[8:11], s23 offen offset:3072 sc1
buffer_load_dwordx4 a[16:19], v137, s[8:11], s23 offen offset:0 sc1
buffer_load_dwordx4 a[20:23], v137, s[8:11], s23 offen offset:1024 sc1
buffer_load_dwordx4 a[24:27], v137, s[8:11], s23 offen offset:2048 sc1
buffer_load_dwordx4 a[28:31], v137, s[8:11], s23 offen offset:3072 sc1
buffer_load_dwordx4 a[32:35], v138, s[8:11], s23 offen offset:0 sc1
buffer_load_dwordx4 a[36:39], v138, s[8:11], s23 offen offset:1024 sc1
s_barrier
ds_read_b64_tr_b16 a[128:129], v120 offset:32768
ds_read_b64_tr_b16 a[130:131], v120 offset:34816
ds_read_b64_tr_b16 a[132:133], v120 offset:36864
ds_read_b64_tr_b16 a[134:135], v120 offset:38912
ds_read_b64_tr_b16 a[136:137], v120 offset:40960
ds_read_b64_tr_b16 a[138:139], v120 offset:43008
ds_read_b64_tr_b16 a[140:141], v120 offset:45056
ds_read_b64_tr_b16 a[142:143], v120 offset:47104
ds_read_b64_tr_b16 a[156:157], v121 offset:45056
ds_read_b64_tr_b16 a[158:159], v121 offset:47104
ds_read_b64_tr_b16 a[152:153], v121 offset:40960
ds_read_b64_tr_b16 a[154:155], v121 offset:43008
ds_read_b64_tr_b16 a[148:149], v121 offset:36864
ds_read_b64_tr_b16 a[150:151], v121 offset:38912
ds_read_b64_tr_b16 a[144:145], v121 offset:32768
ds_read_b64_tr_b16 a[146:147], v121 offset:34816
s_waitcnt vmcnt(9) lgkmcnt(14)
v_mfma_f32_16x16x32_bf16 v[0:3], a[128:131], a[0:3], 0
s_waitcnt vmcnt(8) lgkmcnt(12)
buffer_load_dwordx4 a[40:43], v138, s[8:11], s23 offen offset:2048 sc1
ds_read_b64_tr_b16 a[160:161], v122 offset:32768
v_mfma_f32_16x16x32_bf16 v[0:3], a[132:135], a[4:7], v[0:3]
s_waitcnt vmcnt(8) lgkmcnt(11)
buffer_load_dwordx4 a[44:47], v138, s[8:11], s23 offen offset:3072 sc1
ds_read_b64_tr_b16 a[162:163], v122 offset:34816
v_mfma_f32_16x16x32_bf16 v[0:3], a[136:139], a[8:11], v[0:3]
s_waitcnt vmcnt(8) lgkmcnt(10)
buffer_load_dwordx4 a[48:51], v139, s[8:11], s23 offen offset:0 sc1
ds_read_b64_tr_b16 a[164:165], v122 offset:36864
v_mfma_f32_16x16x32_bf16 v[0:3], a[140:143], a[12:15], v[0:3]
s_waitcnt lgkmcnt(9)
buffer_load_dwordx4 a[52:55], v139, s[8:11], s23 offen offset:1024 sc1
ds_read_b64_tr_b16 a[166:167], v122 offset:38912
ds_read_b64_tr_b16 a[168:169], v122 offset:40960
v_mfma_f32_16x16x32_bf16 v[4:7], a[156:159], a[12:15], 0
s_waitcnt lgkmcnt(5)
ds_read_b64_tr_b16 a[170:171], v122 offset:43008
ds_read_b64_tr_b16 a[172:173], v122 offset:45056
ds_read_b64_tr_b16 a[174:175], v122 offset:47104
v_mfma_f32_16x16x32_bf16 v[4:7], a[152:155], a[8:11], v[4:7]
ds_read_b64_tr_b16 a[188:189], v123 offset:45056
ds_read_b64_tr_b16 a[190:191], v123 offset:47104
ds_read_b64_tr_b16 a[184:185], v123 offset:40960
v_mfma_f32_16x16x32_bf16 v[4:7], a[148:151], a[4:7], v[4:7]
ds_read_b64_tr_b16 a[186:187], v123 offset:43008
ds_read_b64_tr_b16 a[180:181], v123 offset:36864
ds_read_b64_tr_b16 a[182:183], v123 offset:38912
v_mfma_f32_16x16x32_bf16 v[4:7], a[144:147], a[0:3], v[4:7]
s_waitcnt lgkmcnt(11)
ds_read_b64_tr_b16 a[176:177], v123 offset:32768
ds_read_b64_tr_b16 a[178:179], v123 offset:34816
v_mfma_f32_16x16x32_bf16 v[8:11], a[160:163], a[0:3], 0
s_waitcnt lgkmcnt(11)
v_mfma_f32_16x16x32_bf16 v[8:11], a[164:167], a[4:7], v[8:11]
s_waitcnt lgkmcnt(8)
v_mfma_f32_16x16x32_bf16 v[8:11], a[168:171], a[8:11], v[8:11]
v_mfma_f32_16x16x32_bf16 v[8:11], a[172:175], a[12:15], v[8:11]
s_waitcnt lgkmcnt(2)
v_mfma_f32_16x16x32_bf16 v[12:15], a[188:191], a[12:15], 0
buffer_load_dwordx4 a[56:59], v139, s[8:11], s23 offen offset:2048 sc1
v_mfma_f32_16x16x32_bf16 v[12:15], a[184:187], a[8:11], v[12:15]
ds_read_b64_tr_b16 a[128:129], v120 offset:49152
ds_read_b64_tr_b16 a[130:131], v120 offset:51200
v_mfma_f32_16x16x32_bf16 v[12:15], a[180:183], a[4:7], v[12:15]
s_waitcnt lgkmcnt(2)
ds_read_b64_tr_b16 a[132:133], v120 offset:53248
ds_read_b64_tr_b16 a[134:135], v120 offset:55296
v_mfma_f32_16x16x32_bf16 v[12:15], a[176:179], a[0:3], v[12:15]
s_waitcnt vmcnt(10) lgkmcnt(2)
buffer_load_dwordx4 a[60:63], v139, s[8:11], s23 offen offset:3072 sc1
ds_read_b64_tr_b16 a[136:137], v120 offset:57344
v_mfma_f32_16x16x32_bf16 v[0:3], a[128:131], a[16:19], v[0:3]
s_waitcnt vmcnt(10) lgkmcnt(1)
ds_read_b64_tr_b16 a[138:139], v120 offset:59392
ds_read_b64_tr_b16 a[140:141], v120 offset:61440
ds_read_b64_tr_b16 a[142:143], v120 offset:63488
v_mfma_f32_16x16x32_bf16 v[0:3], a[132:135], a[20:23], v[0:3]
s_waitcnt vmcnt(9) lgkmcnt(2)
buffer_load_dwordx4 a[64:67], v140, s[8:11], s23 offen offset:0 sc1
ds_read_b64_tr_b16 a[156:157], v121 offset:61440
ds_read_b64_tr_b16 a[158:159], v121 offset:63488
v_mfma_f32_16x16x32_bf16 v[0:3], a[136:139], a[24:27], v[0:3]
s_waitcnt vmcnt(9) lgkmcnt(2)
buffer_load_dwordx4 a[68:71], v140, s[8:11], s23 offen offset:1024 sc1
ds_read_b64_tr_b16 a[152:153], v121 offset:57344
ds_read_b64_tr_b16 a[154:155], v121 offset:59392
v_mfma_f32_16x16x32_bf16 v[0:3], a[140:143], a[28:31], v[0:3]
s_barrier
s_waitcnt lgkmcnt(2)
ds_read_b64_tr_b16 a[148:149], v121 offset:53248
ds_read_b64_tr_b16 a[150:151], v121 offset:55296
ds_read_b64_tr_b16 a[144:145], v121 offset:49152
v_mfma_f32_16x16x32_bf16 v[4:7], a[156:159], a[28:31], v[4:7]
s_waitcnt lgkmcnt(3)
ds_read_b64_tr_b16 a[146:147], v121 offset:51200
ds_read_b64_tr_b16 a[160:161], v122 offset:49152
ds_read_b64_tr_b16 a[162:163], v122 offset:51200
v_mfma_f32_16x16x32_bf16 v[4:7], a[152:155], a[24:27], v[4:7]
s_waitcnt lgkmcnt(4)
ds_read_b64_tr_b16 a[164:165], v122 offset:53248
ds_read_b64_tr_b16 a[166:167], v122 offset:55296
ds_read_b64_tr_b16 a[168:169], v122 offset:57344
v_mfma_f32_16x16x32_bf16 v[4:7], a[148:151], a[20:23], v[4:7]
s_waitcnt lgkmcnt(5)
ds_read_b64_tr_b16 a[170:171], v122 offset:59392
ds_read_b64_tr_b16 a[172:173], v122 offset:61440
ds_read_b64_tr_b16 a[174:175], v122 offset:63488
v_mfma_f32_16x16x32_bf16 v[4:7], a[144:147], a[16:19], v[4:7]
s_waitcnt lgkmcnt(6)
ds_read_b64_tr_b16 a[188:189], v123 offset:61440
ds_read_b64_tr_b16 a[190:191], v123 offset:63488
ds_read_b64_tr_b16 a[184:185], v123 offset:57344
v_mfma_f32_16x16x32_bf16 v[8:11], a[160:163], a[16:19], v[8:11]
s_waitcnt lgkmcnt(7)
buffer_load_dwordx4 a[72:75], v140, s[8:11], s23 offen offset:2048 sc1
ds_read_b64_tr_b16 a[186:187], v123 offset:59392
ds_read_b64_tr_b16 a[180:181], v123 offset:53248
v_mfma_f32_16x16x32_bf16 v[8:11], a[164:167], a[20:23], v[8:11]
s_waitcnt lgkmcnt(7)
ds_read_b64_tr_b16 a[182:183], v123 offset:55296
ds_read_b64_tr_b16 a[176:177], v123 offset:49152
ds_read_b64_tr_b16 a[178:179], v123 offset:51200
v_mfma_f32_16x16x32_bf16 v[8:11], a[168:171], a[24:27], v[8:11]
s_waitcnt lgkmcnt(8)
ds_read_b64_tr_b16 a[128:129], v112 offset:0
ds_read_b64_tr_b16 a[130:131], v112 offset:2048
ds_read_b64_tr_b16 a[132:133], v112 offset:4096
v_mfma_f32_16x16x32_bf16 v[8:11], a[172:175], a[28:31], v[8:11]
s_waitcnt lgkmcnt(9)
buffer_load_dwordx4 a[76:79], v140, s[8:11], s23 offen offset:3072 sc1
ds_read_b64_tr_b16 a[134:135], v112 offset:6144
ds_read_b64_tr_b16 a[136:137], v112 offset:8192
v_mfma_f32_16x16x32_bf16 v[12:15], a[188:191], a[28:31], v[12:15]
s_waitcnt lgkmcnt(9)
ds_read_b64_tr_b16 a[138:139], v112 offset:10240
ds_read_b64_tr_b16 a[140:141], v112 offset:12288
ds_read_b64_tr_b16 a[142:143], v112 offset:14336
v_mfma_f32_16x16x32_bf16 v[12:15], a[184:187], a[24:27], v[12:15]
s_waitcnt lgkmcnt(10)
ds_read_b64_tr_b16 a[156:157], v113 offset:12288
ds_read_b64_tr_b16 a[158:159], v113 offset:14336
ds_read_b64_tr_b16 a[152:153], v113 offset:8192
v_mfma_f32_16x16x32_bf16 v[12:15], a[180:183], a[20:23], v[12:15]
s_waitcnt lgkmcnt(11)
buffer_load_dwordx4 a[80:83], v141, s[8:11], s23 offen offset:0 sc1
ds_read_b64_tr_b16 a[154:155], v113 offset:10240
ds_read_b64_tr_b16 a[148:149], v113 offset:4096
v_mfma_f32_16x16x32_bf16 v[12:15], a[176:179], a[16:19], v[12:15]
s_waitcnt vmcnt(12) lgkmcnt(10)
ds_read_b64_tr_b16 a[150:151], v113 offset:6144
ds_read_b64_tr_b16 a[144:145], v113 offset:0
ds_read_b64_tr_b16 a[146:147], v113 offset:2048
v_mfma_f32_16x16x32_bf16 v[0:3], a[128:131], a[32:35], v[0:3]
s_waitcnt vmcnt(11) lgkmcnt(11)
ds_read_b64_tr_b16 a[160:161], v114 offset:0
ds_read_b64_tr_b16 a[162:163], v114 offset:2048
ds_read_b64_tr_b16 a[164:165], v114 offset:4096
v_mfma_f32_16x16x32_bf16 v[0:3], a[132:135], a[36:39], v[0:3]
s_waitcnt vmcnt(10) lgkmcnt(11)
buffer_load_dwordx4 a[84:87], v141, s[8:11], s23 offen offset:1024 sc1
ds_read_b64_tr_b16 a[166:167], v114 offset:6144
ds_read_b64_tr_b16 a[168:169], v114 offset:8192
v_mfma_f32_16x16x32_bf16 v[0:3], a[136:139], a[40:43], v[0:3]
s_waitcnt vmcnt(10)
ds_read_b64_tr_b16 a[170:171], v114 offset:10240
ds_read_b64_tr_b16 a[172:173], v114 offset:12288
ds_read_b64_tr_b16 a[174:175], v114 offset:14336
v_mfma_f32_16x16x32_bf16 v[0:3], a[140:143], a[44:47], v[0:3]
s_barrier
s_waitcnt lgkmcnt(11)
ds_read_b64_tr_b16 a[188:189], v115 offset:12288
ds_read_b64_tr_b16 a[190:191], v115 offset:14336
ds_read_b64_tr_b16 a[184:185], v115 offset:8192
v_mfma_f32_16x16x32_bf16 v[4:7], a[156:159], a[44:47], v[4:7]
buffer_load_dwordx4 a[88:91], v141, s[8:11], s23 offen offset:2048 sc1
ds_read_b64_tr_b16 a[186:187], v115 offset:10240
ds_read_b64_tr_b16 a[180:181], v115 offset:4096
v_mfma_f32_16x16x32_bf16 v[4:7], a[152:155], a[40:43], v[4:7]
s_waitcnt lgkmcnt(10)
ds_read_b64_tr_b16 a[182:183], v115 offset:6144
ds_read_b64_tr_b16 a[176:177], v115 offset:0
ds_read_b64_tr_b16 a[178:179], v115 offset:2048
v_mfma_f32_16x16x32_bf16 v[4:7], a[148:151], a[36:39], v[4:7]
ds_read_b64_tr_b16 a[128:129], v116 offset:0
ds_read_b64_tr_b16 a[130:131], v116 offset:2048
ds_read_b64_tr_b16 a[132:133], v116 offset:4096
v_mfma_f32_16x16x32_bf16 v[4:7], a[144:147], a[32:35], v[4:7]
buffer_load_dwordx4 a[92:95], v141, s[8:11], s23 offen offset:3072 sc1
ds_read_b64_tr_b16 a[134:135], v116 offset:6144
ds_read_b64_tr_b16 a[136:137], v116 offset:8192
v_mfma_f32_16x16x32_bf16 v[8:11], a[160:163], a[32:35], v[8:11]
s_waitcnt lgkmcnt(10)
ds_read_b64_tr_b16 a[138:139], v116 offset:10240
ds_read_b64_tr_b16 a[140:141], v116 offset:12288
ds_read_b64_tr_b16 a[142:143], v116 offset:14336
v_mfma_f32_16x16x32_bf16 v[8:11], a[164:167], a[36:39], v[8:11]
ds_read_b64_tr_b16 a[156:157], v117 offset:12288
ds_read_b64_tr_b16 a[158:159], v117 offset:14336
v_mfma_f32_16x16x32_bf16 v[8:11], a[168:171], a[40:43], v[8:11]
buffer_load_dwordx4 a[96:99], v142, s[8:11], s23 offen offset:0 sc1
ds_read_b64_tr_b16 a[152:153], v117 offset:8192
ds_read_b64_tr_b16 a[154:155], v117 offset:10240
v_mfma_f32_16x16x32_bf16 v[8:11], a[172:175], a[44:47], v[8:11]
ds_read_b64_tr_b16 a[148:149], v117 offset:4096
ds_read_b64_tr_b16 a[150:151], v117 offset:6144
ds_read_b64_tr_b16 a[144:145], v117 offset:0
v_mfma_f32_16x16x32_bf16 v[12:15], a[188:191], a[44:47], v[12:15]
s_waitcnt lgkmcnt(10)
ds_read_b64_tr_b16 a[146:147], v117 offset:2048
ds_read_b64_tr_b16 a[160:161], v118 offset:0
ds_read_b64_tr_b16 a[162:163], v118 offset:2048
v_mfma_f32_16x16x32_bf16 v[12:15], a[184:187], a[40:43], v[12:15]
buffer_load_dwordx4 a[100:103], v142, s[8:11], s23 offen offset:1024 sc1
ds_read_b64_tr_b16 a[164:165], v118 offset:4096
v_mfma_f32_16x16x32_bf16 v[12:15], a[180:183], a[36:39], v[12:15]
ds_read_b64_tr_b16 a[166:167], v118 offset:6144
ds_read_b64_tr_b16 a[168:169], v118 offset:8192
ds_read_b64_tr_b16 a[170:171], v118 offset:10240
v_mfma_f32_16x16x32_bf16 v[12:15], a[176:179], a[32:35], v[12:15]
s_waitcnt vmcnt(13)
ds_read_b64_tr_b16 a[172:173], v118 offset:12288
ds_read_b64_tr_b16 a[174:175], v118 offset:14336
ds_read_b64_tr_b16 a[188:189], v119 offset:12288
v_mfma_f32_16x16x32_bf16 v[0:3], a[128:131], a[48:51], v[0:3]
s_waitcnt vmcnt(12)
buffer_load_dwordx4 a[104:107], v142, s[8:11], s23 offen offset:2048 sc1
ds_read_b64_tr_b16 a[190:191], v119 offset:14336
v_mfma_f32_16x16x32_bf16 v[0:3], a[132:135], a[52:55], v[0:3]
s_waitcnt vmcnt(12) lgkmcnt(8)
ds_read_b64_tr_b16 a[184:185], v119 offset:8192
ds_read_b64_tr_b16 a[186:187], v119 offset:10240
v_mfma_f32_16x16x32_bf16 v[0:3], a[136:139], a[56:59], v[0:3]
s_waitcnt vmcnt(11)
ds_read_b64_tr_b16 a[180:181], v119 offset:4096
ds_read_b64_tr_b16 a[182:183], v119 offset:6144
ds_read_b64_tr_b16 a[176:177], v119 offset:0
v_mfma_f32_16x16x32_bf16 v[0:3], a[140:143], a[60:63], v[0:3]
s_barrier
buffer_load_dwordx4 a[108:111], v142, s[8:11], s23 offen offset:3072 sc1
ds_read_b64_tr_b16 a[178:179], v119 offset:2048
ds_read_b64_tr_b16 a[128:129], v116 offset:16384
v_mfma_f32_16x16x32_bf16 v[4:7], a[156:159], a[60:63], v[4:7]
ds_read_b64_tr_b16 a[130:131], v116 offset:18432
ds_read_b64_tr_b16 a[132:133], v116 offset:20480
v_mfma_f32_16x16x32_bf16 v[4:7], a[152:155], a[56:59], v[4:7]
ds_read_b64_tr_b16 a[134:135], v116 offset:22528
ds_read_b64_tr_b16 a[136:137], v116 offset:24576
v_mfma_f32_16x16x32_bf16 v[4:7], a[148:151], a[52:55], v[4:7]
buffer_load_dwordx4 a[112:115], v143, s[8:11], s23 offen offset:0 sc1
ds_read_b64_tr_b16 a[138:139], v116 offset:26624
ds_read_b64_tr_b16 a[140:141], v116 offset:28672
v_mfma_f32_16x16x32_bf16 v[4:7], a[144:147], a[48:51], v[4:7]
ds_read_b64_tr_b16 a[142:143], v116 offset:30720
ds_read_b64_tr_b16 a[156:157], v117 offset:28672
ds_read_b64_tr_b16 a[158:159], v117 offset:30720
v_mfma_f32_16x16x32_bf16 v[8:11], a[160:163], a[48:51], v[8:11]
s_waitcnt lgkmcnt(9)
ds_read_b64_tr_b16 a[152:153], v117 offset:24576
ds_read_b64_tr_b16 a[154:155], v117 offset:26624
v_mfma_f32_16x16x32_bf16 v[8:11], a[164:167], a[52:55], v[8:11]
buffer_load_dwordx4 a[116:119], v143, s[8:11], s23 offen offset:1024 sc1
ds_read_b64_tr_b16 a[148:149], v117 offset:20480
v_mfma_f32_16x16x32_bf16 v[8:11], a[168:171], a[56:59], v[8:11]
ds_read_b64_tr_b16 a[150:151], v117 offset:22528
ds_read_b64_tr_b16 a[144:145], v117 offset:16384
ds_read_b64_tr_b16 a[146:147], v117 offset:18432
v_mfma_f32_16x16x32_bf16 v[8:11], a[172:175], a[60:63], v[8:11]
ds_read_b64_tr_b16 a[160:161], v118 offset:16384
ds_read_b64_tr_b16 a[162:163], v118 offset:18432
v_mfma_f32_16x16x32_bf16 v[12:15], a[188:191], a[60:63], v[12:15]
buffer_load_dwordx4 a[120:123], v143, s[8:11], s23 offen offset:2048 sc1
ds_read_b64_tr_b16 a[164:165], v118 offset:20480
v_mfma_f32_16x16x32_bf16 v[12:15], a[184:187], a[56:59], v[12:15]
ds_read_b64_tr_b16 a[166:167], v118 offset:22528
ds_read_b64_tr_b16 a[168:169], v118 offset:24576
v_mfma_f32_16x16x32_bf16 v[12:15], a[180:183], a[52:55], v[12:15]
ds_read_b64_tr_b16 a[170:171], v118 offset:26624
ds_read_b64_tr_b16 a[172:173], v118 offset:28672
ds_read_b64_tr_b16 a[174:175], v118 offset:30720
v_mfma_f32_16x16x32_bf16 v[12:15], a[176:179], a[48:51], v[12:15]
s_waitcnt vmcnt(14) lgkmcnt(8)
buffer_load_dwordx4 a[124:127], v143, s[8:11], s23 offen offset:3072 sc1
ds_read_b64_tr_b16 a[188:189], v119 offset:28672
v_mfma_f32_16x16x32_bf16 v[0:3], a[128:131], a[64:67], v[0:3]
s_waitcnt vmcnt(14)
ds_read_b64_tr_b16 a[190:191], v119 offset:30720
ds_read_b64_tr_b16 a[184:185], v119 offset:24576
v_mfma_f32_16x16x32_bf16 v[0:3], a[132:135], a[68:71], v[0:3]
s_waitcnt vmcnt(13)
ds_read_b64_tr_b16 a[186:187], v119 offset:26624
ds_read_b64_tr_b16 a[180:181], v119 offset:20480
v_mfma_f32_16x16x32_bf16 v[0:3], a[136:139], a[72:75], v[0:3]
s_waitcnt vmcnt(12)
buffer_load_dwordx4 v[64:67], v109, s[8:11], s92 offen offset:0 sc1
ds_read_b64_tr_b16 a[182:183], v119 offset:22528
ds_read_b64_tr_b16 a[176:177], v119 offset:16384
v_mfma_f32_16x16x32_bf16 v[0:3], a[140:143], a[76:79], v[0:3]
s_barrier
ds_read_b64_tr_b16 a[178:179], v119 offset:18432
ds_read_b64_tr_b16 a[128:129], v116 offset:32768
ds_read_b64_tr_b16 a[130:131], v116 offset:34816
v_mfma_f32_16x16x32_bf16 v[4:7], a[156:159], a[76:79], v[4:7]
ds_read_b64_tr_b16 a[132:133], v116 offset:36864
ds_read_b64_tr_b16 a[134:135], v116 offset:38912
v_mfma_f32_16x16x32_bf16 v[4:7], a[152:155], a[72:75], v[4:7]
buffer_load_dwordx4 v[68:71], v109, s[8:11], s92 offen offset:1024 sc1
ds_read_b64_tr_b16 a[136:137], v116 offset:40960
v_mfma_f32_16x16x32_bf16 v[4:7], a[148:151], a[68:71], v[4:7]
ds_read_b64_tr_b16 a[138:139], v116 offset:43008
ds_read_b64_tr_b16 a[140:141], v116 offset:45056
ds_read_b64_tr_b16 a[142:143], v116 offset:47104
v_mfma_f32_16x16x32_bf16 v[4:7], a[144:147], a[64:67], v[4:7]
s_waitcnt lgkmcnt(9)
ds_read_b64_tr_b16 a[156:157], v117 offset:45056
ds_read_b64_tr_b16 a[158:159], v117 offset:47104
v_mfma_f32_16x16x32_bf16 v[8:11], a[160:163], a[64:67], v[8:11]
buffer_load_dwordx4 v[72:75], v109, s[8:11], s92 offen offset:2048 sc1
ds_read_b64_tr_b16 a[152:153], v117 offset:40960
v_mfma_f32_16x16x32_bf16 v[8:11], a[164:167], a[68:71], v[8:11]
ds_read_b64_tr_b16 a[154:155], v117 offset:43008
ds_read_b64_tr_b16 a[148:149], v117 offset:36864
v_mfma_f32_16x16x32_bf16 v[8:11], a[168:171], a[72:75], v[8:11]
ds_read_b64_tr_b16 a[150:151], v117 offset:38912
ds_read_b64_tr_b16 a[144:145], v117 offset:32768
ds_read_b64_tr_b16 a[146:147], v117 offset:34816
v_mfma_f32_16x16x32_bf16 v[8:11], a[172:175], a[76:79], v[8:11]
buffer_load_dwordx4 v[76:79], v109, s[8:11], s92 offen offset:3072 sc1
ds_read_b64_tr_b16 a[160:161], v118 offset:32768
v_mfma_f32_16x16x32_bf16 v[12:15], a[188:191], a[76:79], v[12:15]
ds_read_b64_tr_b16 a[162:163], v118 offset:34816
ds_read_b64_tr_b16 a[164:165], v118 offset:36864
v_mfma_f32_16x16x32_bf16 v[12:15], a[184:187], a[72:75], v[12:15]
ds_read_b64_tr_b16 a[166:167], v118 offset:38912
ds_read_b64_tr_b16 a[168:169], v118 offset:40960
v_mfma_f32_16x16x32_bf16 v[12:15], a[180:183], a[68:71], v[12:15]
s_waitcnt lgkmcnt(8)
buffer_load_dwordx4 v98, s[12:15], s32 offen offset:0 lds
ds_read_b64_tr_b16 a[170:171], v118 offset:43008
ds_read_b64_tr_b16 a[172:173], v118 offset:45056
v_mfma_f32_16x16x32_bf16 v[12:15], a[176:179], a[64:67], v[12:15]
s_waitcnt vmcnt(16)
ds_read_b64_tr_b16 a[174:175], v118 offset:47104
ds_read_b64_tr_b16 a[188:189], v119 offset:45056
ds_read_b64_tr_b16 a[190:191], v119 offset:47104
v_mfma_f32_16x16x32_bf16 v[0:3], a[128:131], a[80:83], v[0:3]
s_waitcnt vmcnt(15)
ds_read_b64_tr_b16 a[184:185], v119 offset:40960
ds_read_b64_tr_b16 a[186:187], v119 offset:43008
v_mfma_f32_16x16x32_bf16 v[0:3], a[132:135], a[84:87], v[0:3]
s_waitcnt vmcnt(14)
buffer_load_dwordx4 v98, s[12:15], s33 offen offset:1024 lds
ds_read_b64_tr_b16 a[180:181], v119 offset:36864
v_mfma_f32_16x16x32_bf16 v[0:3], a[136:139], a[88:91], v[0:3]
s_waitcnt vmcnt(14)
ds_read_b64_tr_b16 a[182:183], v119 offset:38912
ds_read_b64_tr_b16 a[176:177], v119 offset:32768
ds_read_b64_tr_b16 a[178:179], v119 offset:34816
v_mfma_f32_16x16x32_bf16 v[0:3], a[140:143], a[92:95], v[0:3]
s_barrier
ds_read_b64_tr_b16 a[128:129], v116 offset:49152
ds_read_b64_tr_b16 a[130:131], v116 offset:51200
v_mfma_f32_16x16x32_bf16 v[4:7], a[156:159], a[92:95], v[4:7]
buffer_load_dwordx4 v98, s[12:15], s34 offen offset:2048 lds
ds_read_b64_tr_b16 a[132:133], v116 offset:53248
v_mfma_f32_16x16x32_bf16 v[4:7], a[152:155], a[88:91], v[4:7]
s_waitcnt lgkmcnt(7)
ds_read_b64_tr_b16 a[134:135], v116 offset:55296
ds_read_b64_tr_b16 a[136:137], v116 offset:57344
v_mfma_f32_16x16x32_bf16 v[4:7], a[148:151], a[84:87], v[4:7]
ds_read_b64_tr_b16 a[138:139], v116 offset:59392
ds_read_b64_tr_b16 a[140:141], v116 offset:61440
ds_read_b64_tr_b16 a[142:143], v116 offset:63488
v_mfma_f32_16x16x32_bf16 v[4:7], a[144:147], a[80:83], v[4:7]
buffer_load_dwordx4 v98, s[12:15], s35 offen offset:3072 lds
ds_read_b64_tr_b16 a[156:157], v117 offset:61440
v_add_u32 v98, 0x40000, v98
v_mfma_f32_16x16x32_bf16 v[8:11], a[160:163], a[80:83], v[8:11]
s_add_u32 m0, s24, 0x1c000
ds_read_b64_tr_b16 a[158:159], v117 offset:63488
ds_read_b64_tr_b16 a[152:153], v117 offset:57344
v_mfma_f32_16x16x32_bf16 v[8:11], a[164:167], a[84:87], v[8:11]
ds_read_b64_tr_b16 a[154:155], v117 offset:59392
ds_read_b64_tr_b16 a[148:149], v117 offset:53248
v_mfma_f32_16x16x32_bf16 v[8:11], a[168:171], a[88:91], v[8:11]
buffer_load_dwordx4 v98, s[12:15], s32 offen offset:0 lds
ds_read_b64_tr_b16 a[150:151], v117 offset:55296
ds_read_b64_tr_b16 a[144:145], v117 offset:49152
v_mfma_f32_16x16x32_bf16 v[8:11], a[172:175], a[92:95], v[8:11]
ds_read_b64_tr_b16 a[146:147], v117 offset:51200
ds_read_b64_tr_b16 a[160:161], v118 offset:49152
ds_read_b64_tr_b16 a[162:163], v118 offset:51200
v_mfma_f32_16x16x32_bf16 v[12:15], a[188:191], a[92:95], v[12:15]
ds_read_b64_tr_b16 a[164:165], v118 offset:53248
ds_read_b64_tr_b16 a[166:167], v118 offset:55296
v_mfma_f32_16x16x32_bf16 v[12:15], a[184:187], a[88:91], v[12:15]
s_waitcnt lgkmcnt(9)
buffer_load_dwordx4 v98, s[12:15], s33 offen offset:1024 lds
ds_read_b64_tr_b16 a[168:169], v118 offset:57344
v_mfma_f32_16x16x32_bf16 v[12:15], a[180:183], a[84:87], v[12:15]
ds_read_b64_tr_b16 a[170:171], v118 offset:59392
ds_read_b64_tr_b16 a[172:173], v118 offset:61440
ds_read_b64_tr_b16 a[174:175], v118 offset:63488
v_mfma_f32_16x16x32_bf16 v[12:15], a[176:179], a[80:83], v[12:15]
s_waitcnt vmcnt(17)
ds_read_b64_tr_b16 a[188:189], v119 offset:61440
ds_read_b64_tr_b16 a[190:191], v119 offset:63488
v_mfma_f32_16x16x32_bf16 v[0:3], a[128:131], a[96:99], v[0:3]
s_waitcnt vmcnt(16)
buffer_load_dwordx4 v98, s[12:15], s34 offen offset:2048 lds
ds_read_b64_tr_b16 a[184:185], v119 offset:57344
v_mfma_f32_16x16x32_bf16 v[0:3], a[132:135], a[100:103], v[0:3]
s_waitcnt vmcnt(16)
ds_read_b64_tr_b16 a[186:187], v119 offset:59392
ds_read_b64_tr_b16 a[180:181], v119 offset:53248
v_mfma_f32_16x16x32_bf16 v[0:3], a[136:139], a[104:107], v[0:3]
s_waitcnt vmcnt(15)
ds_read_b64_tr_b16 a[182:183], v119 offset:55296
ds_read_b64_tr_b16 a[176:177], v119 offset:49152
ds_read_b64_tr_b16 a[178:179], v119 offset:51200
v_mfma_f32_16x16x32_bf16 v[0:3], a[140:143], a[108:111], v[0:3]
s_barrier
buffer_load_dwordx4 v98, s[12:15], s35 offen offset:3072 lds
ds_read_b64_tr_b16 a[128:129], v120 offset:0
v_add_u32 v98, 0x40000, v98
v_mfma_f32_16x16x32_bf16 v[4:7], a[156:159], a[108:111], v[4:7]
s_waitcnt lgkmcnt(7)
s_add_u32 m0, s24, 0x20000
ds_read_b64_tr_b16 a[130:131], v120 offset:2048
ds_read_b64_tr_b16 a[132:133], v120 offset:4096
v_mfma_f32_16x16x32_bf16 v[4:7], a[152:155], a[104:107], v[4:7]
ds_read_b64_tr_b16 a[134:135], v120 offset:6144
ds_read_b64_tr_b16 a[136:137], v120 offset:8192
v_mfma_f32_16x16x32_bf16 v[4:7], a[148:151], a[100:103], v[4:7]
buffer_load_dwordx4 v98, s[12:15], s32 offen offset:0 lds
ds_read_b64_tr_b16 a[138:139], v120 offset:10240
ds_read_b64_tr_b16 a[140:141], v120 offset:12288
v_mfma_f32_16x16x32_bf16 v[4:7], a[144:147], a[96:99], v[4:7]
ds_read_b64_tr_b16 a[142:143], v120 offset:14336
ds_read_b64_tr_b16 a[156:157], v121 offset:12288
ds_read_b64_tr_b16 a[158:159], v121 offset:14336
v_mfma_f32_16x16x32_bf16 v[8:11], a[160:163], a[96:99], v[8:11]
ds_read_b64_tr_b16 a[152:153], v121 offset:8192
ds_read_b64_tr_b16 a[154:155], v121 offset:10240
v_mfma_f32_16x16x32_bf16 v[8:11], a[164:167], a[100:103], v[8:11]
buffer_load_dwordx4 v98, s[12:15], s33 offen offset:1024 lds
ds_read_b64_tr_b16 a[148:149], v121 offset:4096
v_mfma_f32_16x16x32_bf16 v[8:11], a[168:171], a[104:107], v[8:11]
ds_read_b64_tr_b16 a[150:151], v121 offset:6144
ds_read_b64_tr_b16 a[144:145], v121 offset:0
ds_read_b64_tr_b16 a[146:147], v121 offset:2048
v_mfma_f32_16x16x32_bf16 v[8:11], a[172:175], a[108:111], v[8:11]
ds_read_b64_tr_b16 a[160:161], v122 offset:0
ds_read_b64_tr_b16 a[162:163], v122 offset:2048
v_mfma_f32_16x16x32_bf16 v[12:15], a[188:191], a[108:111], v[12:15]
s_waitcnt lgkmcnt(8)
buffer_load_dwordx4 v98, s[12:15], s34 offen offset:2048 lds
ds_read_b64_tr_b16 a[164:165], v122 offset:4096
v_mfma_f32_16x16x32_bf16 v[12:15], a[184:187], a[104:107], v[12:15]
ds_read_b64_tr_b16 a[166:167], v122 offset:6144
ds_read_b64_tr_b16 a[168:169], v122 offset:8192
v_mfma_f32_16x16x32_bf16 v[12:15], a[180:183], a[100:103], v[12:15]
ds_read_b64_tr_b16 a[170:171], v122 offset:10240
ds_read_b64_tr_b16 a[172:173], v122 offset:12288
ds_read_b64_tr_b16 a[174:175], v122 offset:14336
v_mfma_f32_16x16x32_bf16 v[12:15], a[176:179], a[96:99], v[12:15]
s_waitcnt vmcnt(18)
buffer_load_dwordx4 v98, s[12:15], s35 offen offset:3072 lds
ds_read_b64_tr_b16 a[188:189], v123 offset:12288
v_add_u32 v98, 0x40000, v98
v_mfma_f32_16x16x32_bf16 v[0:3], a[128:131], a[112:115], v[0:3]
s_waitcnt vmcnt(18)
s_add_u32 m0, s24, 0x0
ds_read_b64_tr_b16 a[190:191], v123 offset:14336
ds_read_b64_tr_b16 a[184:185], v123 offset:8192
v_mfma_f32_16x16x32_bf16 v[0:3], a[132:135], a[116:119], v[0:3]
s_waitcnt vmcnt(17)
ds_read_b64_tr_b16 a[186:187], v123 offset:10240
ds_read_b64_tr_b16 a[180:181], v123 offset:4096
v_mfma_f32_16x16x32_bf16 v[0:3], a[136:139], a[120:123], v[0:3]
s_waitcnt vmcnt(16)
buffer_load_dwordx4 v98, s[12:15], s32 offen offset:0 lds
ds_read_b64_tr_b16 a[182:183], v123 offset:6144
ds_read_b64_tr_b16 a[176:177], v123 offset:0
v_mfma_f32_16x16x32_bf16 v[0:3], a[140:143], a[124:127], v[0:3]
s_barrier
ds_read_b64_tr_b16 a[178:179], v123 offset:2048
ds_read_b64_tr_b16 a[128:129], v120 offset:16384
ds_read_b64_tr_b16 a[130:131], v120 offset:18432
v_mfma_f32_16x16x32_bf16 v[4:7], a[156:159], a[124:127], v[4:7]
s_waitcnt lgkmcnt(9)
ds_read_b64_tr_b16 a[132:133], v120 offset:20480
ds_read_b64_tr_b16 a[134:135], v120 offset:22528
v_mfma_f32_16x16x32_bf16 v[4:7], a[152:155], a[120:123], v[4:7]
buffer_load_dwordx4 v98, s[12:15], s33 offen offset:1024 lds
ds_read_b64_tr_b16 a[136:137], v120 offset:24576
v_mfma_f32_16x16x32_bf16 v[4:7], a[148:151], a[116:119], v[4:7]
ds_read_b64_tr_b16 a[138:139], v120 offset:26624
ds_read_b64_tr_b16 a[140:141], v120 offset:28672
ds_read_b64_tr_b16 a[142:143], v120 offset:30720
v_mfma_f32_16x16x32_bf16 v[4:7], a[144:147], a[112:115], v[4:7]
ds_read_b64_tr_b16 a[156:157], v121 offset:28672
ds_read_b64_tr_b16 a[158:159], v121 offset:30720
v_mfma_f32_16x16x32_bf16 v[8:11], a[160:163], a[112:115], v[8:11]
buffer_load_dwordx4 v98, s[12:15], s34 offen offset:2048 lds
ds_read_b64_tr_b16 a[152:153], v121 offset:24576
v_mfma_f32_16x16x32_bf16 v[8:11], a[164:167], a[116:119], v[8:11]
ds_read_b64_tr_b16 a[154:155], v121 offset:26624
ds_read_b64_tr_b16 a[148:149], v121 offset:20480
v_mfma_f32_16x16x32_bf16 v[8:11], a[168:171], a[120:123], v[8:11]
ds_read_b64_tr_b16 a[150:151], v121 offset:22528
ds_read_b64_tr_b16 a[144:145], v121 offset:16384
ds_read_b64_tr_b16 a[146:147], v121 offset:18432
v_mfma_f32_16x16x32_bf16 v[8:11], a[172:175], a[124:127], v[8:11]
s_waitcnt lgkmcnt(8)
buffer_load_dwordx4 v98, s[12:15], s35 offen offset:3072 lds
ds_read_b64_tr_b16 a[160:161], v122 offset:16384
v_add_u32 v98, 0x40000, v98
v_mfma_f32_16x16x32_bf16 v[12:15], a[188:191], a[124:127], v[12:15]
s_add_u32 m0, s24, 0x4000
ds_read_b64_tr_b16 a[162:163], v122 offset:18432
ds_read_b64_tr_b16 a[164:165], v122 offset:20480
v_mfma_f32_16x16x32_bf16 v[12:15], a[184:187], a[120:123], v[12:15]
ds_read_b64_tr_b16 a[166:167], v122 offset:22528
ds_read_b64_tr_b16 a[168:169], v122 offset:24576
v_mfma_f32_16x16x32_bf16 v[12:15], a[180:183], a[116:119], v[12:15]
buffer_load_dwordx4 v98, s[12:15], s32 offen offset:0 lds
ds_read_b64_tr_b16 a[170:171], v122 offset:26624
ds_read_b64_tr_b16 a[172:173], v122 offset:28672
v_mfma_f32_16x16x32_bf16 v[12:15], a[176:179], a[112:115], v[12:15]
ds_read_b64_tr_b16 a[174:175], v122 offset:30720
ds_read_b64_tr_b16 a[188:189], v123 offset:28672
ds_read_b64_tr_b16 a[190:191], v123 offset:30720
v_mfma_f32_16x16x32_bf16 v[16:19], a[128:131], a[0:3], 0
s_add_u32 s26, s31, 0x800000
ds_read_b64_tr_b16 a[184:185], v123 offset:24576
ds_read_b64_tr_b16 a[186:187], v123 offset:26624
v_mfma_f32_16x16x32_bf16 v[16:19], a[132:135], a[4:7], v[16:19]
buffer_load_dwordx4 v98, s[12:15], s33 offen offset:1024 lds
ds_read_b64_tr_b16 a[180:181], v123 offset:20480
v_mfma_f32_16x16x32_bf16 v[16:19], a[136:139], a[8:11], v[16:19]
ds_read_b64_tr_b16 a[182:183], v123 offset:22528
ds_read_b64_tr_b16 a[176:177], v123 offset:16384
ds_read_b64_tr_b16 a[178:179], v123 offset:18432
v_mfma_f32_16x16x32_bf16 v[16:19], a[140:143], a[12:15], v[16:19]
s_waitcnt vmcnt(14)
s_barrier
s_waitcnt lgkmcnt(9)
ds_read_b64_tr_b16 a[128:129], v120 offset:32768
ds_read_b64_tr_b16 a[130:131], v120 offset:34816
v_mfma_f32_16x16x32_bf16 v[20:23], a[156:159], a[12:15], 0
buffer_load_dwordx4 v98, s[12:15], s34 offen offset:2048 lds
ds_read_b64_tr_b16 a[132:133], v120 offset:36864
v_mov_b32 v133, s58
v_lshlrev_b32 v124, 16, v64
v_mfma_f32_16x16x32_bf16 v[20:23], a[152:155], a[8:11], v[20:23]
ds_read_b64_tr_b16 a[134:135], v120 offset:38912
ds_read_b64_tr_b16 a[136:137], v120 offset:40960
v_and_b32 v125, 0xffff0000, v64
v_add_f32 v0, v0, v124
v_mfma_f32_16x16x32_bf16 v[20:23], a[148:151], a[4:7], v[20:23]
ds_read_b64_tr_b16 a[138:139], v120 offset:43008
ds_read_b64_tr_b16 a[140:141], v120 offset:45056
ds_read_b64_tr_b16 a[142:143], v120 offset:47104
v_add_f32 v1, v1, v125
v_mfma_f32_16x16x32_bf16 v[20:23], a[144:147], a[0:3], v[20:23]
buffer_load_dwordx4 v98, s[12:15], s35 offen offset:3072 lds
ds_read_b64_tr_b16 a[156:157], v121 offset:45056
v_add_u32 v98, 0x40000, v98
v_cvt_pk_bf16_f32 v64, v0, v1
v_mfma_f32_16x16x32_bf16 v[24:27], a[160:163], a[0:3], 0
s_add_u32 m0, s24, 0x8000
ds_read_b64_tr_b16 a[158:159], v121 offset:47104
ds_read_b64_tr_b16 a[152:153], v121 offset:40960
v_lshlrev_b32 v126, 16, v65
v_and_b32 v127, 0xffff0000, v65
v_mfma_f32_16x16x32_bf16 v[24:27], a[164:167], a[4:7], v[24:27]
ds_read_b64_tr_b16 a[154:155], v121 offset:43008
ds_read_b64_tr_b16 a[148:149], v121 offset:36864
v_add_f32 v2, v2, v126
v_add_f32 v3, v3, v127
v_mfma_f32_16x16x32_bf16 v[24:27], a[168:171], a[8:11], v[24:27]
s_waitcnt lgkmcnt(8)
buffer_load_dwordx4 v98, s[12:15], s32 offen offset:0 lds
ds_read_b64_tr_b16 a[150:151], v121 offset:38912
ds_read_b64_tr_b16 a[144:145], v121 offset:32768
v_cvt_pk_bf16_f32 v65, v2, v3
v_lshlrev_b32 v124, 16, v66
v_mfma_f32_16x16x32_bf16 v[24:27], a[172:175], a[12:15], v[24:27]
ds_read_b64_tr_b16 a[146:147], v121 offset:34816
ds_read_b64_tr_b16 a[160:161], v122 offset:32768
ds_read_b64_tr_b16 a[162:163], v122 offset:34816
v_and_b32 v125, 0xffff0000, v66
v_add_f32 v4, v4, v124
v_mfma_f32_16x16x32_bf16 v[28:31], a[188:191], a[12:15], 0
ds_read_b64_tr_b16 a[164:165], v122 offset:36864
ds_read_b64_tr_b16 a[166:167], v122 offset:38912
v_add_f32 v5, v5, v125
v_cvt_pk_bf16_f32 v66, v4, v5
v_lshlrev_b32 v126, 16, v67
v_mfma_f32_16x16x32_bf16 v[28:31], a[184:187], a[8:11], v[28:31]
buffer_load_dwordx4 v98, s[12:15], s33 offen offset:1024 lds
ds_read_b64_tr_b16 a[168:169], v122 offset:40960
v_and_b32 v127, 0xffff0000, v67
v_add_f32 v6, v6, v126
v_add_f32 v7, v7, v127
v_mfma_f32_16x16x32_bf16 v[28:31], a[180:183], a[4:7], v[28:31]
ds_read_b64_tr_b16 a[170:171], v122 offset:43008
ds_read_b64_tr_b16 a[172:173], v122 offset:45056
ds_read_b64_tr_b16 a[174:175], v122 offset:47104
v_cvt_pk_bf16_f32 v67, v6, v7
v_mfma_f32_16x16x32_bf16 v[28:31], a[176:179], a[0:3], v[28:31]
ds_read_b64_tr_b16 a[188:189], v123 offset:45056
ds_read_b64_tr_b16 a[190:191], v123 offset:47104
buffer_store_dwordx4 v[64:67], v109, s[8:11], s26 offen offset:0 sc1
v_lshlrev_b32 v124, 16, v68
v_and_b32 v125, 0xffff0000, v68
v_mfma_f32_16x16x32_bf16 v[16:19], a[128:131], a[16:19], v[16:19]
buffer_load_dwordx4 v98, s[12:15], s34 offen offset:2048 lds
ds_read_b64_tr_b16 a[184:185], v123 offset:40960
v_add_f32 v8, v8, v124
v_add_f32 v9, v9, v125
v_cvt_pk_bf16_f32 v68, v8, v9
v_mfma_f32_16x16x32_bf16 v[16:19], a[132:135], a[20:23], v[16:19]
s_waitcnt lgkmcnt(7)
ds_read_b64_tr_b16 a[186:187], v123 offset:43008
ds_read_b64_tr_b16 a[180:181], v123 offset:36864
v_lshlrev_b32 v126, 16, v69
v_and_b32 v127, 0xffff0000, v69
v_add_f32 v10, v10, v126
v_mfma_f32_16x16x32_bf16 v[16:19], a[136:139], a[24:27], v[16:19]
ds_read_b64_tr_b16 a[182:183], v123 offset:38912
ds_read_b64_tr_b16 a[176:177], v123 offset:32768
ds_read_b64_tr_b16 a[178:179], v123 offset:34816
v_add_f32 v11, v11, v127
v_cvt_pk_bf16_f32 v69, v10, v11
v_mfma_f32_16x16x32_bf16 v[16:19], a[140:143], a[28:31], v[16:19]
s_waitcnt vmcnt(16)
s_barrier
buffer_load_dwordx4 v98, s[12:15], s35 offen offset:3072 lds
ds_read_b64_tr_b16 a[128:129], v120 offset:49152
v_add_u32 v98, 0x40000, v98
v_lshlrev_b32 v124, 16, v70
v_mfma_f32_16x16x32_bf16 v[20:23], a[156:159], a[28:31], v[20:23]
s_add_u32 m0, s24, 0xc000
ds_read_b64_tr_b16 a[130:131], v120 offset:51200
ds_read_b64_tr_b16 a[132:133], v120 offset:53248
v_and_b32 v125, 0xffff0000, v70
v_add_f32 v12, v12, v124
v_add_f32 v13, v13, v125
v_mfma_f32_16x16x32_bf16 v[20:23], a[152:155], a[24:27], v[20:23]
ds_read_b64_tr_b16 a[134:135], v120 offset:55296
ds_read_b64_tr_b16 a[136:137], v120 offset:57344
v_cvt_pk_bf16_f32 v70, v12, v13
v_lshlrev_b32 v126, 16, v71
v_mfma_f32_16x16x32_bf16 v[20:23], a[148:151], a[20:23], v[20:23]
buffer_load_dwordx4 v98, s[12:15], s32 offen offset:0 lds
ds_read_b64_tr_b16 a[138:139], v120 offset:59392
ds_read_b64_tr_b16 a[140:141], v120 offset:61440
v_and_b32 v127, 0xffff0000, v71
v_mfma_f32_16x16x32_bf16 v[20:23], a[144:147], a[16:19], v[20:23]
ds_read_b64_tr_b16 a[142:143], v120 offset:63488
ds_read_b64_tr_b16 a[156:157], v121 offset:61440
ds_read_b64_tr_b16 a[158:159], v121 offset:63488
v_add_f32 v14, v14, v126
v_mfma_f32_16x16x32_bf16 v[24:27], a[160:163], a[16:19], v[24:27]
ds_read_b64_tr_b16 a[152:153], v121 offset:57344
ds_read_b64_tr_b16 a[154:155], v121 offset:59392
v_add_f32 v15, v15, v127
v_cvt_pk_bf16_f32 v71, v14, v15
v_mfma_f32_16x16x32_bf16 v[24:27], a[164:167], a[20:23], v[24:27]
s_waitcnt lgkmcnt(9)
buffer_load_dwordx4 v98, s[12:15], s33 offen offset:1024 lds
ds_read_b64_tr_b16 a[148:149], v121 offset:53248
buffer_store_dwordx4 v[68:71], v109, s[8:11], s26 offen offset:1024 sc1
v_mfma_f32_16x16x32_bf16 v[24:27], a[168:171], a[24:27], v[24:27]
ds_read_b64_tr_b16 a[150:151], v121 offset:55296
ds_read_b64_tr_b16 a[144:145], v121 offset:49152
ds_read_b64_tr_b16 a[146:147], v121 offset:51200
v_mfma_f32_16x16x32_bf16 v[24:27], a[172:175], a[28:31], v[24:27]
ds_read_b64_tr_b16 a[160:161], v122 offset:49152
ds_read_b64_tr_b16 a[162:163], v122 offset:51200
v_mfma_f32_16x16x32_bf16 v[28:31], a[188:191], a[28:31], v[28:31]
buffer_load_dwordx4 v98, s[12:15], s34 offen offset:2048 lds
ds_read_b64_tr_b16 a[164:165], v122 offset:53248
v_mfma_f32_16x16x32_bf16 v[28:31], a[184:187], a[24:27], v[28:31]
ds_read_b64_tr_b16 a[166:167], v122 offset:55296
ds_read_b64_tr_b16 a[168:169], v122 offset:57344
v_mfma_f32_16x16x32_bf16 v[28:31], a[180:183], a[20:23], v[28:31]
ds_read_b64_tr_b16 a[170:171], v122 offset:59392
ds_read_b64_tr_b16 a[172:173], v122 offset:61440
ds_read_b64_tr_b16 a[174:175], v122 offset:63488
v_mfma_f32_16x16x32_bf16 v[28:31], a[176:179], a[16:19], v[28:31]
buffer_load_dwordx4 v98, s[12:15], s35 offen offset:3072 lds
ds_read_b64_tr_b16 a[188:189], v123 offset:61440
v_mfma_f32_16x16x32_bf16 v[16:19], a[128:131], a[32:35], v[16:19]
s_waitcnt lgkmcnt(7)
ds_read_b64_tr_b16 a[190:191], v123 offset:63488
ds_read_b64_tr_b16 a[184:185], v123 offset:57344
v_mfma_f32_16x16x32_bf16 v[16:19], a[132:135], a[36:39], v[16:19]
ds_read_b64_tr_b16 a[186:187], v123 offset:59392
ds_read_b64_tr_b16 a[180:181], v123 offset:53248
v_mfma_f32_16x16x32_bf16 v[16:19], a[136:139], a[40:43], v[16:19]
ds_read_b64_tr_b16 a[182:183], v123 offset:55296
ds_read_b64_tr_b16 a[176:177], v123 offset:49152
ds_read_b64_tr_b16 a[178:179], v123 offset:51200
v_mfma_f32_16x16x32_bf16 v[16:19], a[140:143], a[44:47], v[16:19]
s_waitcnt vmcnt(18)
s_barrier
ds_read_b64_tr_b16 a[128:129], v112 offset:0
ds_read_b64_tr_b16 a[130:131], v112 offset:2048
v_mfma_f32_16x16x32_bf16 v[20:23], a[156:159], a[44:47], v[20:23]
ds_read_b64_tr_b16 a[132:133], v112 offset:4096
ds_read_b64_tr_b16 a[134:135], v112 offset:6144
v_mfma_f32_16x16x32_bf16 v[20:23], a[152:155], a[40:43], v[20:23]
ds_read_b64_tr_b16 a[136:137], v112 offset:8192
ds_read_b64_tr_b16 a[138:139], v112 offset:10240
v_mfma_f32_16x16x32_bf16 v[20:23], a[148:151], a[36:39], v[20:23]
ds_read_b64_tr_b16 a[140:141], v112 offset:12288
ds_read_b64_tr_b16 a[142:143], v112 offset:14336
v_mfma_f32_16x16x32_bf16 v[20:23], a[144:147], a[32:35], v[20:23]
ds_read_b64_tr_b16 a[156:157], v113 offset:12288
ds_read_b64_tr_b16 a[158:159], v113 offset:14336
v_mfma_f32_16x16x32_bf16 v[24:27], a[160:163], a[32:35], v[24:27]
s_waitcnt lgkmcnt(8)
ds_read_b64_tr_b16 a[152:153], v113 offset:8192
ds_read_b64_tr_b16 a[154:155], v113 offset:10240
v_mfma_f32_16x16x32_bf16 v[24:27], a[164:167], a[36:39], v[24:27]
ds_read_b64_tr_b16 a[148:149], v113 offset:4096
ds_read_b64_tr_b16 a[150:151], v113 offset:6144
v_mfma_f32_16x16x32_bf16 v[24:27], a[168:171], a[40:43], v[24:27]
ds_read_b64_tr_b16 a[144:145], v113 offset:0
ds_read_b64_tr_b16 a[146:147], v113 offset:2048
v_mfma_f32_16x16x32_bf16 v[24:27], a[172:175], a[44:47], v[24:27]
ds_read_b64_tr_b16 a[160:161], v114 offset:0
ds_read_b64_tr_b16 a[162:163], v114 offset:2048
v_mfma_f32_16x16x32_bf16 v[28:31], a[188:191], a[44:47], v[28:31]
ds_read_b64_tr_b16 a[164:165], v114 offset:4096
ds_read_b64_tr_b16 a[166:167], v114 offset:6144
v_mfma_f32_16x16x32_bf16 v[28:31], a[184:187], a[40:43], v[28:31]
ds_read_b64_tr_b16 a[168:169], v114 offset:8192
ds_read_b64_tr_b16 a[170:171], v114 offset:10240
v_mfma_f32_16x16x32_bf16 v[28:31], a[180:183], a[36:39], v[28:31]
ds_read_b64_tr_b16 a[172:173], v114 offset:12288
ds_read_b64_tr_b16 a[174:175], v114 offset:14336
v_mfma_f32_16x16x32_bf16 v[28:31], a[176:179], a[32:35], v[28:31]
ds_read_b64_tr_b16 a[188:189], v115 offset:12288
ds_read_b64_tr_b16 a[190:191], v115 offset:14336
v_mfma_f32_16x16x32_bf16 v[16:19], a[128:131], a[48:51], v[16:19]
s_waitcnt lgkmcnt(8)
ds_read_b64_tr_b16 a[184:185], v115 offset:8192
ds_read_b64_tr_b16 a[186:187], v115 offset:10240
v_mfma_f32_16x16x32_bf16 v[16:19], a[132:135], a[52:55], v[16:19]
ds_read_b64_tr_b16 a[180:181], v115 offset:4096
ds_read_b64_tr_b16 a[182:183], v115 offset:6144
v_mfma_f32_16x16x32_bf16 v[16:19], a[136:139], a[56:59], v[16:19]
ds_read_b64_tr_b16 a[176:177], v115 offset:0
ds_read_b64_tr_b16 a[178:179], v115 offset:2048
v_mfma_f32_16x16x32_bf16 v[16:19], a[140:143], a[60:63], v[16:19]
s_waitcnt vmcnt(14)
s_barrier
ds_read_b64_tr_b16 a[128:129], v116 offset:0
ds_read_b64_tr_b16 a[130:131], v116 offset:2048
v_mfma_f32_16x16x32_bf16 v[20:23], a[156:159], a[60:63], v[20:23]
ds_read_b64_tr_b16 a[132:133], v116 offset:4096
ds_read_b64_tr_b16 a[134:135], v116 offset:6144
v_mfma_f32_16x16x32_bf16 v[20:23], a[152:155], a[56:59], v[20:23]
ds_read_b64_tr_b16 a[136:137], v116 offset:8192
ds_read_b64_tr_b16 a[138:139], v116 offset:10240
v_mfma_f32_16x16x32_bf16 v[20:23], a[148:151], a[52:55], v[20:23]
ds_read_b64_tr_b16 a[140:141], v116 offset:12288
ds_read_b64_tr_b16 a[142:143], v116 offset:14336
v_mfma_f32_16x16x32_bf16 v[20:23], a[144:147], a[48:51], v[20:23]
ds_read_b64_tr_b16 a[156:157], v117 offset:12288
ds_read_b64_tr_b16 a[158:159], v117 offset:14336
v_mfma_f32_16x16x32_bf16 v[24:27], a[160:163], a[48:51], v[24:27]
s_waitcnt lgkmcnt(8)
ds_read_b64_tr_b16 a[152:153], v117 offset:8192
ds_read_b64_tr_b16 a[154:155], v117 offset:10240
v_mfma_f32_16x16x32_bf16 v[24:27], a[164:167], a[52:55], v[24:27]
ds_read_b64_tr_b16 a[148:149], v117 offset:4096
ds_read_b64_tr_b16 a[150:151], v117 offset:6144
v_mfma_f32_16x16x32_bf16 v[24:27], a[168:171], a[56:59], v[24:27]
ds_read_b64_tr_b16 a[144:145], v117 offset:0
ds_read_b64_tr_b16 a[146:147], v117 offset:2048
v_mfma_f32_16x16x32_bf16 v[24:27], a[172:175], a[60:63], v[24:27]
ds_read_b64_tr_b16 a[160:161], v118 offset:0
ds_read_b64_tr_b16 a[162:163], v118 offset:2048
v_mfma_f32_16x16x32_bf16 v[28:31], a[188:191], a[60:63], v[28:31]
ds_read_b64_tr_b16 a[164:165], v118 offset:4096
ds_read_b64_tr_b16 a[166:167], v118 offset:6144
v_mfma_f32_16x16x32_bf16 v[28:31], a[184:187], a[56:59], v[28:31]
ds_read_b64_tr_b16 a[168:169], v118 offset:8192
ds_read_b64_tr_b16 a[170:171], v118 offset:10240
v_mfma_f32_16x16x32_bf16 v[28:31], a[180:183], a[52:55], v[28:31]
ds_read_b64_tr_b16 a[172:173], v118 offset:12288
ds_read_b64_tr_b16 a[174:175], v118 offset:14336
v_mfma_f32_16x16x32_bf16 v[28:31], a[176:179], a[48:51], v[28:31]
ds_read_b64_tr_b16 a[188:189], v119 offset:12288
ds_read_b64_tr_b16 a[190:191], v119 offset:14336
v_mfma_f32_16x16x32_bf16 v[16:19], a[128:131], a[64:67], v[16:19]
s_waitcnt lgkmcnt(8)
ds_read_b64_tr_b16 a[184:185], v119 offset:8192
ds_read_b64_tr_b16 a[186:187], v119 offset:10240
v_mfma_f32_16x16x32_bf16 v[16:19], a[132:135], a[68:71], v[16:19]
ds_read_b64_tr_b16 a[180:181], v119 offset:4096
ds_read_b64_tr_b16 a[182:183], v119 offset:6144
v_mfma_f32_16x16x32_bf16 v[16:19], a[136:139], a[72:75], v[16:19]
ds_read_b64_tr_b16 a[176:177], v119 offset:0
ds_read_b64_tr_b16 a[178:179], v119 offset:2048
v_mfma_f32_16x16x32_bf16 v[16:19], a[140:143], a[76:79], v[16:19]
s_waitcnt vmcnt(10)
s_barrier
ds_read_b64_tr_b16 a[128:129], v116 offset:16384
ds_read_b64_tr_b16 a[130:131], v116 offset:18432
v_mfma_f32_16x16x32_bf16 v[20:23], a[156:159], a[76:79], v[20:23]
s_add_u32 m0, s4, 0x1a000
s_nop 0
buffer_load_dwordx4 v232, s[16:19], 0 offen offset:0 lds
ds_read_b64_tr_b16 a[132:133], v116 offset:20480
v_mfma_f32_16x16x32_bf16 v[20:23], a[152:155], a[72:75], v[20:23]
ds_read_b64_tr_b16 a[134:135], v116 offset:22528
ds_read_b64_tr_b16 a[136:137], v116 offset:24576
v_mfma_f32_16x16x32_bf16 v[20:23], a[148:151], a[68:71], v[20:23]
ds_read_b64_tr_b16 a[138:139], v116 offset:26624
ds_read_b64_tr_b16 a[140:141], v116 offset:28672
ds_read_b64_tr_b16 a[142:143], v116 offset:30720
v_mfma_f32_16x16x32_bf16 v[20:23], a[144:147], a[64:67], v[20:23]
buffer_load_dwordx4 v233, s[16:19], 0 offen offset:1024 lds
ds_read_b64_tr_b16 a[156:157], v117 offset:28672
v_mfma_f32_16x16x32_bf16 v[24:27], a[160:163], a[64:67], v[24:27]
s_waitcnt lgkmcnt(7)
ds_read_b64_tr_b16 a[158:159], v117 offset:30720
ds_read_b64_tr_b16 a[152:153], v117 offset:24576
v_mfma_f32_16x16x32_bf16 v[24:27], a[164:167], a[68:71], v[24:27]
ds_read_b64_tr_b16 a[154:155], v117 offset:26624
ds_read_b64_tr_b16 a[148:149], v117 offset:20480
v_mfma_f32_16x16x32_bf16 v[24:27], a[168:171], a[72:75], v[24:27]
buffer_load_dwordx4 v234, s[16:19], 0 offen offset:2048 lds
ds_read_b64_tr_b16 a[150:151], v117 offset:22528
ds_read_b64_tr_b16 a[144:145], v117 offset:16384
v_mfma_f32_16x16x32_bf16 v[24:27], a[172:175], a[76:79], v[24:27]
ds_read_b64_tr_b16 a[146:147], v117 offset:18432
ds_read_b64_tr_b16 a[160:161], v118 offset:16384
ds_read_b64_tr_b16 a[162:163], v118 offset:18432
v_mfma_f32_16x16x32_bf16 v[28:31], a[188:191], a[76:79], v[28:31]
ds_read_b64_tr_b16 a[164:165], v118 offset:20480
ds_read_b64_tr_b16 a[166:167], v118 offset:22528
v_mfma_f32_16x16x32_bf16 v[28:31], a[184:187], a[72:75], v[28:31]
buffer_load_dwordx4 v235, s[16:19], 0 offen offset:3072 lds
ds_read_b64_tr_b16 a[168:169], v118 offset:24576
v_mfma_f32_16x16x32_bf16 v[28:31], a[180:183], a[68:71], v[28:31]
s_add_u32 m0, s4, 0x1b000
ds_read_b64_tr_b16 a[170:171], v118 offset:26624
ds_read_b64_tr_b16 a[172:173], v118 offset:28672
ds_read_b64_tr_b16 a[174:175], v118 offset:30720
v_mfma_f32_16x16x32_bf16 v[28:31], a[176:179], a[64:67], v[28:31]
ds_read_b64_tr_b16 a[188:189], v119 offset:28672
ds_read_b64_tr_b16 a[190:191], v119 offset:30720
v_mfma_f32_16x16x32_bf16 v[16:19], a[128:131], a[80:83], v[16:19]
s_waitcnt lgkmcnt(8)
buffer_load_dwordx4 v236, s[16:19], 0 offen offset:0 lds
ds_read_b64_tr_b16 a[184:185], v119 offset:24576
v_mfma_f32_16x16x32_bf16 v[16:19], a[132:135], a[84:87], v[16:19]
ds_read_b64_tr_b16 a[186:187], v119 offset:26624
ds_read_b64_tr_b16 a[180:181], v119 offset:20480
v_mfma_f32_16x16x32_bf16 v[16:19], a[136:139], a[88:91], v[16:19]
s_waitcnt vmcnt(7)
buffer_load_dwordx4 v237, s[16:19], 0 offen offset:1024 lds
ds_read_b64_tr_b16 a[182:183], v119 offset:22528
ds_read_b64_tr_b16 a[176:177], v119 offset:16384
v_mfma_f32_16x16x32_bf16 v[16:19], a[140:143], a[92:95], v[16:19]
s_barrier
s_cmp_lg_u32 s20, 3
s_cbranch_scc1 L_k2e_ns
s_mov_b64 exec, 1
buffer_store_dword v133, off, s[8:11], s100 sc1
s_mov_b64 exec, -1
L_k2e_ns:
s_add_u32 s100, s100, 0x88000
buffer_load_dwordx4 v238, s[16:19], 0 offen offset:2048 lds
ds_read_b64_tr_b16 a[178:179], v119 offset:18432
v_mfma_f32_16x16x32_bf16 v[20:23], a[156:159], a[92:95], v[20:23]
s_add_u32 m0, s4, 0x21000
s_nop 0
buffer_load_dwordx4 v232, s[16:19], s5 offen offset:0 lds
ds_read_b64_tr_b16 a[128:129], v116 offset:32768
v_mfma_f32_16x16x32_bf16 v[20:23], a[152:155], a[88:91], v[20:23]
ds_read_b64_tr_b16 a[130:131], v116 offset:34816
ds_read_b64_tr_b16 a[132:133], v116 offset:36864
v_mfma_f32_16x16x32_bf16 v[20:23], a[148:151], a[84:87], v[20:23]
ds_read_b64_tr_b16 a[134:135], v116 offset:38912
ds_read_b64_tr_b16 a[136:137], v116 offset:40960
ds_read_b64_tr_b16 a[138:139], v116 offset:43008
v_mfma_f32_16x16x32_bf16 v[20:23], a[144:147], a[80:83], v[20:23]
ds_read_b64_tr_b16 a[140:141], v116 offset:45056
ds_read_b64_tr_b16 a[142:143], v116 offset:47104
ds_read_b64_tr_b16 a[156:157], v117 offset:45056
v_mfma_f32_16x16x32_bf16 v[24:27], a[160:163], a[80:83], v[24:27]
s_waitcnt lgkmcnt(9)
ds_read_b64_tr_b16 a[158:159], v117 offset:47104
ds_read_b64_tr_b16 a[152:153], v117 offset:40960
v_mfma_f32_16x16x32_bf16 v[24:27], a[164:167], a[84:87], v[24:27]
ds_read_b64_tr_b16 a[154:155], v117 offset:43008
ds_read_b64_tr_b16 a[148:149], v117 offset:36864
v_mfma_f32_16x16x32_bf16 v[24:27], a[168:171], a[88:91], v[24:27]
ds_read_b64_tr_b16 a[150:151], v117 offset:38912
ds_read_b64_tr_b16 a[144:145], v117 offset:32768
ds_read_b64_tr_b16 a[146:147], v117 offset:34816
v_mfma_f32_16x16x32_bf16 v[24:27], a[172:175], a[92:95], v[24:27]
ds_read_b64_tr_b16 a[160:161], v118 offset:32768
ds_read_b64_tr_b16 a[162:163], v118 offset:34816
v_mfma_f32_16x16x32_bf16 v[28:31], a[188:191], a[92:95], v[28:31]
buffer_load_dwordx4 v233, s[16:19], s5 offen offset:1024 lds
ds_read_b64_tr_b16 a[164:165], v118 offset:36864
v_mfma_f32_16x16x32_bf16 v[28:31], a[184:187], a[88:91], v[28:31]
ds_read_b64_tr_b16 a[166:167], v118 offset:38912
ds_read_b64_tr_b16 a[168:169], v118 offset:40960
v_mfma_f32_16x16x32_bf16 v[28:31], a[180:183], a[84:87], v[28:31]
ds_read_b64_tr_b16 a[170:171], v118 offset:43008
ds_read_b64_tr_b16 a[172:173], v118 offset:45056
ds_read_b64_tr_b16 a[174:175], v118 offset:47104
v_mfma_f32_16x16x32_bf16 v[28:31], a[176:179], a[80:83], v[28:31]
s_waitcnt lgkmcnt(8)
buffer_load_dwordx4 v234, s[16:19], s5 offen offset:2048 lds
ds_read_b64_tr_b16 a[188:189], v119 offset:45056
v_mfma_f32_16x16x32_bf16 v[16:19], a[128:131], a[96:99], v[16:19]
ds_read_b64_tr_b16 a[190:191], v119 offset:47104
ds_read_b64_tr_b16 a[184:185], v119 offset:40960
v_mfma_f32_16x16x32_bf16 v[16:19], a[132:135], a[100:103], v[16:19]
ds_read_b64_tr_b16 a[186:187], v119 offset:43008
ds_read_b64_tr_b16 a[180:181], v119 offset:36864
v_mfma_f32_16x16x32_bf16 v[16:19], a[136:139], a[104:107], v[16:19]
buffer_load_dwordx4 v235, s[16:19], s5 offen offset:3072 lds
ds_read_b64_tr_b16 a[182:183], v119 offset:38912
ds_read_b64_tr_b16 a[176:177], v119 offset:32768
v_mfma_f32_16x16x32_bf16 v[16:19], a[140:143], a[108:111], v[16:19]
s_waitcnt vmcnt(11)
s_barrier
s_add_u32 m0, s4, 0x22000
ds_read_b64_tr_b16 a[178:179], v119 offset:34816
ds_read_b64_tr_b16 a[128:129], v116 offset:49152
ds_read_b64_tr_b16 a[130:131], v116 offset:51200
v_mfma_f32_16x16x32_bf16 v[20:23], a[156:159], a[108:111], v[20:23]
ds_read_b64_tr_b16 a[132:133], v116 offset:53248
ds_read_b64_tr_b16 a[134:135], v116 offset:55296
v_mfma_f32_16x16x32_bf16 v[20:23], a[152:155], a[104:107], v[20:23]
buffer_load_dwordx4 v236, s[16:19], s5 offen offset:0 lds
ds_read_b64_tr_b16 a[136:137], v116 offset:57344
v_mfma_f32_16x16x32_bf16 v[20:23], a[148:151], a[100:103], v[20:23]
ds_read_b64_tr_b16 a[138:139], v116 offset:59392
ds_read_b64_tr_b16 a[140:141], v116 offset:61440
ds_read_b64_tr_b16 a[142:143], v116 offset:63488
v_mfma_f32_16x16x32_bf16 v[20:23], a[144:147], a[96:99], v[20:23]
s_waitcnt lgkmcnt(9)
ds_read_b64_tr_b16 a[156:157], v117 offset:61440
ds_read_b64_tr_b16 a[158:159], v117 offset:63488
v_mfma_f32_16x16x32_bf16 v[24:27], a[160:163], a[96:99], v[24:27]
buffer_load_dwordx4 v237, s[16:19], s5 offen offset:1024 lds
ds_read_b64_tr_b16 a[152:153], v117 offset:57344
v_mfma_f32_16x16x32_bf16 v[24:27], a[164:167], a[100:103], v[24:27]
ds_read_b64_tr_b16 a[154:155], v117 offset:59392
ds_read_b64_tr_b16 a[148:149], v117 offset:53248
v_mfma_f32_16x16x32_bf16 v[24:27], a[168:171], a[104:107], v[24:27]
ds_read_b64_tr_b16 a[150:151], v117 offset:55296
ds_read_b64_tr_b16 a[144:145], v117 offset:49152
ds_read_b64_tr_b16 a[146:147], v117 offset:51200
v_mfma_f32_16x16x32_bf16 v[24:27], a[172:175], a[108:111], v[24:27]
buffer_load_dwordx4 v238, s[16:19], s5 offen offset:2048 lds
ds_read_b64_tr_b16 a[160:161], v118 offset:49152
v_mfma_f32_16x16x32_bf16 v[28:31], a[188:191], a[108:111], v[28:31]
ds_read_b64_tr_b16 a[162:163], v118 offset:51200
ds_read_b64_tr_b16 a[164:165], v118 offset:53248
v_mfma_f32_16x16x32_bf16 v[28:31], a[184:187], a[104:107], v[28:31]
ds_read_b64_tr_b16 a[166:167], v118 offset:55296
ds_read_b64_tr_b16 a[168:169], v118 offset:57344
v_mfma_f32_16x16x32_bf16 v[28:31], a[180:183], a[100:103], v[28:31]
s_waitcnt lgkmcnt(8)
ds_read_b64_tr_b16 a[170:171], v118 offset:59392
ds_read_b64_tr_b16 a[172:173], v118 offset:61440
ds_read_b64_tr_b16 a[174:175], v118 offset:63488
v_mfma_f32_16x16x32_bf16 v[28:31], a[176:179], a[96:99], v[28:31]
ds_read_b64_tr_b16 a[188:189], v119 offset:61440
ds_read_b64_tr_b16 a[190:191], v119 offset:63488
v_mfma_f32_16x16x32_bf16 v[16:19], a[128:131], a[112:115], v[16:19]
ds_read_b64_tr_b16 a[184:185], v119 offset:57344
ds_read_b64_tr_b16 a[186:187], v119 offset:59392
v_mfma_f32_16x16x32_bf16 v[16:19], a[132:135], a[116:119], v[16:19]
ds_read_b64_tr_b16 a[180:181], v119 offset:53248
ds_read_b64_tr_b16 a[182:183], v119 offset:55296
v_mfma_f32_16x16x32_bf16 v[16:19], a[136:139], a[120:123], v[16:19]
ds_read_b64_tr_b16 a[176:177], v119 offset:49152
ds_read_b64_tr_b16 a[178:179], v119 offset:51200
v_mfma_f32_16x16x32_bf16 v[16:19], a[140:143], a[124:127], v[16:19]
v_mfma_f32_16x16x32_bf16 v[20:23], a[156:159], a[124:127], v[20:23]
v_mfma_f32_16x16x32_bf16 v[20:23], a[152:155], a[120:123], v[20:23]
s_waitcnt lgkmcnt(4)
v_mfma_f32_16x16x32_bf16 v[20:23], a[148:151], a[116:119], v[20:23]
v_mfma_f32_16x16x32_bf16 v[20:23], a[144:147], a[112:115], v[20:23]
v_mfma_f32_16x16x32_bf16 v[24:27], a[160:163], a[112:115], v[24:27]
v_mfma_f32_16x16x32_bf16 v[24:27], a[164:167], a[116:119], v[24:27]
v_mfma_f32_16x16x32_bf16 v[24:27], a[168:171], a[120:123], v[24:27]
v_mfma_f32_16x16x32_bf16 v[24:27], a[172:175], a[124:127], v[24:27]
v_mfma_f32_16x16x32_bf16 v[28:31], a[188:191], a[124:127], v[28:31]
v_mfma_f32_16x16x32_bf16 v[28:31], a[184:187], a[120:123], v[28:31]
s_waitcnt lgkmcnt(0)
v_mfma_f32_16x16x32_bf16 v[28:31], a[180:183], a[116:119], v[28:31]
v_mfma_f32_16x16x32_bf16 v[28:31], a[176:179], a[112:115], v[28:31]
buffer_load_dword v230, v241, s[8:11], s6 offen sc1
s_barrier
v_lshlrev_b32 v124, 16, v72
v_and_b32 v125, 0xffff0000, v72
v_pk_add_f32 v[16:17], v[16:17], v[124:125]
v_cvt_pk_bf16_f32 v72, v16, v17
v_lshlrev_b32 v126, 16, v73
v_and_b32 v127, 0xffff0000, v73
v_pk_add_f32 v[18:19], v[18:19], v[126:127]
v_cvt_pk_bf16_f32 v73, v18, v19
v_lshlrev_b32 v124, 16, v74
v_and_b32 v125, 0xffff0000, v74
v_pk_add_f32 v[20:21], v[20:21], v[124:125]
v_cvt_pk_bf16_f32 v74, v20, v21
v_lshlrev_b32 v126, 16, v75
v_and_b32 v127, 0xffff0000, v75
v_pk_add_f32 v[22:23], v[22:23], v[126:127]
v_cvt_pk_bf16_f32 v75, v22, v23
v_lshlrev_b32 v124, 16, v76
v_and_b32 v125, 0xffff0000, v76
v_pk_add_f32 v[24:25], v[24:25], v[124:125]
v_cvt_pk_bf16_f32 v76, v24, v25
v_lshlrev_b32 v126, 16, v77
v_and_b32 v127, 0xffff0000, v77
v_pk_add_f32 v[26:27], v[26:27], v[126:127]
v_cvt_pk_bf16_f32 v77, v26, v27
v_lshlrev_b32 v124, 16, v78
v_and_b32 v125, 0xffff0000, v78
v_pk_add_f32 v[28:29], v[28:29], v[124:125]
v_cvt_pk_bf16_f32 v78, v28, v29
v_lshlrev_b32 v126, 16, v79
v_and_b32 v127, 0xffff0000, v79
v_pk_add_f32 v[30:31], v[30:31], v[126:127]
v_cvt_pk_bf16_f32 v79, v30, v31
buffer_store_dwordx4 v[72:75], v109, s[8:11], s26 offen offset:2048 sc1
buffer_store_dwordx4 v[76:79], v109, s[8:11], s26 offen offset:3072 sc1
s_lshl_b32 s60, s21, 11
s_lshr_b32 s28, s22, 1
s_lshl_b32 s28, s28, 9
s_add_u32 s60, s60, s28
s_and_b32 s28, s22, 1
s_lshl_b32 s28, s28, 4
s_add_u32 s60, s60, s28
s_add_u32 s60, s60, 0x1a40000
v_and_b32 v132, 15, v105
v_lshlrev_b32 v132, 5, v132
s_and_b32 s27, s2, 7
s_lshr_b32 s28, s2, 3
s_and_b32 s26, s27, 1
s_lshl_b32 s26, s26, 2
s_and_b32 s29, s28, 3
s_add_u32 s26, s26, s29
s_lshr_b32 s22, s27, 1
s_lshl_b32 s22, s22, 3
s_lshr_b32 s29, s28, 2
s_add_u32 s22, s22, s29
s_lshl_b32 s97, s26, 12
s_lshl_b32 s99, s22, 7
s_add_u32 s99, s99, s97
s_add_u32 s99, s99, 0x1d50000
s_add_u32 s99, s99, s57
s_lshl_b32 s27, s20, 10
s_add_u32 s97, s97, s27
s_add_u32 s97, s97, 0x1d48000
s_add_u32 s97, s97, s57
s_lshl_b32 s21, s26, 4
s_lshl_b32 s27, s20, 2
s_add_u32 s21, s21, s27
s_and_b32 s25, s22, 1
s_mul_i32 s24, s20, 7168
s_add_u32 s24, s24, 0xc000
s_lshl_b32 s23, s21, 15
s_add_u32 s23, s23, 0x800000
s_add_u32 s40, s23, 0x8000
s_mov_b32 s4, 2
s_mov_b32 s6, 0x7000
s_mov_b32 s7, s24
s_add_u32 s3, s24, 0x1c000
s_mov_b32 m0, s7
s_add_u32 s4, s4, 1
s_cmp_eq_u32 s4, 4
s_cselect_b32 s5, 0xfffeb000, s6
s_cselect_b32 s4, 0, s4
s_mov_b32 s41, 1835008
s_mov_b32 s12, s16
s_mov_b32 s13, s17
s_mov_b32 s14, s18
s_mov_b32 s15, s19
s_add_u32 s31, s23, 2048
s_waitcnt vmcnt(2)
v_cmp_ne_u32 s[46:47], s58, v230
s_nop 4
s_cmp_eq_u64 s[46:47], 0
s_cbranch_scc1 L_k3_go
s_mov_b32 s56, 0x100000
L_k3_poll:
buffer_load_dword v230, v241, s[8:11], s97 offen sc1
s_waitcnt vmcnt(0)
v_cmp_ne_u32 s[46:47], s58, v230
s_nop 4
s_cmp_eq_u64 s[46:47], 0
s_cbranch_scc1 L_k3_go
s_sub_u32 s56, s56, 1
s_cbranch_scc0 L_k3_poll
L_k3_go:
s_add_u32 s97, s97, 0x88000
buffer_load_dwordx4 a[112:115], v225, s[8:11], s23 offen offset:0 sc1
buffer_load_dwordx4 a[116:119], v226, s[8:11], s23 offen offset:0 sc1
buffer_load_dwordx4 a[120:123], v227, s[8:11], s23 offen offset:0 sc1
buffer_load_dwordx4 a[124:127], v228, s[8:11], s23 offen offset:0 sc1
buffer_load_dwordx4 a[128:131], v225, s[8:11], s23 offen offset:1024 sc1
buffer_load_dwordx4 a[132:135], v226, s[8:11], s23 offen offset:1024 sc1
buffer_load_dwordx4 a[136:139], v227, s[8:11], s23 offen offset:1024 sc1
buffer_load_dwordx4 a[140:143], v228, s[8:11], s23 offen offset:1024 sc1
s_add_u32 s23, s23, 4096
s_cmp_eq_u32 s23, s40
s_cselect_b32 s23, s31, s23
buffer_load_dwordx4 a[144:147], v225, s[8:11], s23 offen offset:0 sc1
buffer_load_dwordx4 a[148:151], v226, s[8:11], s23 offen offset:0 sc1
buffer_load_dwordx4 a[152:155], v227, s[8:11], s23 offen offset:0 sc1
buffer_load_dwordx4 a[156:159], v228, s[8:11], s23 offen offset:0 sc1
v_lshlrev_b32 v0, 16, v64
v_lshlrev_b32 v16, 16, v72
v_and_b32 v1, 0xffff0000, v64
v_and_b32 v17, 0xffff0000, v72
v_lshlrev_b32 v2, 16, v65
v_lshlrev_b32 v18, 16, v73
v_and_b32 v3, 0xffff0000, v65
v_and_b32 v19, 0xffff0000, v73
v_lshlrev_b32 v4, 16, v66
v_lshlrev_b32 v20, 16, v74
v_and_b32 v5, 0xffff0000, v66
v_and_b32 v21, 0xffff0000, v74
v_lshlrev_b32 v6, 16, v67
v_lshlrev_b32 v22, 16, v75
v_and_b32 v7, 0xffff0000, v67
v_and_b32 v23, 0xffff0000, v75
v_lshlrev_b32 v8, 16, v68
v_lshlrev_b32 v24, 16, v76
v_and_b32 v9, 0xffff0000, v68
v_and_b32 v25, 0xffff0000, v76
v_lshlrev_b32 v10, 16, v69
v_lshlrev_b32 v26, 16, v77
v_and_b32 v11, 0xffff0000, v69
v_and_b32 v27, 0xffff0000, v77
v_lshlrev_b32 v12, 16, v70
v_lshlrev_b32 v28, 16, v78
v_and_b32 v13, 0xffff0000, v70
v_and_b32 v29, 0xffff0000, v78
v_lshlrev_b32 v14, 16, v71
v_lshlrev_b32 v30, 16, v79
v_and_b32 v15, 0xffff0000, v71
v_and_b32 v31, 0xffff0000, v79
v_pk_add_f32 v[124:125], v[0:1], v[2:3]
v_pk_add_f32 v[126:127], v[16:17], v[18:19]
v_pk_add_f32 v[124:125], v[124:125], v[4:5]
v_pk_add_f32 v[126:127], v[126:127], v[20:21]
v_pk_add_f32 v[124:125], v[124:125], v[6:7]
v_pk_add_f32 v[126:127], v[126:127], v[22:23]
v_pk_add_f32 v[124:125], v[124:125], v[8:9]
v_pk_add_f32 v[126:127], v[126:127], v[24:25]
v_pk_add_f32 v[124:125], v[124:125], v[10:11]
v_pk_add_f32 v[126:127], v[126:127], v[26:27]
v_pk_add_f32 v[124:125], v[124:125], v[12:13]
v_pk_add_f32 v[126:127], v[126:127], v[28:29]
v_pk_add_f32 v[124:125], v[124:125], v[14:15]
v_pk_add_f32 v[126:127], v[126:127], v[30:31]
v_add_f32 v124, v124, v125
v_add_f32 v126, v126, v127
v_mov_b32 v128, v124
v_mov_b32 v129, v126
s_nop 0
v_permlane16_swap_b32 v124, v128
v_permlane16_swap_b32 v126, v129
v_add_f32 v124, v124, v128
v_add_f32 v126, v126, v129
v_mov_b32 v128, v124
v_mov_b32 v129, v126
s_nop 0
v_permlane32_swap_b32 v124, v128
v_permlane32_swap_b32 v126, v129
v_add_f32 v124, v124, v128
v_add_f32 v126, v126, v129
v_mul_f32 v125, 0x3c800000, v124
v_mul_f32 v127, 0x3c800000, v126
v_pk_add_f32 v[0:1], v[0:1], v[124:125] op_sel:[0,1] op_sel_hi:[1,1] neg_lo:[0,1] neg_hi:[0,1]
v_pk_add_f32 v[16:17], v[16:17], v[126:127] op_sel:[0,1] op_sel_hi:[1,1] neg_lo:[0,1] neg_hi:[0,1]
v_pk_add_f32 v[2:3], v[2:3], v[124:125] op_sel:[0,1] op_sel_hi:[1,1] neg_lo:[0,1] neg_hi:[0,1]
v_pk_add_f32 v[18:19], v[18:19], v[126:127] op_sel:[0,1] op_sel_hi:[1,1] neg_lo:[0,1] neg_hi:[0,1]
v_pk_add_f32 v[4:5], v[4:5], v[124:125] op_sel:[0,1] op_sel_hi:[1,1] neg_lo:[0,1] neg_hi:[0,1]
v_pk_add_f32 v[20:21], v[20:21], v[126:127] op_sel:[0,1] op_sel_hi:[1,1] neg_lo:[0,1] neg_hi:[0,1]
v_pk_add_f32 v[6:7], v[6:7], v[124:125] op_sel:[0,1] op_sel_hi:[1,1] neg_lo:[0,1] neg_hi:[0,1]
v_pk_add_f32 v[22:23], v[22:23], v[126:127] op_sel:[0,1] op_sel_hi:[1,1] neg_lo:[0,1] neg_hi:[0,1]
v_pk_add_f32 v[8:9], v[8:9], v[124:125] op_sel:[0,1] op_sel_hi:[1,1] neg_lo:[0,1] neg_hi:[0,1]
v_pk_add_f32 v[24:25], v[24:25], v[126:127] op_sel:[0,1] op_sel_hi:[1,1] neg_lo:[0,1] neg_hi:[0,1]
v_pk_add_f32 v[10:11], v[10:11], v[124:125] op_sel:[0,1] op_sel_hi:[1,1] neg_lo:[0,1] neg_hi:[0,1]
v_pk_add_f32 v[26:27], v[26:27], v[126:127] op_sel:[0,1] op_sel_hi:[1,1] neg_lo:[0,1] neg_hi:[0,1]
v_pk_add_f32 v[12:13], v[12:13], v[124:125] op_sel:[0,1] op_sel_hi:[1,1] neg_lo:[0,1] neg_hi:[0,1]
v_pk_add_f32 v[28:29], v[28:29], v[126:127] op_sel:[0,1] op_sel_hi:[1,1] neg_lo:[0,1] neg_hi:[0,1]
v_pk_add_f32 v[14:15], v[14:15], v[124:125] op_sel:[0,1] op_sel_hi:[1,1] neg_lo:[0,1] neg_hi:[0,1]
v_pk_add_f32 v[30:31], v[30:31], v[126:127] op_sel:[0,1] op_sel_hi:[1,1] neg_lo:[0,1] neg_hi:[0,1]
v_pk_mul_f32 v[0:1], v[0:1], v[0:1]
v_pk_mul_f32 v[16:17], v[16:17], v[16:17]
v_pk_fma_f32 v[0:1], v[2:3], v[2:3], v[0:1]
v_pk_fma_f32 v[16:17], v[18:19], v[18:19], v[16:17]
v_pk_fma_f32 v[0:1], v[4:5], v[4:5], v[0:1]
v_pk_fma_f32 v[16:17], v[20:21], v[20:21], v[16:17]
v_pk_fma_f32 v[0:1], v[6:7], v[6:7], v[0:1]
v_pk_fma_f32 v[16:17], v[22:23], v[22:23], v[16:17]
v_pk_fma_f32 v[0:1], v[8:9], v[8:9], v[0:1]
v_pk_fma_f32 v[16:17], v[24:25], v[24:25], v[16:17]
v_pk_fma_f32 v[0:1], v[10:11], v[10:11], v[0:1]
v_pk_fma_f32 v[16:17], v[26:27], v[26:27], v[16:17]
v_pk_fma_f32 v[0:1], v[12:13], v[12:13], v[0:1]
v_pk_fma_f32 v[16:17], v[28:29], v[28:29], v[16:17]
v_pk_fma_f32 v[0:1], v[14:15], v[14:15], v[0:1]
v_pk_fma_f32 v[16:17], v[30:31], v[30:31], v[16:17]
v_add_f32 v125, v0, v1
v_add_f32 v127, v16, v17
v_mov_b32 v128, v125
v_mov_b32 v129, v127
s_nop 0
v_permlane16_swap_b32 v125, v128
v_permlane16_swap_b32 v127, v129
v_add_f32 v125, v125, v128
v_add_f32 v127, v127, v129
v_mov_b32 v128, v125
v_mov_b32 v129, v127
s_nop 0
v_permlane32_swap_b32 v125, v128
v_permlane32_swap_b32 v127, v129
v_add_f32 v125, v125, v128
v_add_f32 v127, v127, v129
buffer_store_dwordx2 v[124:125], v132, s[8:11], s60 offen offset:0 sc1
buffer_store_dwordx2 v[126:127], v132, s[8:11], s60 offen offset:8 sc1
s_lshl_b32 s92, s21, 11
s_add_u32 s92, s92, 0x1a40000
s_add_u32 s98, s92, 4096
s_mul_i32 s93, s22, 448
s_add_u32 s93, s93, 0x1a83000
s_add_u32 s94, s93, 40960
s_add_u32 s95, s93, 81920
s_add_u32 s96, s93, 122880
s_lshl_b32 s32, s20, 13
s_add_u32 s32, s32, 0x1d48000
s_add_u32 s32, s32, s57
s_mov_b32 s16, s52
s_and_b32 s17, s53, 0xffff
s_mov_b32 s18, 0x700000
s_mov_b32 s19, 0x20000
s_lshl_b32 s36, s2, 2
s_add_u32 s36, s36, s20
s_mul_i32 s36, s36, 7168
s_cmp_lg_u32 s30, 0
s_cselect_b32 s36, 0x80000000, s36
s_mov_b32 s37, 0x80000000
s_mov_b32 s101, 99
s_barrier
ds_read_b64_tr_b16 a[0:1], v229 offset:0
ds_read_b64_tr_b16 a[2:3], v229 offset:3584
ds_read_b64_tr_b16 a[56:57], v229 offset:7168
ds_read_b64_tr_b16 a[58:59], v229 offset:10752
ds_read_b64_tr_b16 a[4:5], v229 offset:14336
ds_read_b64_tr_b16 a[6:7], v229 offset:17920
ds_read_b64_tr_b16 a[60:61], v229 offset:21504
ds_read_b64_tr_b16 a[62:63], v229 offset:25088
ds_read_b64_tr_b16 a[8:9], v229 offset:32
ds_read_b64_tr_b16 a[10:11], v229 offset:3616
ds_read_b64_tr_b16 a[64:65], v229 offset:7200
ds_read_b64_tr_b16 a[66:67], v229 offset:10784
s_waitcnt vmcnt(13) lgkmcnt(8)
v_mfma_f32_16x16x32_bf16 v[0:3], a[0:3], a[112:115], 0
s_waitcnt vmcnt(9)
buffer_load_dwordx4 a[160:163], v225, s[8:11], s23 offen offset:1024 sc1
v_mfma_f32_16x16x32_bf16 v[0:3], a[56:59], a[128:131], v[0:3]
s_waitcnt vmcnt(9)
ds_read_b64_tr_b16 a[12:13], v229 offset:14368
v_mfma_f32_16x16x32_bf16 v[56:59], a[56:59], a[132:135], 0
ds_read_b64_tr_b16 a[14:15], v229 offset:17952
v_mfma_f32_16x16x32_bf16 v[56:59], a[0:3], a[116:119], v[56:59]
ds_read_b64_tr_b16 a[68:69], v229 offset:21536
v_mfma_f32_16x16x32_bf16 v[112:115], a[0:3], a[120:123], 0
s_waitcnt vmcnt(8)
ds_read_b64_tr_b16 a[70:71], v229 offset:25120
v_mfma_f32_16x16x32_bf16 v[112:115], a[56:59], a[136:139], v[112:115]
s_waitcnt vmcnt(7)
buffer_load_dwordx4 a[164:167], v226, s[8:11], s23 offen offset:1024 sc1
v_mfma_f32_16x16x32_bf16 v[168:171], a[56:59], a[140:143], 0
ds_read_b64_tr_b16 a[16:17], v229 offset:64
v_mfma_f32_16x16x32_bf16 v[168:171], a[0:3], a[124:127], v[168:171]
s_barrier
s_waitcnt lgkmcnt(9)
ds_read_b64_tr_b16 a[18:19], v229 offset:3648
v_mfma_f32_16x16x32_bf16 v[172:175], a[4:7], a[124:127], 0
ds_read_b64_tr_b16 a[72:73], v229 offset:7232
v_mfma_f32_16x16x32_bf16 v[172:175], a[60:63], a[140:143], v[172:175]
ds_read_b64_tr_b16 a[74:75], v229 offset:10816
v_mfma_f32_16x16x32_bf16 v[116:119], a[60:63], a[136:139], 0
buffer_load_dwordx4 a[168:171], v227, s[8:11], s23 offen offset:1024 sc1
v_mfma_f32_16x16x32_bf16 v[116:119], a[4:7], a[120:123], v[116:119]
ds_read_b64_tr_b16 a[20:21], v229 offset:14400
v_mfma_f32_16x16x32_bf16 v[60:63], a[4:7], a[116:119], 0
ds_read_b64_tr_b16 a[22:23], v229 offset:17984
v_mfma_f32_16x16x32_bf16 v[60:63], a[60:63], a[132:135], v[60:63]
ds_read_b64_tr_b16 a[76:77], v229 offset:21568
v_mfma_f32_16x16x32_bf16 v[4:7], a[60:63], a[128:131], 0
ds_read_b64_tr_b16 a[78:79], v229 offset:25152
ds_read_b64_tr_b16 a[24:25], v229 offset:96
v_mfma_f32_16x16x32_bf16 v[4:7], a[4:7], a[112:115], v[4:7]
s_waitcnt lgkmcnt(9)
buffer_load_dwordx4 a[172:175], v228, s[8:11], s23 offen offset:1024 sc1
v_mfma_f32_16x16x32_bf16 v[8:11], a[8:11], a[112:115], 0
s_add_u32 s23, s23, 4096
ds_read_b64_tr_b16 a[26:27], v229 offset:3680
v_mfma_f32_16x16x32_bf16 v[8:11], a[64:67], a[128:131], v[8:11]
s_cmp_eq_u32 s23, s40
ds_read_b64_tr_b16 a[80:81], v229 offset:7264
v_mfma_f32_16x16x32_bf16 v[64:67], a[64:67], a[132:135], 0
s_cselect_b32 s23, s31, s23
ds_read_b64_tr_b16 a[82:83], v229 offset:10848
ds_read_b64_tr_b16 a[28:29], v229 offset:14432
v_mfma_f32_16x16x32_bf16 v[64:67], a[8:11], a[116:119], v[64:67]
ds_read_b64_tr_b16 a[30:31], v229 offset:18016
v_mfma_f32_16x16x32_bf16 v[120:123], a[8:11], a[120:123], 0
buffer_load_dwordx4 v232, s[12:15], s41 offen offset:0 lds
v_mfma_f32_16x16x32_bf16 v[120:123], a[64:67], a[136:139], v[120:123]
ds_read_b64_tr_b16 a[84:85], v229 offset:21600
v_mfma_f32_16x16x32_bf16 v[176:179], a[64:67], a[140:143], 0
ds_read_b64_tr_b16 a[86:87], v229 offset:25184
ds_read_b64_tr_b16 a[32:33], v229 offset:128
v_mfma_f32_16x16x32_bf16 v[176:179], a[8:11], a[124:127], v[176:179]
ds_read_b64_tr_b16 a[34:35], v229 offset:3712
v_mfma_f32_16x16x32_bf16 v[180:183], a[12:15], a[124:127], 0
ds_read_b64_tr_b16 a[88:89], v229 offset:7296
v_mfma_f32_16x16x32_bf16 v[180:183], a[68:71], a[140:143], v[180:183]
buffer_load_dwordx4 v233, s[12:15], s41 offen offset:1024 lds
v_mfma_f32_16x16x32_bf16 v[124:127], a[68:71], a[136:139], 0
ds_read_b64_tr_b16 a[90:91], v229 offset:10880
ds_read_b64_tr_b16 a[36:37], v229 offset:14464
v_mfma_f32_16x16x32_bf16 v[124:127], a[12:15], a[120:123], v[124:127]
ds_read_b64_tr_b16 a[38:39], v229 offset:18048
v_mfma_f32_16x16x32_bf16 v[68:71], a[12:15], a[116:119], 0
ds_read_b64_tr_b16 a[92:93], v229 offset:21632
v_mfma_f32_16x16x32_bf16 v[68:71], a[68:71], a[132:135], v[68:71]
ds_read_b64_tr_b16 a[94:95], v229 offset:25216
v_mfma_f32_16x16x32_bf16 v[12:15], a[68:71], a[128:131], 0
s_waitcnt vmcnt(6)
s_barrier
s_cmp_lg_u32 s20, 3
s_cbranch_scc1 L_k3l_ns
s_mov_b64 exec, 1
buffer_store_dword v248, off, s[8:11], s100 sc1
s_mov_b64 exec, -1
L_k3l_ns:
s_mov_b32 s100, s99
buffer_load_dwordx4 v234, s[12:15], s41 offen offset:2048 lds
v_mfma_f32_16x16x32_bf16 v[12:15], a[12:15], a[112:115], v[12:15]
s_waitcnt lgkmcnt(9)
ds_read_b64_tr_b16 a[40:41], v229 offset:160
v_mfma_f32_16x16x32_bf16 v[16:19], a[16:19], a[112:115], 0
ds_read_b64_tr_b16 a[42:43], v229 offset:3744
v_mfma_f32_16x16x32_bf16 v[16:19], a[72:75], a[128:131], v[16:19]
ds_read_b64_tr_b16 a[96:97], v229 offset:7328
v_mfma_f32_16x16x32_bf16 v[72:75], a[72:75], a[132:135], 0
ds_read_b64_tr_b16 a[98:99], v229 offset:10912
ds_read_b64_tr_b16 a[44:45], v229 offset:14496
v_mfma_f32_16x16x32_bf16 v[72:75], a[16:19], a[116:119], v[72:75]
buffer_load_dwordx4 v235, s[12:15], s41 offen offset:3072 lds
v_mfma_f32_16x16x32_bf16 v[128:131], a[16:19], a[120:123], 0
s_add_u32 m0, s7, 4096
ds_read_b64_tr_b16 a[46:47], v229 offset:18080
v_mfma_f32_16x16x32_bf16 v[128:131], a[72:75], a[136:139], v[128:131]
ds_read_b64_tr_b16 a[100:101], v229 offset:21664
v_mfma_f32_16x16x32_bf16 v[184:187], a[72:75], a[140:143], 0
ds_read_b64_tr_b16 a[102:103], v229 offset:25248
ds_read_b64_tr_b16 a[48:49], v229 offset:192
v_mfma_f32_16x16x32_bf16 v[184:187], a[16:19], a[124:127], v[184:187]
ds_read_b64_tr_b16 a[50:51], v229 offset:3776
v_mfma_f32_16x16x32_bf16 v[188:191], a[20:23], a[124:127], 0
buffer_load_dwordx4 v236, s[12:15], s41 offen offset:0 lds
v_mfma_f32_16x16x32_bf16 v[188:191], a[76:79], a[140:143], v[188:191]
ds_read_b64_tr_b16 a[104:105], v229 offset:7360
v_mfma_f32_16x16x32_bf16 v[132:135], a[76:79], a[136:139], 0
ds_read_b64_tr_b16 a[106:107], v229 offset:10944
ds_read_b64_tr_b16 a[52:53], v229 offset:14528
v_mfma_f32_16x16x32_bf16 v[132:135], a[20:23], a[120:123], v[132:135]
ds_read_b64_tr_b16 a[54:55], v229 offset:18112
v_mfma_f32_16x16x32_bf16 v[76:79], a[20:23], a[116:119], 0
ds_read_b64_tr_b16 a[108:109], v229 offset:21696
v_mfma_f32_16x16x32_bf16 v[76:79], a[76:79], a[132:135], v[76:79]
buffer_load_dwordx4 v237, s[12:15], s41 offen offset:1024 lds
v_mfma_f32_16x16x32_bf16 v[20:23], a[76:79], a[128:131], 0
ds_read_b64_tr_b16 a[110:111], v229 offset:25280
v_mfma_f32_16x16x32_bf16 v[20:23], a[20:23], a[112:115], v[20:23]
v_mfma_f32_16x16x32_bf16 v[24:27], a[24:27], a[112:115], 0
v_mfma_f32_16x16x32_bf16 v[24:27], a[80:83], a[128:131], v[24:27]
v_mfma_f32_16x16x32_bf16 v[80:83], a[80:83], a[132:135], 0
buffer_load_dwordx4 v238, s[12:15], s41 offen offset:2048 lds
v_mfma_f32_16x16x32_bf16 v[80:83], a[24:27], a[116:119], v[80:83]
s_add_u32 s7, s7, s6
v_mfma_f32_16x16x32_bf16 v[136:139], a[24:27], a[120:123], 0
s_cmp_eq_u32 s7, s3
v_mfma_f32_16x16x32_bf16 v[136:139], a[80:83], a[136:139], v[136:139]
s_cselect_b32 s7, s24, s7
v_mfma_f32_16x16x32_bf16 v[192:195], a[80:83], a[140:143], 0
s_mov_b32 m0, s7
v_mfma_f32_16x16x32_bf16 v[192:195], a[24:27], a[124:127], v[192:195]
s_waitcnt lgkmcnt(1)
s_add_u32 s41, s41, 917504
s_cmp_eq_u32 s41, 7340032
s_cselect_b32 s41, 458752, s41
buffer_load_dwordx4 v232, s[12:15], s41 offen offset:0 lds
v_mfma_f32_16x16x32_bf16 v[196:199], a[28:31], a[124:127], 0
v_mfma_f32_16x16x32_bf16 v[196:199], a[84:87], a[140:143], v[196:199]
v_mfma_f32_16x16x32_bf16 v[140:143], a[84:87], a[136:139], 0
v_mfma_f32_16x16x32_bf16 v[140:143], a[28:31], a[120:123], v[140:143]
v_add_u32 v229, s5, v229
v_mfma_f32_16x16x32_bf16 v[84:87], a[28:31], a[116:119], 0
s_add_u32 s4, s4, 1
s_cmp_eq_u32 s4, 4
s_cselect_b32 s5, 0xfffeb000, s6
s_cselect_b32 s4, 0, s4
buffer_load_dwordx4 v233, s[12:15], s41 offen offset:1024 lds
v_mfma_f32_16x16x32_bf16 v[84:87], a[84:87], a[132:135], v[84:87]
ds_read_b64_tr_b16 a[0:1], v229 offset:0
v_mfma_f32_16x16x32_bf16 v[28:31], a[84:87], a[128:131], 0
ds_read_b64_tr_b16 a[2:3], v229 offset:3584
v_mfma_f32_16x16x32_bf16 v[28:31], a[28:31], a[112:115], v[28:31]
ds_read_b64_tr_b16 a[56:57], v229 offset:7168
v_mfma_f32_16x16x32_bf16 v[32:35], a[32:35], a[112:115], 0
ds_read_b64_tr_b16 a[58:59], v229 offset:10752
v_mfma_f32_16x16x32_bf16 v[32:35], a[88:91], a[128:131], v[32:35]
buffer_load_dwordx4 v234, s[12:15], s41 offen offset:2048 lds
v_mfma_f32_16x16x32_bf16 v[88:91], a[88:91], a[132:135], 0
ds_read_b64_tr_b16 a[4:5], v229 offset:14336
v_mfma_f32_16x16x32_bf16 v[88:91], a[32:35], a[116:119], v[88:91]
ds_read_b64_tr_b16 a[6:7], v229 offset:17920
ds_read_b64_tr_b16 a[60:61], v229 offset:21504
v_mfma_f32_16x16x32_bf16 v[144:147], a[32:35], a[120:123], 0
ds_read_b64_tr_b16 a[62:63], v229 offset:25088
ds_read_b64_tr_b16 a[8:9], v229 offset:32
v_mfma_f32_16x16x32_bf16 v[144:147], a[88:91], a[136:139], v[144:147]
ds_read_b64_tr_b16 a[10:11], v229 offset:3616
ds_read_b64_tr_b16 a[64:65], v229 offset:7200
v_mfma_f32_16x16x32_bf16 v[200:203], a[88:91], a[140:143], 0
buffer_load_dwordx4 v235, s[12:15], s41 offen offset:3072 lds
ds_read_b64_tr_b16 a[66:67], v229 offset:10784
v_mfma_f32_16x16x32_bf16 v[200:203], a[32:35], a[124:127], v[200:203]
s_add_u32 m0, s7, 4096
ds_read_b64_tr_b16 a[12:13], v229 offset:14368
ds_read_b64_tr_b16 a[14:15], v229 offset:17952
v_mfma_f32_16x16x32_bf16 v[204:207], a[36:39], a[124:127], 0
ds_read_b64_tr_b16 a[68:69], v229 offset:21536
ds_read_b64_tr_b16 a[70:71], v229 offset:25120
v_mfma_f32_16x16x32_bf16 v[204:207], a[92:95], a[140:143], v[204:207]
ds_read_b64_tr_b16 a[16:17], v229 offset:64
ds_read_b64_tr_b16 a[18:19], v229 offset:3648
v_mfma_f32_16x16x32_bf16 v[148:151], a[92:95], a[136:139], 0
ds_read_b64_tr_b16 a[72:73], v229 offset:7232
ds_read_b64_tr_b16 a[74:75], v229 offset:10816
v_mfma_f32_16x16x32_bf16 v[148:151], a[36:39], a[120:123], v[148:151]
buffer_load_dwordx4 v236, s[12:15], s41 offen offset:0 lds
ds_read_b64_tr_b16 a[20:21], v229 offset:14400
v_mfma_f32_16x16x32_bf16 v[92:95], a[36:39], a[116:119], 0
ds_read_b64_tr_b16 a[22:23], v229 offset:17984
ds_read_b64_tr_b16 a[76:77], v229 offset:21568
v_mfma_f32_16x16x32_bf16 v[92:95], a[92:95], a[132:135], v[92:95]
ds_read_b64_tr_b16 a[78:79], v229 offset:25152
ds_read_b64_tr_b16 a[24:25], v229 offset:96
v_mfma_f32_16x16x32_bf16 v[36:39], a[92:95], a[128:131], 0
ds_read_b64_tr_b16 a[26:27], v229 offset:3680
ds_read_b64_tr_b16 a[80:81], v229 offset:7264
v_mfma_f32_16x16x32_bf16 v[36:39], a[36:39], a[112:115], v[36:39]
ds_read_b64_tr_b16 a[82:83], v229 offset:10848
ds_read_b64_tr_b16 a[28:29], v229 offset:14432
v_mfma_f32_16x16x32_bf16 v[40:43], a[40:43], a[112:115], 0
buffer_load_dwordx4 v237, s[12:15], s41 offen offset:1024 lds
ds_read_b64_tr_b16 a[30:31], v229 offset:18016
v_mfma_f32_16x16x32_bf16 v[40:43], a[96:99], a[128:131], v[40:43]
ds_read_b64_tr_b16 a[84:85], v229 offset:21600
ds_read_b64_tr_b16 a[86:87], v229 offset:25184
v_mfma_f32_16x16x32_bf16 v[96:99], a[96:99], a[132:135], 0
ds_read_b64_tr_b16 a[32:33], v229 offset:128
ds_read_b64_tr_b16 a[34:35], v229 offset:3712
v_mfma_f32_16x16x32_bf16 v[96:99], a[40:43], a[116:119], v[96:99]
ds_read_b64_tr_b16 a[88:89], v229 offset:7296
ds_read_b64_tr_b16 a[90:91], v229 offset:10880
v_mfma_f32_16x16x32_bf16 v[152:155], a[40:43], a[120:123], 0
ds_read_b64_tr_b16 a[36:37], v229 offset:14464
v_mfma_f32_16x16x32_bf16 v[152:155], a[96:99], a[136:139], v[152:155]
buffer_load_dwordx4 v238, s[12:15], s41 offen offset:2048 lds
ds_read_b64_tr_b16 a[38:39], v229 offset:18048
v_mfma_f32_16x16x32_bf16 v[208:211], a[96:99], a[140:143], 0
s_add_u32 s7, s7, s6
ds_read_b64_tr_b16 a[92:93], v229 offset:21632
ds_read_b64_tr_b16 a[94:95], v229 offset:25216
v_mfma_f32_16x16x32_bf16 v[208:211], a[40:43], a[124:127], v[208:211]
s_cmp_eq_u32 s7, s3
ds_read_b64_tr_b16 a[40:41], v229 offset:160
v_mfma_f32_16x16x32_bf16 v[212:215], a[44:47], a[124:127], 0
s_cselect_b32 s7, s24, s7
ds_read_b64_tr_b16 a[42:43], v229 offset:3744
v_mfma_f32_16x16x32_bf16 v[212:215], a[100:103], a[140:143], v[212:215]
s_mov_b32 m0, s7
ds_read_b64_tr_b16 a[96:97], v229 offset:7328
v_mfma_f32_16x16x32_bf16 v[156:159], a[100:103], a[136:139], 0
s_add_u32 s41, s41, 917504
ds_read_b64_tr_b16 a[98:99], v229 offset:10912
v_mfma_f32_16x16x32_bf16 v[156:159], a[44:47], a[120:123], v[156:159]
s_cmp_eq_u32 s41, 7340032
v_mfma_f32_16x16x32_bf16 v[100:103], a[44:47], a[116:119], 0
s_cselect_b32 s41, 458752, s41
v_mfma_f32_16x16x32_bf16 v[100:103], a[100:103], a[132:135], v[100:103]
v_mfma_f32_16x16x32_bf16 v[44:47], a[100:103], a[128:131], 0
v_mfma_f32_16x16x32_bf16 v[44:47], a[44:47], a[112:115], v[44:47]
ds_read_b64_tr_b16 a[44:45], v229 offset:14496
v_mfma_f32_16x16x32_bf16 v[48:51], a[48:51], a[112:115], 0
ds_read_b64_tr_b16 a[46:47], v229 offset:18080
v_mfma_f32_16x16x32_bf16 v[48:51], a[104:107], a[128:131], v[48:51]
ds_read_b64_tr_b16 a[100:101], v229 offset:21664
v_mfma_f32_16x16x32_bf16 v[104:107], a[104:107], a[132:135], 0
ds_read_b64_tr_b16 a[102:103], v229 offset:25248
v_mfma_f32_16x16x32_bf16 v[104:107], a[48:51], a[116:119], v[104:107]
v_mfma_f32_16x16x32_bf16 v[160:163], a[48:51], a[120:123], 0
v_mfma_f32_16x16x32_bf16 v[160:163], a[104:107], a[136:139], v[160:163]
v_mfma_f32_16x16x32_bf16 v[216:219], a[104:107], a[140:143], 0
v_mfma_f32_16x16x32_bf16 v[216:219], a[48:51], a[124:127], v[216:219]
s_waitcnt lgkmcnt(4)
ds_read_b64_tr_b16 a[48:49], v229 offset:192
v_mfma_f32_16x16x32_bf16 v[220:223], a[52:55], a[124:127], 0
ds_read_b64_tr_b16 a[50:51], v229 offset:3776
v_mfma_f32_16x16x32_bf16 v[220:223], a[108:111], a[140:143], v[220:223]
ds_read_b64_tr_b16 a[104:105], v229 offset:7360
v_mfma_f32_16x16x32_bf16 v[164:167], a[108:111], a[136:139], 0
ds_read_b64_tr_b16 a[106:107], v229 offset:10944
v_mfma_f32_16x16x32_bf16 v[164:167], a[52:55], a[120:123], v[164:167]
v_mfma_f32_16x16x32_bf16 v[108:111], a[52:55], a[116:119], 0
v_mfma_f32_16x16x32_bf16 v[108:111], a[108:111], a[132:135], v[108:111]
v_mfma_f32_16x16x32_bf16 v[52:55], a[108:111], a[128:131], 0
buffer_load_dword v230, v241, s[8:11], s97 offen sc1
v_mfma_f32_16x16x32_bf16 v[52:55], a[52:55], a[112:115], v[52:55]
ds_read_b64_tr_b16 a[52:53], v229 offset:14528
s_waitcnt vmcnt(15)
v_mfma_f32_16x16x32_bf16 v[0:3], a[0:3], a[144:147], v[0:3]
ds_read_b64_tr_b16 a[54:55], v229 offset:18112
v_mfma_f32_16x16x32_bf16 v[0:3], a[56:59], a[160:163], v[0:3]
ds_read_b64_tr_b16 a[108:109], v229 offset:21696
v_mfma_f32_16x16x32_bf16 v[56:59], a[56:59], a[164:167], v[56:59]
ds_read_b64_tr_b16 a[110:111], v229 offset:25280
v_mfma_f32_16x16x32_bf16 v[56:59], a[0:3], a[148:151], v[56:59]
buffer_load_dwordx4 a[112:115], v225, s[8:11], s23 offen offset:0 sc1
v_mfma_f32_16x16x32_bf16 v[112:115], a[0:3], a[152:155], v[112:115]
v_mfma_f32_16x16x32_bf16 v[112:115], a[56:59], a[168:171], v[112:115]
v_mfma_f32_16x16x32_bf16 v[168:171], a[56:59], a[172:175], v[168:171]
v_add_u32 v229, s5, v229
v_mfma_f32_16x16x32_bf16 v[168:171], a[0:3], a[156:159], v[168:171]
s_waitcnt vmcnt(9)
s_barrier
s_add_u32 s4, s4, 1
ds_read_b64_tr_b16 a[0:1], v229 offset:0
v_mfma_f32_16x16x32_bf16 v[172:175], a[4:7], a[156:159], v[172:175]
s_cmp_eq_u32 s4, 4
s_cselect_b32 s5, 0xfffeb000, s6
s_cselect_b32 s4, 0, s4
buffer_load_dwordx4 a[116:119], v226, s[8:11], s23 offen offset:0 sc1
v_mfma_f32_16x16x32_bf16 v[172:175], a[60:63], a[172:175], v[172:175]
ds_read_b64_tr_b16 a[2:3], v229 offset:3584
v_mfma_f32_16x16x32_bf16 v[116:119], a[60:63], a[168:171], v[116:119]
ds_read_b64_tr_b16 a[56:57], v229 offset:7168
v_mfma_f32_16x16x32_bf16 v[116:119], a[4:7], a[152:155], v[116:119]
ds_read_b64_tr_b16 a[58:59], v229 offset:10752
v_mfma_f32_16x16x32_bf16 v[60:63], a[4:7], a[148:151], v[60:63]
v_mfma_f32_16x16x32_bf16 v[60:63], a[60:63], a[164:167], v[60:63]
buffer_load_dwordx4 a[120:123], v227, s[8:11], s23 offen offset:0 sc1
v_mfma_f32_16x16x32_bf16 v[4:7], a[60:63], a[160:163], v[4:7]
v_mfma_f32_16x16x32_bf16 v[4:7], a[4:7], a[144:147], v[4:7]
ds_read_b64_tr_b16 a[4:5], v229 offset:14336
v_mfma_f32_16x16x32_bf16 v[8:11], a[8:11], a[144:147], v[8:11]
ds_read_b64_tr_b16 a[6:7], v229 offset:17920
v_mfma_f32_16x16x32_bf16 v[8:11], a[64:67], a[160:163], v[8:11]
ds_read_b64_tr_b16 a[60:61], v229 offset:21504
v_mfma_f32_16x16x32_bf16 v[64:67], a[64:67], a[164:167], v[64:67]
buffer_load_dwordx4 a[124:127], v228, s[8:11], s23 offen offset:0 sc1
v_mfma_f32_16x16x32_bf16 v[64:67], a[8:11], a[148:151], v[64:67]
ds_read_b64_tr_b16 a[62:63], v229 offset:25088
v_mfma_f32_16x16x32_bf16 v[120:123], a[8:11], a[152:155], v[120:123]
v_mfma_f32_16x16x32_bf16 v[120:123], a[64:67], a[168:171], v[120:123]
v_mfma_f32_16x16x32_bf16 v[176:179], a[64:67], a[172:175], v[176:179]
v_mfma_f32_16x16x32_bf16 v[176:179], a[8:11], a[156:159], v[176:179]
buffer_load_dwordx4 a[128:131], v225, s[8:11], s23 offen offset:1024 sc1
v_mfma_f32_16x16x32_bf16 v[180:183], a[12:15], a[156:159], v[180:183]
ds_read_b64_tr_b16 a[8:9], v229 offset:32
v_mfma_f32_16x16x32_bf16 v[180:183], a[68:71], a[172:175], v[180:183]
ds_read_b64_tr_b16 a[10:11], v229 offset:3616
v_mfma_f32_16x16x32_bf16 v[124:127], a[68:71], a[168:171], v[124:127]
ds_read_b64_tr_b16 a[64:65], v229 offset:7200
v_mfma_f32_16x16x32_bf16 v[124:127], a[12:15], a[152:155], v[124:127]
ds_read_b64_tr_b16 a[66:67], v229 offset:10784
v_mfma_f32_16x16x32_bf16 v[68:71], a[12:15], a[148:151], v[68:71]
buffer_load_dwordx4 a[132:135], v226, s[8:11], s23 offen offset:1024 sc1
v_mfma_f32_16x16x32_bf16 v[68:71], a[68:71], a[164:167], v[68:71]
v_mfma_f32_16x16x32_bf16 v[12:15], a[68:71], a[160:163], v[12:15]
v_mfma_f32_16x16x32_bf16 v[12:15], a[12:15], a[144:147], v[12:15]
ds_read_b64_tr_b16 a[12:13], v229 offset:14368
v_mfma_f32_16x16x32_bf16 v[16:19], a[16:19], a[144:147], v[16:19]
ds_read_b64_tr_b16 a[14:15], v229 offset:17952
v_mfma_f32_16x16x32_bf16 v[16:19], a[72:75], a[160:163], v[16:19]
buffer_load_dwordx4 a[136:139], v227, s[8:11], s23 offen offset:1024 sc1
v_mfma_f32_16x16x32_bf16 v[72:75], a[72:75], a[164:167], v[72:75]
ds_read_b64_tr_b16 a[68:69], v229 offset:21536
v_mfma_f32_16x16x32_bf16 v[72:75], a[16:19], a[148:151], v[72:75]
ds_read_b64_tr_b16 a[70:71], v229 offset:25120
v_mfma_f32_16x16x32_bf16 v[128:131], a[16:19], a[152:155], v[128:131]
v_mfma_f32_16x16x32_bf16 v[128:131], a[72:75], a[168:171], v[128:131]
v_mfma_f32_16x16x32_bf16 v[184:187], a[72:75], a[172:175], v[184:187]
buffer_load_dwordx4 a[140:143], v228, s[8:11], s23 offen offset:1024 sc1
v_mfma_f32_16x16x32_bf16 v[184:187], a[16:19], a[156:159], v[184:187]
s_add_u32 s23, s23, 4096
ds_read_b64_tr_b16 a[16:17], v229 offset:64
v_mfma_f32_16x16x32_bf16 v[188:191], a[20:23], a[156:159], v[188:191]
s_cmp_eq_u32 s23, s40
ds_read_b64_tr_b16 a[18:19], v229 offset:3648
v_mfma_f32_16x16x32_bf16 v[188:191], a[76:79], a[172:175], v[188:191]
s_cselect_b32 s23, s31, s23
ds_read_b64_tr_b16 a[72:73], v229 offset:7232
v_mfma_f32_16x16x32_bf16 v[132:135], a[76:79], a[168:171], v[132:135]
ds_read_b64_tr_b16 a[74:75], v229 offset:10816
v_mfma_f32_16x16x32_bf16 v[132:135], a[20:23], a[152:155], v[132:135]
buffer_load_dwordx4 v232, s[12:15], s41 offen offset:0 lds
v_mfma_f32_16x16x32_bf16 v[76:79], a[20:23], a[148:151], v[76:79]
v_mfma_f32_16x16x32_bf16 v[76:79], a[76:79], a[164:167], v[76:79]
v_mfma_f32_16x16x32_bf16 v[20:23], a[76:79], a[160:163], v[20:23]
v_mfma_f32_16x16x32_bf16 v[20:23], a[20:23], a[144:147], v[20:23]
ds_read_b64_tr_b16 a[20:21], v229 offset:14400
v_mfma_f32_16x16x32_bf16 v[24:27], a[24:27], a[144:147], v[24:27]
buffer_load_dwordx4 v233, s[12:15], s41 offen offset:1024 lds
v_mfma_f32_16x16x32_bf16 v[24:27], a[80:83], a[160:163], v[24:27]
ds_read_b64_tr_b16 a[22:23], v229 offset:17984
v_mfma_f32_16x16x32_bf16 v[80:83], a[80:83], a[164:167], v[80:83]
ds_read_b64_tr_b16 a[76:77], v229 offset:21568
v_mfma_f32_16x16x32_bf16 v[80:83], a[24:27], a[148:151], v[80:83]
ds_read_b64_tr_b16 a[78:79], v229 offset:25152
v_mfma_f32_16x16x32_bf16 v[136:139], a[24:27], a[152:155], v[136:139]
v_mfma_f32_16x16x32_bf16 v[136:139], a[80:83], a[168:171], v[136:139]
buffer_load_dword v249, v231, s[8:11], s32 offen sc1
v_mfma_f32_16x16x32_bf16 v[192:195], a[80:83], a[172:175], v[192:195]
v_mfma_f32_16x16x32_bf16 v[192:195], a[24:27], a[156:159], v[192:195]
ds_read_b64_tr_b16 a[24:25], v229 offset:96
v_mfma_f32_16x16x32_bf16 v[196:199], a[28:31], a[156:159], v[196:199]
ds_read_b64_tr_b16 a[26:27], v229 offset:3680
v_mfma_f32_16x16x32_bf16 v[196:199], a[84:87], a[172:175], v[196:199]
ds_read_b64_tr_b16 a[80:81], v229 offset:7264
v_mfma_f32_16x16x32_bf16 v[140:143], a[84:87], a[168:171], v[140:143]
s_waitcnt vmcnt(11)
v_cmp_ne_u32 s[46:47], s58, v230
s_nop 4
s_cmp_eq_u64 s[46:47], 0
s_cbranch_scc1 L_k3s_go
s_mov_b32 s56, 0x100000
L_k3s_poll:
buffer_load_dword v230, v241, s[8:11], s97 offen sc1
s_waitcnt vmcnt(0)
v_cmp_ne_u32 s[46:47], s58, v230
s_nop 4
s_cmp_eq_u64 s[46:47], 0
s_cbranch_scc1 L_k3s_go
s_sub_u32 s56, s56, 1
s_cbranch_scc0 L_k3s_poll
L_k3s_go:
buffer_load_dwordx4 a[184:187], v240, s[8:11], s92 offen offset:0 sc1
v_mfma_f32_16x16x32_bf16 v[140:143], a[28:31], a[152:155], v[140:143]
ds_read_b64_tr_b16 a[82:83], v229 offset:10848
v_mfma_f32_16x16x32_bf16 v[84:87], a[28:31], a[148:151], v[84:87]
v_mfma_f32_16x16x32_bf16 v[84:87], a[84:87], a[164:167], v[84:87]
v_mfma_f32_16x16x32_bf16 v[28:31], a[84:87], a[160:163], v[28:31]
v_mfma_f32_16x16x32_bf16 v[28:31], a[28:31], a[144:147], v[28:31]
buffer_load_dwordx4 a[188:191], v240, s[8:11], s92 offen offset:16 sc1
v_mfma_f32_16x16x32_bf16 v[32:35], a[32:35], a[144:147], v[32:35]
ds_read_b64_tr_b16 a[28:29], v229 offset:14432
v_mfma_f32_16x16x32_bf16 v[32:35], a[88:91], a[160:163], v[32:35]
ds_read_b64_tr_b16 a[30:31], v229 offset:18016
v_mfma_f32_16x16x32_bf16 v[88:91], a[88:91], a[164:167], v[88:91]
ds_read_b64_tr_b16 a[84:85], v229 offset:21600
v_mfma_f32_16x16x32_bf16 v[88:91], a[32:35], a[148:151], v[88:91]
ds_read_b64_tr_b16 a[86:87], v229 offset:25184
v_mfma_f32_16x16x32_bf16 v[144:147], a[32:35], a[152:155], v[144:147]
buffer_load_dwordx4 a[192:195], v240, s[8:11], s92 offen offset:2048 sc1
v_mfma_f32_16x16x32_bf16 v[144:147], a[88:91], a[168:171], v[144:147]
v_mfma_f32_16x16x32_bf16 v[200:203], a[88:91], a[172:175], v[200:203]
v_mfma_f32_16x16x32_bf16 v[200:203], a[32:35], a[156:159], v[200:203]
ds_read_b64_tr_b16 a[32:33], v229 offset:128
v_mfma_f32_16x16x32_bf16 v[204:207], a[36:39], a[156:159], v[204:207]
ds_read_b64_tr_b16 a[34:35], v229 offset:3712
v_mfma_f32_16x16x32_bf16 v[204:207], a[92:95], a[172:175], v[204:207]
buffer_load_dwordx4 a[196:199], v240, s[8:11], s92 offen offset:2064 sc1
v_mfma_f32_16x16x32_bf16 v[148:151], a[92:95], a[168:171], v[148:151]
ds_read_b64_tr_b16 a[88:89], v229 offset:7296
v_mfma_f32_16x16x32_bf16 v[148:151], a[36:39], a[152:155], v[148:151]
ds_read_b64_tr_b16 a[90:91], v229 offset:10880
v_mfma_f32_16x16x32_bf16 v[92:95], a[36:39], a[148:151], v[92:95]
v_mfma_f32_16x16x32_bf16 v[92:95], a[92:95], a[164:167], v[92:95]
v_mfma_f32_16x16x32_bf16 v[36:39], a[92:95], a[160:163], v[36:39]
buffer_load_dwordx4 a[200:203], v240, s[8:11], s98 offen offset:0 sc1
v_mfma_f32_16x16x32_bf16 v[36:39], a[36:39], a[144:147], v[36:39]
ds_read_b64_tr_b16 a[36:37], v229 offset:14464
v_mfma_f32_16x16x32_bf16 v[40:43], a[40:43], a[144:147], v[40:43]
ds_read_b64_tr_b16 a[38:39], v229 offset:18048
v_mfma_f32_16x16x32_bf16 v[40:43], a[96:99], a[160:163], v[40:43]
ds_read_b64_tr_b16 a[92:93], v229 offset:21632
v_mfma_f32_16x16x32_bf16 v[96:99], a[96:99], a[164:167], v[96:99]
ds_read_b64_tr_b16 a[94:95], v229 offset:25216
v_mfma_f32_16x16x32_bf16 v[96:99], a[40:43], a[148:151], v[96:99]
buffer_load_dwordx4 a[204:207], v240, s[8:11], s98 offen offset:16 sc1
v_mfma_f32_16x16x32_bf16 v[152:155], a[40:43], a[152:155], v[152:155]
v_mfma_f32_16x16x32_bf16 v[152:155], a[96:99], a[168:171], v[152:155]
v_mfma_f32_16x16x32_bf16 v[208:211], a[96:99], a[172:175], v[208:211]
v_mfma_f32_16x16x32_bf16 v[208:211], a[40:43], a[156:159], v[208:211]
s_waitcnt lgkmcnt(4)
ds_read_b64_tr_b16 a[40:41], v229 offset:160
v_mfma_f32_16x16x32_bf16 v[212:215], a[44:47], a[156:159], v[212:215]
buffer_load_dwordx4 a[208:211], v240, s[8:11], s98 offen offset:2048 sc1
v_mfma_f32_16x16x32_bf16 v[212:215], a[100:103], a[172:175], v[212:215]
ds_read_b64_tr_b16 a[42:43], v229 offset:3744
v_mfma_f32_16x16x32_bf16 v[156:159], a[100:103], a[168:171], v[156:159]
ds_read_b64_tr_b16 a[96:97], v229 offset:7328
v_mfma_f32_16x16x32_bf16 v[156:159], a[44:47], a[152:155], v[156:159]
ds_read_b64_tr_b16 a[98:99], v229 offset:10912
v_mfma_f32_16x16x32_bf16 v[100:103], a[44:47], a[148:151], v[100:103]
v_mfma_f32_16x16x32_bf16 v[100:103], a[100:103], a[164:167], v[100:103]
buffer_load_dwordx4 a[212:215], v240, s[8:11], s98 offen offset:2064 sc1
v_mfma_f32_16x16x32_bf16 v[44:47], a[100:103], a[160:163], v[44:47]
v_mfma_f32_16x16x32_bf16 v[44:47], a[44:47], a[144:147], v[44:47]
ds_read_b64_tr_b16 a[44:45], v229 offset:14496
v_mfma_f32_16x16x32_bf16 v[48:51], a[48:51], a[144:147], v[48:51]
ds_read_b64_tr_b16 a[46:47], v229 offset:18080
v_mfma_f32_16x16x32_bf16 v[48:51], a[104:107], a[160:163], v[48:51]
ds_read_b64_tr_b16 a[100:101], v229 offset:21664
v_mfma_f32_16x16x32_bf16 v[104:107], a[104:107], a[164:167], v[104:107]
buffer_load_dwordx4 v234, s[12:15], s41 offen offset:2048 lds
v_mfma_f32_16x16x32_bf16 v[104:107], a[48:51], a[148:151], v[104:107]
ds_read_b64_tr_b16 a[102:103], v229 offset:25248
v_mfma_f32_16x16x32_bf16 v[160:163], a[48:51], a[152:155], v[160:163]
v_mfma_f32_16x16x32_bf16 v[160:163], a[104:107], a[168:171], v[160:163]
v_mfma_f32_16x16x32_bf16 v[216:219], a[104:107], a[172:175], v[216:219]
v_mfma_f32_16x16x32_bf16 v[216:219], a[48:51], a[156:159], v[216:219]
buffer_load_dwordx4 v235, s[12:15], s41 offen offset:3072 lds
v_mfma_f32_16x16x32_bf16 v[220:223], a[52:55], a[156:159], v[220:223]
s_add_u32 m0, s7, 4096
ds_read_b64_tr_b16 a[48:49], v229 offset:192
v_mfma_f32_16x16x32_bf16 v[220:223], a[108:111], a[172:175], v[220:223]
ds_read_b64_tr_b16 a[50:51], v229 offset:3776
v_mfma_f32_16x16x32_bf16 v[164:167], a[108:111], a[168:171], v[164:167]
ds_read_b64_tr_b16 a[104:105], v229 offset:7360
v_mfma_f32_16x16x32_bf16 v[164:167], a[52:55], a[152:155], v[164:167]
ds_read_b64_tr_b16 a[106:107], v229 offset:10944
v_mfma_f32_16x16x32_bf16 v[108:111], a[52:55], a[148:151], v[108:111]
buffer_load_dwordx4 v236, s[12:15], s41 offen offset:0 lds
v_mfma_f32_16x16x32_bf16 v[108:111], a[108:111], a[164:167], v[108:111]
v_mfma_f32_16x16x32_bf16 v[52:55], a[108:111], a[160:163], v[52:55]
v_mfma_f32_16x16x32_bf16 v[52:55], a[52:55], a[144:147], v[52:55]
s_waitcnt vmcnt(14)
ds_read_b64_tr_b16 a[52:53], v229 offset:14528
v_mfma_f32_16x16x32_bf16 v[0:3], a[0:3], a[112:115], v[0:3]
ds_read_b64_tr_b16 a[54:55], v229 offset:18112
v_mfma_f32_16x16x32_bf16 v[0:3], a[56:59], a[128:131], v[0:3]
buffer_load_dwordx4 a[144:147], v225, s[8:11], s23 offen offset:0 sc1
v_mfma_f32_16x16x32_bf16 v[56:59], a[56:59], a[132:135], v[56:59]
ds_read_b64_tr_b16 a[108:109], v229 offset:21696
v_mfma_f32_16x16x32_bf16 v[56:59], a[0:3], a[116:119], v[56:59]
ds_read_b64_tr_b16 a[110:111], v229 offset:25280
v_mfma_f32_16x16x32_bf16 v[112:115], a[0:3], a[120:123], v[112:115]
v_mfma_f32_16x16x32_bf16 v[112:115], a[56:59], a[136:139], v[112:115]
s_waitcnt vmcnt(12)
v_cmp_ne_u32 s[46:47], s58, v249
s_nop 4
s_cmp_eq_u64 s[46:47], 0
s_cbranch_scc1 L_k3cs_go
s_cmp_lg_u32 s30, 0
s_cbranch_scc1 L_k3cs_go
s_mov_b32 s56, 0x100000
L_k3cs_poll:
buffer_load_dword v249, v231, s[8:11], s32 offen sc1
s_waitcnt vmcnt(0)
v_cmp_ne_u32 s[46:47], s58, v249
s_nop 4
s_cmp_eq_u64 s[46:47], 0
s_cbranch_scc1 L_k3cs_go
s_sub_u32 s56, s56, 1
s_cbranch_scc0 L_k3cs_poll
L_k3cs_go:
v_mfma_f32_16x16x32_bf16 v[168:171], a[56:59], a[140:143], v[168:171]
buffer_load_dwordx4 a[148:151], v226, s[8:11], s23 offen offset:0 sc1
v_add_u32 v229, s5, v229
v_mfma_f32_16x16x32_bf16 v[168:171], a[0:3], a[124:127], v[168:171]
s_barrier
s_add_u32 s4, s4, 1
ds_read_b64_tr_b16 a[0:1], v229 offset:0
v_mfma_f32_16x16x32_bf16 v[172:175], a[4:7], a[124:127], v[172:175]
s_cmp_eq_u32 s4, 4
ds_read_b64_tr_b16 a[2:3], v229 offset:3584
v_mfma_f32_16x16x32_bf16 v[172:175], a[60:63], a[140:143], v[172:175]
s_cselect_b32 s5, 0xfffeb000, s6
ds_read_b64_tr_b16 a[56:57], v229 offset:7168
v_mfma_f32_16x16x32_bf16 v[116:119], a[60:63], a[136:139], v[116:119]
s_cselect_b32 s4, 0, s4
ds_read_b64_tr_b16 a[58:59], v229 offset:10752
v_mfma_f32_16x16x32_bf16 v[116:119], a[4:7], a[120:123], v[116:119]
buffer_load_dword a248, v243, s[8:11], s93 offen sc1
v_mfma_f32_16x16x32_bf16 v[60:63], a[4:7], a[116:119], v[60:63]
v_mfma_f32_16x16x32_bf16 v[60:63], a[60:63], a[132:135], v[60:63]
v_mfma_f32_16x16x32_bf16 v[4:7], a[60:63], a[128:131], v[4:7]
v_mfma_f32_16x16x32_bf16 v[4:7], a[4:7], a[112:115], v[4:7]
ds_read_b64_tr_b16 a[4:5], v229 offset:14336
v_mfma_f32_16x16x32_bf16 v[8:11], a[8:11], a[112:115], v[8:11]
buffer_load_dword a249, v243, s[8:11], s94 offen sc1
v_mfma_f32_16x16x32_bf16 v[8:11], a[64:67], a[128:131], v[8:11]
ds_read_b64_tr_b16 a[6:7], v229 offset:17920
v_mfma_f32_16x16x32_bf16 v[64:67], a[64:67], a[132:135], v[64:67]
ds_read_b64_tr_b16 a[60:61], v229 offset:21504
v_mfma_f32_16x16x32_bf16 v[64:67], a[8:11], a[116:119], v[64:67]
ds_read_b64_tr_b16 a[62:63], v229 offset:25088
v_mfma_f32_16x16x32_bf16 v[120:123], a[8:11], a[120:123], v[120:123]
v_mfma_f32_16x16x32_bf16 v[120:123], a[64:67], a[136:139], v[120:123]
buffer_load_dword a250, v243, s[8:11], s95 offen sc1
v_mfma_f32_16x16x32_bf16 v[176:179], a[64:67], a[140:143], v[176:179]
v_mfma_f32_16x16x32_bf16 v[176:179], a[8:11], a[124:127], v[176:179]
ds_read_b64_tr_b16 a[8:9], v229 offset:32
v_mfma_f32_16x16x32_bf16 v[180:183], a[12:15], a[124:127], v[180:183]
ds_read_b64_tr_b16 a[10:11], v229 offset:3616
v_mfma_f32_16x16x32_bf16 v[180:183], a[68:71], a[140:143], v[180:183]
ds_read_b64_tr_b16 a[64:65], v229 offset:7200
v_mfma_f32_16x16x32_bf16 v[124:127], a[68:71], a[136:139], v[124:127]
buffer_load_dword a251, v243, s[8:11], s96 offen sc1
v_mfma_f32_16x16x32_bf16 v[124:127], a[12:15], a[120:123], v[124:127]
ds_read_b64_tr_b16 a[66:67], v229 offset:10784
v_mfma_f32_16x16x32_bf16 v[68:71], a[12:15], a[116:119], v[68:71]
v_mfma_f32_16x16x32_bf16 v[68:71], a[68:71], a[132:135], v[68:71]
v_mfma_f32_16x16x32_bf16 v[12:15], a[68:71], a[128:131], v[12:15]
v_mfma_f32_16x16x32_bf16 v[12:15], a[12:15], a[112:115], v[12:15]
buffer_load_dwordx4 a[152:155], v227, s[8:11], s23 offen offset:0 sc1
v_mfma_f32_16x16x32_bf16 v[16:19], a[16:19], a[112:115], v[16:19]
ds_read_b64_tr_b16 a[12:13], v229 offset:14368
v_mfma_f32_16x16x32_bf16 v[16:19], a[72:75], a[128:131], v[16:19]
ds_read_b64_tr_b16 a[14:15], v229 offset:17952
v_mfma_f32_16x16x32_bf16 v[72:75], a[72:75], a[132:135], v[72:75]
ds_read_b64_tr_b16 a[68:69], v229 offset:21536
v_mfma_f32_16x16x32_bf16 v[72:75], a[16:19], a[116:119], v[72:75]
ds_read_b64_tr_b16 a[70:71], v229 offset:25120
v_mfma_f32_16x16x32_bf16 v[128:131], a[16:19], a[120:123], v[128:131]
buffer_load_dwordx4 a[156:159], v228, s[8:11], s23 offen offset:0 sc1
v_mfma_f32_16x16x32_bf16 v[128:131], a[72:75], a[136:139], v[128:131]
v_mfma_f32_16x16x32_bf16 v[184:187], a[72:75], a[140:143], v[184:187]
v_mfma_f32_16x16x32_bf16 v[184:187], a[16:19], a[124:127], v[184:187]
ds_read_b64_tr_b16 a[16:17], v229 offset:64
v_mfma_f32_16x16x32_bf16 v[188:191], a[20:23], a[124:127], v[188:191]
ds_read_b64_tr_b16 a[18:19], v229 offset:3648
v_mfma_f32_16x16x32_bf16 v[188:191], a[76:79], a[140:143], v[188:191]
buffer_load_dwordx4 a[160:163], v225, s[8:11], s23 offen offset:1024 sc1
v_mfma_f32_16x16x32_bf16 v[132:135], a[76:79], a[136:139], v[132:135]
ds_read_b64_tr_b16 a[72:73], v229 offset:7232
v_mfma_f32_16x16x32_bf16 v[132:135], a[20:23], a[120:123], v[132:135]
ds_read_b64_tr_b16 a[74:75], v229 offset:10816
v_mfma_f32_16x16x32_bf16 v[76:79], a[20:23], a[116:119], v[76:79]
v_mfma_f32_16x16x32_bf16 v[76:79], a[76:79], a[132:135], v[76:79]
v_mfma_f32_16x16x32_bf16 v[20:23], a[76:79], a[128:131], v[20:23]
buffer_load_dwordx4 a[164:167], v226, s[8:11], s23 offen offset:1024 sc1
v_mfma_f32_16x16x32_bf16 v[20:23], a[20:23], a[112:115], v[20:23]
ds_read_b64_tr_b16 a[20:21], v229 offset:14400
v_mfma_f32_16x16x32_bf16 v[24:27], a[24:27], a[112:115], v[24:27]
ds_read_b64_tr_b16 a[22:23], v229 offset:17984
v_mfma_f32_16x16x32_bf16 v[24:27], a[80:83], a[128:131], v[24:27]
ds_read_b64_tr_b16 a[76:77], v229 offset:21568
v_mfma_f32_16x16x32_bf16 v[80:83], a[80:83], a[132:135], v[80:83]
ds_read_b64_tr_b16 a[78:79], v229 offset:25152
v_mfma_f32_16x16x32_bf16 v[80:83], a[24:27], a[116:119], v[80:83]
buffer_load_dwordx4 a[168:171], v227, s[8:11], s23 offen offset:1024 sc1
v_mfma_f32_16x16x32_bf16 v[136:139], a[24:27], a[120:123], v[136:139]
v_mfma_f32_16x16x32_bf16 v[136:139], a[80:83], a[136:139], v[136:139]
v_mfma_f32_16x16x32_bf16 v[192:195], a[80:83], a[140:143], v[192:195]
v_mfma_f32_16x16x32_bf16 v[192:195], a[24:27], a[124:127], v[192:195]
ds_read_b64_tr_b16 a[24:25], v229 offset:96
v_mfma_f32_16x16x32_bf16 v[196:199], a[28:31], a[124:127], v[196:199]
buffer_load_dwordx4 a[172:175], v228, s[8:11], s23 offen offset:1024 sc1
v_mfma_f32_16x16x32_bf16 v[196:199], a[84:87], a[140:143], v[196:199]
s_add_u32 s23, s23, 4096
ds_read_b64_tr_b16 a[26:27], v229 offset:3680
v_mfma_f32_16x16x32_bf16 v[140:143], a[84:87], a[136:139], v[140:143]
s_cmp_eq_u32 s23, s40
ds_read_b64_tr_b16 a[80:81], v229 offset:7264
v_mfma_f32_16x16x32_bf16 v[140:143], a[28:31], a[120:123], v[140:143]
s_cselect_b32 s23, s31, s23
ds_read_b64_tr_b16 a[82:83], v229 offset:10848
v_mfma_f32_16x16x32_bf16 v[84:87], a[28:31], a[116:119], v[84:87]
v_mfma_f32_16x16x32_bf16 v[84:87], a[84:87], a[132:135], v[84:87]
buffer_load_dwordx4 v237, s[12:15], s41 offen offset:1024 lds
v_mfma_f32_16x16x32_bf16 v[28:31], a[84:87], a[128:131], v[28:31]
v_mfma_f32_16x16x32_bf16 v[28:31], a[28:31], a[112:115], v[28:31]
ds_read_b64_tr_b16 a[28:29], v229 offset:14432
v_mfma_f32_16x16x32_bf16 v[32:35], a[32:35], a[112:115], v[32:35]
ds_read_b64_tr_b16 a[30:31], v229 offset:18016
v_mfma_f32_16x16x32_bf16 v[32:35], a[88:91], a[128:131], v[32:35]
ds_read_b64_tr_b16 a[84:85], v229 offset:21600
v_mfma_f32_16x16x32_bf16 v[88:91], a[88:91], a[132:135], v[88:91]
buffer_load_dwordx4 v238, s[12:15], s41 offen offset:2048 lds
v_mfma_f32_16x16x32_bf16 v[88:91], a[32:35], a[116:119], v[88:91]
s_add_u32 s7, s7, s6
ds_read_b64_tr_b16 a[86:87], v229 offset:25184
v_mfma_f32_16x16x32_bf16 v[144:147], a[32:35], a[120:123], v[144:147]
s_cmp_eq_u32 s7, s3
v_mfma_f32_16x16x32_bf16 v[144:147], a[88:91], a[136:139], v[144:147]
s_cselect_b32 s7, s24, s7
v_mfma_f32_16x16x32_bf16 v[200:203], a[88:91], a[140:143], v[200:203]
s_mov_b32 m0, s7
v_mfma_f32_16x16x32_bf16 v[200:203], a[32:35], a[124:127], v[200:203]
s_waitcnt lgkmcnt(4)
s_add_u32 s41, s41, 917504
s_cmp_eq_u32 s41, 7340032
s_cselect_b32 s41, 458752, s41
buffer_load_dwordx4 v232, s[12:15], s41 offen offset:0 lds
v_mfma_f32_16x16x32_bf16 v[204:207], a[36:39], a[124:127], v[204:207]
ds_read_b64_tr_b16 a[32:33], v229 offset:128
v_mfma_f32_16x16x32_bf16 v[204:207], a[92:95], a[140:143], v[204:207]
ds_read_b64_tr_b16 a[34:35], v229 offset:3712
v_mfma_f32_16x16x32_bf16 v[148:151], a[92:95], a[136:139], v[148:151]
ds_read_b64_tr_b16 a[88:89], v229 offset:7296
v_mfma_f32_16x16x32_bf16 v[148:151], a[36:39], a[120:123], v[148:151]
ds_read_b64_tr_b16 a[90:91], v229 offset:10880
v_mfma_f32_16x16x32_bf16 v[92:95], a[36:39], a[116:119], v[92:95]
buffer_load_dwordx4 v233, s[12:15], s41 offen offset:1024 lds
v_mfma_f32_16x16x32_bf16 v[92:95], a[92:95], a[132:135], v[92:95]
s_waitcnt vmcnt(10)
v_accvgpr_read_b32 v248, a248
v_mfma_f32_16x16x32_bf16 v[36:39], a[92:95], a[128:131], v[36:39]
v_accvgpr_read_b32 v249, a249
v_mfma_f32_16x16x32_bf16 v[36:39], a[36:39], a[112:115], v[36:39]
ds_read_b64_tr_b16 a[36:37], v229 offset:14464
v_accvgpr_read_b32 v250, a250
v_mfma_f32_16x16x32_bf16 v[40:43], a[40:43], a[112:115], v[40:43]
ds_read_b64_tr_b16 a[38:39], v229 offset:18048
v_accvgpr_read_b32 v251, a251
v_mfma_f32_16x16x32_bf16 v[40:43], a[96:99], a[128:131], v[40:43]
buffer_load_dwordx4 v234, s[12:15], s41 offen offset:2048 lds
v_add_f32 v248, v248, v249
v_mfma_f32_16x16x32_bf16 v[96:99], a[96:99], a[132:135], v[96:99]
ds_read_b64_tr_b16 a[92:93], v229 offset:21632
v_add_f32 v250, v250, v251
v_mfma_f32_16x16x32_bf16 v[96:99], a[40:43], a[116:119], v[96:99]
ds_read_b64_tr_b16 a[94:95], v229 offset:25216
v_add_f32 v248, v248, v250
v_mfma_f32_16x16x32_bf16 v[152:155], a[40:43], a[120:123], v[152:155]
ds_write_b32 v242, v248
v_mfma_f32_16x16x32_bf16 v[152:155], a[96:99], a[136:139], v[152:155]
v_mfma_f32_16x16x32_bf16 v[208:211], a[96:99], a[140:143], v[208:211]
buffer_load_dwordx4 v235, s[12:15], s41 offen offset:3072 lds
v_mfma_f32_16x16x32_bf16 v[208:211], a[40:43], a[124:127], v[208:211]
s_add_u32 m0, s7, 4096
ds_read_b64_tr_b16 a[40:41], v229 offset:160
v_mfma_f32_16x16x32_bf16 v[212:215], a[44:47], a[124:127], v[212:215]
ds_read_b64_tr_b16 a[42:43], v229 offset:3744
v_mfma_f32_16x16x32_bf16 v[212:215], a[100:103], a[140:143], v[212:215]
ds_read_b64_tr_b16 a[96:97], v229 offset:7328
v_mfma_f32_16x16x32_bf16 v[156:159], a[100:103], a[136:139], v[156:159]
ds_read_b64_tr_b16 a[98:99], v229 offset:10912
v_mfma_f32_16x16x32_bf16 v[156:159], a[44:47], a[120:123], v[156:159]
buffer_load_dwordx4 v236, s[12:15], s41 offen offset:0 lds
v_mfma_f32_16x16x32_bf16 v[100:103], a[44:47], a[116:119], v[100:103]
v_mfma_f32_16x16x32_bf16 v[100:103], a[100:103], a[132:135], v[100:103]
v_mfma_f32_16x16x32_bf16 v[44:47], a[100:103], a[128:131], v[44:47]
v_mfma_f32_16x16x32_bf16 v[44:47], a[44:47], a[112:115], v[44:47]
ds_read_b64_tr_b16 a[44:45], v229 offset:14496
v_mfma_f32_16x16x32_bf16 v[48:51], a[48:51], a[112:115], v[48:51]
buffer_load_dwordx4 v237, s[12:15], s41 offen offset:1024 lds
v_mfma_f32_16x16x32_bf16 v[48:51], a[104:107], a[128:131], v[48:51]
ds_read_b64_tr_b16 a[46:47], v229 offset:18080
v_mfma_f32_16x16x32_bf16 v[104:107], a[104:107], a[132:135], v[104:107]
ds_read_b64_tr_b16 a[100:101], v229 offset:21664
v_mfma_f32_16x16x32_bf16 v[104:107], a[48:51], a[116:119], v[104:107]
ds_read_b64_tr_b16 a[102:103], v229 offset:25248
v_mfma_f32_16x16x32_bf16 v[160:163], a[48:51], a[120:123], v[160:163]
v_mfma_f32_16x16x32_bf16 v[160:163], a[104:107], a[136:139], v[160:163]
v_mfma_f32_16x16x32_bf16 v[216:219], a[104:107], a[140:143], v[216:219]
buffer_load_dwordx4 v238, s[12:15], s41 offen offset:2048 lds
v_mfma_f32_16x16x32_bf16 v[216:219], a[48:51], a[124:127], v[216:219]
s_add_u32 s7, s7, s6
ds_read_b64_tr_b16 a[48:49], v229 offset:192
v_mfma_f32_16x16x32_bf16 v[220:223], a[52:55], a[124:127], v[220:223]
s_cmp_eq_u32 s7, s3
ds_read_b64_tr_b16 a[50:51], v229 offset:3776
v_mfma_f32_16x16x32_bf16 v[220:223], a[108:111], a[140:143], v[220:223]
s_cselect_b32 s7, s24, s7
ds_read_b64_tr_b16 a[104:105], v229 offset:7360
v_mfma_f32_16x16x32_bf16 v[164:167], a[108:111], a[136:139], v[164:167]
s_mov_b32 m0, s7
ds_read_b64_tr_b16 a[106:107], v229 offset:10944
v_mfma_f32_16x16x32_bf16 v[164:167], a[52:55], a[120:123], v[164:167]
s_add_u32 s41, s41, 917504
v_mfma_f32_16x16x32_bf16 v[108:111], a[52:55], a[116:119], v[108:111]
s_cmp_eq_u32 s41, 7340032
v_mfma_f32_16x16x32_bf16 v[108:111], a[108:111], a[132:135], v[108:111]
s_cselect_b32 s41, 458752, s41
v_mfma_f32_16x16x32_bf16 v[52:55], a[108:111], a[128:131], v[52:55]
v_mfma_f32_16x16x32_bf16 v[52:55], a[52:55], a[112:115], v[52:55]
buffer_load_dwordx4 a[112:115], v225, s[8:11], s23 offen offset:0 sc1
s_mov_b32 s101, 4
L_k3_loop:
s_waitcnt vmcnt(8) lgkmcnt(4)
v_mfma_f32_16x16x32_bf16 v[0:3], a[0:3], a[144:147], v[0:3]
ds_read_b64_tr_b16 a[52:53], v229 offset:14528
v_mfma_f32_16x16x32_bf16 v[0:3], a[56:59], a[160:163], v[0:3]
ds_read_b64_tr_b16 a[54:55], v229 offset:18112
v_mfma_f32_16x16x32_bf16 v[56:59], a[56:59], a[164:167], v[56:59]
ds_read_b64_tr_b16 a[108:109], v229 offset:21696
v_mfma_f32_16x16x32_bf16 v[56:59], a[0:3], a[148:151], v[56:59]
ds_read_b64_tr_b16 a[110:111], v229 offset:25280
v_mfma_f32_16x16x32_bf16 v[112:115], a[0:3], a[152:155], v[112:115]
v_mfma_f32_16x16x32_bf16 v[112:115], a[56:59], a[168:171], v[112:115]
buffer_load_dwordx4 a[116:119], v226, s[8:11], s23 offen offset:0 sc1
v_mfma_f32_16x16x32_bf16 v[168:171], a[56:59], a[172:175], v[168:171]
v_add_u32 v229, s5, v229
v_mfma_f32_16x16x32_bf16 v[168:171], a[0:3], a[156:159], v[168:171]
s_waitcnt vmcnt(9)
s_barrier
s_add_u32 s4, s4, 1
ds_read_b64_tr_b16 a[0:1], v229 offset:0
v_mfma_f32_16x16x32_bf16 v[172:175], a[4:7], a[156:159], v[172:175]
s_cmp_eq_u32 s4, 4
ds_read_b64_tr_b16 a[2:3], v229 offset:3584
v_mfma_f32_16x16x32_bf16 v[172:175], a[60:63], a[172:175], v[172:175]
s_cselect_b32 s5, 0xfffeb000, s6
ds_read_b64_tr_b16 a[56:57], v229 offset:7168
v_mfma_f32_16x16x32_bf16 v[116:119], a[60:63], a[168:171], v[116:119]
s_cselect_b32 s4, 0, s4
ds_read_b64_tr_b16 a[58:59], v229 offset:10752
v_mfma_f32_16x16x32_bf16 v[116:119], a[4:7], a[152:155], v[116:119]
buffer_load_dwordx4 a[120:123], v227, s[8:11], s23 offen offset:0 sc1
v_mfma_f32_16x16x32_bf16 v[60:63], a[4:7], a[148:151], v[60:63]
v_mfma_f32_16x16x32_bf16 v[60:63], a[60:63], a[164:167], v[60:63]
v_mfma_f32_16x16x32_bf16 v[4:7], a[60:63], a[160:163], v[4:7]
v_mfma_f32_16x16x32_bf16 v[4:7], a[4:7], a[144:147], v[4:7]
ds_read_b64_tr_b16 a[4:5], v229 offset:14336
v_mfma_f32_16x16x32_bf16 v[8:11], a[8:11], a[144:147], v[8:11]
ds_read_b64_tr_b16 a[6:7], v229 offset:17920
v_mfma_f32_16x16x32_bf16 v[8:11], a[64:67], a[160:163], v[8:11]
buffer_load_dwordx4 a[124:127], v228, s[8:11], s23 offen offset:0 sc1
v_mfma_f32_16x16x32_bf16 v[64:67], a[64:67], a[164:167], v[64:67]
ds_read_b64_tr_b16 a[60:61], v229 offset:21504
v_mfma_f32_16x16x32_bf16 v[64:67], a[8:11], a[148:151], v[64:67]
ds_read_b64_tr_b16 a[62:63], v229 offset:25088
v_mfma_f32_16x16x32_bf16 v[120:123], a[8:11], a[152:155], v[120:123]
v_mfma_f32_16x16x32_bf16 v[120:123], a[64:67], a[168:171], v[120:123]
v_mfma_f32_16x16x32_bf16 v[176:179], a[64:67], a[172:175], v[176:179]
v_mfma_f32_16x16x32_bf16 v[176:179], a[8:11], a[156:159], v[176:179]
buffer_load_dwordx4 a[128:131], v225, s[8:11], s23 offen offset:1024 sc1
v_mfma_f32_16x16x32_bf16 v[180:183], a[12:15], a[156:159], v[180:183]
ds_read_b64_tr_b16 a[8:9], v229 offset:32
v_mfma_f32_16x16x32_bf16 v[180:183], a[68:71], a[172:175], v[180:183]
ds_read_b64_tr_b16 a[10:11], v229 offset:3616
v_mfma_f32_16x16x32_bf16 v[124:127], a[68:71], a[168:171], v[124:127]
ds_read_b64_tr_b16 a[64:65], v229 offset:7200
v_mfma_f32_16x16x32_bf16 v[124:127], a[12:15], a[152:155], v[124:127]
ds_read_b64_tr_b16 a[66:67], v229 offset:10784
v_mfma_f32_16x16x32_bf16 v[68:71], a[12:15], a[148:151], v[68:71]
v_mfma_f32_16x16x32_bf16 v[68:71], a[68:71], a[164:167], v[68:71]
buffer_load_dwordx4 a[132:135], v226, s[8:11], s23 offen offset:1024 sc1
v_mfma_f32_16x16x32_bf16 v[12:15], a[68:71], a[160:163], v[12:15]
v_mfma_f32_16x16x32_bf16 v[12:15], a[12:15], a[144:147], v[12:15]
ds_read_b64_tr_b16 a[12:13], v229 offset:14368
v_mfma_f32_16x16x32_bf16 v[16:19], a[16:19], a[144:147], v[16:19]
ds_read_b64_tr_b16 a[14:15], v229 offset:17952
v_mfma_f32_16x16x32_bf16 v[16:19], a[72:75], a[160:163], v[16:19]
ds_read_b64_tr_b16 a[68:69], v229 offset:21536
v_mfma_f32_16x16x32_bf16 v[72:75], a[72:75], a[164:167], v[72:75]
ds_read_b64_tr_b16 a[70:71], v229 offset:25120
v_mfma_f32_16x16x32_bf16 v[72:75], a[16:19], a[148:151], v[72:75]
buffer_load_dwordx4 a[136:139], v227, s[8:11], s23 offen offset:1024 sc1
v_mfma_f32_16x16x32_bf16 v[128:131], a[16:19], a[152:155], v[128:131]
v_mfma_f32_16x16x32_bf16 v[128:131], a[72:75], a[168:171], v[128:131]
v_mfma_f32_16x16x32_bf16 v[184:187], a[72:75], a[172:175], v[184:187]
v_mfma_f32_16x16x32_bf16 v[184:187], a[16:19], a[156:159], v[184:187]
ds_read_b64_tr_b16 a[16:17], v229 offset:64
v_mfma_f32_16x16x32_bf16 v[188:191], a[20:23], a[156:159], v[188:191]
ds_read_b64_tr_b16 a[18:19], v229 offset:3648
v_mfma_f32_16x16x32_bf16 v[188:191], a[76:79], a[172:175], v[188:191]
buffer_load_dwordx4 a[140:143], v228, s[8:11], s23 offen offset:1024 sc1
v_mfma_f32_16x16x32_bf16 v[132:135], a[76:79], a[168:171], v[132:135]
s_add_u32 s23, s23, 4096
ds_read_b64_tr_b16 a[72:73], v229 offset:7232
v_mfma_f32_16x16x32_bf16 v[132:135], a[20:23], a[152:155], v[132:135]
s_cmp_eq_u32 s23, s40
ds_read_b64_tr_b16 a[74:75], v229 offset:10816
v_mfma_f32_16x16x32_bf16 v[76:79], a[20:23], a[148:151], v[76:79]
s_cselect_b32 s23, s31, s23
v_mfma_f32_16x16x32_bf16 v[76:79], a[76:79], a[164:167], v[76:79]
v_mfma_f32_16x16x32_bf16 v[20:23], a[76:79], a[160:163], v[20:23]
v_mfma_f32_16x16x32_bf16 v[20:23], a[20:23], a[144:147], v[20:23]
buffer_load_dword a248, v239, s[16:19], s36 offen
v_mfma_f32_16x16x32_bf16 v[24:27], a[24:27], a[144:147], v[24:27]
s_add_u32 s36, s36, 1792
ds_read_b64_tr_b16 a[20:21], v229 offset:14400
v_mfma_f32_16x16x32_bf16 v[24:27], a[80:83], a[160:163], v[24:27]
ds_read_b64_tr_b16 a[22:23], v229 offset:17984
v_mfma_f32_16x16x32_bf16 v[80:83], a[80:83], a[164:167], v[80:83]
ds_read_b64_tr_b16 a[76:77], v229 offset:21568
v_mfma_f32_16x16x32_bf16 v[80:83], a[24:27], a[148:151], v[80:83]
ds_read_b64_tr_b16 a[78:79], v229 offset:25152
v_mfma_f32_16x16x32_bf16 v[136:139], a[24:27], a[152:155], v[136:139]
v_mfma_f32_16x16x32_bf16 v[136:139], a[80:83], a[168:171], v[136:139]
buffer_load_dwordx4 v232, s[12:15], s41 offen offset:0 lds
v_mfma_f32_16x16x32_bf16 v[192:195], a[80:83], a[172:175], v[192:195]
v_mfma_f32_16x16x32_bf16 v[192:195], a[24:27], a[156:159], v[192:195]
ds_read_b64_tr_b16 a[24:25], v229 offset:96
v_mfma_f32_16x16x32_bf16 v[196:199], a[28:31], a[156:159], v[196:199]
ds_read_b64_tr_b16 a[26:27], v229 offset:3680
v_mfma_f32_16x16x32_bf16 v[196:199], a[84:87], a[172:175], v[196:199]
ds_read_b64_tr_b16 a[80:81], v229 offset:7264
v_mfma_f32_16x16x32_bf16 v[140:143], a[84:87], a[168:171], v[140:143]
ds_read_b64_tr_b16 a[82:83], v229 offset:10848
v_mfma_f32_16x16x32_bf16 v[140:143], a[28:31], a[152:155], v[140:143]
buffer_load_dwordx4 v233, s[12:15], s41 offen offset:1024 lds
v_mfma_f32_16x16x32_bf16 v[84:87], a[28:31], a[148:151], v[84:87]
v_mfma_f32_16x16x32_bf16 v[84:87], a[84:87], a[164:167], v[84:87]
v_mfma_f32_16x16x32_bf16 v[28:31], a[84:87], a[160:163], v[28:31]
v_mfma_f32_16x16x32_bf16 v[28:31], a[28:31], a[144:147], v[28:31]
ds_read_b64_tr_b16 a[28:29], v229 offset:14432
v_mfma_f32_16x16x32_bf16 v[32:35], a[32:35], a[144:147], v[32:35]
ds_read_b64_tr_b16 a[30:31], v229 offset:18016
v_mfma_f32_16x16x32_bf16 v[32:35], a[88:91], a[160:163], v[32:35]
buffer_load_dwordx4 v234, s[12:15], s41 offen offset:2048 lds
v_mfma_f32_16x16x32_bf16 v[88:91], a[88:91], a[164:167], v[88:91]
ds_read_b64_tr_b16 a[84:85], v229 offset:21600
v_mfma_f32_16x16x32_bf16 v[88:91], a[32:35], a[148:151], v[88:91]
ds_read_b64_tr_b16 a[86:87], v229 offset:25184
v_mfma_f32_16x16x32_bf16 v[144:147], a[32:35], a[152:155], v[144:147]
v_mfma_f32_16x16x32_bf16 v[144:147], a[88:91], a[168:171], v[144:147]
v_mfma_f32_16x16x32_bf16 v[200:203], a[88:91], a[172:175], v[200:203]
v_mfma_f32_16x16x32_bf16 v[200:203], a[32:35], a[156:159], v[200:203]
buffer_load_dwordx4 v235, s[12:15], s41 offen offset:3072 lds
v_mfma_f32_16x16x32_bf16 v[204:207], a[36:39], a[156:159], v[204:207]
s_add_u32 m0, s7, 4096
ds_read_b64_tr_b16 a[32:33], v229 offset:128
v_mfma_f32_16x16x32_bf16 v[204:207], a[92:95], a[172:175], v[204:207]
ds_read_b64_tr_b16 a[34:35], v229 offset:3712
v_mfma_f32_16x16x32_bf16 v[148:151], a[92:95], a[168:171], v[148:151]
ds_read_b64_tr_b16 a[88:89], v229 offset:7296
v_mfma_f32_16x16x32_bf16 v[148:151], a[36:39], a[152:155], v[148:151]
ds_read_b64_tr_b16 a[90:91], v229 offset:10880
v_mfma_f32_16x16x32_bf16 v[92:95], a[36:39], a[148:151], v[92:95]
v_mfma_f32_16x16x32_bf16 v[92:95], a[92:95], a[164:167], v[92:95]
buffer_load_dwordx4 v236, s[12:15], s41 offen offset:0 lds
v_mfma_f32_16x16x32_bf16 v[36:39], a[92:95], a[160:163], v[36:39]
v_mfma_f32_16x16x32_bf16 v[36:39], a[36:39], a[144:147], v[36:39]
ds_read_b64_tr_b16 a[36:37], v229 offset:14464
v_mfma_f32_16x16x32_bf16 v[40:43], a[40:43], a[144:147], v[40:43]
ds_read_b64_tr_b16 a[38:39], v229 offset:18048
v_mfma_f32_16x16x32_bf16 v[40:43], a[96:99], a[160:163], v[40:43]
ds_read_b64_tr_b16 a[92:93], v229 offset:21632
v_mfma_f32_16x16x32_bf16 v[96:99], a[96:99], a[164:167], v[96:99]
ds_read_b64_tr_b16 a[94:95], v229 offset:25216
v_mfma_f32_16x16x32_bf16 v[96:99], a[40:43], a[148:151], v[96:99]
buffer_load_dwordx4 v237, s[12:15], s41 offen offset:1024 lds
v_mfma_f32_16x16x32_bf16 v[152:155], a[40:43], a[152:155], v[152:155]
v_mfma_f32_16x16x32_bf16 v[152:155], a[96:99], a[168:171], v[152:155]
v_mfma_f32_16x16x32_bf16 v[208:211], a[96:99], a[172:175], v[208:211]
v_mfma_f32_16x16x32_bf16 v[208:211], a[40:43], a[156:159], v[208:211]
ds_read_b64_tr_b16 a[40:41], v229 offset:160
v_mfma_f32_16x16x32_bf16 v[212:215], a[44:47], a[156:159], v[212:215]
ds_read_b64_tr_b16 a[42:43], v229 offset:3744
v_mfma_f32_16x16x32_bf16 v[212:215], a[100:103], a[172:175], v[212:215]
buffer_load_dwordx4 v238, s[12:15], s41 offen offset:2048 lds
v_mfma_f32_16x16x32_bf16 v[156:159], a[100:103], a[168:171], v[156:159]
s_add_u32 s7, s7, s6
ds_read_b64_tr_b16 a[96:97], v229 offset:7328
v_mfma_f32_16x16x32_bf16 v[156:159], a[44:47], a[152:155], v[156:159]
s_cmp_eq_u32 s7, s3
ds_read_b64_tr_b16 a[98:99], v229 offset:10912
v_mfma_f32_16x16x32_bf16 v[100:103], a[44:47], a[148:151], v[100:103]
s_cselect_b32 s7, s24, s7
v_mfma_f32_16x16x32_bf16 v[100:103], a[100:103], a[164:167], v[100:103]
s_mov_b32 m0, s7
v_mfma_f32_16x16x32_bf16 v[44:47], a[100:103], a[160:163], v[44:47]
s_add_u32 s41, s41, 917504
v_mfma_f32_16x16x32_bf16 v[44:47], a[44:47], a[144:147], v[44:47]
s_waitcnt lgkmcnt(4)
s_cmp_eq_u32 s41, 7340032
ds_read_b64_tr_b16 a[44:45], v229 offset:14496
v_mfma_f32_16x16x32_bf16 v[48:51], a[48:51], a[144:147], v[48:51]
s_cselect_b32 s41, 458752, s41
ds_read_b64_tr_b16 a[46:47], v229 offset:18080
v_mfma_f32_16x16x32_bf16 v[48:51], a[104:107], a[160:163], v[48:51]
ds_read_b64_tr_b16 a[100:101], v229 offset:21664
v_mfma_f32_16x16x32_bf16 v[104:107], a[104:107], a[164:167], v[104:107]
ds_read_b64_tr_b16 a[102:103], v229 offset:25248
v_mfma_f32_16x16x32_bf16 v[104:107], a[48:51], a[148:151], v[104:107]
v_mfma_f32_16x16x32_bf16 v[160:163], a[48:51], a[152:155], v[160:163]
v_mfma_f32_16x16x32_bf16 v[160:163], a[104:107], a[168:171], v[160:163]
v_mfma_f32_16x16x32_bf16 v[216:219], a[104:107], a[172:175], v[216:219]
v_mfma_f32_16x16x32_bf16 v[216:219], a[48:51], a[156:159], v[216:219]
ds_read_b64_tr_b16 a[48:49], v229 offset:192
v_mfma_f32_16x16x32_bf16 v[220:223], a[52:55], a[156:159], v[220:223]
ds_read_b64_tr_b16 a[50:51], v229 offset:3776
v_mfma_f32_16x16x32_bf16 v[220:223], a[108:111], a[172:175], v[220:223]
ds_read_b64_tr_b16 a[104:105], v229 offset:7360
v_mfma_f32_16x16x32_bf16 v[164:167], a[108:111], a[168:171], v[164:167]
ds_read_b64_tr_b16 a[106:107], v229 offset:10944
v_mfma_f32_16x16x32_bf16 v[164:167], a[52:55], a[152:155], v[164:167]
v_mfma_f32_16x16x32_bf16 v[108:111], a[52:55], a[148:151], v[108:111]
v_mfma_f32_16x16x32_bf16 v[108:111], a[108:111], a[164:167], v[108:111]
v_mfma_f32_16x16x32_bf16 v[52:55], a[108:111], a[160:163], v[52:55]
v_mfma_f32_16x16x32_bf16 v[52:55], a[52:55], a[144:147], v[52:55]
s_waitcnt vmcnt(8)
buffer_load_dwordx4 a[144:147], v225, s[8:11], s23 offen offset:0 sc1
v_mfma_f32_16x16x32_bf16 v[0:3], a[0:3], a[112:115], v[0:3]
ds_read_b64_tr_b16 a[52:53], v229 offset:14528
v_mfma_f32_16x16x32_bf16 v[0:3], a[56:59], a[128:131], v[0:3]
ds_read_b64_tr_b16 a[54:55], v229 offset:18112
v_mfma_f32_16x16x32_bf16 v[56:59], a[56:59], a[132:135], v[56:59]
ds_read_b64_tr_b16 a[108:109], v229 offset:21696
v_mfma_f32_16x16x32_bf16 v[56:59], a[0:3], a[116:119], v[56:59]
ds_read_b64_tr_b16 a[110:111], v229 offset:25280
v_mfma_f32_16x16x32_bf16 v[112:115], a[0:3], a[120:123], v[112:115]
v_mfma_f32_16x16x32_bf16 v[112:115], a[56:59], a[136:139], v[112:115]
buffer_load_dwordx4 a[148:151], v226, s[8:11], s23 offen offset:0 sc1
v_mfma_f32_16x16x32_bf16 v[168:171], a[56:59], a[140:143], v[168:171]
v_add_u32 v229, s5, v229
v_mfma_f32_16x16x32_bf16 v[168:171], a[0:3], a[124:127], v[168:171]
s_barrier
s_add_u32 s4, s4, 1
ds_read_b64_tr_b16 a[0:1], v229 offset:0
v_mfma_f32_16x16x32_bf16 v[172:175], a[4:7], a[124:127], v[172:175]
s_cmp_eq_u32 s4, 4
ds_read_b64_tr_b16 a[2:3], v229 offset:3584
v_mfma_f32_16x16x32_bf16 v[172:175], a[60:63], a[140:143], v[172:175]
s_cselect_b32 s5, 0xfffeb000, s6
ds_read_b64_tr_b16 a[56:57], v229 offset:7168
v_mfma_f32_16x16x32_bf16 v[116:119], a[60:63], a[136:139], v[116:119]
s_cselect_b32 s4, 0, s4
ds_read_b64_tr_b16 a[58:59], v229 offset:10752
v_mfma_f32_16x16x32_bf16 v[116:119], a[4:7], a[120:123], v[116:119]
buffer_load_dwordx4 a[152:155], v227, s[8:11], s23 offen offset:0 sc1
v_mfma_f32_16x16x32_bf16 v[60:63], a[4:7], a[116:119], v[60:63]
v_mfma_f32_16x16x32_bf16 v[60:63], a[60:63], a[132:135], v[60:63]
v_mfma_f32_16x16x32_bf16 v[4:7], a[60:63], a[128:131], v[4:7]
v_mfma_f32_16x16x32_bf16 v[4:7], a[4:7], a[112:115], v[4:7]
ds_read_b64_tr_b16 a[4:5], v229 offset:14336
v_mfma_f32_16x16x32_bf16 v[8:11], a[8:11], a[112:115], v[8:11]
ds_read_b64_tr_b16 a[6:7], v229 offset:17920
v_mfma_f32_16x16x32_bf16 v[8:11], a[64:67], a[128:131], v[8:11]
buffer_load_dwordx4 a[156:159], v228, s[8:11], s23 offen offset:0 sc1
v_mfma_f32_16x16x32_bf16 v[64:67], a[64:67], a[132:135], v[64:67]
ds_read_b64_tr_b16 a[60:61], v229 offset:21504
v_mfma_f32_16x16x32_bf16 v[64:67], a[8:11], a[116:119], v[64:67]
ds_read_b64_tr_b16 a[62:63], v229 offset:25088
v_mfma_f32_16x16x32_bf16 v[120:123], a[8:11], a[120:123], v[120:123]
v_mfma_f32_16x16x32_bf16 v[120:123], a[64:67], a[136:139], v[120:123]
v_mfma_f32_16x16x32_bf16 v[176:179], a[64:67], a[140:143], v[176:179]
v_mfma_f32_16x16x32_bf16 v[176:179], a[8:11], a[124:127], v[176:179]
buffer_load_dwordx4 a[160:163], v225, s[8:11], s23 offen offset:1024 sc1
v_mfma_f32_16x16x32_bf16 v[180:183], a[12:15], a[124:127], v[180:183]
ds_read_b64_tr_b16 a[8:9], v229 offset:32
v_mfma_f32_16x16x32_bf16 v[180:183], a[68:71], a[140:143], v[180:183]
ds_read_b64_tr_b16 a[10:11], v229 offset:3616
v_mfma_f32_16x16x32_bf16 v[124:127], a[68:71], a[136:139], v[124:127]
ds_read_b64_tr_b16 a[64:65], v229 offset:7200
v_mfma_f32_16x16x32_bf16 v[124:127], a[12:15], a[120:123], v[124:127]
ds_read_b64_tr_b16 a[66:67], v229 offset:10784
v_mfma_f32_16x16x32_bf16 v[68:71], a[12:15], a[116:119], v[68:71]
v_mfma_f32_16x16x32_bf16 v[68:71], a[68:71], a[132:135], v[68:71]
buffer_load_dwordx4 a[164:167], v226, s[8:11], s23 offen offset:1024 sc1
v_mfma_f32_16x16x32_bf16 v[12:15], a[68:71], a[128:131], v[12:15]
v_mfma_f32_16x16x32_bf16 v[12:15], a[12:15], a[112:115], v[12:15]
ds_read_b64_tr_b16 a[12:13], v229 offset:14368
v_mfma_f32_16x16x32_bf16 v[16:19], a[16:19], a[112:115], v[16:19]
ds_read_b64_tr_b16 a[14:15], v229 offset:17952
v_mfma_f32_16x16x32_bf16 v[16:19], a[72:75], a[128:131], v[16:19]
ds_read_b64_tr_b16 a[68:69], v229 offset:21536
v_mfma_f32_16x16x32_bf16 v[72:75], a[72:75], a[132:135], v[72:75]
ds_read_b64_tr_b16 a[70:71], v229 offset:25120
v_mfma_f32_16x16x32_bf16 v[72:75], a[16:19], a[116:119], v[72:75]
buffer_load_dwordx4 a[168:171], v227, s[8:11], s23 offen offset:1024 sc1
v_mfma_f32_16x16x32_bf16 v[128:131], a[16:19], a[120:123], v[128:131]
v_mfma_f32_16x16x32_bf16 v[128:131], a[72:75], a[136:139], v[128:131]
v_mfma_f32_16x16x32_bf16 v[184:187], a[72:75], a[140:143], v[184:187]
v_mfma_f32_16x16x32_bf16 v[184:187], a[16:19], a[124:127], v[184:187]
ds_read_b64_tr_b16 a[16:17], v229 offset:64
v_mfma_f32_16x16x32_bf16 v[188:191], a[20:23], a[124:127], v[188:191]
ds_read_b64_tr_b16 a[18:19], v229 offset:3648
v_mfma_f32_16x16x32_bf16 v[188:191], a[76:79], a[140:143], v[188:191]
buffer_load_dwordx4 a[172:175], v228, s[8:11], s23 offen offset:1024 sc1
v_mfma_f32_16x16x32_bf16 v[132:135], a[76:79], a[136:139], v[132:135]
s_add_u32 s23, s23, 4096
ds_read_b64_tr_b16 a[72:73], v229 offset:7232
v_mfma_f32_16x16x32_bf16 v[132:135], a[20:23], a[120:123], v[132:135]
s_cmp_eq_u32 s23, s40
ds_read_b64_tr_b16 a[74:75], v229 offset:10816
v_mfma_f32_16x16x32_bf16 v[76:79], a[20:23], a[116:119], v[76:79]
s_cselect_b32 s23, s31, s23
v_mfma_f32_16x16x32_bf16 v[76:79], a[76:79], a[132:135], v[76:79]
v_mfma_f32_16x16x32_bf16 v[20:23], a[76:79], a[128:131], v[20:23]
v_mfma_f32_16x16x32_bf16 v[20:23], a[20:23], a[112:115], v[20:23]
buffer_load_dwordx4 v232, s[12:15], s41 offen offset:0 lds
v_mfma_f32_16x16x32_bf16 v[24:27], a[24:27], a[112:115], v[24:27]
ds_read_b64_tr_b16 a[20:21], v229 offset:14400
v_mfma_f32_16x16x32_bf16 v[24:27], a[80:83], a[128:131], v[24:27]
ds_read_b64_tr_b16 a[22:23], v229 offset:17984
v_mfma_f32_16x16x32_bf16 v[80:83], a[80:83], a[132:135], v[80:83]
ds_read_b64_tr_b16 a[76:77], v229 offset:21568
v_mfma_f32_16x16x32_bf16 v[80:83], a[24:27], a[116:119], v[80:83]
ds_read_b64_tr_b16 a[78:79], v229 offset:25152
v_mfma_f32_16x16x32_bf16 v[136:139], a[24:27], a[120:123], v[136:139]
v_mfma_f32_16x16x32_bf16 v[136:139], a[80:83], a[136:139], v[136:139]
buffer_load_dwordx4 v233, s[12:15], s41 offen offset:1024 lds
v_mfma_f32_16x16x32_bf16 v[192:195], a[80:83], a[140:143], v[192:195]
v_mfma_f32_16x16x32_bf16 v[192:195], a[24:27], a[124:127], v[192:195]
ds_read_b64_tr_b16 a[24:25], v229 offset:96
v_mfma_f32_16x16x32_bf16 v[196:199], a[28:31], a[124:127], v[196:199]
ds_read_b64_tr_b16 a[26:27], v229 offset:3680
v_mfma_f32_16x16x32_bf16 v[196:199], a[84:87], a[140:143], v[196:199]
ds_read_b64_tr_b16 a[80:81], v229 offset:7264
v_mfma_f32_16x16x32_bf16 v[140:143], a[84:87], a[136:139], v[140:143]
ds_read_b64_tr_b16 a[82:83], v229 offset:10848
v_mfma_f32_16x16x32_bf16 v[140:143], a[28:31], a[120:123], v[140:143]
buffer_load_dwordx4 v234, s[12:15], s41 offen offset:2048 lds
v_mfma_f32_16x16x32_bf16 v[84:87], a[28:31], a[116:119], v[84:87]
v_mfma_f32_16x16x32_bf16 v[84:87], a[84:87], a[132:135], v[84:87]
v_mfma_f32_16x16x32_bf16 v[28:31], a[84:87], a[128:131], v[28:31]
v_mfma_f32_16x16x32_bf16 v[28:31], a[28:31], a[112:115], v[28:31]
ds_read_b64_tr_b16 a[28:29], v229 offset:14432
v_mfma_f32_16x16x32_bf16 v[32:35], a[32:35], a[112:115], v[32:35]
ds_read_b64_tr_b16 a[30:31], v229 offset:18016
v_mfma_f32_16x16x32_bf16 v[32:35], a[88:91], a[128:131], v[32:35]
buffer_load_dwordx4 v235, s[12:15], s41 offen offset:3072 lds
v_mfma_f32_16x16x32_bf16 v[88:91], a[88:91], a[132:135], v[88:91]
s_add_u32 m0, s7, 4096
ds_read_b64_tr_b16 a[84:85], v229 offset:21600
v_mfma_f32_16x16x32_bf16 v[88:91], a[32:35], a[116:119], v[88:91]
ds_read_b64_tr_b16 a[86:87], v229 offset:25184
v_mfma_f32_16x16x32_bf16 v[144:147], a[32:35], a[120:123], v[144:147]
v_mfma_f32_16x16x32_bf16 v[144:147], a[88:91], a[136:139], v[144:147]
v_mfma_f32_16x16x32_bf16 v[200:203], a[88:91], a[140:143], v[200:203]
v_mfma_f32_16x16x32_bf16 v[200:203], a[32:35], a[124:127], v[200:203]
buffer_load_dwordx4 v236, s[12:15], s41 offen offset:0 lds
v_mfma_f32_16x16x32_bf16 v[204:207], a[36:39], a[124:127], v[204:207]
ds_read_b64_tr_b16 a[32:33], v229 offset:128
v_mfma_f32_16x16x32_bf16 v[204:207], a[92:95], a[140:143], v[204:207]
ds_read_b64_tr_b16 a[34:35], v229 offset:3712
v_mfma_f32_16x16x32_bf16 v[148:151], a[92:95], a[136:139], v[148:151]
ds_read_b64_tr_b16 a[88:89], v229 offset:7296
v_mfma_f32_16x16x32_bf16 v[148:151], a[36:39], a[120:123], v[148:151]
ds_read_b64_tr_b16 a[90:91], v229 offset:10880
v_mfma_f32_16x16x32_bf16 v[92:95], a[36:39], a[116:119], v[92:95]
v_mfma_f32_16x16x32_bf16 v[92:95], a[92:95], a[132:135], v[92:95]
buffer_load_dwordx4 v237, s[12:15], s41 offen offset:1024 lds
v_mfma_f32_16x16x32_bf16 v[36:39], a[92:95], a[128:131], v[36:39]
v_mfma_f32_16x16x32_bf16 v[36:39], a[36:39], a[112:115], v[36:39]
s_waitcnt lgkmcnt(4)
ds_read_b64_tr_b16 a[36:37], v229 offset:14464
v_mfma_f32_16x16x32_bf16 v[40:43], a[40:43], a[112:115], v[40:43]
ds_read_b64_tr_b16 a[38:39], v229 offset:18048
v_mfma_f32_16x16x32_bf16 v[40:43], a[96:99], a[128:131], v[40:43]
ds_read_b64_tr_b16 a[92:93], v229 offset:21632
v_mfma_f32_16x16x32_bf16 v[96:99], a[96:99], a[132:135], v[96:99]
ds_read_b64_tr_b16 a[94:95], v229 offset:25216
v_mfma_f32_16x16x32_bf16 v[96:99], a[40:43], a[116:119], v[96:99]
buffer_load_dwordx4 v238, s[12:15], s41 offen offset:2048 lds
v_mfma_f32_16x16x32_bf16 v[152:155], a[40:43], a[120:123], v[152:155]
s_add_u32 s7, s7, s6
v_mfma_f32_16x16x32_bf16 v[152:155], a[96:99], a[136:139], v[152:155]
s_cmp_eq_u32 s7, s3
v_mfma_f32_16x16x32_bf16 v[208:211], a[96:99], a[140:143], v[208:211]
s_cselect_b32 s7, s24, s7
v_mfma_f32_16x16x32_bf16 v[208:211], a[40:43], a[124:127], v[208:211]
s_mov_b32 m0, s7
ds_read_b64_tr_b16 a[40:41], v229 offset:160
v_mfma_f32_16x16x32_bf16 v[212:215], a[44:47], a[124:127], v[212:215]
s_add_u32 s41, s41, 917504
ds_read_b64_tr_b16 a[42:43], v229 offset:3744
v_mfma_f32_16x16x32_bf16 v[212:215], a[100:103], a[140:143], v[212:215]
s_cmp_eq_u32 s41, 7340032
ds_read_b64_tr_b16 a[96:97], v229 offset:7328
v_mfma_f32_16x16x32_bf16 v[156:159], a[100:103], a[136:139], v[156:159]
s_cselect_b32 s41, 458752, s41
ds_read_b64_tr_b16 a[98:99], v229 offset:10912
v_mfma_f32_16x16x32_bf16 v[156:159], a[44:47], a[120:123], v[156:159]
v_mfma_f32_16x16x32_bf16 v[100:103], a[44:47], a[116:119], v[100:103]
v_mfma_f32_16x16x32_bf16 v[100:103], a[100:103], a[132:135], v[100:103]
v_mfma_f32_16x16x32_bf16 v[44:47], a[100:103], a[128:131], v[44:47]
v_mfma_f32_16x16x32_bf16 v[44:47], a[44:47], a[112:115], v[44:47]
ds_read_b64_tr_b16 a[44:45], v229 offset:14496
v_mfma_f32_16x16x32_bf16 v[48:51], a[48:51], a[112:115], v[48:51]
ds_read_b64_tr_b16 a[46:47], v229 offset:18080
v_mfma_f32_16x16x32_bf16 v[48:51], a[104:107], a[128:131], v[48:51]
ds_read_b64_tr_b16 a[100:101], v229 offset:21664
v_mfma_f32_16x16x32_bf16 v[104:107], a[104:107], a[132:135], v[104:107]
ds_read_b64_tr_b16 a[102:103], v229 offset:25248
v_mfma_f32_16x16x32_bf16 v[104:107], a[48:51], a[116:119], v[104:107]
v_mfma_f32_16x16x32_bf16 v[160:163], a[48:51], a[120:123], v[160:163]
v_mfma_f32_16x16x32_bf16 v[160:163], a[104:107], a[136:139], v[160:163]
v_mfma_f32_16x16x32_bf16 v[216:219], a[104:107], a[140:143], v[216:219]
v_mfma_f32_16x16x32_bf16 v[216:219], a[48:51], a[124:127], v[216:219]
ds_read_b64_tr_b16 a[48:49], v229 offset:192
v_mfma_f32_16x16x32_bf16 v[220:223], a[52:55], a[124:127], v[220:223]
ds_read_b64_tr_b16 a[50:51], v229 offset:3776
v_mfma_f32_16x16x32_bf16 v[220:223], a[108:111], a[140:143], v[220:223]
ds_read_b64_tr_b16 a[104:105], v229 offset:7360
v_mfma_f32_16x16x32_bf16 v[164:167], a[108:111], a[136:139], v[164:167]
ds_read_b64_tr_b16 a[106:107], v229 offset:10944
v_mfma_f32_16x16x32_bf16 v[164:167], a[52:55], a[120:123], v[164:167]
v_mfma_f32_16x16x32_bf16 v[108:111], a[52:55], a[116:119], v[108:111]
v_mfma_f32_16x16x32_bf16 v[108:111], a[108:111], a[132:135], v[108:111]
v_mfma_f32_16x16x32_bf16 v[52:55], a[108:111], a[128:131], v[52:55]
v_mfma_f32_16x16x32_bf16 v[52:55], a[52:55], a[112:115], v[52:55]
buffer_load_dwordx4 a[112:115], v225, s[8:11], s23 offen offset:0 sc1
s_sub_u32 s101, s101, 1
s_cmp_lg_u32 s101, 0
s_cbranch_scc1 L_k3_loop
s_waitcnt lgkmcnt(4)
s_waitcnt vmcnt(8)
v_mfma_f32_16x16x32_bf16 v[0:3], a[0:3], a[144:147], v[0:3]
ds_read_b64_tr_b16 a[52:53], v229 offset:14528
v_mfma_f32_16x16x32_bf16 v[0:3], a[56:59], a[160:163], v[0:3]
ds_read_b64_tr_b16 a[54:55], v229 offset:18112
v_accvgpr_read_b32 v255, a191
v_mfma_f32_16x16x32_bf16 v[56:59], a[56:59], a[164:167], v[56:59]
ds_read_b64_tr_b16 a[108:109], v229 offset:21696
v_accvgpr_read_b32 v254, a190
v_mfma_f32_16x16x32_bf16 v[56:59], a[0:3], a[148:151], v[56:59]
ds_read_b64_tr_b16 a[110:111], v229 offset:25280
v_accvgpr_read_b32 v253, a189
v_mfma_f32_16x16x32_bf16 v[112:115], a[0:3], a[152:155], v[112:115]
v_accvgpr_read_b32 v252, a188
v_accvgpr_read_b32 v251, a187
v_mfma_f32_16x16x32_bf16 v[112:115], a[56:59], a[168:171], v[112:115]
buffer_load_dwordx4 a[116:119], v226, s[8:11], s23 offen offset:0 sc1
v_accvgpr_read_b32 v250, a186
v_mfma_f32_16x16x32_bf16 v[168:171], a[56:59], a[172:175], v[168:171]
v_add_u32 v229, s5, v229
v_accvgpr_read_b32 v249, a185
v_mfma_f32_16x16x32_bf16 v[168:171], a[0:3], a[156:159], v[168:171]
s_barrier
s_add_u32 s4, s4, 1
ds_read_b64_tr_b16 a[0:1], v229 offset:0
v_mfma_f32_16x16x32_bf16 v[172:175], a[4:7], a[156:159], v[172:175]
s_cmp_eq_u32 s4, 4
ds_read_b64_tr_b16 a[2:3], v229 offset:3584
v_accvgpr_read_b32 v248, a184
v_mfma_f32_16x16x32_bf16 v[172:175], a[60:63], a[172:175], v[172:175]
s_cselect_b32 s5, 0xfffeb000, s6
s_cselect_b32 s4, 0, s4
buffer_load_dwordx4 a[120:123], v227, s[8:11], s23 offen offset:0 sc1
v_mfma_f32_16x16x32_bf16 v[116:119], a[60:63], a[168:171], v[116:119]
ds_read_b64_tr_b16 a[56:57], v229 offset:7168
v_add_f32 v244, v248, v250
v_mfma_f32_16x16x32_bf16 v[116:119], a[4:7], a[152:155], v[116:119]
ds_read_b64_tr_b16 a[58:59], v229 offset:10752
v_add_f32 v246, v252, v254
v_mfma_f32_16x16x32_bf16 v[60:63], a[4:7], a[148:151], v[60:63]
v_add_f32 v244, v244, v246
v_mov_b32 v246, v244
v_mfma_f32_16x16x32_bf16 v[60:63], a[60:63], a[164:167], v[60:63]
buffer_load_dwordx4 a[124:127], v228, s[8:11], s23 offen offset:0 sc1
v_permlane16_swap_b32 v244, v246
v_mfma_f32_16x16x32_bf16 v[4:7], a[60:63], a[160:163], v[4:7]
v_add_f32 v244, v244, v246
v_mov_b32 v246, v244
v_mfma_f32_16x16x32_bf16 v[4:7], a[4:7], a[144:147], v[4:7]
ds_read_b64_tr_b16 a[4:5], v229 offset:14336
v_permlane32_swap_b32 v244, v246
v_mfma_f32_16x16x32_bf16 v[8:11], a[8:11], a[144:147], v[8:11]
ds_read_b64_tr_b16 a[6:7], v229 offset:17920
v_add_f32 v244, v244, v246
v_mfma_f32_16x16x32_bf16 v[8:11], a[64:67], a[160:163], v[8:11]
buffer_load_dwordx4 a[128:131], v225, s[8:11], s23 offen offset:1024 sc1
v_mul_f32 v244, 0x3a800000, v244
v_mfma_f32_16x16x32_bf16 v[64:67], a[64:67], a[164:167], v[64:67]
ds_read_b64_tr_b16 a[60:61], v229 offset:21504
v_add_f32 v245, v249, v251
v_mfma_f32_16x16x32_bf16 v[64:67], a[8:11], a[148:151], v[64:67]
ds_read_b64_tr_b16 a[62:63], v229 offset:25088
v_add_f32 v246, v253, v255
v_mfma_f32_16x16x32_bf16 v[120:123], a[8:11], a[152:155], v[120:123]
v_add_f32 v245, v245, v246
v_mul_f32 v246, 0x3c800000, v248
v_mfma_f32_16x16x32_bf16 v[120:123], a[64:67], a[168:171], v[120:123]
buffer_load_dwordx4 a[132:135], v226, s[8:11], s23 offen offset:1024 sc1
v_sub_f32 v246, v246, v244
v_mfma_f32_16x16x32_bf16 v[176:179], a[64:67], a[172:175], v[176:179]
v_mul_f32 v247, v246, v246
v_mul_f32 v246, 0x3c800000, v250
v_mfma_f32_16x16x32_bf16 v[176:179], a[8:11], a[156:159], v[176:179]
ds_read_b64_tr_b16 a[8:9], v229 offset:32
v_sub_f32 v246, v246, v244
v_mfma_f32_16x16x32_bf16 v[180:183], a[12:15], a[156:159], v[180:183]
ds_read_b64_tr_b16 a[10:11], v229 offset:3616
v_fmac_f32 v247, v246, v246
v_mfma_f32_16x16x32_bf16 v[180:183], a[68:71], a[172:175], v[180:183]
buffer_load_dwordx4 a[136:139], v227, s[8:11], s23 offen offset:1024 sc1
v_mul_f32 v246, 0x3c800000, v252
v_mfma_f32_16x16x32_bf16 v[124:127], a[68:71], a[168:171], v[124:127]
ds_read_b64_tr_b16 a[64:65], v229 offset:7200
v_sub_f32 v246, v246, v244
v_mfma_f32_16x16x32_bf16 v[124:127], a[12:15], a[152:155], v[124:127]
ds_read_b64_tr_b16 a[66:67], v229 offset:10784
v_fmac_f32 v247, v246, v246
v_mfma_f32_16x16x32_bf16 v[68:71], a[12:15], a[148:151], v[68:71]
v_mul_f32 v246, 0x3c800000, v254
v_sub_f32 v246, v246, v244
v_mfma_f32_16x16x32_bf16 v[68:71], a[68:71], a[164:167], v[68:71]
buffer_load_dwordx4 a[140:143], v228, s[8:11], s23 offen offset:1024 sc1
v_fmac_f32 v247, v246, v246
v_mfma_f32_16x16x32_bf16 v[12:15], a[68:71], a[160:163], v[12:15]
s_add_u32 s23, s23, 4096
v_fmamk_f32 v245, v247, 0x42800000, v245
v_mov_b32 v246, v245
v_mfma_f32_16x16x32_bf16 v[12:15], a[12:15], a[144:147], v[12:15]
s_cmp_eq_u32 s23, s40
ds_read_b64_tr_b16 a[12:13], v229 offset:14368
v_permlane16_swap_b32 v245, v246
v_mfma_f32_16x16x32_bf16 v[16:19], a[16:19], a[144:147], v[16:19]
s_cselect_b32 s23, s31, s23
ds_read_b64_tr_b16 a[14:15], v229 offset:17952
v_add_f32 v245, v245, v246
v_mfma_f32_16x16x32_bf16 v[16:19], a[72:75], a[160:163], v[16:19]
buffer_load_dwordx4 v232, s[12:15], s41 offen offset:0 lds
v_mov_b32 v246, v245
v_mfma_f32_16x16x32_bf16 v[72:75], a[72:75], a[164:167], v[72:75]
ds_read_b64_tr_b16 a[68:69], v229 offset:21536
v_permlane32_swap_b32 v245, v246
v_mfma_f32_16x16x32_bf16 v[72:75], a[16:19], a[148:151], v[72:75]
ds_read_b64_tr_b16 a[70:71], v229 offset:25120
v_add_f32 v245, v245, v246
v_mfma_f32_16x16x32_bf16 v[128:131], a[16:19], a[152:155], v[128:131]
v_mov_b32 v246, 0x3727c5ac
v_fmamk_f32 v245, v245, 0x3a800000, v246
v_mfma_f32_16x16x32_bf16 v[128:131], a[72:75], a[168:171], v[128:131]
buffer_load_dwordx4 v233, s[12:15], s41 offen offset:1024 lds
v_rsq_f32 v245, v245
v_mfma_f32_16x16x32_bf16 v[184:187], a[72:75], a[172:175], v[184:187]
v_sub_f32 v244, 0, v244
v_mul_f32 v245, v245, v245
v_mfma_f32_16x16x32_bf16 v[184:187], a[16:19], a[156:159], v[184:187]
ds_read_b64_tr_b16 a[16:17], v229 offset:64
v_accvgpr_write_b32 a176, v244
v_mfma_f32_16x16x32_bf16 v[188:191], a[20:23], a[156:159], v[188:191]
ds_read_b64_tr_b16 a[18:19], v229 offset:3648
v_accvgpr_write_b32 a177, v245
v_mfma_f32_16x16x32_bf16 v[188:191], a[76:79], a[172:175], v[188:191]
buffer_load_dwordx4 v234, s[12:15], s41 offen offset:2048 lds
v_accvgpr_read_b32 v255, a199
v_mfma_f32_16x16x32_bf16 v[132:135], a[76:79], a[168:171], v[132:135]
ds_read_b64_tr_b16 a[72:73], v229 offset:7232
v_accvgpr_read_b32 v254, a198
v_mfma_f32_16x16x32_bf16 v[132:135], a[20:23], a[152:155], v[132:135]
ds_read_b64_tr_b16 a[74:75], v229 offset:10816
v_accvgpr_read_b32 v253, a197
v_mfma_f32_16x16x32_bf16 v[76:79], a[20:23], a[148:151], v[76:79]
v_accvgpr_read_b32 v252, a196
v_accvgpr_read_b32 v251, a195
v_mfma_f32_16x16x32_bf16 v[76:79], a[76:79], a[164:167], v[76:79]
buffer_load_dwordx4 v235, s[12:15], s41 offen offset:3072 lds
v_accvgpr_read_b32 v250, a194
v_mfma_f32_16x16x32_bf16 v[20:23], a[76:79], a[160:163], v[20:23]
s_add_u32 m0, s7, 4096
v_accvgpr_read_b32 v249, a193
v_accvgpr_read_b32 v248, a192
v_mfma_f32_16x16x32_bf16 v[20:23], a[20:23], a[144:147], v[20:23]
ds_read_b64_tr_b16 a[20:21], v229 offset:14400
v_add_f32 v244, v248, v250
v_mfma_f32_16x16x32_bf16 v[24:27], a[24:27], a[144:147], v[24:27]
ds_read_b64_tr_b16 a[22:23], v229 offset:17984
v_add_f32 v246, v252, v254
v_mfma_f32_16x16x32_bf16 v[24:27], a[80:83], a[160:163], v[24:27]
buffer_load_dwordx4 v236, s[12:15], s41 offen offset:0 lds
v_add_f32 v244, v244, v246
v_mfma_f32_16x16x32_bf16 v[80:83], a[80:83], a[164:167], v[80:83]
ds_read_b64_tr_b16 a[76:77], v229 offset:21568
v_mov_b32 v246, v244
v_mfma_f32_16x16x32_bf16 v[80:83], a[24:27], a[148:151], v[80:83]
ds_read_b64_tr_b16 a[78:79], v229 offset:25152
v_permlane16_swap_b32 v244, v246
v_mfma_f32_16x16x32_bf16 v[136:139], a[24:27], a[152:155], v[136:139]
v_add_f32 v244, v244, v246
v_mov_b32 v246, v244
v_mfma_f32_16x16x32_bf16 v[136:139], a[80:83], a[168:171], v[136:139]
buffer_load_dwordx4 v237, s[12:15], s41 offen offset:1024 lds
v_permlane32_swap_b32 v244, v246
v_mfma_f32_16x16x32_bf16 v[192:195], a[80:83], a[172:175], v[192:195]
v_add_f32 v244, v244, v246
v_mul_f32 v244, 0x3a800000, v244
v_mfma_f32_16x16x32_bf16 v[192:195], a[24:27], a[156:159], v[192:195]
ds_read_b64_tr_b16 a[24:25], v229 offset:96
v_add_f32 v245, v249, v251
v_mfma_f32_16x16x32_bf16 v[196:199], a[28:31], a[156:159], v[196:199]
ds_read_b64_tr_b16 a[26:27], v229 offset:3680
v_add_f32 v246, v253, v255
v_mfma_f32_16x16x32_bf16 v[196:199], a[84:87], a[172:175], v[196:199]
buffer_load_dwordx4 v238, s[12:15], s41 offen offset:2048 lds
v_add_f32 v245, v245, v246
v_mfma_f32_16x16x32_bf16 v[140:143], a[84:87], a[168:171], v[140:143]
s_add_u32 s7, s7, s6
ds_read_b64_tr_b16 a[80:81], v229 offset:7264
v_mul_f32 v246, 0x3c800000, v248
v_mfma_f32_16x16x32_bf16 v[140:143], a[28:31], a[152:155], v[140:143]
s_cmp_eq_u32 s7, s3
ds_read_b64_tr_b16 a[82:83], v229 offset:10848
v_sub_f32 v246, v246, v244
v_mfma_f32_16x16x32_bf16 v[84:87], a[28:31], a[148:151], v[84:87]
s_cselect_b32 s7, s24, s7
v_mul_f32 v247, v246, v246
v_mul_f32 v246, 0x3c800000, v250
v_sub_f32 v246, v246, v244
v_mfma_f32_16x16x32_bf16 v[84:87], a[84:87], a[164:167], v[84:87]
s_mov_b32 m0, s7
v_fmac_f32 v247, v246, v246
v_mul_f32 v246, 0x3c800000, v252
v_mfma_f32_16x16x32_bf16 v[28:31], a[84:87], a[160:163], v[28:31]
s_add_u32 s41, s41, 917504
v_sub_f32 v246, v246, v244
v_fmac_f32 v247, v246, v246
v_mfma_f32_16x16x32_bf16 v[28:31], a[28:31], a[144:147], v[28:31]
s_cmp_eq_u32 s41, 7340032
ds_read_b64_tr_b16 a[28:29], v229 offset:14432
v_mul_f32 v246, 0x3c800000, v254
v_mfma_f32_16x16x32_bf16 v[32:35], a[32:35], a[144:147], v[32:35]
s_cselect_b32 s41, 458752, s41
ds_read_b64_tr_b16 a[30:31], v229 offset:18016
v_sub_f32 v246, v246, v244
v_mfma_f32_16x16x32_bf16 v[32:35], a[88:91], a[160:163], v[32:35]
ds_read_b64_tr_b16 a[84:85], v229 offset:21600
v_fmac_f32 v247, v246, v246
v_mfma_f32_16x16x32_bf16 v[88:91], a[88:91], a[164:167], v[88:91]
ds_read_b64_tr_b16 a[86:87], v229 offset:25184
v_fmamk_f32 v245, v247, 0x42800000, v245
v_mfma_f32_16x16x32_bf16 v[88:91], a[32:35], a[148:151], v[88:91]
v_mov_b32 v246, v245
s_nop 1
v_permlane16_swap_b32 v245, v246
v_mfma_f32_16x16x32_bf16 v[144:147], a[32:35], a[152:155], v[144:147]
v_add_f32 v245, v245, v246
v_mov_b32 v246, v245
v_mfma_f32_16x16x32_bf16 v[144:147], a[88:91], a[168:171], v[144:147]
s_nop 0
v_permlane32_swap_b32 v245, v246
v_add_f32 v245, v245, v246
v_mfma_f32_16x16x32_bf16 v[200:203], a[88:91], a[172:175], v[200:203]
v_mov_b32 v246, 0x3727c5ac
v_fmamk_f32 v245, v245, 0x3a800000, v246
v_mfma_f32_16x16x32_bf16 v[200:203], a[32:35], a[156:159], v[200:203]
v_rsq_f32 v245, v245
v_sub_f32 v244, 0, v244
v_mfma_f32_16x16x32_bf16 v[204:207], a[36:39], a[156:159], v[204:207]
v_mul_f32 v245, v245, v245
v_accvgpr_write_b32 a178, v244
v_mfma_f32_16x16x32_bf16 v[204:207], a[92:95], a[172:175], v[204:207]
v_accvgpr_write_b32 a179, v245
v_accvgpr_read_b32 v255, a207
v_mfma_f32_16x16x32_bf16 v[148:151], a[92:95], a[168:171], v[148:151]
v_accvgpr_read_b32 v254, a206
v_accvgpr_read_b32 v253, a205
v_mfma_f32_16x16x32_bf16 v[148:151], a[36:39], a[152:155], v[148:151]
v_accvgpr_read_b32 v252, a204
v_accvgpr_read_b32 v251, a203
v_mfma_f32_16x16x32_bf16 v[92:95], a[36:39], a[148:151], v[92:95]
v_accvgpr_read_b32 v250, a202
v_accvgpr_read_b32 v249, a201
v_mfma_f32_16x16x32_bf16 v[92:95], a[92:95], a[164:167], v[92:95]
v_accvgpr_read_b32 v248, a200
v_add_f32 v244, v248, v250
v_mfma_f32_16x16x32_bf16 v[36:39], a[92:95], a[160:163], v[36:39]
v_add_f32 v246, v252, v254
v_add_f32 v244, v244, v246
v_mfma_f32_16x16x32_bf16 v[36:39], a[36:39], a[144:147], v[36:39]
v_mov_b32 v246, v244
s_nop 1
v_permlane16_swap_b32 v244, v246
v_mfma_f32_16x16x32_bf16 v[40:43], a[40:43], a[144:147], v[40:43]
v_add_f32 v244, v244, v246
v_mov_b32 v246, v244
v_mfma_f32_16x16x32_bf16 v[40:43], a[96:99], a[160:163], v[40:43]
s_nop 0
v_permlane32_swap_b32 v244, v246
v_add_f32 v244, v244, v246
v_mfma_f32_16x16x32_bf16 v[96:99], a[96:99], a[164:167], v[96:99]
v_mul_f32 v244, 0x3a800000, v244
v_add_f32 v245, v249, v251
v_mfma_f32_16x16x32_bf16 v[96:99], a[40:43], a[148:151], v[96:99]
v_add_f32 v246, v253, v255
v_add_f32 v245, v245, v246
v_mfma_f32_16x16x32_bf16 v[152:155], a[40:43], a[152:155], v[152:155]
v_mul_f32 v246, 0x3c800000, v248
v_sub_f32 v246, v246, v244
v_mfma_f32_16x16x32_bf16 v[152:155], a[96:99], a[168:171], v[152:155]
v_mul_f32 v247, v246, v246
v_mul_f32 v246, 0x3c800000, v250
v_mfma_f32_16x16x32_bf16 v[208:211], a[96:99], a[172:175], v[208:211]
v_sub_f32 v246, v246, v244
v_fmac_f32 v247, v246, v246
v_mfma_f32_16x16x32_bf16 v[208:211], a[40:43], a[156:159], v[208:211]
v_mul_f32 v246, 0x3c800000, v252
v_sub_f32 v246, v246, v244
v_mfma_f32_16x16x32_bf16 v[212:215], a[44:47], a[156:159], v[212:215]
v_fmac_f32 v247, v246, v246
v_mul_f32 v246, 0x3c800000, v254
v_mfma_f32_16x16x32_bf16 v[212:215], a[100:103], a[172:175], v[212:215]
v_sub_f32 v246, v246, v244
v_fmac_f32 v247, v246, v246
v_mfma_f32_16x16x32_bf16 v[156:159], a[100:103], a[168:171], v[156:159]
v_fmamk_f32 v245, v247, 0x42800000, v245
v_mov_b32 v246, v245
v_mfma_f32_16x16x32_bf16 v[156:159], a[44:47], a[152:155], v[156:159]
s_nop 0
v_permlane16_swap_b32 v245, v246
v_mfma_f32_16x16x32_bf16 v[100:103], a[44:47], a[148:151], v[100:103]
v_add_f32 v245, v245, v246
v_mov_b32 v246, v245
v_mfma_f32_16x16x32_bf16 v[100:103], a[100:103], a[164:167], v[100:103]
s_nop 0
v_permlane32_swap_b32 v245, v246
v_mfma_f32_16x16x32_bf16 v[44:47], a[100:103], a[160:163], v[44:47]
v_add_f32 v245, v245, v246
v_mov_b32 v246, 0x3727c5ac
v_mfma_f32_16x16x32_bf16 v[44:47], a[44:47], a[144:147], v[44:47]
s_waitcnt lgkmcnt(0)
v_fmamk_f32 v245, v245, 0x3a800000, v246
v_mfma_f32_16x16x32_bf16 v[48:51], a[48:51], a[144:147], v[48:51]
v_rsq_f32 v245, v245
v_sub_f32 v244, 0, v244
v_mfma_f32_16x16x32_bf16 v[48:51], a[104:107], a[160:163], v[48:51]
v_mul_f32 v245, v245, v245
v_mfma_f32_16x16x32_bf16 v[104:107], a[104:107], a[164:167], v[104:107]
v_accvgpr_write_b32 a180, v244
v_mfma_f32_16x16x32_bf16 v[104:107], a[48:51], a[148:151], v[104:107]
v_accvgpr_write_b32 a181, v245
v_accvgpr_read_b32 v255, a215
v_mfma_f32_16x16x32_bf16 v[160:163], a[48:51], a[152:155], v[160:163]
v_accvgpr_read_b32 v254, a214
v_mfma_f32_16x16x32_bf16 v[160:163], a[104:107], a[168:171], v[160:163]
v_accvgpr_read_b32 v253, a213
v_accvgpr_read_b32 v252, a212
v_mfma_f32_16x16x32_bf16 v[216:219], a[104:107], a[172:175], v[216:219]
v_accvgpr_read_b32 v251, a211
v_mfma_f32_16x16x32_bf16 v[216:219], a[48:51], a[156:159], v[216:219]
v_accvgpr_read_b32 v250, a210
v_accvgpr_read_b32 v249, a209
v_mfma_f32_16x16x32_bf16 v[220:223], a[52:55], a[156:159], v[220:223]
v_accvgpr_read_b32 v248, a208
v_mfma_f32_16x16x32_bf16 v[220:223], a[108:111], a[172:175], v[220:223]
v_add_f32 v244, v248, v250
v_mfma_f32_16x16x32_bf16 v[164:167], a[108:111], a[168:171], v[164:167]
v_add_f32 v246, v252, v254
v_add_f32 v244, v244, v246
v_mfma_f32_16x16x32_bf16 v[164:167], a[52:55], a[152:155], v[164:167]
v_mov_b32 v246, v244
v_mfma_f32_16x16x32_bf16 v[108:111], a[52:55], a[148:151], v[108:111]
s_nop 0
v_permlane16_swap_b32 v244, v246
v_add_f32 v244, v244, v246
v_mfma_f32_16x16x32_bf16 v[108:111], a[108:111], a[164:167], v[108:111]
v_mov_b32 v246, v244
v_mfma_f32_16x16x32_bf16 v[52:55], a[108:111], a[160:163], v[52:55]
s_nop 0
v_permlane32_swap_b32 v244, v246
v_add_f32 v244, v244, v246
v_mfma_f32_16x16x32_bf16 v[52:55], a[52:55], a[144:147], v[52:55]
s_waitcnt vmcnt(7)
buffer_load_dwordx4 a[144:147], v225, s[8:11], s23 offen offset:0 sc1
v_mul_f32 v244, 0x3a800000, v244
v_mfma_f32_16x16x32_bf16 v[0:3], a[0:3], a[112:115], v[0:3]
v_add_f32 v245, v249, v251
v_mfma_f32_16x16x32_bf16 v[0:3], a[56:59], a[128:131], v[0:3]
v_add_f32 v246, v253, v255
v_add_f32 v245, v245, v246
v_mfma_f32_16x16x32_bf16 v[56:59], a[56:59], a[132:135], v[56:59]
v_mul_f32 v246, 0x3c800000, v248
v_mfma_f32_16x16x32_bf16 v[56:59], a[0:3], a[116:119], v[56:59]
buffer_load_dwordx4 a[148:151], v226, s[8:11], s23 offen offset:0 sc1
v_sub_f32 v246, v246, v244
v_mfma_f32_16x16x32_bf16 v[112:115], a[0:3], a[120:123], v[112:115]
v_mul_f32 v247, v246, v246
v_mul_f32 v246, 0x3c800000, v250
v_mfma_f32_16x16x32_bf16 v[112:115], a[56:59], a[136:139], v[112:115]
v_sub_f32 v246, v246, v244
v_fmac_f32 v247, v246, v246
v_mfma_f32_16x16x32_bf16 v[168:171], a[56:59], a[140:143], v[168:171]
v_add_u32 v229, s5, v229
v_mul_f32 v246, 0x3c800000, v252
v_mfma_f32_16x16x32_bf16 v[168:171], a[0:3], a[124:127], v[168:171]
s_barrier
s_add_u32 s4, s4, 1
s_cmp_eq_u32 s4, 4
s_cselect_b32 s5, 0xfffeb000, s6
s_cselect_b32 s4, 0, s4
buffer_load_dwordx4 a[152:155], v227, s[8:11], s23 offen offset:0 sc1
v_mfma_f32_16x16x32_bf16 v[172:175], a[4:7], a[124:127], v[172:175]
ds_read_b64_tr_b16 a[0:1], v229 offset:0
v_sub_f32 v246, v246, v244
v_mfma_f32_16x16x32_bf16 v[172:175], a[60:63], a[140:143], v[172:175]
ds_read_b64_tr_b16 a[2:3], v229 offset:3584
v_fmac_f32 v247, v246, v246
v_mfma_f32_16x16x32_bf16 v[116:119], a[60:63], a[136:139], v[116:119]
ds_read_b64_tr_b16 a[56:57], v229 offset:7168
v_mul_f32 v246, 0x3c800000, v254
v_mfma_f32_16x16x32_bf16 v[116:119], a[4:7], a[120:123], v[116:119]
buffer_load_dwordx4 a[156:159], v228, s[8:11], s23 offen offset:0 sc1
v_sub_f32 v246, v246, v244
v_mfma_f32_16x16x32_bf16 v[60:63], a[4:7], a[116:119], v[60:63]
ds_read_b64_tr_b16 a[58:59], v229 offset:10752
v_fmac_f32 v247, v246, v246
v_mfma_f32_16x16x32_bf16 v[60:63], a[60:63], a[132:135], v[60:63]
v_fmamk_f32 v245, v247, 0x42800000, v245
v_mov_b32 v246, v245
v_mfma_f32_16x16x32_bf16 v[4:7], a[60:63], a[128:131], v[4:7]
s_nop 0
v_permlane16_swap_b32 v245, v246
v_add_f32 v245, v245, v246
v_mfma_f32_16x16x32_bf16 v[4:7], a[4:7], a[112:115], v[4:7]
buffer_load_dwordx4 a[160:163], v225, s[8:11], s23 offen offset:1024 sc1
v_mov_b32 v246, v245
v_mfma_f32_16x16x32_bf16 v[8:11], a[8:11], a[112:115], v[8:11]
ds_read_b64_tr_b16 a[4:5], v229 offset:14336
v_permlane32_swap_b32 v245, v246
v_mfma_f32_16x16x32_bf16 v[8:11], a[64:67], a[128:131], v[8:11]
ds_read_b64_tr_b16 a[6:7], v229 offset:17920
v_add_f32 v245, v245, v246
v_mfma_f32_16x16x32_bf16 v[64:67], a[64:67], a[132:135], v[64:67]
ds_read_b64_tr_b16 a[60:61], v229 offset:21504
v_mov_b32 v246, 0x3727c5ac
v_mfma_f32_16x16x32_bf16 v[64:67], a[8:11], a[116:119], v[64:67]
buffer_load_dwordx4 a[164:167], v226, s[8:11], s23 offen offset:1024 sc1
v_fmamk_f32 v245, v245, 0x3a800000, v246
v_mfma_f32_16x16x32_bf16 v[120:123], a[8:11], a[120:123], v[120:123]
ds_read_b64_tr_b16 a[62:63], v229 offset:25088
v_rsq_f32 v245, v245
v_mfma_f32_16x16x32_bf16 v[120:123], a[64:67], a[136:139], v[120:123]
v_sub_f32 v244, 0, v244
v_mul_f32 v245, v245, v245
v_mfma_f32_16x16x32_bf16 v[176:179], a[64:67], a[140:143], v[176:179]
v_accvgpr_write_b32 a182, v244
v_accvgpr_write_b32 a183, v245
v_mfma_f32_16x16x32_bf16 v[176:179], a[8:11], a[124:127], v[176:179]
buffer_load_dwordx4 a[168:171], v227, s[8:11], s23 offen offset:1024 sc1
v_mfma_f32_16x16x32_bf16 v[180:183], a[12:15], a[124:127], v[180:183]
ds_read_b64_tr_b16 a[8:9], v229 offset:32
v_mfma_f32_16x16x32_bf16 v[180:183], a[68:71], a[140:143], v[180:183]
ds_read_b64_tr_b16 a[10:11], v229 offset:3616
v_mfma_f32_16x16x32_bf16 v[124:127], a[68:71], a[136:139], v[124:127]
ds_read_b64_tr_b16 a[64:65], v229 offset:7200
v_mfma_f32_16x16x32_bf16 v[124:127], a[12:15], a[120:123], v[124:127]
buffer_load_dwordx4 a[172:175], v228, s[8:11], s23 offen offset:1024 sc1
v_mfma_f32_16x16x32_bf16 v[68:71], a[12:15], a[116:119], v[68:71]
s_add_u32 s23, s23, 4096
ds_read_b64_tr_b16 a[66:67], v229 offset:10784
v_mfma_f32_16x16x32_bf16 v[68:71], a[68:71], a[132:135], v[68:71]
s_cmp_eq_u32 s23, s40
v_mfma_f32_16x16x32_bf16 v[12:15], a[68:71], a[128:131], v[12:15]
s_cselect_b32 s23, s31, s23
v_mfma_f32_16x16x32_bf16 v[12:15], a[12:15], a[112:115], v[12:15]
buffer_load_dwordx4 v232, s[12:15], s41 offen offset:0 lds
v_mfma_f32_16x16x32_bf16 v[16:19], a[16:19], a[112:115], v[16:19]
ds_read_b64_tr_b16 a[12:13], v229 offset:14368
v_mfma_f32_16x16x32_bf16 v[16:19], a[72:75], a[128:131], v[16:19]
ds_read_b64_tr_b16 a[14:15], v229 offset:17952
v_mfma_f32_16x16x32_bf16 v[72:75], a[72:75], a[132:135], v[72:75]
ds_read_b64_tr_b16 a[68:69], v229 offset:21536
v_mfma_f32_16x16x32_bf16 v[72:75], a[16:19], a[116:119], v[72:75]
buffer_load_dwordx4 a[184:187], v225, s[8:11], s23 offen offset:0 sc1
v_mfma_f32_16x16x32_bf16 v[128:131], a[16:19], a[120:123], v[128:131]
ds_read_b64_tr_b16 a[70:71], v229 offset:25120
v_mfma_f32_16x16x32_bf16 v[128:131], a[72:75], a[136:139], v[128:131]
v_mfma_f32_16x16x32_bf16 v[184:187], a[72:75], a[140:143], v[184:187]
v_mfma_f32_16x16x32_bf16 v[184:187], a[16:19], a[124:127], v[184:187]
buffer_load_dwordx4 a[188:191], v226, s[8:11], s23 offen offset:0 sc1
v_mfma_f32_16x16x32_bf16 v[188:191], a[20:23], a[124:127], v[188:191]
ds_read_b64_tr_b16 a[16:17], v229 offset:64
v_mfma_f32_16x16x32_bf16 v[188:191], a[76:79], a[140:143], v[188:191]
ds_read_b64_tr_b16 a[18:19], v229 offset:3648
v_mfma_f32_16x16x32_bf16 v[132:135], a[76:79], a[136:139], v[132:135]
ds_read_b64_tr_b16 a[72:73], v229 offset:7232
v_mfma_f32_16x16x32_bf16 v[132:135], a[20:23], a[120:123], v[132:135]
buffer_load_dwordx4 a[192:195], v227, s[8:11], s23 offen offset:0 sc1
v_mfma_f32_16x16x32_bf16 v[76:79], a[20:23], a[116:119], v[76:79]
ds_read_b64_tr_b16 a[74:75], v229 offset:10816
v_mfma_f32_16x16x32_bf16 v[76:79], a[76:79], a[132:135], v[76:79]
v_mfma_f32_16x16x32_bf16 v[20:23], a[76:79], a[128:131], v[20:23]
v_mfma_f32_16x16x32_bf16 v[20:23], a[20:23], a[112:115], v[20:23]
buffer_load_dwordx4 a[196:199], v228, s[8:11], s23 offen offset:0 sc1
v_mfma_f32_16x16x32_bf16 v[24:27], a[24:27], a[112:115], v[24:27]
ds_read_b64_tr_b16 a[20:21], v229 offset:14400
v_mfma_f32_16x16x32_bf16 v[24:27], a[80:83], a[128:131], v[24:27]
ds_read_b64_tr_b16 a[22:23], v229 offset:17984
v_mfma_f32_16x16x32_bf16 v[80:83], a[80:83], a[132:135], v[80:83]
ds_read_b64_tr_b16 a[76:77], v229 offset:21568
v_mfma_f32_16x16x32_bf16 v[80:83], a[24:27], a[116:119], v[80:83]
buffer_load_dwordx4 a[200:203], v225, s[8:11], s23 offen offset:1024 sc1
v_mfma_f32_16x16x32_bf16 v[136:139], a[24:27], a[120:123], v[136:139]
ds_read_b64_tr_b16 a[78:79], v229 offset:25152
v_mfma_f32_16x16x32_bf16 v[136:139], a[80:83], a[136:139], v[136:139]
v_mfma_f32_16x16x32_bf16 v[192:195], a[80:83], a[140:143], v[192:195]
v_mfma_f32_16x16x32_bf16 v[192:195], a[24:27], a[124:127], v[192:195]
buffer_load_dwordx4 a[204:207], v226, s[8:11], s23 offen offset:1024 sc1
v_mfma_f32_16x16x32_bf16 v[196:199], a[28:31], a[124:127], v[196:199]
ds_read_b64_tr_b16 a[24:25], v229 offset:96
v_mfma_f32_16x16x32_bf16 v[196:199], a[84:87], a[140:143], v[196:199]
ds_read_b64_tr_b16 a[26:27], v229 offset:3680
v_mfma_f32_16x16x32_bf16 v[140:143], a[84:87], a[136:139], v[140:143]
ds_read_b64_tr_b16 a[80:81], v229 offset:7264
v_mfma_f32_16x16x32_bf16 v[140:143], a[28:31], a[120:123], v[140:143]
buffer_load_dwordx4 a[208:211], v227, s[8:11], s23 offen offset:1024 sc1
v_mfma_f32_16x16x32_bf16 v[84:87], a[28:31], a[116:119], v[84:87]
ds_read_b64_tr_b16 a[82:83], v229 offset:10848
v_mfma_f32_16x16x32_bf16 v[84:87], a[84:87], a[132:135], v[84:87]
v_mfma_f32_16x16x32_bf16 v[28:31], a[84:87], a[128:131], v[28:31]
v_mfma_f32_16x16x32_bf16 v[28:31], a[28:31], a[112:115], v[28:31]
s_waitcnt vmcnt(8) lgkmcnt(4)
buffer_load_dwordx4 a[212:215], v228, s[8:11], s23 offen offset:1024 sc1
v_mfma_f32_16x16x32_bf16 v[0:3], a[0:3], a[144:147], v[0:3]
s_add_u32 s23, s23, 4096
ds_read_b64_tr_b16 a[28:29], v229 offset:14432
v_mfma_f32_16x16x32_bf16 v[0:3], a[56:59], a[160:163], v[0:3]
s_cmp_eq_u32 s23, s40
ds_read_b64_tr_b16 a[30:31], v229 offset:18016
v_mfma_f32_16x16x32_bf16 v[56:59], a[56:59], a[164:167], v[56:59]
s_cselect_b32 s23, s31, s23
ds_read_b64_tr_b16 a[84:85], v229 offset:21600
v_mfma_f32_16x16x32_bf16 v[56:59], a[0:3], a[148:151], v[56:59]
buffer_load_dwordx4 v233, s[12:15], s41 offen offset:1024 lds
v_mfma_f32_16x16x32_bf16 v[112:115], a[0:3], a[152:155], v[112:115]
ds_read_b64_tr_b16 a[86:87], v229 offset:25184
v_mfma_f32_16x16x32_bf16 v[112:115], a[56:59], a[168:171], v[112:115]
v_mfma_f32_16x16x32_bf16 v[168:171], a[56:59], a[172:175], v[168:171]
v_add_u32 v229, s5, v229
v_mfma_f32_16x16x32_bf16 v[168:171], a[0:3], a[156:159], v[168:171]
s_barrier
s_add_u32 s4, s4, 1
s_cmp_eq_u32 s4, 4
s_cselect_b32 s5, 0xfffeb000, s6
s_cselect_b32 s4, 0, s4
buffer_load_dwordx4 v234, s[12:15], s41 offen offset:2048 lds
v_mfma_f32_16x16x32_bf16 v[172:175], a[4:7], a[156:159], v[172:175]
ds_read_b64_tr_b16 a[0:1], v229 offset:0
v_mfma_f32_16x16x32_bf16 v[172:175], a[60:63], a[172:175], v[172:175]
ds_read_b64_tr_b16 a[2:3], v229 offset:3584
v_mfma_f32_16x16x32_bf16 v[116:119], a[60:63], a[168:171], v[116:119]
ds_read_b64_tr_b16 a[56:57], v229 offset:7168
v_mfma_f32_16x16x32_bf16 v[116:119], a[4:7], a[152:155], v[116:119]
buffer_load_dwordx4 v235, s[12:15], s41 offen offset:3072 lds
v_mfma_f32_16x16x32_bf16 v[60:63], a[4:7], a[148:151], v[60:63]
s_add_u32 m0, s7, 4096
ds_read_b64_tr_b16 a[58:59], v229 offset:10752
v_mfma_f32_16x16x32_bf16 v[60:63], a[60:63], a[164:167], v[60:63]
v_mfma_f32_16x16x32_bf16 v[4:7], a[60:63], a[160:163], v[4:7]
v_mfma_f32_16x16x32_bf16 v[4:7], a[4:7], a[144:147], v[4:7]
buffer_load_dwordx4 v236, s[12:15], s41 offen offset:0 lds
v_mfma_f32_16x16x32_bf16 v[8:11], a[8:11], a[144:147], v[8:11]
ds_read_b64_tr_b16 a[4:5], v229 offset:14336
v_mfma_f32_16x16x32_bf16 v[8:11], a[64:67], a[160:163], v[8:11]
ds_read_b64_tr_b16 a[6:7], v229 offset:17920
v_mfma_f32_16x16x32_bf16 v[64:67], a[64:67], a[164:167], v[64:67]
ds_read_b64_tr_b16 a[60:61], v229 offset:21504
v_mfma_f32_16x16x32_bf16 v[64:67], a[8:11], a[148:151], v[64:67]
buffer_load_dwordx4 v237, s[12:15], s41 offen offset:1024 lds
v_mfma_f32_16x16x32_bf16 v[120:123], a[8:11], a[152:155], v[120:123]
ds_read_b64_tr_b16 a[62:63], v229 offset:25088
v_mfma_f32_16x16x32_bf16 v[120:123], a[64:67], a[168:171], v[120:123]
v_mfma_f32_16x16x32_bf16 v[176:179], a[64:67], a[172:175], v[176:179]
v_mfma_f32_16x16x32_bf16 v[176:179], a[8:11], a[156:159], v[176:179]
buffer_load_dwordx4 v238, s[12:15], s41 offen offset:2048 lds
v_mfma_f32_16x16x32_bf16 v[180:183], a[12:15], a[156:159], v[180:183]
s_add_u32 s7, s7, s6
ds_read_b64_tr_b16 a[8:9], v229 offset:32
v_mfma_f32_16x16x32_bf16 v[180:183], a[68:71], a[172:175], v[180:183]
s_cmp_eq_u32 s7, s3
ds_read_b64_tr_b16 a[10:11], v229 offset:3616
v_mfma_f32_16x16x32_bf16 v[124:127], a[68:71], a[168:171], v[124:127]
s_cselect_b32 s7, s24, s7
ds_read_b64_tr_b16 a[64:65], v229 offset:7200
v_mfma_f32_16x16x32_bf16 v[124:127], a[12:15], a[152:155], v[124:127]
s_mov_b32 m0, s7
s_add_u32 s41, s41, 917504
s_cmp_eq_u32 s41, 7340032
s_cselect_b32 s41, 458752, s41
buffer_load_dwordx4 a[216:219], v225, s[8:11], s23 offen offset:0 sc1
v_mfma_f32_16x16x32_bf16 v[68:71], a[12:15], a[148:151], v[68:71]
ds_read_b64_tr_b16 a[66:67], v229 offset:10784
v_mfma_f32_16x16x32_bf16 v[68:71], a[68:71], a[164:167], v[68:71]
v_mfma_f32_16x16x32_bf16 v[12:15], a[68:71], a[160:163], v[12:15]
v_mfma_f32_16x16x32_bf16 v[12:15], a[12:15], a[144:147], v[12:15]
buffer_load_dwordx4 a[220:223], v226, s[8:11], s23 offen offset:0 sc1
v_mfma_f32_16x16x32_bf16 v[16:19], a[16:19], a[144:147], v[16:19]
ds_read_b64_tr_b16 a[12:13], v229 offset:14368
v_mfma_f32_16x16x32_bf16 v[16:19], a[72:75], a[160:163], v[16:19]
ds_read_b64_tr_b16 a[14:15], v229 offset:17952
v_mfma_f32_16x16x32_bf16 v[72:75], a[72:75], a[164:167], v[72:75]
ds_read_b64_tr_b16 a[68:69], v229 offset:21536
v_mfma_f32_16x16x32_bf16 v[72:75], a[16:19], a[148:151], v[72:75]
buffer_load_dwordx4 a[224:227], v227, s[8:11], s23 offen offset:0 sc1
v_mfma_f32_16x16x32_bf16 v[128:131], a[16:19], a[152:155], v[128:131]
ds_read_b64_tr_b16 a[70:71], v229 offset:25120
v_mfma_f32_16x16x32_bf16 v[128:131], a[72:75], a[168:171], v[128:131]
v_mfma_f32_16x16x32_bf16 v[184:187], a[72:75], a[172:175], v[184:187]
v_mfma_f32_16x16x32_bf16 v[184:187], a[16:19], a[156:159], v[184:187]
buffer_load_dwordx4 a[228:231], v228, s[8:11], s23 offen offset:0 sc1
v_mfma_f32_16x16x32_bf16 v[188:191], a[20:23], a[156:159], v[188:191]
ds_read_b64_tr_b16 a[16:17], v229 offset:64
v_mfma_f32_16x16x32_bf16 v[188:191], a[76:79], a[172:175], v[188:191]
ds_read_b64_tr_b16 a[18:19], v229 offset:3648
v_mfma_f32_16x16x32_bf16 v[132:135], a[76:79], a[168:171], v[132:135]
ds_read_b64_tr_b16 a[72:73], v229 offset:7232
v_mfma_f32_16x16x32_bf16 v[132:135], a[20:23], a[152:155], v[132:135]
buffer_load_dwordx4 a[232:235], v225, s[8:11], s23 offen offset:1024 sc1
v_mfma_f32_16x16x32_bf16 v[76:79], a[20:23], a[148:151], v[76:79]
ds_read_b64_tr_b16 a[74:75], v229 offset:10816
v_mfma_f32_16x16x32_bf16 v[76:79], a[76:79], a[164:167], v[76:79]
v_mfma_f32_16x16x32_bf16 v[20:23], a[76:79], a[160:163], v[20:23]
v_mfma_f32_16x16x32_bf16 v[20:23], a[20:23], a[144:147], v[20:23]
buffer_load_dwordx4 a[236:239], v226, s[8:11], s23 offen offset:1024 sc1
s_waitcnt lgkmcnt(4)
v_mfma_f32_16x16x32_bf16 v[24:27], a[24:27], a[144:147], v[24:27]
ds_read_b64_tr_b16 a[20:21], v229 offset:14400
v_mfma_f32_16x16x32_bf16 v[24:27], a[80:83], a[160:163], v[24:27]
ds_read_b64_tr_b16 a[22:23], v229 offset:17984
v_mfma_f32_16x16x32_bf16 v[80:83], a[80:83], a[164:167], v[80:83]
ds_read_b64_tr_b16 a[76:77], v229 offset:21568
v_mfma_f32_16x16x32_bf16 v[80:83], a[24:27], a[148:151], v[80:83]
buffer_load_dwordx4 a[240:243], v227, s[8:11], s23 offen offset:1024 sc1
v_mfma_f32_16x16x32_bf16 v[136:139], a[24:27], a[152:155], v[136:139]
ds_read_b64_tr_b16 a[78:79], v229 offset:25152
v_mfma_f32_16x16x32_bf16 v[136:139], a[80:83], a[168:171], v[136:139]
v_mfma_f32_16x16x32_bf16 v[192:195], a[80:83], a[172:175], v[192:195]
v_mfma_f32_16x16x32_bf16 v[192:195], a[24:27], a[156:159], v[192:195]
buffer_load_dwordx4 a[244:247], v228, s[8:11], s23 offen offset:1024 sc1
v_mfma_f32_16x16x32_bf16 v[196:199], a[28:31], a[156:159], v[196:199]
ds_read_b64_tr_b16 a[24:25], v229 offset:96
v_mfma_f32_16x16x32_bf16 v[196:199], a[84:87], a[172:175], v[196:199]
s_mul_i32 s26, s21, 114688
ds_read_b64_tr_b16 a[26:27], v229 offset:3680
v_mfma_f32_16x16x32_bf16 v[140:143], a[84:87], a[168:171], v[140:143]
s_mul_i32 s27, s22, 7
ds_read_b64_tr_b16 a[80:81], v229 offset:7264
v_mfma_f32_16x16x32_bf16 v[140:143], a[28:31], a[152:155], v[140:143]
s_add_u32 s27, s27, s25
ds_read_b64_tr_b16 a[82:83], v229 offset:10848
v_mfma_f32_16x16x32_bf16 v[84:87], a[28:31], a[148:151], v[84:87]
s_lshl_b32 s27, s27, 9
v_mfma_f32_16x16x32_bf16 v[84:87], a[84:87], a[164:167], v[84:87]
s_add_u32 s26, s26, s27
v_mfma_f32_16x16x32_bf16 v[28:31], a[84:87], a[160:163], v[28:31]
s_add_u32 s32, s26, 0xc00000
v_mfma_f32_16x16x32_bf16 v[28:31], a[28:31], a[144:147], v[28:31]
s_waitcnt vmcnt(14)
s_mul_i32 s27, s25, -4088
ds_read_b64_tr_b16 a[28:29], v229 offset:14432
v_mfma_f32_16x16x32_bf16 v[0:3], a[0:3], a[184:187], v[0:3]
s_add_u32 s27, s27, 3072
ds_read_b64_tr_b16 a[30:31], v229 offset:18016
v_mfma_f32_16x16x32_bf16 v[0:3], a[56:59], a[200:203], v[0:3]
s_add_u32 s36, s32, s27
ds_read_b64_tr_b16 a[84:85], v229 offset:21600
v_mfma_f32_16x16x32_bf16 v[56:59], a[56:59], a[204:207], v[56:59]
s_add_u32 s33, s32, 114688
ds_read_b64_tr_b16 a[86:87], v229 offset:25184
v_mfma_f32_16x16x32_bf16 v[56:59], a[0:3], a[188:191], v[56:59]
s_add_u32 s37, s36, 114688
v_mfma_f32_16x16x32_bf16 v[112:115], a[0:3], a[192:195], v[112:115]
s_add_u32 s34, s32, 229376
v_mfma_f32_16x16x32_bf16 v[112:115], a[56:59], a[208:211], v[112:115]
s_add_u32 s38, s36, 229376
v_mfma_f32_16x16x32_bf16 v[168:171], a[56:59], a[212:215], v[168:171]
s_add_u32 s35, s32, 344064
s_add_u32 s39, s36, 344064
v_add_u32 v229, s5, v229
v_mfma_f32_16x16x32_bf16 v[168:171], a[0:3], a[196:199], v[168:171]
s_waitcnt vmcnt(8)
s_barrier
s_add_u32 s4, s4, 1
ds_read_b64_tr_b16 a[0:1], v229 offset:0
v_mfma_f32_16x16x32_bf16 v[172:175], a[4:7], a[196:199], v[172:175]
s_cmp_eq_u32 s4, 4
ds_read_b64_tr_b16 a[2:3], v229 offset:3584
v_mfma_f32_16x16x32_bf16 v[172:175], a[60:63], a[212:215], v[172:175]
s_cselect_b32 s5, 0xfffeb000, s6
ds_read_b64_tr_b16 a[56:57], v229 offset:7168
v_mfma_f32_16x16x32_bf16 v[116:119], a[60:63], a[208:211], v[116:119]
s_cselect_b32 s4, 0, s4
ds_read_b64_tr_b16 a[58:59], v229 offset:10752
v_mfma_f32_16x16x32_bf16 v[116:119], a[4:7], a[192:195], v[116:119]
v_mfma_f32_16x16x32_bf16 v[60:63], a[4:7], a[188:191], v[60:63]
v_mfma_f32_16x16x32_bf16 v[60:63], a[60:63], a[204:207], v[60:63]
v_mfma_f32_16x16x32_bf16 v[4:7], a[60:63], a[200:203], v[4:7]
v_mfma_f32_16x16x32_bf16 v[4:7], a[4:7], a[184:187], v[4:7]
ds_read_b64_tr_b16 a[4:5], v229 offset:14336
v_mfma_f32_16x16x32_bf16 v[8:11], a[8:11], a[184:187], v[8:11]
ds_read_b64_tr_b16 a[6:7], v229 offset:17920
v_mfma_f32_16x16x32_bf16 v[8:11], a[64:67], a[200:203], v[8:11]
ds_read_b64_tr_b16 a[60:61], v229 offset:21504
v_mfma_f32_16x16x32_bf16 v[64:67], a[64:67], a[204:207], v[64:67]
ds_read_b64_tr_b16 a[62:63], v229 offset:25088
v_mfma_f32_16x16x32_bf16 v[64:67], a[8:11], a[188:191], v[64:67]
v_mfma_f32_16x16x32_bf16 v[120:123], a[8:11], a[192:195], v[120:123]
v_mfma_f32_16x16x32_bf16 v[120:123], a[64:67], a[208:211], v[120:123]
v_mfma_f32_16x16x32_bf16 v[176:179], a[64:67], a[212:215], v[176:179]
v_mfma_f32_16x16x32_bf16 v[176:179], a[8:11], a[196:199], v[176:179]
ds_read_b64_tr_b16 a[8:9], v229 offset:32
v_mfma_f32_16x16x32_bf16 v[180:183], a[12:15], a[196:199], v[180:183]
ds_read_b64_tr_b16 a[10:11], v229 offset:3616
v_mfma_f32_16x16x32_bf16 v[180:183], a[68:71], a[212:215], v[180:183]
ds_read_b64_tr_b16 a[64:65], v229 offset:7200
v_mfma_f32_16x16x32_bf16 v[124:127], a[68:71], a[208:211], v[124:127]
ds_read_b64_tr_b16 a[66:67], v229 offset:10784
v_mfma_f32_16x16x32_bf16 v[124:127], a[12:15], a[192:195], v[124:127]
v_mfma_f32_16x16x32_bf16 v[68:71], a[12:15], a[188:191], v[68:71]
s_bfe_u32 s28, s2, 0x20001
v_lshrrev_b32 v242, 4, v224
v_mfma_f32_16x16x32_bf16 v[68:71], a[68:71], a[204:207], v[68:71]
s_mul_i32 s28, s28, 1835008
v_and_b32 v243, 15, v224
v_mfma_f32_16x16x32_bf16 v[12:15], a[68:71], a[200:203], v[12:15]
s_lshr_b32 s29, s2, 5
v_lshlrev_b32 v245, 1, v242
v_mfma_f32_16x16x32_bf16 v[12:15], a[12:15], a[184:187], v[12:15]
s_waitcnt lgkmcnt(4)
s_lshl_b32 s29, s29, 8
ds_read_b64_tr_b16 a[12:13], v229 offset:14368
v_xor_b32 v243, v243, v245
v_mfma_f32_16x16x32_bf16 v[16:19], a[16:19], a[184:187], v[16:19]
s_add_u32 s28, s28, s29
ds_read_b64_tr_b16 a[14:15], v229 offset:17952
v_lshlrev_b32 v242, 11, v242
v_mfma_f32_16x16x32_bf16 v[16:19], a[72:75], a[200:203], v[16:19]
s_lshl_b32 s29, s20, 15
ds_read_b64_tr_b16 a[68:69], v229 offset:21536
v_lshl_add_u32 v244, v243, 4, v242
v_mfma_f32_16x16x32_bf16 v[72:75], a[72:75], a[204:207], v[72:75]
s_add_u32 s28, s28, s29
ds_read_b64_tr_b16 a[70:71], v229 offset:25120
v_xor_b32 v243, 128, v244
v_mfma_f32_16x16x32_bf16 v[72:75], a[16:19], a[188:191], v[72:75]
s_lshl_b32 s24, s20, 12
v_add_u32 v245, 7168, v243
v_mfma_f32_16x16x32_bf16 v[128:131], a[16:19], a[192:195], v[128:131]
s_mov_b32 s12, s52
v_add_u32 v246, 14336, v244
v_mfma_f32_16x16x32_bf16 v[128:131], a[72:75], a[208:211], v[128:131]
s_and_b32 s13, s53, 0xffff
v_add_u32 v247, 21504, v243
v_mfma_f32_16x16x32_bf16 v[184:187], a[72:75], a[212:215], v[184:187]
s_mov_b32 s14, 0x700000
v_mfma_f32_16x16x32_bf16 v[184:187], a[16:19], a[196:199], v[184:187]
s_mov_b32 s15, 0x20000
ds_read_b64_tr_b16 a[16:17], v229 offset:64
v_mfma_f32_16x16x32_bf16 v[188:191], a[20:23], a[196:199], v[188:191]
s_add_u32 s12, s12, s28
ds_read_b64_tr_b16 a[18:19], v229 offset:3648
v_mfma_f32_16x16x32_bf16 v[188:191], a[76:79], a[212:215], v[188:191]
s_addc_u32 s13, s13, 0
ds_read_b64_tr_b16 a[72:73], v229 offset:7232
v_mfma_f32_16x16x32_bf16 v[132:135], a[76:79], a[208:211], v[132:135]
s_sub_u32 s14, s14, s28
ds_read_b64_tr_b16 a[74:75], v229 offset:10816
v_mfma_f32_16x16x32_bf16 v[132:135], a[20:23], a[192:195], v[132:135]
s_add_u32 m0, s24, 0x0
v_mfma_f32_16x16x32_bf16 v[76:79], a[20:23], a[188:191], v[76:79]
v_mfma_f32_16x16x32_bf16 v[76:79], a[76:79], a[204:207], v[76:79]
v_mfma_f32_16x16x32_bf16 v[20:23], a[76:79], a[200:203], v[20:23]
v_mfma_f32_16x16x32_bf16 v[20:23], a[20:23], a[184:187], v[20:23]
ds_read_b64_tr_b16 a[20:21], v229 offset:14400
v_mfma_f32_16x16x32_bf16 v[24:27], a[24:27], a[184:187], v[24:27]
buffer_load_dwordx4 v244, s[12:15], 0 offen offset:0 lds
v_add_u32 v244, 0x40000, v244
v_mfma_f32_16x16x32_bf16 v[24:27], a[80:83], a[200:203], v[24:27]
ds_read_b64_tr_b16 a[22:23], v229 offset:17984
v_mfma_f32_16x16x32_bf16 v[80:83], a[80:83], a[204:207], v[80:83]
ds_read_b64_tr_b16 a[76:77], v229 offset:21568
v_mfma_f32_16x16x32_bf16 v[80:83], a[24:27], a[188:191], v[80:83]
ds_read_b64_tr_b16 a[78:79], v229 offset:25152
v_mfma_f32_16x16x32_bf16 v[136:139], a[24:27], a[192:195], v[136:139]
buffer_load_dwordx4 v245, s[12:15], 0 offen offset:1024 lds
v_add_u32 v245, 0x40000, v245
v_mfma_f32_16x16x32_bf16 v[136:139], a[80:83], a[208:211], v[136:139]
v_mfma_f32_16x16x32_bf16 v[192:195], a[80:83], a[212:215], v[192:195]
v_mfma_f32_16x16x32_bf16 v[192:195], a[24:27], a[196:199], v[192:195]
ds_read_b64_tr_b16 a[24:25], v229 offset:96
v_mfma_f32_16x16x32_bf16 v[196:199], a[28:31], a[196:199], v[196:199]
buffer_load_dwordx4 v246, s[12:15], 0 offen offset:2048 lds
v_add_u32 v246, 0x40000, v246
v_mfma_f32_16x16x32_bf16 v[196:199], a[84:87], a[212:215], v[196:199]
ds_read_b64_tr_b16 a[26:27], v229 offset:3680
v_mfma_f32_16x16x32_bf16 v[140:143], a[84:87], a[208:211], v[140:143]
ds_read_b64_tr_b16 a[80:81], v229 offset:7264
v_mfma_f32_16x16x32_bf16 v[140:143], a[28:31], a[192:195], v[140:143]
ds_read_b64_tr_b16 a[82:83], v229 offset:10848
v_mfma_f32_16x16x32_bf16 v[84:87], a[28:31], a[188:191], v[84:87]
buffer_load_dwordx4 v247, s[12:15], 0 offen offset:3072 lds
v_add_u32 v247, 0x40000, v247
v_mfma_f32_16x16x32_bf16 v[84:87], a[84:87], a[204:207], v[84:87]
s_add_u32 m0, s24, 0x4000
v_mfma_f32_16x16x32_bf16 v[28:31], a[84:87], a[200:203], v[28:31]
v_mfma_f32_16x16x32_bf16 v[28:31], a[28:31], a[184:187], v[28:31]
s_waitcnt vmcnt(4)
ds_read_b64_tr_b16 a[28:29], v229 offset:14432
v_mfma_f32_16x16x32_bf16 v[0:3], a[0:3], a[216:219], v[0:3]
buffer_load_dwordx4 v244, s[12:15], 0 offen offset:0 lds
v_add_u32 v244, 0x30000, v244
v_mfma_f32_16x16x32_bf16 v[0:3], a[56:59], a[232:235], v[0:3]
ds_read_b64_tr_b16 a[30:31], v229 offset:18016
v_mfma_f32_16x16x32_bf16 v[56:59], a[56:59], a[236:239], v[56:59]
ds_read_b64_tr_b16 a[84:85], v229 offset:21600
v_lshrrev_b32 v230, 4, v224
v_mfma_f32_16x16x32_bf16 v[56:59], a[0:3], a[220:223], v[56:59]
ds_read_b64_tr_b16 a[86:87], v229 offset:25184
v_lshlrev_b32 v230, 4, v230
v_mfma_f32_16x16x32_bf16 v[112:115], a[0:3], a[224:227], v[112:115]
buffer_load_dwordx4 v245, s[12:15], 0 offen offset:1024 lds
v_add_u32 v245, 0x30000, v245
v_mfma_f32_16x16x32_bf16 v[112:115], a[56:59], a[240:243], v[112:115]
v_add_u32 v230, 0xbc00, v230
v_accvgpr_read_b32 v240, a176
v_mfma_f32_16x16x32_bf16 v[168:171], a[56:59], a[244:247], v[168:171]
v_add_u32 v229, s5, v229
v_accvgpr_read_b32 v241, a178
v_mfma_f32_16x16x32_bf16 v[168:171], a[0:3], a[228:231], v[168:171]
s_add_u32 s4, s4, 1
ds_read_b64_tr_b16 a[32:33], v229 offset:128
v_accvgpr_read_b32 v242, a180
v_mfma_f32_16x16x32_bf16 v[172:175], a[4:7], a[228:231], v[172:175]
s_cmp_eq_u32 s4, 4
s_cselect_b32 s5, 0xfffeb000, s6
s_cselect_b32 s4, 0, s4
buffer_load_dwordx4 v246, s[12:15], 0 offen offset:2048 lds
v_add_u32 v246, 0x30000, v246
v_mfma_f32_16x16x32_bf16 v[172:175], a[60:63], a[244:247], v[172:175]
ds_read_b64_tr_b16 a[34:35], v229 offset:3712
v_accvgpr_read_b32 v243, a182
v_mfma_f32_16x16x32_bf16 v[116:119], a[60:63], a[240:243], v[116:119]
ds_read_b64_tr_b16 a[88:89], v229 offset:7296
v_mfma_f32_16x16x32_bf16 v[116:119], a[4:7], a[224:227], v[116:119]
ds_read_b64_tr_b16 a[90:91], v229 offset:10880
v_mfma_f32_16x16x32_bf16 v[60:63], a[4:7], a[220:223], v[60:63]
buffer_load_dwordx4 v247, s[12:15], 0 offen offset:3072 lds
v_add_u32 v247, 0x30000, v247
v_mfma_f32_16x16x32_bf16 v[60:63], a[60:63], a[236:239], v[60:63]
s_add_u32 m0, s24, 0x1c000
v_mfma_f32_16x16x32_bf16 v[4:7], a[60:63], a[232:235], v[4:7]
ds_read_b128 v[232:235], v230 offset:0
ds_read_b128 v[236:239], v230 offset:64
ds_read_b128 v[248:251], v230 offset:128
ds_read_b128 v[252:255], v230 offset:192
v_mfma_f32_16x16x32_bf16 v[4:7], a[4:7], a[216:219], v[4:7]
s_waitcnt lgkmcnt(8)
ds_read_b64_tr_b16 a[36:37], v229 offset:14464
v_mfma_f32_16x16x32_bf16 v[8:11], a[8:11], a[216:219], v[8:11]
ds_read_b64_tr_b16 a[38:39], v229 offset:18048
v_mfma_f32_16x16x32_bf16 v[8:11], a[64:67], a[232:235], v[8:11]
ds_read_b64_tr_b16 a[92:93], v229 offset:21632
v_mfma_f32_16x16x32_bf16 v[64:67], a[64:67], a[236:239], v[64:67]
ds_read_b64_tr_b16 a[94:95], v229 offset:25216
v_mfma_f32_16x16x32_bf16 v[64:67], a[8:11], a[220:223], v[64:67]
v_mfma_f32_16x16x32_bf16 v[120:123], a[8:11], a[224:227], v[120:123]
v_mfma_f32_16x16x32_bf16 v[120:123], a[64:67], a[240:243], v[120:123]
v_mfma_f32_16x16x32_bf16 v[176:179], a[64:67], a[244:247], v[176:179]
v_mfma_f32_16x16x32_bf16 v[176:179], a[8:11], a[228:231], v[176:179]
ds_read_b64_tr_b16 a[40:41], v229 offset:160
v_mfma_f32_16x16x32_bf16 v[180:183], a[12:15], a[228:231], v[180:183]
ds_read_b64_tr_b16 a[42:43], v229 offset:3744
s_waitcnt lgkmcnt(8)
v_fmac_f32 v0, v232, v240
v_fmac_f32 v1, v233, v240
v_fmac_f32 v2, v234, v240
v_mfma_f32_16x16x32_bf16 v[180:183], a[68:71], a[244:247], v[180:183]
ds_read_b64_tr_b16 a[96:97], v229 offset:7328
v_fmac_f32 v3, v235, v240
v_fmac_f32 v4, v236, v240
v_fmac_f32 v5, v237, v240
v_mfma_f32_16x16x32_bf16 v[124:127], a[68:71], a[240:243], v[124:127]
ds_read_b64_tr_b16 a[98:99], v229 offset:10912
v_fmac_f32 v6, v238, v240
v_fmac_f32 v7, v239, v240
v_mul_f32 v4, v0, v4
v_mfma_f32_16x16x32_bf16 v[124:127], a[12:15], a[224:227], v[124:127]
v_mul_f32 v5, v1, v5
v_mul_f32 v6, v2, v6
v_mul_f32 v7, v3, v7
v_cvt_pk_bf16_f32 v0, v4, v5
v_mfma_f32_16x16x32_bf16 v[68:71], a[12:15], a[220:223], v[68:71]
v_cvt_pk_bf16_f32 v1, v6, v7
v_fmac_f32 v56, v232, v241
v_fmac_f32 v57, v233, v241
v_mfma_f32_16x16x32_bf16 v[68:71], a[68:71], a[236:239], v[68:71]
v_fmac_f32 v58, v234, v241
v_fmac_f32 v59, v235, v241
v_fmac_f32 v60, v236, v241
v_mfma_f32_16x16x32_bf16 v[12:15], a[68:71], a[232:235], v[12:15]
v_fmac_f32 v61, v237, v241
v_fmac_f32 v62, v238, v241
v_fmac_f32 v63, v239, v241
v_mfma_f32_16x16x32_bf16 v[12:15], a[12:15], a[216:219], v[12:15]
ds_read_b64_tr_b16 a[44:45], v229 offset:14496
v_mul_f32 v60, v56, v60
v_mul_f32 v61, v57, v61
v_mul_f32 v62, v58, v62
v_mfma_f32_16x16x32_bf16 v[16:19], a[16:19], a[216:219], v[16:19]
ds_read_b64_tr_b16 a[46:47], v229 offset:18080
v_mul_f32 v63, v59, v63
v_cvt_pk_bf16_f32 v56, v60, v61
v_cvt_pk_bf16_f32 v57, v62, v63
v_mfma_f32_16x16x32_bf16 v[16:19], a[72:75], a[232:235], v[16:19]
ds_read_b64_tr_b16 a[100:101], v229 offset:21664
v_fmac_f32 v112, v232, v242
v_fmac_f32 v113, v233, v242
v_fmac_f32 v114, v234, v242
v_mfma_f32_16x16x32_bf16 v[72:75], a[72:75], a[236:239], v[72:75]
ds_read_b64_tr_b16 a[102:103], v229 offset:25248
v_fmac_f32 v115, v235, v242
v_fmac_f32 v116, v236, v242
v_fmac_f32 v117, v237, v242
v_mfma_f32_16x16x32_bf16 v[72:75], a[16:19], a[220:223], v[72:75]
v_fmac_f32 v118, v238, v242
v_fmac_f32 v119, v239, v242
v_mul_f32 v116, v112, v116
v_mfma_f32_16x16x32_bf16 v[128:131], a[16:19], a[224:227], v[128:131]
v_mul_f32 v117, v113, v117
v_mul_f32 v118, v114, v118
v_mul_f32 v119, v115, v119
v_mfma_f32_16x16x32_bf16 v[128:131], a[72:75], a[240:243], v[128:131]
v_cvt_pk_bf16_f32 v112, v116, v117
v_cvt_pk_bf16_f32 v113, v118, v119
v_fmac_f32 v168, v232, v243
v_mfma_f32_16x16x32_bf16 v[184:187], a[72:75], a[244:247], v[184:187]
v_fmac_f32 v169, v233, v243
v_fmac_f32 v170, v234, v243
v_fmac_f32 v171, v235, v243
v_mfma_f32_16x16x32_bf16 v[184:187], a[16:19], a[228:231], v[184:187]
ds_read_b64_tr_b16 a[48:49], v229 offset:192
v_fmac_f32 v172, v236, v243
v_fmac_f32 v173, v237, v243
v_fmac_f32 v174, v238, v243
v_mfma_f32_16x16x32_bf16 v[188:191], a[20:23], a[228:231], v[188:191]
ds_read_b64_tr_b16 a[50:51], v229 offset:3776
v_fmac_f32 v175, v239, v243
v_mul_f32 v172, v168, v172
v_mul_f32 v173, v169, v173
v_mfma_f32_16x16x32_bf16 v[188:191], a[76:79], a[244:247], v[188:191]
ds_read_b64_tr_b16 a[104:105], v229 offset:7360
v_mul_f32 v174, v170, v174
v_mul_f32 v175, v171, v175
v_cvt_pk_bf16_f32 v168, v172, v173
v_mfma_f32_16x16x32_bf16 v[132:135], a[76:79], a[240:243], v[132:135]
ds_read_b64_tr_b16 a[106:107], v229 offset:10944
v_cvt_pk_bf16_f32 v169, v174, v175
v_mfma_f32_16x16x32_bf16 v[132:135], a[20:23], a[224:227], v[132:135]
ds_read_b128 v[232:235], v230 offset:256
ds_read_b128 v[236:239], v230 offset:320
s_waitcnt lgkmcnt(15)
v_fmac_f32 v8, v248, v240
v_fmac_f32 v9, v249, v240
v_mfma_f32_16x16x32_bf16 v[76:79], a[20:23], a[220:223], v[76:79]
v_fmac_f32 v10, v250, v240
v_fmac_f32 v11, v251, v240
v_fmac_f32 v12, v252, v240
v_fmac_f32 v13, v253, v240
v_mfma_f32_16x16x32_bf16 v[76:79], a[76:79], a[236:239], v[76:79]
v_fmac_f32 v14, v254, v240
v_fmac_f32 v15, v255, v240
v_mul_f32 v12, v8, v12
v_mul_f32 v13, v9, v13
v_mfma_f32_16x16x32_bf16 v[20:23], a[76:79], a[232:235], v[20:23]
v_mul_f32 v14, v10, v14
v_mul_f32 v15, v11, v15
v_cvt_pk_bf16_f32 v2, v12, v13
v_cvt_pk_bf16_f32 v3, v14, v15
v_mfma_f32_16x16x32_bf16 v[20:23], a[20:23], a[216:219], v[20:23]
ds_read_b64_tr_b16 a[52:53], v229 offset:14528
buffer_store_dwordx4 v[0:3], v225, s[8:11], s32 offen offset:0 sc1
v_fmac_f32 v64, v248, v241
v_fmac_f32 v65, v249, v241
v_mfma_f32_16x16x32_bf16 v[24:27], a[24:27], a[216:219], v[24:27]
ds_read_b64_tr_b16 a[54:55], v229 offset:18112
v_fmac_f32 v66, v250, v241
v_fmac_f32 v67, v251, v241
v_fmac_f32 v68, v252, v241
v_mfma_f32_16x16x32_bf16 v[24:27], a[80:83], a[232:235], v[24:27]
ds_read_b64_tr_b16 a[108:109], v229 offset:21696
v_fmac_f32 v69, v253, v241
v_fmac_f32 v70, v254, v241
v_fmac_f32 v71, v255, v241
v_mfma_f32_16x16x32_bf16 v[80:83], a[80:83], a[236:239], v[80:83]
ds_read_b64_tr_b16 a[110:111], v229 offset:25280
v_mul_f32 v68, v64, v68
v_mul_f32 v69, v65, v69
v_mul_f32 v70, v66, v70
v_mfma_f32_16x16x32_bf16 v[80:83], a[24:27], a[220:223], v[80:83]
v_mul_f32 v71, v67, v71
v_cvt_pk_bf16_f32 v58, v68, v69
v_cvt_pk_bf16_f32 v59, v70, v71
v_mfma_f32_16x16x32_bf16 v[136:139], a[24:27], a[224:227], v[136:139]
buffer_store_dwordx4 v[56:59], v225, s[8:11], s33 offen offset:0 sc1
v_fmac_f32 v120, v248, v242
v_fmac_f32 v121, v249, v242
v_fmac_f32 v122, v250, v242
v_mfma_f32_16x16x32_bf16 v[136:139], a[80:83], a[240:243], v[136:139]
v_fmac_f32 v123, v251, v242
v_fmac_f32 v124, v252, v242
v_fmac_f32 v125, v253, v242
v_fmac_f32 v126, v254, v242
v_mfma_f32_16x16x32_bf16 v[192:195], a[80:83], a[244:247], v[192:195]
v_fmac_f32 v127, v255, v242
v_mul_f32 v124, v120, v124
v_mul_f32 v125, v121, v125
v_mfma_f32_16x16x32_bf16 v[192:195], a[24:27], a[228:231], v[192:195]
v_mul_f32 v126, v122, v126
v_mul_f32 v127, v123, v127
v_cvt_pk_bf16_f32 v114, v124, v125
v_mfma_f32_16x16x32_bf16 v[196:199], a[28:31], a[228:231], v[196:199]
v_cvt_pk_bf16_f32 v115, v126, v127
v_mfma_f32_16x16x32_bf16 v[196:199], a[84:87], a[244:247], v[196:199]
buffer_store_dwordx4 v[112:115], v225, s[8:11], s34 offen offset:0 sc1
v_fmac_f32 v176, v248, v243
v_fmac_f32 v177, v249, v243
v_fmac_f32 v178, v250, v243
v_mfma_f32_16x16x32_bf16 v[140:143], a[84:87], a[240:243], v[140:143]
v_fmac_f32 v179, v251, v243
v_fmac_f32 v180, v252, v243
v_fmac_f32 v181, v253, v243
v_fmac_f32 v182, v254, v243
v_mfma_f32_16x16x32_bf16 v[140:143], a[28:31], a[224:227], v[140:143]
v_fmac_f32 v183, v255, v243
v_mul_f32 v180, v176, v180
v_mul_f32 v181, v177, v181
v_mul_f32 v182, v178, v182
v_mfma_f32_16x16x32_bf16 v[84:87], a[28:31], a[220:223], v[84:87]
v_mul_f32 v183, v179, v183
v_cvt_pk_bf16_f32 v170, v180, v181
v_cvt_pk_bf16_f32 v171, v182, v183
v_mfma_f32_16x16x32_bf16 v[84:87], a[84:87], a[236:239], v[84:87]
buffer_store_dwordx4 v[168:171], v225, s[8:11], s35 offen offset:0 sc1
ds_read_b128 v[248:251], v230 offset:384
ds_read_b128 v[252:255], v230 offset:448
s_waitcnt lgkmcnt(6)
v_fmac_f32 v16, v232, v240
v_mfma_f32_16x16x32_bf16 v[28:31], a[84:87], a[232:235], v[28:31]
v_fmac_f32 v17, v233, v240
v_fmac_f32 v18, v234, v240
v_fmac_f32 v19, v235, v240
v_fmac_f32 v20, v236, v240
v_mfma_f32_16x16x32_bf16 v[28:31], a[28:31], a[216:219], v[28:31]
v_fmac_f32 v21, v237, v240
v_fmac_f32 v22, v238, v240
v_fmac_f32 v23, v239, v240
v_mul_f32 v20, v16, v20
v_mfma_f32_16x16x32_bf16 v[32:35], a[32:35], a[112:115], v[32:35]
v_mul_f32 v21, v17, v21
v_mul_f32 v22, v18, v22
v_mul_f32 v23, v19, v23
v_mfma_f32_16x16x32_bf16 v[32:35], a[88:91], a[128:131], v[32:35]
v_cvt_pk_bf16_f32 v16, v20, v21
v_cvt_pk_bf16_f32 v17, v22, v23
v_fmac_f32 v72, v232, v241
v_mfma_f32_16x16x32_bf16 v[88:91], a[88:91], a[132:135], v[88:91]
v_fmac_f32 v73, v233, v241
v_fmac_f32 v74, v234, v241
v_fmac_f32 v75, v235, v241
v_mfma_f32_16x16x32_bf16 v[88:91], a[32:35], a[116:119], v[88:91]
v_fmac_f32 v76, v236, v241
v_fmac_f32 v77, v237, v241
v_fmac_f32 v78, v238, v241
v_mfma_f32_16x16x32_bf16 v[144:147], a[32:35], a[120:123], v[144:147]
v_fmac_f32 v79, v239, v241
v_mul_f32 v76, v72, v76
v_mul_f32 v77, v73, v77
v_mfma_f32_16x16x32_bf16 v[144:147], a[88:91], a[136:139], v[144:147]
v_mul_f32 v78, v74, v78
v_mul_f32 v79, v75, v79
v_cvt_pk_bf16_f32 v72, v76, v77
v_mfma_f32_16x16x32_bf16 v[200:203], a[88:91], a[140:143], v[200:203]
v_add_u32 v229, s5, v229
v_cvt_pk_bf16_f32 v73, v78, v79
v_fmac_f32 v128, v232, v242
v_fmac_f32 v129, v233, v242
v_mfma_f32_16x16x32_bf16 v[200:203], a[32:35], a[124:127], v[200:203]
s_add_u32 s4, s4, 1
ds_read_b64_tr_b16 a[32:33], v229 offset:128
v_fmac_f32 v130, v234, v242
v_fmac_f32 v131, v235, v242
v_fmac_f32 v132, v236, v242
v_mfma_f32_16x16x32_bf16 v[204:207], a[36:39], a[124:127], v[204:207]
s_cmp_eq_u32 s4, 4
ds_read_b64_tr_b16 a[34:35], v229 offset:3712
v_fmac_f32 v133, v237, v242
v_fmac_f32 v134, v238, v242
v_fmac_f32 v135, v239, v242
v_mfma_f32_16x16x32_bf16 v[204:207], a[92:95], a[140:143], v[204:207]
s_cselect_b32 s5, 0xfffeb000, s6
ds_read_b64_tr_b16 a[88:89], v229 offset:7296
v_mul_f32 v132, v128, v132
v_mul_f32 v133, v129, v133
v_mul_f32 v134, v130, v134
v_mfma_f32_16x16x32_bf16 v[148:151], a[92:95], a[136:139], v[148:151]
s_cselect_b32 s4, 0, s4
ds_read_b64_tr_b16 a[90:91], v229 offset:10880
v_mul_f32 v135, v131, v135
v_cvt_pk_bf16_f32 v128, v132, v133
v_cvt_pk_bf16_f32 v129, v134, v135
v_mfma_f32_16x16x32_bf16 v[148:151], a[36:39], a[120:123], v[148:151]
v_fmac_f32 v184, v232, v243
v_fmac_f32 v185, v233, v243
v_fmac_f32 v186, v234, v243
v_mfma_f32_16x16x32_bf16 v[92:95], a[36:39], a[116:119], v[92:95]
v_fmac_f32 v187, v235, v243
v_fmac_f32 v188, v236, v243
v_fmac_f32 v189, v237, v243
v_mfma_f32_16x16x32_bf16 v[92:95], a[92:95], a[132:135], v[92:95]
v_fmac_f32 v190, v238, v243
v_fmac_f32 v191, v239, v243
v_mul_f32 v188, v184, v188
v_mfma_f32_16x16x32_bf16 v[36:39], a[92:95], a[128:131], v[36:39]
v_mul_f32 v189, v185, v189
v_mul_f32 v190, v186, v190
v_mul_f32 v191, v187, v191
v_mfma_f32_16x16x32_bf16 v[36:39], a[36:39], a[112:115], v[36:39]
ds_read_b64_tr_b16 a[36:37], v229 offset:14464
v_cvt_pk_bf16_f32 v184, v188, v189
v_cvt_pk_bf16_f32 v185, v190, v191
v_mfma_f32_16x16x32_bf16 v[40:43], a[40:43], a[112:115], v[40:43]
ds_read_b64_tr_b16 a[38:39], v229 offset:18048
ds_read_b128 v[232:235], v230 offset:512
ds_read_b128 v[236:239], v230 offset:576
s_waitcnt lgkmcnt(8)
v_fmac_f32 v24, v248, v240
v_mfma_f32_16x16x32_bf16 v[40:43], a[96:99], a[128:131], v[40:43]
ds_read_b64_tr_b16 a[92:93], v229 offset:21632
v_fmac_f32 v25, v249, v240
v_fmac_f32 v26, v250, v240
v_fmac_f32 v27, v251, v240
v_mfma_f32_16x16x32_bf16 v[96:99], a[96:99], a[132:135], v[96:99]
ds_read_b64_tr_b16 a[94:95], v229 offset:25216
v_fmac_f32 v28, v252, v240
v_fmac_f32 v29, v253, v240
v_fmac_f32 v30, v254, v240
v_mfma_f32_16x16x32_bf16 v[96:99], a[40:43], a[116:119], v[96:99]
v_fmac_f32 v31, v255, v240
v_mul_f32 v28, v24, v28
v_mul_f32 v29, v25, v29
v_mul_f32 v30, v26, v30
v_mfma_f32_16x16x32_bf16 v[152:155], a[40:43], a[120:123], v[152:155]
v_mul_f32 v31, v27, v31
v_cvt_pk_bf16_f32 v18, v28, v29
v_cvt_pk_bf16_f32 v19, v30, v31
v_mfma_f32_16x16x32_bf16 v[152:155], a[96:99], a[136:139], v[152:155]
buffer_store_dwordx4 v[16:19], v225, s[8:11], s32 offen offset:1024 sc1
v_fmac_f32 v80, v248, v241
v_fmac_f32 v81, v249, v241
v_fmac_f32 v82, v250, v241
v_mfma_f32_16x16x32_bf16 v[208:211], a[96:99], a[140:143], v[208:211]
v_fmac_f32 v83, v251, v241
v_fmac_f32 v84, v252, v241
v_fmac_f32 v85, v253, v241
v_fmac_f32 v86, v254, v241
v_mfma_f32_16x16x32_bf16 v[208:211], a[40:43], a[124:127], v[208:211]
ds_read_b64_tr_b16 a[40:41], v229 offset:160
v_fmac_f32 v87, v255, v241
v_mul_f32 v84, v80, v84
v_mul_f32 v85, v81, v85
v_mfma_f32_16x16x32_bf16 v[212:215], a[44:47], a[124:127], v[212:215]
ds_read_b64_tr_b16 a[42:43], v229 offset:3744
v_mul_f32 v86, v82, v86
v_mul_f32 v87, v83, v87
v_cvt_pk_bf16_f32 v74, v84, v85
v_mfma_f32_16x16x32_bf16 v[212:215], a[100:103], a[140:143], v[212:215]
ds_read_b64_tr_b16 a[96:97], v229 offset:7328
v_cvt_pk_bf16_f32 v75, v86, v87
v_mfma_f32_16x16x32_bf16 v[156:159], a[100:103], a[136:139], v[156:159]
ds_read_b64_tr_b16 a[98:99], v229 offset:10912
buffer_store_dwordx4 v[72:75], v225, s[8:11], s33 offen offset:1024 sc1
v_fmac_f32 v136, v248, v242
v_fmac_f32 v137, v249, v242
v_mfma_f32_16x16x32_bf16 v[156:159], a[44:47], a[120:123], v[156:159]
v_fmac_f32 v138, v250, v242
v_fmac_f32 v139, v251, v242
v_fmac_f32 v140, v252, v242
v_fmac_f32 v141, v253, v242
v_mfma_f32_16x16x32_bf16 v[100:103], a[44:47], a[116:119], v[100:103]
v_fmac_f32 v142, v254, v242
v_fmac_f32 v143, v255, v242
v_mul_f32 v140, v136, v140
v_mul_f32 v141, v137, v141
v_mfma_f32_16x16x32_bf16 v[100:103], a[100:103], a[132:135], v[100:103]
v_mul_f32 v142, v138, v142
v_mul_f32 v143, v139, v143
v_cvt_pk_bf16_f32 v130, v140, v141
v_cvt_pk_bf16_f32 v131, v142, v143
v_mfma_f32_16x16x32_bf16 v[44:47], a[100:103], a[128:131], v[44:47]
buffer_store_dwordx4 v[128:131], v225, s[8:11], s34 offen offset:1024 sc1
v_fmac_f32 v192, v248, v243
v_fmac_f32 v193, v249, v243
v_fmac_f32 v194, v250, v243
v_mfma_f32_16x16x32_bf16 v[44:47], a[44:47], a[112:115], v[44:47]
ds_read_b64_tr_b16 a[44:45], v229 offset:14496
v_fmac_f32 v195, v251, v243
v_fmac_f32 v196, v252, v243
v_fmac_f32 v197, v253, v243
v_mfma_f32_16x16x32_bf16 v[48:51], a[48:51], a[112:115], v[48:51]
ds_read_b64_tr_b16 a[46:47], v229 offset:18080
v_fmac_f32 v198, v254, v243
v_fmac_f32 v199, v255, v243
v_mul_f32 v196, v192, v196
v_mfma_f32_16x16x32_bf16 v[48:51], a[104:107], a[128:131], v[48:51]
ds_read_b64_tr_b16 a[100:101], v229 offset:21664
v_mul_f32 v197, v193, v197
v_mul_f32 v198, v194, v198
v_mul_f32 v199, v195, v199
v_mfma_f32_16x16x32_bf16 v[104:107], a[104:107], a[132:135], v[104:107]
ds_read_b64_tr_b16 a[102:103], v229 offset:25248
v_cvt_pk_bf16_f32 v186, v196, v197
v_cvt_pk_bf16_f32 v187, v198, v199
v_mfma_f32_16x16x32_bf16 v[104:107], a[48:51], a[116:119], v[104:107]
buffer_store_dwordx4 v[184:187], v225, s[8:11], s35 offen offset:1024 sc1
ds_read_b128 v[248:251], v230 offset:640
ds_read_b128 v[252:255], v230 offset:704
v_mfma_f32_16x16x32_bf16 v[160:163], a[48:51], a[120:123], v[160:163]
v_mfma_f32_16x16x32_bf16 v[160:163], a[104:107], a[136:139], v[160:163]
v_mfma_f32_16x16x32_bf16 v[216:219], a[104:107], a[140:143], v[216:219]
v_mfma_f32_16x16x32_bf16 v[216:219], a[48:51], a[124:127], v[216:219]
ds_read_b64_tr_b16 a[48:49], v229 offset:192
v_mfma_f32_16x16x32_bf16 v[220:223], a[52:55], a[124:127], v[220:223]
ds_read_b64_tr_b16 a[50:51], v229 offset:3776
v_mfma_f32_16x16x32_bf16 v[220:223], a[108:111], a[140:143], v[220:223]
ds_read_b64_tr_b16 a[104:105], v229 offset:7360
v_mfma_f32_16x16x32_bf16 v[164:167], a[108:111], a[136:139], v[164:167]
ds_read_b64_tr_b16 a[106:107], v229 offset:10944
v_mfma_f32_16x16x32_bf16 v[164:167], a[52:55], a[120:123], v[164:167]
v_mfma_f32_16x16x32_bf16 v[108:111], a[52:55], a[116:119], v[108:111]
v_mfma_f32_16x16x32_bf16 v[108:111], a[108:111], a[132:135], v[108:111]
v_mfma_f32_16x16x32_bf16 v[52:55], a[108:111], a[128:131], v[52:55]
v_mfma_f32_16x16x32_bf16 v[52:55], a[52:55], a[112:115], v[52:55]
s_waitcnt lgkmcnt(4)
ds_read_b64_tr_b16 a[52:53], v229 offset:14528
v_mfma_f32_16x16x32_bf16 v[32:35], a[32:35], a[144:147], v[32:35]
ds_read_b64_tr_b16 a[54:55], v229 offset:18112
v_mfma_f32_16x16x32_bf16 v[32:35], a[88:91], a[160:163], v[32:35]
ds_read_b64_tr_b16 a[108:109], v229 offset:21696
v_mfma_f32_16x16x32_bf16 v[88:91], a[88:91], a[164:167], v[88:91]
ds_read_b64_tr_b16 a[110:111], v229 offset:25280
v_mfma_f32_16x16x32_bf16 v[88:91], a[32:35], a[148:151], v[88:91]
v_mfma_f32_16x16x32_bf16 v[144:147], a[32:35], a[152:155], v[144:147]
v_mfma_f32_16x16x32_bf16 v[144:147], a[88:91], a[168:171], v[144:147]
v_mfma_f32_16x16x32_bf16 v[200:203], a[88:91], a[172:175], v[200:203]
v_add_u32 v229, s5, v229
v_mfma_f32_16x16x32_bf16 v[200:203], a[32:35], a[156:159], v[200:203]
s_add_u32 s4, s4, 1
ds_read_b64_tr_b16 a[32:33], v229 offset:128
v_mfma_f32_16x16x32_bf16 v[204:207], a[36:39], a[156:159], v[204:207]
s_cmp_eq_u32 s4, 4
ds_read_b64_tr_b16 a[34:35], v229 offset:3712
v_mfma_f32_16x16x32_bf16 v[204:207], a[92:95], a[172:175], v[204:207]
s_cselect_b32 s5, 0xfffeb000, s6
ds_read_b64_tr_b16 a[88:89], v229 offset:7296
v_mfma_f32_16x16x32_bf16 v[148:151], a[92:95], a[168:171], v[148:151]
s_cselect_b32 s4, 0, s4
ds_read_b64_tr_b16 a[90:91], v229 offset:10880
v_mfma_f32_16x16x32_bf16 v[148:151], a[36:39], a[152:155], v[148:151]
v_mfma_f32_16x16x32_bf16 v[92:95], a[36:39], a[148:151], v[92:95]
v_mfma_f32_16x16x32_bf16 v[92:95], a[92:95], a[164:167], v[92:95]
v_mfma_f32_16x16x32_bf16 v[36:39], a[92:95], a[160:163], v[36:39]
v_mfma_f32_16x16x32_bf16 v[36:39], a[36:39], a[144:147], v[36:39]
ds_read_b64_tr_b16 a[36:37], v229 offset:14464
v_mfma_f32_16x16x32_bf16 v[40:43], a[40:43], a[144:147], v[40:43]
ds_read_b64_tr_b16 a[38:39], v229 offset:18048
v_mfma_f32_16x16x32_bf16 v[40:43], a[96:99], a[160:163], v[40:43]
ds_read_b64_tr_b16 a[92:93], v229 offset:21632
v_mfma_f32_16x16x32_bf16 v[96:99], a[96:99], a[164:167], v[96:99]
ds_read_b64_tr_b16 a[94:95], v229 offset:25216
v_mfma_f32_16x16x32_bf16 v[96:99], a[40:43], a[148:151], v[96:99]
v_mfma_f32_16x16x32_bf16 v[152:155], a[40:43], a[152:155], v[152:155]
v_mfma_f32_16x16x32_bf16 v[152:155], a[96:99], a[168:171], v[152:155]
v_mfma_f32_16x16x32_bf16 v[208:211], a[96:99], a[172:175], v[208:211]
v_mfma_f32_16x16x32_bf16 v[208:211], a[40:43], a[156:159], v[208:211]
ds_read_b64_tr_b16 a[40:41], v229 offset:160
v_mfma_f32_16x16x32_bf16 v[212:215], a[44:47], a[156:159], v[212:215]
ds_read_b64_tr_b16 a[42:43], v229 offset:3744
v_mfma_f32_16x16x32_bf16 v[212:215], a[100:103], a[172:175], v[212:215]
ds_read_b64_tr_b16 a[96:97], v229 offset:7328
v_mfma_f32_16x16x32_bf16 v[156:159], a[100:103], a[168:171], v[156:159]
ds_read_b64_tr_b16 a[98:99], v229 offset:10912
v_mfma_f32_16x16x32_bf16 v[156:159], a[44:47], a[152:155], v[156:159]
v_mfma_f32_16x16x32_bf16 v[100:103], a[44:47], a[148:151], v[100:103]
v_mfma_f32_16x16x32_bf16 v[100:103], a[100:103], a[164:167], v[100:103]
v_mfma_f32_16x16x32_bf16 v[44:47], a[100:103], a[160:163], v[44:47]
v_mfma_f32_16x16x32_bf16 v[44:47], a[44:47], a[144:147], v[44:47]
ds_read_b64_tr_b16 a[44:45], v229 offset:14496
s_waitcnt lgkmcnt(5)
v_mfma_f32_16x16x32_bf16 v[48:51], a[48:51], a[144:147], v[48:51]
ds_read_b64_tr_b16 a[46:47], v229 offset:18080
v_mfma_f32_16x16x32_bf16 v[48:51], a[104:107], a[160:163], v[48:51]
ds_read_b64_tr_b16 a[100:101], v229 offset:21664
v_mfma_f32_16x16x32_bf16 v[104:107], a[104:107], a[164:167], v[104:107]
ds_read_b64_tr_b16 a[102:103], v229 offset:25248
v_mfma_f32_16x16x32_bf16 v[104:107], a[48:51], a[148:151], v[104:107]
v_mfma_f32_16x16x32_bf16 v[160:163], a[48:51], a[152:155], v[160:163]
v_mfma_f32_16x16x32_bf16 v[160:163], a[104:107], a[168:171], v[160:163]
v_mfma_f32_16x16x32_bf16 v[216:219], a[104:107], a[172:175], v[216:219]
v_mfma_f32_16x16x32_bf16 v[216:219], a[48:51], a[156:159], v[216:219]
ds_read_b64_tr_b16 a[48:49], v229 offset:192
v_mfma_f32_16x16x32_bf16 v[220:223], a[52:55], a[156:159], v[220:223]
ds_read_b64_tr_b16 a[50:51], v229 offset:3776
v_mfma_f32_16x16x32_bf16 v[220:223], a[108:111], a[172:175], v[220:223]
ds_read_b64_tr_b16 a[104:105], v229 offset:7360
v_mfma_f32_16x16x32_bf16 v[164:167], a[108:111], a[168:171], v[164:167]
ds_read_b64_tr_b16 a[106:107], v229 offset:10944
v_mfma_f32_16x16x32_bf16 v[164:167], a[52:55], a[152:155], v[164:167]
v_mfma_f32_16x16x32_bf16 v[108:111], a[52:55], a[148:151], v[108:111]
v_mfma_f32_16x16x32_bf16 v[108:111], a[108:111], a[164:167], v[108:111]
v_mfma_f32_16x16x32_bf16 v[52:55], a[108:111], a[160:163], v[52:55]
v_mfma_f32_16x16x32_bf16 v[52:55], a[52:55], a[144:147], v[52:55]
ds_read_b64_tr_b16 a[52:53], v229 offset:14528
v_mfma_f32_16x16x32_bf16 v[32:35], a[32:35], a[184:187], v[32:35]
ds_read_b64_tr_b16 a[54:55], v229 offset:18112
v_mfma_f32_16x16x32_bf16 v[32:35], a[88:91], a[200:203], v[32:35]
ds_read_b64_tr_b16 a[108:109], v229 offset:21696
v_mfma_f32_16x16x32_bf16 v[88:91], a[88:91], a[204:207], v[88:91]
ds_read_b64_tr_b16 a[110:111], v229 offset:25280
v_mfma_f32_16x16x32_bf16 v[88:91], a[32:35], a[188:191], v[88:91]
v_mfma_f32_16x16x32_bf16 v[144:147], a[32:35], a[192:195], v[144:147]
v_mfma_f32_16x16x32_bf16 v[144:147], a[88:91], a[208:211], v[144:147]
v_mfma_f32_16x16x32_bf16 v[200:203], a[88:91], a[212:215], v[200:203]
v_add_u32 v229, s5, v229
v_mfma_f32_16x16x32_bf16 v[200:203], a[32:35], a[196:199], v[200:203]
s_add_u32 s4, s4, 1
ds_read_b64_tr_b16 a[32:33], v229 offset:128
v_mfma_f32_16x16x32_bf16 v[204:207], a[36:39], a[196:199], v[204:207]
s_cmp_eq_u32 s4, 4
ds_read_b64_tr_b16 a[34:35], v229 offset:3712
v_mfma_f32_16x16x32_bf16 v[204:207], a[92:95], a[212:215], v[204:207]
s_cselect_b32 s5, 0xfffeb000, s6
ds_read_b64_tr_b16 a[88:89], v229 offset:7296
v_mfma_f32_16x16x32_bf16 v[148:151], a[92:95], a[208:211], v[148:151]
s_cselect_b32 s4, 0, s4
ds_read_b64_tr_b16 a[90:91], v229 offset:10880
v_mfma_f32_16x16x32_bf16 v[148:151], a[36:39], a[192:195], v[148:151]
v_mfma_f32_16x16x32_bf16 v[92:95], a[36:39], a[188:191], v[92:95]
v_mfma_f32_16x16x32_bf16 v[92:95], a[92:95], a[204:207], v[92:95]
v_mfma_f32_16x16x32_bf16 v[36:39], a[92:95], a[200:203], v[36:39]
v_mfma_f32_16x16x32_bf16 v[36:39], a[36:39], a[184:187], v[36:39]
s_waitcnt lgkmcnt(4)
ds_read_b64_tr_b16 a[36:37], v229 offset:14464
v_mfma_f32_16x16x32_bf16 v[40:43], a[40:43], a[184:187], v[40:43]
ds_read_b64_tr_b16 a[38:39], v229 offset:18048
v_mfma_f32_16x16x32_bf16 v[40:43], a[96:99], a[200:203], v[40:43]
ds_read_b64_tr_b16 a[92:93], v229 offset:21632
v_mfma_f32_16x16x32_bf16 v[96:99], a[96:99], a[204:207], v[96:99]
ds_read_b64_tr_b16 a[94:95], v229 offset:25216
v_mfma_f32_16x16x32_bf16 v[96:99], a[40:43], a[188:191], v[96:99]
v_mfma_f32_16x16x32_bf16 v[152:155], a[40:43], a[192:195], v[152:155]
v_mfma_f32_16x16x32_bf16 v[152:155], a[96:99], a[208:211], v[152:155]
v_mfma_f32_16x16x32_bf16 v[208:211], a[96:99], a[212:215], v[208:211]
v_mfma_f32_16x16x32_bf16 v[208:211], a[40:43], a[196:199], v[208:211]
ds_read_b64_tr_b16 a[40:41], v229 offset:160
v_mfma_f32_16x16x32_bf16 v[212:215], a[44:47], a[196:199], v[212:215]
ds_read_b64_tr_b16 a[42:43], v229 offset:3744
v_mfma_f32_16x16x32_bf16 v[212:215], a[100:103], a[212:215], v[212:215]
ds_read_b64_tr_b16 a[96:97], v229 offset:7328
v_mfma_f32_16x16x32_bf16 v[156:159], a[100:103], a[208:211], v[156:159]
ds_read_b64_tr_b16 a[98:99], v229 offset:10912
v_mfma_f32_16x16x32_bf16 v[156:159], a[44:47], a[192:195], v[156:159]
v_mfma_f32_16x16x32_bf16 v[100:103], a[44:47], a[188:191], v[100:103]
v_mfma_f32_16x16x32_bf16 v[100:103], a[100:103], a[204:207], v[100:103]
v_mfma_f32_16x16x32_bf16 v[44:47], a[100:103], a[200:203], v[44:47]
v_mfma_f32_16x16x32_bf16 v[44:47], a[44:47], a[184:187], v[44:47]
ds_read_b64_tr_b16 a[44:45], v229 offset:14496
v_mfma_f32_16x16x32_bf16 v[48:51], a[48:51], a[184:187], v[48:51]
ds_read_b64_tr_b16 a[46:47], v229 offset:18080
v_mfma_f32_16x16x32_bf16 v[48:51], a[104:107], a[200:203], v[48:51]
ds_read_b64_tr_b16 a[100:101], v229 offset:21664
v_mfma_f32_16x16x32_bf16 v[104:107], a[104:107], a[204:207], v[104:107]
ds_read_b64_tr_b16 a[102:103], v229 offset:25248
v_mfma_f32_16x16x32_bf16 v[104:107], a[48:51], a[188:191], v[104:107]
v_mfma_f32_16x16x32_bf16 v[160:163], a[48:51], a[192:195], v[160:163]
v_mfma_f32_16x16x32_bf16 v[160:163], a[104:107], a[208:211], v[160:163]
v_mfma_f32_16x16x32_bf16 v[216:219], a[104:107], a[212:215], v[216:219]
v_mfma_f32_16x16x32_bf16 v[216:219], a[48:51], a[196:199], v[216:219]
ds_read_b64_tr_b16 a[48:49], v229 offset:192
v_mfma_f32_16x16x32_bf16 v[220:223], a[52:55], a[196:199], v[220:223]
ds_read_b64_tr_b16 a[50:51], v229 offset:3776
v_mfma_f32_16x16x32_bf16 v[220:223], a[108:111], a[212:215], v[220:223]
ds_read_b64_tr_b16 a[104:105], v229 offset:7360
v_mfma_f32_16x16x32_bf16 v[164:167], a[108:111], a[208:211], v[164:167]
ds_read_b64_tr_b16 a[106:107], v229 offset:10944
v_mfma_f32_16x16x32_bf16 v[164:167], a[52:55], a[192:195], v[164:167]
v_mfma_f32_16x16x32_bf16 v[108:111], a[52:55], a[188:191], v[108:111]
v_mfma_f32_16x16x32_bf16 v[108:111], a[108:111], a[204:207], v[108:111]
v_mfma_f32_16x16x32_bf16 v[52:55], a[108:111], a[200:203], v[52:55]
v_mfma_f32_16x16x32_bf16 v[52:55], a[52:55], a[184:187], v[52:55]
s_waitcnt lgkmcnt(4)
ds_read_b64_tr_b16 a[52:53], v229 offset:14528
v_mfma_f32_16x16x32_bf16 v[32:35], a[32:35], a[216:219], v[32:35]
ds_read_b64_tr_b16 a[54:55], v229 offset:18112
v_mfma_f32_16x16x32_bf16 v[32:35], a[88:91], a[232:235], v[32:35]
ds_read_b64_tr_b16 a[108:109], v229 offset:21696
v_mfma_f32_16x16x32_bf16 v[88:91], a[88:91], a[236:239], v[88:91]
ds_read_b64_tr_b16 a[110:111], v229 offset:25280
v_mfma_f32_16x16x32_bf16 v[88:91], a[32:35], a[220:223], v[88:91]
v_mfma_f32_16x16x32_bf16 v[144:147], a[32:35], a[224:227], v[144:147]
v_mov_b32 v231, s58
s_waitcnt vmcnt(0)
s_barrier
s_cmp_lg_u32 s20, 3
s_cbranch_scc1 L_k3_ne
s_mov_b64 exec, 1
buffer_store_dword v231, off, s[8:11], s100 sc1
s_mov_b64 exec, -1
L_k3_ne:
s_add_u32 s100, s100, 0x78000
v_mfma_f32_16x16x32_bf16 v[144:147], a[88:91], a[240:243], v[144:147]
buffer_load_dwordx4 v244, s[12:15], 0 offen offset:0 lds
v_add_u32 v244, 0x40000, v244
v_mfma_f32_16x16x32_bf16 v[200:203], a[88:91], a[244:247], v[200:203]
v_mfma_f32_16x16x32_bf16 v[200:203], a[32:35], a[228:231], v[200:203]
v_mfma_f32_16x16x32_bf16 v[204:207], a[36:39], a[228:231], v[204:207]
v_mfma_f32_16x16x32_bf16 v[204:207], a[92:95], a[244:247], v[204:207]
buffer_load_dwordx4 v245, s[12:15], 0 offen offset:1024 lds
v_add_u32 v245, 0x40000, v245
v_mfma_f32_16x16x32_bf16 v[148:151], a[92:95], a[240:243], v[148:151]
v_mfma_f32_16x16x32_bf16 v[148:151], a[36:39], a[224:227], v[148:151]
v_mfma_f32_16x16x32_bf16 v[92:95], a[36:39], a[220:223], v[92:95]
v_mfma_f32_16x16x32_bf16 v[92:95], a[92:95], a[236:239], v[92:95]
buffer_load_dwordx4 v246, s[12:15], 0 offen offset:2048 lds
v_add_u32 v246, 0x40000, v246
v_mfma_f32_16x16x32_bf16 v[36:39], a[92:95], a[232:235], v[36:39]
v_mfma_f32_16x16x32_bf16 v[36:39], a[36:39], a[216:219], v[36:39]
v_mfma_f32_16x16x32_bf16 v[40:43], a[40:43], a[216:219], v[40:43]
v_mfma_f32_16x16x32_bf16 v[40:43], a[96:99], a[232:235], v[40:43]
buffer_load_dwordx4 v247, s[12:15], 0 offen offset:3072 lds
v_add_u32 v247, 0x40000, v247
v_mfma_f32_16x16x32_bf16 v[96:99], a[96:99], a[236:239], v[96:99]
s_add_u32 m0, s24, 0x20000
v_mfma_f32_16x16x32_bf16 v[96:99], a[40:43], a[220:223], v[96:99]
v_mfma_f32_16x16x32_bf16 v[152:155], a[40:43], a[224:227], v[152:155]
v_mfma_f32_16x16x32_bf16 v[152:155], a[96:99], a[240:243], v[152:155]
buffer_load_dwordx4 v244, s[12:15], 0 offen offset:0 lds
v_add_u32 v244, 0x30000, v244
v_mfma_f32_16x16x32_bf16 v[208:211], a[96:99], a[244:247], v[208:211]
v_mfma_f32_16x16x32_bf16 v[208:211], a[40:43], a[228:231], v[208:211]
v_mfma_f32_16x16x32_bf16 v[212:215], a[44:47], a[228:231], v[212:215]
v_mfma_f32_16x16x32_bf16 v[212:215], a[100:103], a[244:247], v[212:215]
buffer_load_dwordx4 v245, s[12:15], 0 offen offset:1024 lds
v_add_u32 v245, 0x30000, v245
v_mfma_f32_16x16x32_bf16 v[156:159], a[100:103], a[240:243], v[156:159]
v_mfma_f32_16x16x32_bf16 v[156:159], a[44:47], a[224:227], v[156:159]
v_mfma_f32_16x16x32_bf16 v[100:103], a[44:47], a[220:223], v[100:103]
v_mfma_f32_16x16x32_bf16 v[100:103], a[100:103], a[236:239], v[100:103]
buffer_load_dwordx4 v246, s[12:15], 0 offen offset:2048 lds
v_add_u32 v246, 0x30000, v246
v_mfma_f32_16x16x32_bf16 v[44:47], a[100:103], a[232:235], v[44:47]
v_mfma_f32_16x16x32_bf16 v[44:47], a[44:47], a[216:219], v[44:47]
s_waitcnt lgkmcnt(0)
v_mfma_f32_16x16x32_bf16 v[48:51], a[48:51], a[216:219], v[48:51]
v_mfma_f32_16x16x32_bf16 v[48:51], a[104:107], a[232:235], v[48:51]
buffer_load_dwordx4 v247, s[12:15], 0 offen offset:3072 lds
v_add_u32 v247, 0x30000, v247
v_mfma_f32_16x16x32_bf16 v[104:107], a[104:107], a[236:239], v[104:107]
s_add_u32 m0, s24, 0x24000
v_mfma_f32_16x16x32_bf16 v[104:107], a[48:51], a[220:223], v[104:107]
v_mfma_f32_16x16x32_bf16 v[160:163], a[48:51], a[224:227], v[160:163]
v_mfma_f32_16x16x32_bf16 v[160:163], a[104:107], a[240:243], v[160:163]
buffer_load_dwordx4 v244, s[12:15], 0 offen offset:0 lds
v_add_u32 v244, 0x40000, v244
v_mfma_f32_16x16x32_bf16 v[216:219], a[104:107], a[244:247], v[216:219]
v_mfma_f32_16x16x32_bf16 v[216:219], a[48:51], a[228:231], v[216:219]
v_mfma_f32_16x16x32_bf16 v[220:223], a[52:55], a[228:231], v[220:223]
v_mfma_f32_16x16x32_bf16 v[220:223], a[108:111], a[244:247], v[220:223]
buffer_load_dwordx4 v245, s[12:15], 0 offen offset:1024 lds
v_add_u32 v245, 0x40000, v245
v_mfma_f32_16x16x32_bf16 v[164:167], a[108:111], a[240:243], v[164:167]
v_mfma_f32_16x16x32_bf16 v[164:167], a[52:55], a[224:227], v[164:167]
v_mfma_f32_16x16x32_bf16 v[108:111], a[52:55], a[220:223], v[108:111]
v_mfma_f32_16x16x32_bf16 v[108:111], a[108:111], a[236:239], v[108:111]
buffer_load_dwordx4 v246, s[12:15], 0 offen offset:2048 lds
v_add_u32 v246, 0x40000, v246
v_mfma_f32_16x16x32_bf16 v[52:55], a[108:111], a[232:235], v[52:55]
v_mfma_f32_16x16x32_bf16 v[52:55], a[52:55], a[216:219], v[52:55]
buffer_load_dwordx4 v247, s[12:15], 0 offen offset:3072 lds
s_add_u32 m0, s24, 0xc000
v_add_u32 v247, 0x40000, v247
buffer_load_dwordx4 v244, s[12:15], 0 offen offset:0 lds
v_add_u32 v244, 0x30000, v244
buffer_load_dwordx4 v245, s[12:15], 0 offen offset:1024 lds
v_add_u32 v245, 0x30000, v245
buffer_load_dwordx4 v246, s[12:15], 0 offen offset:2048 lds
v_add_u32 v246, 0x30000, v246
buffer_load_dwordx4 v247, s[12:15], 0 offen offset:3072 lds
s_add_u32 m0, s24, 0x10000
v_add_u32 v247, 0x30000, v247
s_barrier
v_mbcnt_lo_u32_b32 v168, -1, 0
v_mbcnt_hi_u32_b32 v168, -1, v168
s_bfe_u32 s25, s2, 0x20001
s_and_b32 s26, s2, 1
s_lshl_b32 s26, s26, 2
s_bfe_u32 s27, s2, 0x20003
s_add_u32 s26, s26, s27
s_lshr_b32 s22, s2, 5
s_lshl_b32 s31, s26, 3
s_add_u32 s31, s31, s22
s_lshl_b32 s40, s26, 2
s_add_u32 s40, s40, s25
s_lshl_b32 s40, s40, 10
s_add_u32 s40, s40, 0x1d50000
s_add_u32 s40, s40, s57
s_lshl_b32 s41, s31, 2
s_add_u32 s41, s41, s25
s_lshl_b32 s41, s41, 7
s_add_u32 s41, s41, 0x1e58000
s_add_u32 s41, s41, s57
s_lshl_b32 s21, s26, 4
s_lshl_b32 s27, s20, 2
s_add_u32 s21, s21, s27
v_lshlrev_b32 v172, 4, v168
s_mul_i32 s28, s21, 114688
s_mul_i32 s27, s25, 28672
s_add_u32 s28, s28, s27
s_add_u32 s28, s28, 0xc00000
s_add_u32 s27, s25, 0
s_and_b32 s27, s27, 3
s_mul_i32 s27, s27, 114688
s_add_u32 s23, s27, s28
s_add_u32 s27, s25, 1
s_and_b32 s27, s27, 3
s_mul_i32 s27, s27, 114688
s_add_u32 s98, s27, s28
s_add_u32 s27, s25, 2
s_and_b32 s27, s27, 3
s_mul_i32 s27, s27, 114688
s_add_u32 s99, s27, s28
s_add_u32 s27, s25, 3
s_and_b32 s27, s27, 3
s_mul_i32 s27, s27, 114688
s_add_u32 s60, s27, s28
s_lshr_b32 s3, s20, 1
s_mul_i32 s3, s3, 393216
s_add_u32 s3, s3, 0xffef0000
v_and_b32 v191, 7, v168
v_lshlrev_b32 v191, 7, v191
s_waitcnt lgkmcnt(0)
v_pk_fma_f32 v[32:33], v[232:233], v[240:241], v[32:33] op_sel:[0,0,0] op_sel_hi:[1,0,1]
v_pk_fma_f32 v[36:37], v[236:237], v[240:241], v[36:37] op_sel:[0,0,0] op_sel_hi:[1,0,1]
v_pk_fma_f32 v[34:35], v[234:235], v[240:241], v[34:35] op_sel:[0,0,0] op_sel_hi:[1,0,1]
v_pk_fma_f32 v[38:39], v[238:239], v[240:241], v[38:39] op_sel:[0,0,0] op_sel_hi:[1,0,1]
v_pk_mul_f32 v[36:37], v[32:33], v[36:37]
v_pk_mul_f32 v[38:39], v[34:35], v[38:39]
v_cvt_pk_bf16_f32 v32, v36, v37
v_cvt_pk_bf16_f32 v33, v38, v39
v_pk_fma_f32 v[88:89], v[232:233], v[240:241], v[88:89] op_sel:[0,1,0] op_sel_hi:[1,1,1]
v_pk_fma_f32 v[92:93], v[236:237], v[240:241], v[92:93] op_sel:[0,1,0] op_sel_hi:[1,1,1]
v_pk_fma_f32 v[90:91], v[234:235], v[240:241], v[90:91] op_sel:[0,1,0] op_sel_hi:[1,1,1]
v_pk_fma_f32 v[94:95], v[238:239], v[240:241], v[94:95] op_sel:[0,1,0] op_sel_hi:[1,1,1]
v_pk_mul_f32 v[92:93], v[88:89], v[92:93]
v_pk_mul_f32 v[94:95], v[90:91], v[94:95]
v_cvt_pk_bf16_f32 v88, v92, v93
v_cvt_pk_bf16_f32 v89, v94, v95
v_pk_fma_f32 v[144:145], v[232:233], v[242:243], v[144:145] op_sel:[0,0,0] op_sel_hi:[1,0,1]
v_pk_fma_f32 v[148:149], v[236:237], v[242:243], v[148:149] op_sel:[0,0,0] op_sel_hi:[1,0,1]
v_pk_fma_f32 v[146:147], v[234:235], v[242:243], v[146:147] op_sel:[0,0,0] op_sel_hi:[1,0,1]
v_pk_fma_f32 v[150:151], v[238:239], v[242:243], v[150:151] op_sel:[0,0,0] op_sel_hi:[1,0,1]
v_pk_mul_f32 v[148:149], v[144:145], v[148:149]
v_pk_mul_f32 v[150:151], v[146:147], v[150:151]
v_cvt_pk_bf16_f32 v144, v148, v149
v_cvt_pk_bf16_f32 v145, v150, v151
v_pk_fma_f32 v[200:201], v[232:233], v[242:243], v[200:201] op_sel:[0,1,0] op_sel_hi:[1,1,1]
v_pk_fma_f32 v[204:205], v[236:237], v[242:243], v[204:205] op_sel:[0,1,0] op_sel_hi:[1,1,1]
v_pk_fma_f32 v[202:203], v[234:235], v[242:243], v[202:203] op_sel:[0,1,0] op_sel_hi:[1,1,1]
v_pk_fma_f32 v[206:207], v[238:239], v[242:243], v[206:207] op_sel:[0,1,0] op_sel_hi:[1,1,1]
v_pk_mul_f32 v[204:205], v[200:201], v[204:205]
v_pk_mul_f32 v[206:207], v[202:203], v[206:207]
v_cvt_pk_bf16_f32 v200, v204, v205
v_cvt_pk_bf16_f32 v201, v206, v207
ds_read_b128 v[232:235], v230 offset:768
ds_read_b128 v[236:239], v230 offset:832
buffer_load_dword v190, v191, s[8:11], s40 offen sc1
s_waitcnt lgkmcnt(2)
v_pk_fma_f32 v[40:41], v[248:249], v[240:241], v[40:41] op_sel:[0,0,0] op_sel_hi:[1,0,1]
v_pk_fma_f32 v[44:45], v[252:253], v[240:241], v[44:45] op_sel:[0,0,0] op_sel_hi:[1,0,1]
v_pk_fma_f32 v[42:43], v[250:251], v[240:241], v[42:43] op_sel:[0,0,0] op_sel_hi:[1,0,1]
v_pk_fma_f32 v[46:47], v[254:255], v[240:241], v[46:47] op_sel:[0,0,0] op_sel_hi:[1,0,1]
v_pk_mul_f32 v[44:45], v[40:41], v[44:45]
v_pk_mul_f32 v[46:47], v[42:43], v[46:47]
v_cvt_pk_bf16_f32 v34, v44, v45
v_cvt_pk_bf16_f32 v35, v46, v47
buffer_store_dwordx4 v[32:35], v225, s[8:11], s32 offen offset:2048 sc1
v_pk_fma_f32 v[96:97], v[248:249], v[240:241], v[96:97] op_sel:[0,1,0] op_sel_hi:[1,1,1]
v_pk_fma_f32 v[100:101], v[252:253], v[240:241], v[100:101] op_sel:[0,1,0] op_sel_hi:[1,1,1]
v_pk_fma_f32 v[98:99], v[250:251], v[240:241], v[98:99] op_sel:[0,1,0] op_sel_hi:[1,1,1]
v_pk_fma_f32 v[102:103], v[254:255], v[240:241], v[102:103] op_sel:[0,1,0] op_sel_hi:[1,1,1]
v_pk_mul_f32 v[100:101], v[96:97], v[100:101]
v_pk_mul_f32 v[102:103], v[98:99], v[102:103]
v_cvt_pk_bf16_f32 v90, v100, v101
v_cvt_pk_bf16_f32 v91, v102, v103
buffer_store_dwordx4 v[88:91], v225, s[8:11], s33 offen offset:2048 sc1
v_pk_fma_f32 v[152:153], v[248:249], v[242:243], v[152:153] op_sel:[0,0,0] op_sel_hi:[1,0,1]
v_pk_fma_f32 v[156:157], v[252:253], v[242:243], v[156:157] op_sel:[0,0,0] op_sel_hi:[1,0,1]
v_pk_fma_f32 v[154:155], v[250:251], v[242:243], v[154:155] op_sel:[0,0,0] op_sel_hi:[1,0,1]
v_pk_fma_f32 v[158:159], v[254:255], v[242:243], v[158:159] op_sel:[0,0,0] op_sel_hi:[1,0,1]
v_pk_mul_f32 v[156:157], v[152:153], v[156:157]
v_pk_mul_f32 v[158:159], v[154:155], v[158:159]
v_cvt_pk_bf16_f32 v146, v156, v157
v_cvt_pk_bf16_f32 v147, v158, v159
buffer_store_dwordx4 v[144:147], v225, s[8:11], s34 offen offset:2048 sc1
v_pk_fma_f32 v[208:209], v[248:249], v[242:243], v[208:209] op_sel:[0,1,0] op_sel_hi:[1,1,1]
v_pk_fma_f32 v[212:213], v[252:253], v[242:243], v[212:213] op_sel:[0,1,0] op_sel_hi:[1,1,1]
v_pk_fma_f32 v[210:211], v[250:251], v[242:243], v[210:211] op_sel:[0,1,0] op_sel_hi:[1,1,1]
v_pk_fma_f32 v[214:215], v[254:255], v[242:243], v[214:215] op_sel:[0,1,0] op_sel_hi:[1,1,1]
v_pk_mul_f32 v[212:213], v[208:209], v[212:213]
v_pk_mul_f32 v[214:215], v[210:211], v[214:215]
v_cvt_pk_bf16_f32 v202, v212, v213
v_cvt_pk_bf16_f32 v203, v214, v215
buffer_store_dwordx4 v[200:203], v225, s[8:11], s35 offen offset:2048 sc1
s_waitcnt lgkmcnt(0)
v_pk_fma_f32 v[48:49], v[232:233], v[240:241], v[48:49] op_sel:[0,0,0] op_sel_hi:[1,0,1]
v_pk_fma_f32 v[52:53], v[236:237], v[240:241], v[52:53] op_sel:[0,0,0] op_sel_hi:[1,0,1]
v_pk_fma_f32 v[50:51], v[234:235], v[240:241], v[50:51] op_sel:[0,0,0] op_sel_hi:[1,0,1]
v_pk_fma_f32 v[54:55], v[238:239], v[240:241], v[54:55] op_sel:[0,0,0] op_sel_hi:[1,0,1]
v_pk_mul_f32 v[52:53], v[48:49], v[52:53]
v_pk_mul_f32 v[54:55], v[50:51], v[54:55]
v_cvt_pk_bf16_f32 v48, v52, v53
v_cvt_pk_bf16_f32 v49, v54, v55
buffer_store_dwordx2 v[48:49], v225, s[8:11], s36 offen sc1
v_pk_fma_f32 v[104:105], v[232:233], v[240:241], v[104:105] op_sel:[0,1,0] op_sel_hi:[1,1,1]
v_pk_fma_f32 v[108:109], v[236:237], v[240:241], v[108:109] op_sel:[0,1,0] op_sel_hi:[1,1,1]
v_pk_fma_f32 v[106:107], v[234:235], v[240:241], v[106:107] op_sel:[0,1,0] op_sel_hi:[1,1,1]
v_pk_fma_f32 v[110:111], v[238:239], v[240:241], v[110:111] op_sel:[0,1,0] op_sel_hi:[1,1,1]
v_pk_mul_f32 v[108:109], v[104:105], v[108:109]
v_pk_mul_f32 v[110:111], v[106:107], v[110:111]
v_cvt_pk_bf16_f32 v104, v108, v109
v_cvt_pk_bf16_f32 v105, v110, v111
buffer_store_dwordx2 v[104:105], v225, s[8:11], s37 offen sc1
v_pk_fma_f32 v[160:161], v[232:233], v[242:243], v[160:161] op_sel:[0,0,0] op_sel_hi:[1,0,1]
v_pk_fma_f32 v[164:165], v[236:237], v[242:243], v[164:165] op_sel:[0,0,0] op_sel_hi:[1,0,1]
v_pk_fma_f32 v[162:163], v[234:235], v[242:243], v[162:163] op_sel:[0,0,0] op_sel_hi:[1,0,1]
v_pk_fma_f32 v[166:167], v[238:239], v[242:243], v[166:167] op_sel:[0,0,0] op_sel_hi:[1,0,1]
v_pk_mul_f32 v[164:165], v[160:161], v[164:165]
v_pk_mul_f32 v[166:167], v[162:163], v[166:167]
v_cvt_pk_bf16_f32 v160, v164, v165
v_cvt_pk_bf16_f32 v161, v166, v167
buffer_store_dwordx2 v[160:161], v225, s[8:11], s38 offen sc1
v_pk_fma_f32 v[216:217], v[232:233], v[242:243], v[216:217] op_sel:[0,1,0] op_sel_hi:[1,1,1]
v_pk_fma_f32 v[220:221], v[236:237], v[242:243], v[220:221] op_sel:[0,1,0] op_sel_hi:[1,1,1]
v_pk_fma_f32 v[218:219], v[234:235], v[242:243], v[218:219] op_sel:[0,1,0] op_sel_hi:[1,1,1]
v_pk_fma_f32 v[222:223], v[238:239], v[242:243], v[222:223] op_sel:[0,1,0] op_sel_hi:[1,1,1]
v_pk_mul_f32 v[220:221], v[216:217], v[220:221]
v_pk_mul_f32 v[222:223], v[218:219], v[222:223]
v_cvt_pk_bf16_f32 v216, v220, v221
v_cvt_pk_bf16_f32 v217, v222, v223
buffer_store_dwordx2 v[216:217], v225, s[8:11], s39 offen sc1
s_cmp_lg_u32 s25, 0
s_cbranch_scc1 L_k3_r0
v_accvgpr_read_b32 v174, a177
L_k3_r0:
s_cmp_lg_u32 s25, 1
s_cbranch_scc1 L_k3_r1
v_accvgpr_read_b32 v174, a179
L_k3_r1:
s_cmp_lg_u32 s25, 2
s_cbranch_scc1 L_k3_r2
v_accvgpr_read_b32 v174, a181
L_k3_r2:
s_cmp_lg_u32 s25, 3
s_cbranch_scc1 L_k3_r3
v_accvgpr_read_b32 v174, a183
L_k3_r3:
v_add_u32 v152, 0x1000, v172
v_add_u32 v153, 0x2000, v172
v_add_u32 v154, 0x3000, v172
v_add_u32 v155, 0x4000, v172
v_add_u32 v156, 0x5000, v172
v_add_u32 v157, 0x6000, v172
s_waitcnt vmcnt(8)
v_cmp_ne_u32 s[46:47], s58, v190
s_nop 4
s_cmp_eq_u64 s[46:47], 0
s_cbranch_scc1 L_k4_go
s_mov_b32 s56, 0x100000
L_k4_poll:
buffer_load_dword v190, v191, s[8:11], s40 offen sc1
s_waitcnt vmcnt(0)
v_cmp_ne_u32 s[46:47], s58, v190
s_nop 4
s_cmp_eq_u64 s[46:47], 0
s_cbranch_scc1 L_k4_go
s_sub_u32 s56, s56, 1
s_cbranch_scc0 L_k4_poll
L_k4_go:
s_add_u32 s40, s40, 0x78000
buffer_load_dwordx4 a[64:67], v172, s[8:11], s23 offen offset:0 sc1
buffer_load_dwordx4 a[68:71], v172, s[8:11], s23 offen offset:1024 sc1
buffer_load_dwordx4 a[136:139], v172, s[8:11], s98 offen offset:0 sc1
buffer_load_dwordx4 a[140:143], v172, s[8:11], s98 offen offset:1024 sc1
buffer_load_dwordx4 a[168:171], v172, s[8:11], s99 offen offset:0 sc1
buffer_load_dwordx4 a[172:175], v172, s[8:11], s99 offen offset:1024 sc1
buffer_load_dwordx4 a[200:203], v172, s[8:11], s60 offen offset:0 sc1
buffer_load_dwordx4 a[204:207], v172, s[8:11], s60 offen offset:1024 sc1
buffer_load_dwordx4 a[72:75], v152, s[8:11], s23 offen offset:0 sc1
buffer_load_dwordx4 a[76:79], v152, s[8:11], s23 offen offset:1024 sc1
v_lshrrev_b32 v176, 2, v168
v_lshlrev_b32 v176, 8, v176
v_and_b32 v177, 3, v168
v_lshl_add_u32 v176, v177, 3, v176
v_bfe_u32 v177, v168, 2, 3
v_xor_b32 v178, 0, v177
v_lshl_add_u32 v200, v178, 5, v176
v_add_u32 v208, 0x10000, v200
v_add_u32 v216, 0x20000, v200
v_xor_b32 v178, 1, v177
v_lshl_add_u32 v201, v178, 5, v176
v_add_u32 v209, 0x10000, v201
v_add_u32 v217, 0x20000, v201
v_xor_b32 v178, 2, v177
v_lshl_add_u32 v202, v178, 5, v176
v_add_u32 v210, 0x10000, v202
v_add_u32 v218, 0x20000, v202
v_xor_b32 v178, 3, v177
v_lshl_add_u32 v203, v178, 5, v176
v_add_u32 v211, 0x10000, v203
v_add_u32 v219, 0x20000, v203
v_xor_b32 v178, 4, v177
v_lshl_add_u32 v204, v178, 5, v176
v_add_u32 v212, 0x10000, v204
v_add_u32 v220, 0x20000, v204
v_xor_b32 v178, 5, v177
v_lshl_add_u32 v205, v178, 5, v176
v_add_u32 v213, 0x10000, v205
v_add_u32 v221, 0x20000, v205
v_xor_b32 v178, 6, v177
v_lshl_add_u32 v206, v178, 5, v176
v_add_u32 v214, 0x10000, v206
v_add_u32 v222, 0x20000, v206
v_xor_b32 v178, 7, v177
v_lshl_add_u32 v207, v178, 5, v176
v_add_u32 v215, 0x10000, v207
v_add_u32 v223, 0x20000, v207
v_mov_b32 v173, s58
s_mov_b32 s16, s54
s_and_b32 s17, s55, 0xffff
s_mov_b32 s18, 0x400000
s_mov_b32 s19, 0x20000
s_add_u32 s21, s21, s25
s_lshl_b32 s92, s21, 15
s_lshl_b32 s27, s22, 12
s_add_u32 s92, s92, s27
s_add_u32 s93, s92, 0x800000
s_add_u32 s27, s25, 0
s_and_b32 s27, s27, 3
s_lshl_b32 s28, s31, 2
s_add_u32 s27, s27, s28
s_lshl_b32 s27, s27, 2
s_add_u32 s27, s27, s20
s_mul_i32 s28, s27, 12288
s_add_u32 s36, s28, 0x2000000
s_mul_i32 s27, s27, 384
s_add_u32 s94, s27, 0x1d60000
s_add_u32 s94, s94, s57
s_add_u32 s27, s25, 1
s_and_b32 s27, s27, 3
s_lshl_b32 s28, s31, 2
s_add_u32 s27, s27, s28
s_lshl_b32 s27, s27, 2
s_add_u32 s27, s27, s20
s_mul_i32 s28, s27, 12288
s_add_u32 s37, s28, 0x2000000
s_mul_i32 s27, s27, 384
s_add_u32 s95, s27, 0x1d60000
s_add_u32 s95, s95, s57
s_add_u32 s27, s25, 2
s_and_b32 s27, s27, 3
s_lshl_b32 s28, s31, 2
s_add_u32 s27, s27, s28
s_lshl_b32 s27, s27, 2
s_add_u32 s27, s27, s20
s_mul_i32 s28, s27, 12288
s_add_u32 s38, s28, 0x2001000
s_mul_i32 s27, s27, 384
s_add_u32 s96, s27, 0x1d60080
s_add_u32 s96, s96, s57
s_add_u32 s27, s25, 3
s_and_b32 s27, s27, 3
s_lshl_b32 s28, s31, 2
s_add_u32 s27, s27, s28
s_lshl_b32 s27, s27, 2
s_add_u32 s27, s27, s20
s_mul_i32 s28, s27, 12288
s_add_u32 s39, s28, 0x2002000
s_mul_i32 s27, s27, 384
s_add_u32 s97, s27, 0x1d60100
s_add_u32 s97, s97, s57
s_add_u32 s61, s36, 4096
s_add_u32 s62, s36, 8192
s_barrier
ds_read_b64_tr_b16 a[0:1], v200 offset:0
ds_read_b64_tr_b16 a[2:3], v200 offset:4096
ds_read_b64_tr_b16 a[32:33], v200 offset:8192
ds_read_b64_tr_b16 a[34:35], v200 offset:12288
ds_read_b64_tr_b16 a[4:5], v201 offset:0
ds_read_b64_tr_b16 a[6:7], v201 offset:4096
ds_read_b64_tr_b16 a[36:37], v201 offset:8192
ds_read_b64_tr_b16 a[38:39], v201 offset:12288
ds_read_b64_tr_b16 a[8:9], v202 offset:0
ds_read_b64_tr_b16 a[10:11], v202 offset:4096
ds_read_b64_tr_b16 a[40:41], v202 offset:8192
ds_read_b64_tr_b16 a[42:43], v202 offset:12288
s_waitcnt vmcnt(9) lgkmcnt(8)
v_mfma_f32_16x16x32_bf16 v[0:3], a[0:3], a[64:67], 0
s_waitcnt vmcnt(8)
buffer_load_dwordx4 a[144:147], v152, s[8:11], s98 offen offset:0 sc1
ds_read_b64_tr_b16 a[12:13], v203 offset:0
v_mfma_f32_16x16x32_bf16 v[0:3], a[32:35], a[68:71], v[0:3]
s_waitcnt vmcnt(7)
buffer_load_dwordx4 a[148:151], v152, s[8:11], s98 offen offset:1024 sc1
ds_read_b64_tr_b16 a[14:15], v203 offset:4096
v_mfma_f32_16x16x32_bf16 v[32:35], a[32:35], a[140:143], 0
buffer_load_dwordx4 a[176:179], v152, s[8:11], s99 offen offset:0 sc1
ds_read_b64_tr_b16 a[44:45], v203 offset:8192
v_mfma_f32_16x16x32_bf16 v[32:35], a[0:3], a[136:139], v[32:35]
s_waitcnt vmcnt(8)
buffer_load_dwordx4 a[180:183], v152, s[8:11], s99 offen offset:1024 sc1
ds_read_b64_tr_b16 a[46:47], v203 offset:12288
v_mfma_f32_16x16x32_bf16 v[64:67], a[0:3], a[168:171], 0
s_waitcnt vmcnt(8)
buffer_load_dwordx4 a[208:211], v152, s[8:11], s60 offen offset:0 sc1
ds_read_b64_tr_b16 a[16:17], v204 offset:0
v_mfma_f32_16x16x32_bf16 v[64:67], a[32:35], a[172:175], v[64:67]
s_waitcnt vmcnt(7)
buffer_load_dwordx4 a[212:215], v152, s[8:11], s60 offen offset:1024 sc1
ds_read_b64_tr_b16 a[18:19], v204 offset:4096
v_mfma_f32_16x16x32_bf16 v[96:99], a[32:35], a[204:207], 0
buffer_load_dwordx4 a[80:83], v152, s[8:11], s23 offen offset:3072 sc1
ds_read_b64_tr_b16 a[48:49], v204 offset:8192
v_mfma_f32_16x16x32_bf16 v[96:99], a[0:3], a[200:203], v[96:99]
s_waitcnt lgkmcnt(11)
buffer_load_dwordx4 a[84:87], v153, s[8:11], s23 offen offset:0 sc1
ds_read_b64_tr_b16 a[50:51], v204 offset:12288
v_mfma_f32_16x16x32_bf16 v[100:103], a[4:7], a[200:203], 0
buffer_load_dwordx4 a[152:155], v152, s[8:11], s98 offen offset:3072 sc1
ds_read_b64_tr_b16 a[20:21], v205 offset:0
v_mfma_f32_16x16x32_bf16 v[100:103], a[36:39], a[204:207], v[100:103]
buffer_load_dwordx4 a[156:159], v153, s[8:11], s98 offen offset:0 sc1
ds_read_b64_tr_b16 a[22:23], v205 offset:4096
v_mfma_f32_16x16x32_bf16 v[68:71], a[36:39], a[172:175], 0
ds_read_b64_tr_b16 a[52:53], v205 offset:8192
v_mfma_f32_16x16x32_bf16 v[68:71], a[4:7], a[168:171], v[68:71]
ds_read_b64_tr_b16 a[54:55], v205 offset:12288
v_mfma_f32_16x16x32_bf16 v[36:39], a[4:7], a[136:139], 0
ds_read_b64_tr_b16 a[24:25], v206 offset:0
v_mfma_f32_16x16x32_bf16 v[36:39], a[36:39], a[140:143], v[36:39]
ds_read_b64_tr_b16 a[26:27], v206 offset:4096
v_mfma_f32_16x16x32_bf16 v[4:7], a[36:39], a[68:71], 0
ds_read_b64_tr_b16 a[56:57], v206 offset:8192
v_mfma_f32_16x16x32_bf16 v[4:7], a[4:7], a[64:67], v[4:7]
s_waitcnt lgkmcnt(9)
ds_read_b64_tr_b16 a[58:59], v206 offset:12288
v_mfma_f32_16x16x32_bf16 v[8:11], a[8:11], a[64:67], 0
ds_read_b64_tr_b16 a[28:29], v207 offset:0
v_mfma_f32_16x16x32_bf16 v[8:11], a[40:43], a[68:71], v[8:11]
ds_read_b64_tr_b16 a[30:31], v207 offset:4096
v_mfma_f32_16x16x32_bf16 v[40:43], a[40:43], a[140:143], 0
ds_read_b64_tr_b16 a[60:61], v207 offset:8192
v_mfma_f32_16x16x32_bf16 v[40:43], a[8:11], a[136:139], v[40:43]
ds_read_b64_tr_b16 a[62:63], v207 offset:12288
v_mfma_f32_16x16x32_bf16 v[72:75], a[8:11], a[168:171], 0
v_mfma_f32_16x16x32_bf16 v[72:75], a[40:43], a[172:175], v[72:75]
v_mfma_f32_16x16x32_bf16 v[104:107], a[40:43], a[204:207], 0
s_barrier
s_cmp_lg_u32 s20, 3
s_cbranch_scc1 L_k4_np
s_mov_b64 exec, 1
buffer_store_dword v173, off, s[8:11], s100 sc1
s_mov_b64 exec, -1
L_k4_np:
s_mov_b32 s100, s41
ds_read_b64_tr_b16 a[0:1], v200 offset:16384
v_mfma_f32_16x16x32_bf16 v[104:107], a[8:11], a[200:203], v[104:107]
ds_read_b64_tr_b16 a[2:3], v200 offset:20480
v_mfma_f32_16x16x32_bf16 v[108:111], a[12:15], a[200:203], 0
ds_read_b64_tr_b16 a[32:33], v200 offset:24576
v_mfma_f32_16x16x32_bf16 v[108:111], a[44:47], a[204:207], v[108:111]
ds_read_b64_tr_b16 a[34:35], v200 offset:28672
ds_read_b64_tr_b16 a[4:5], v201 offset:16384
v_mfma_f32_16x16x32_bf16 v[76:79], a[44:47], a[172:175], 0
ds_read_b64_tr_b16 a[6:7], v201 offset:20480
ds_read_b64_tr_b16 a[36:37], v201 offset:24576
v_mfma_f32_16x16x32_bf16 v[76:79], a[12:15], a[168:171], v[76:79]
ds_read_b64_tr_b16 a[38:39], v201 offset:28672
ds_read_b64_tr_b16 a[8:9], v202 offset:16384
v_mfma_f32_16x16x32_bf16 v[44:47], a[12:15], a[136:139], 0
ds_read_b64_tr_b16 a[10:11], v202 offset:20480
ds_read_b64_tr_b16 a[40:41], v202 offset:24576
v_mfma_f32_16x16x32_bf16 v[44:47], a[44:47], a[140:143], v[44:47]
ds_read_b64_tr_b16 a[42:43], v202 offset:28672
v_mfma_f32_16x16x32_bf16 v[12:15], a[44:47], a[68:71], 0
v_mfma_f32_16x16x32_bf16 v[12:15], a[12:15], a[64:67], v[12:15]
s_waitcnt lgkmcnt(12)
ds_read_b64_tr_b16 a[12:13], v203 offset:16384
v_mfma_f32_16x16x32_bf16 v[16:19], a[16:19], a[64:67], 0
ds_read_b64_tr_b16 a[14:15], v203 offset:20480
v_mfma_f32_16x16x32_bf16 v[16:19], a[48:51], a[68:71], v[16:19]
ds_read_b64_tr_b16 a[44:45], v203 offset:24576
v_mfma_f32_16x16x32_bf16 v[48:51], a[48:51], a[140:143], 0
ds_read_b64_tr_b16 a[46:47], v203 offset:28672
v_mfma_f32_16x16x32_bf16 v[48:51], a[16:19], a[136:139], v[48:51]
v_mfma_f32_16x16x32_bf16 v[80:83], a[16:19], a[168:171], 0
v_mfma_f32_16x16x32_bf16 v[80:83], a[48:51], a[172:175], v[80:83]
v_mfma_f32_16x16x32_bf16 v[112:115], a[48:51], a[204:207], 0
v_mfma_f32_16x16x32_bf16 v[112:115], a[16:19], a[200:203], v[112:115]
ds_read_b64_tr_b16 a[16:17], v204 offset:16384
v_mfma_f32_16x16x32_bf16 v[116:119], a[20:23], a[200:203], 0
ds_read_b64_tr_b16 a[18:19], v204 offset:20480
v_mfma_f32_16x16x32_bf16 v[116:119], a[52:55], a[204:207], v[116:119]
ds_read_b64_tr_b16 a[48:49], v204 offset:24576
v_mfma_f32_16x16x32_bf16 v[84:87], a[52:55], a[172:175], 0
ds_read_b64_tr_b16 a[50:51], v204 offset:28672
v_mfma_f32_16x16x32_bf16 v[84:87], a[20:23], a[168:171], v[84:87]
v_mfma_f32_16x16x32_bf16 v[52:55], a[20:23], a[136:139], 0
v_mfma_f32_16x16x32_bf16 v[52:55], a[52:55], a[140:143], v[52:55]
buffer_load_dwordx4 a[184:187], v152, s[8:11], s99 offen offset:3072 sc1
v_mfma_f32_16x16x32_bf16 v[20:23], a[52:55], a[68:71], 0
v_mfma_f32_16x16x32_bf16 v[20:23], a[20:23], a[64:67], v[20:23]
ds_read_b64_tr_b16 a[20:21], v205 offset:16384
v_mfma_f32_16x16x32_bf16 v[24:27], a[24:27], a[64:67], 0
ds_read_b64_tr_b16 a[22:23], v205 offset:20480
v_mfma_f32_16x16x32_bf16 v[24:27], a[56:59], a[68:71], v[24:27]
ds_read_b64_tr_b16 a[52:53], v205 offset:24576
v_mfma_f32_16x16x32_bf16 v[56:59], a[56:59], a[140:143], 0
buffer_load_dwordx4 a[188:191], v153, s[8:11], s99 offen offset:0 sc1
ds_read_b64_tr_b16 a[54:55], v205 offset:28672
v_mfma_f32_16x16x32_bf16 v[56:59], a[24:27], a[136:139], v[56:59]
v_mfma_f32_16x16x32_bf16 v[88:91], a[24:27], a[168:171], 0
v_mfma_f32_16x16x32_bf16 v[88:91], a[56:59], a[172:175], v[88:91]
v_mfma_f32_16x16x32_bf16 v[120:123], a[56:59], a[204:207], 0
buffer_load_dwordx4 a[216:219], v152, s[8:11], s60 offen offset:3072 sc1
v_mfma_f32_16x16x32_bf16 v[120:123], a[24:27], a[200:203], v[120:123]
ds_read_b64_tr_b16 a[24:25], v206 offset:16384
v_mfma_f32_16x16x32_bf16 v[124:127], a[28:31], a[200:203], 0
ds_read_b64_tr_b16 a[26:27], v206 offset:20480
v_mfma_f32_16x16x32_bf16 v[124:127], a[60:63], a[204:207], v[124:127]
ds_read_b64_tr_b16 a[56:57], v206 offset:24576
v_mfma_f32_16x16x32_bf16 v[92:95], a[60:63], a[172:175], 0
ds_read_b64_tr_b16 a[58:59], v206 offset:28672
v_mfma_f32_16x16x32_bf16 v[92:95], a[28:31], a[168:171], v[92:95]
buffer_load_dwordx4 a[220:223], v153, s[8:11], s60 offen offset:0 sc1
v_mfma_f32_16x16x32_bf16 v[60:63], a[28:31], a[136:139], 0
v_mfma_f32_16x16x32_bf16 v[60:63], a[60:63], a[140:143], v[60:63]
v_mfma_f32_16x16x32_bf16 v[28:31], a[60:63], a[68:71], 0
v_mfma_f32_16x16x32_bf16 v[28:31], a[28:31], a[64:67], v[28:31]
s_waitcnt vmcnt(15) lgkmcnt(4)
buffer_load_dwordx4 a[88:91], v153, s[8:11], s23 offen offset:3072 sc1
ds_read_b64_tr_b16 a[28:29], v207 offset:16384
v_mfma_f32_16x16x32_bf16 v[0:3], a[0:3], a[72:75], v[0:3]
s_waitcnt vmcnt(15)
ds_read_b64_tr_b16 a[30:31], v207 offset:20480
v_mfma_f32_16x16x32_bf16 v[0:3], a[32:35], a[76:79], v[0:3]
s_waitcnt vmcnt(13)
ds_read_b64_tr_b16 a[60:61], v207 offset:24576
v_mfma_f32_16x16x32_bf16 v[32:35], a[32:35], a[148:151], v[32:35]
ds_read_b64_tr_b16 a[62:63], v207 offset:28672
v_mfma_f32_16x16x32_bf16 v[32:35], a[0:3], a[144:147], v[32:35]
s_waitcnt vmcnt(12)
v_mfma_f32_16x16x32_bf16 v[64:67], a[0:3], a[176:179], v[64:67]
s_waitcnt vmcnt(11)
buffer_load_dwordx4 a[92:95], v154, s[8:11], s23 offen offset:0 sc1
v_mfma_f32_16x16x32_bf16 v[64:67], a[32:35], a[180:183], v[64:67]
s_waitcnt vmcnt(10)
buffer_load_dwordx4 a[160:163], v153, s[8:11], s98 offen offset:3072 sc1
v_mfma_f32_16x16x32_bf16 v[96:99], a[32:35], a[212:215], v[96:99]
buffer_load_dwordx4 a[164:167], v154, s[8:11], s98 offen offset:0 sc1
v_mfma_f32_16x16x32_bf16 v[96:99], a[0:3], a[208:211], v[96:99]
s_barrier
ds_read_b64_tr_b16 a[0:1], v208 offset:49152
v_mfma_f32_16x16x32_bf16 v[100:103], a[4:7], a[208:211], v[100:103]
ds_read_b64_tr_b16 a[2:3], v208 offset:53248
v_mfma_f32_16x16x32_bf16 v[100:103], a[36:39], a[212:215], v[100:103]
ds_read_b64_tr_b16 a[32:33], v208 offset:57344
v_mfma_f32_16x16x32_bf16 v[68:71], a[36:39], a[180:183], v[68:71]
ds_read_b64_tr_b16 a[34:35], v208 offset:61440
v_mfma_f32_16x16x32_bf16 v[68:71], a[4:7], a[176:179], v[68:71]
v_mfma_f32_16x16x32_bf16 v[36:39], a[4:7], a[144:147], v[36:39]
v_mfma_f32_16x16x32_bf16 v[36:39], a[36:39], a[148:151], v[36:39]
v_mfma_f32_16x16x32_bf16 v[4:7], a[36:39], a[76:79], v[4:7]
v_mfma_f32_16x16x32_bf16 v[4:7], a[4:7], a[72:75], v[4:7]
ds_read_b64_tr_b16 a[4:5], v209 offset:49152
v_mfma_f32_16x16x32_bf16 v[8:11], a[8:11], a[72:75], v[8:11]
ds_read_b64_tr_b16 a[6:7], v209 offset:53248
v_mfma_f32_16x16x32_bf16 v[8:11], a[40:43], a[76:79], v[8:11]
buffer_load_dwordx4 a[192:195], v153, s[8:11], s99 offen offset:3072 sc1
ds_read_b64_tr_b16 a[36:37], v209 offset:57344
v_mfma_f32_16x16x32_bf16 v[40:43], a[40:43], a[148:151], v[40:43]
ds_read_b64_tr_b16 a[38:39], v209 offset:61440
v_mfma_f32_16x16x32_bf16 v[40:43], a[8:11], a[144:147], v[40:43]
v_mfma_f32_16x16x32_bf16 v[72:75], a[8:11], a[176:179], v[72:75]
v_mfma_f32_16x16x32_bf16 v[72:75], a[40:43], a[180:183], v[72:75]
v_mfma_f32_16x16x32_bf16 v[104:107], a[40:43], a[212:215], v[104:107]
buffer_load_dwordx4 a[196:199], v154, s[8:11], s99 offen offset:0 sc1
v_mfma_f32_16x16x32_bf16 v[104:107], a[8:11], a[208:211], v[104:107]
ds_read_b64_tr_b16 a[8:9], v210 offset:49152
v_mfma_f32_16x16x32_bf16 v[108:111], a[12:15], a[208:211], v[108:111]
ds_read_b64_tr_b16 a[10:11], v210 offset:53248
v_mfma_f32_16x16x32_bf16 v[108:111], a[44:47], a[212:215], v[108:111]
ds_read_b64_tr_b16 a[40:41], v210 offset:57344
v_mfma_f32_16x16x32_bf16 v[76:79], a[44:47], a[180:183], v[76:79]
buffer_load_dwordx4 a[224:227], v153, s[8:11], s60 offen offset:3072 sc1
ds_read_b64_tr_b16 a[42:43], v210 offset:61440
v_mfma_f32_16x16x32_bf16 v[76:79], a[12:15], a[176:179], v[76:79]
v_mfma_f32_16x16x32_bf16 v[44:47], a[12:15], a[144:147], v[44:47]
v_mfma_f32_16x16x32_bf16 v[44:47], a[44:47], a[148:151], v[44:47]
v_mfma_f32_16x16x32_bf16 v[12:15], a[44:47], a[76:79], v[12:15]
v_mfma_f32_16x16x32_bf16 v[12:15], a[12:15], a[72:75], v[12:15]
buffer_load_dwordx4 a[228:231], v154, s[8:11], s60 offen offset:0 sc1
ds_read_b64_tr_b16 a[12:13], v211 offset:49152
v_mfma_f32_16x16x32_bf16 v[16:19], a[16:19], a[72:75], v[16:19]
ds_read_b64_tr_b16 a[14:15], v211 offset:53248
v_mfma_f32_16x16x32_bf16 v[16:19], a[48:51], a[76:79], v[16:19]
ds_read_b64_tr_b16 a[44:45], v211 offset:57344
v_mfma_f32_16x16x32_bf16 v[48:51], a[48:51], a[148:151], v[48:51]
ds_read_b64_tr_b16 a[46:47], v211 offset:61440
v_mfma_f32_16x16x32_bf16 v[48:51], a[16:19], a[144:147], v[48:51]
buffer_load_dwordx4 a[96:99], v154, s[8:11], s23 offen offset:2048 sc1
v_mfma_f32_16x16x32_bf16 v[80:83], a[16:19], a[176:179], v[80:83]
v_mfma_f32_16x16x32_bf16 v[80:83], a[48:51], a[180:183], v[80:83]
v_mfma_f32_16x16x32_bf16 v[112:115], a[48:51], a[212:215], v[112:115]
v_mfma_f32_16x16x32_bf16 v[112:115], a[16:19], a[208:211], v[112:115]
ds_read_b64_tr_b16 a[16:17], v212 offset:49152
v_mfma_f32_16x16x32_bf16 v[116:119], a[20:23], a[208:211], v[116:119]
buffer_load_dwordx4 a[100:103], v154, s[8:11], s23 offen offset:3072 sc1
ds_read_b64_tr_b16 a[18:19], v212 offset:53248
v_mfma_f32_16x16x32_bf16 v[116:119], a[52:55], a[212:215], v[116:119]
ds_read_b64_tr_b16 a[48:49], v212 offset:57344
v_mfma_f32_16x16x32_bf16 v[84:87], a[52:55], a[180:183], v[84:87]
ds_read_b64_tr_b16 a[50:51], v212 offset:61440
v_mfma_f32_16x16x32_bf16 v[84:87], a[20:23], a[176:179], v[84:87]
v_mfma_f32_16x16x32_bf16 v[52:55], a[20:23], a[144:147], v[52:55]
buffer_load_dwordx4 a[136:139], v154, s[8:11], s98 offen offset:2048 sc1
v_mfma_f32_16x16x32_bf16 v[52:55], a[52:55], a[148:151], v[52:55]
v_mfma_f32_16x16x32_bf16 v[20:23], a[52:55], a[76:79], v[20:23]
v_mfma_f32_16x16x32_bf16 v[20:23], a[20:23], a[72:75], v[20:23]
s_waitcnt lgkmcnt(4)
ds_read_b64_tr_b16 a[20:21], v213 offset:49152
v_mfma_f32_16x16x32_bf16 v[24:27], a[24:27], a[72:75], v[24:27]
ds_read_b64_tr_b16 a[22:23], v213 offset:53248
v_mfma_f32_16x16x32_bf16 v[24:27], a[56:59], a[76:79], v[24:27]
buffer_load_dwordx4 a[140:143], v154, s[8:11], s98 offen offset:3072 sc1
ds_read_b64_tr_b16 a[52:53], v213 offset:57344
v_mfma_f32_16x16x32_bf16 v[56:59], a[56:59], a[148:151], v[56:59]
ds_read_b64_tr_b16 a[54:55], v213 offset:61440
v_mfma_f32_16x16x32_bf16 v[56:59], a[24:27], a[144:147], v[56:59]
v_mfma_f32_16x16x32_bf16 v[88:91], a[24:27], a[176:179], v[88:91]
v_mfma_f32_16x16x32_bf16 v[88:91], a[56:59], a[180:183], v[88:91]
buffer_load_dwordx4 a[168:171], v154, s[8:11], s99 offen offset:2048 sc1
v_mfma_f32_16x16x32_bf16 v[120:123], a[56:59], a[212:215], v[120:123]
v_mfma_f32_16x16x32_bf16 v[120:123], a[24:27], a[208:211], v[120:123]
ds_read_b64_tr_b16 a[24:25], v214 offset:49152
v_mfma_f32_16x16x32_bf16 v[124:127], a[28:31], a[208:211], v[124:127]
ds_read_b64_tr_b16 a[26:27], v214 offset:53248
v_mfma_f32_16x16x32_bf16 v[124:127], a[60:63], a[212:215], v[124:127]
ds_read_b64_tr_b16 a[56:57], v214 offset:57344
v_mfma_f32_16x16x32_bf16 v[92:95], a[60:63], a[180:183], v[92:95]
buffer_load_dwordx4 a[172:175], v154, s[8:11], s99 offen offset:3072 sc1
ds_read_b64_tr_b16 a[58:59], v214 offset:61440
v_mfma_f32_16x16x32_bf16 v[92:95], a[28:31], a[176:179], v[92:95]
v_mfma_f32_16x16x32_bf16 v[60:63], a[28:31], a[144:147], v[60:63]
v_mfma_f32_16x16x32_bf16 v[60:63], a[60:63], a[148:151], v[60:63]
v_mfma_f32_16x16x32_bf16 v[28:31], a[60:63], a[76:79], v[28:31]
buffer_load_dwordx4 a[200:203], v154, s[8:11], s60 offen offset:2048 sc1
v_mfma_f32_16x16x32_bf16 v[28:31], a[28:31], a[72:75], v[28:31]
s_waitcnt vmcnt(21)
ds_read_b64_tr_b16 a[28:29], v215 offset:49152
v_mfma_f32_16x16x32_bf16 v[0:3], a[0:3], a[80:83], v[0:3]
ds_read_b64_tr_b16 a[30:31], v215 offset:53248
v_mfma_f32_16x16x32_bf16 v[0:3], a[32:35], a[84:87], v[0:3]
s_waitcnt vmcnt(19)
ds_read_b64_tr_b16 a[60:61], v215 offset:57344
v_mfma_f32_16x16x32_bf16 v[32:35], a[32:35], a[156:159], v[32:35]
ds_read_b64_tr_b16 a[62:63], v215 offset:61440
v_mfma_f32_16x16x32_bf16 v[32:35], a[0:3], a[152:155], v[32:35]
s_waitcnt vmcnt(18)
buffer_load_dwordx4 a[204:207], v154, s[8:11], s60 offen offset:3072 sc1
v_mfma_f32_16x16x32_bf16 v[64:67], a[0:3], a[184:187], v[64:67]
s_waitcnt vmcnt(18)
v_mfma_f32_16x16x32_bf16 v[64:67], a[32:35], a[188:191], v[64:67]
s_waitcnt vmcnt(16)
v_mfma_f32_16x16x32_bf16 v[96:99], a[32:35], a[220:223], v[96:99]
v_mfma_f32_16x16x32_bf16 v[96:99], a[0:3], a[216:219], v[96:99]
s_barrier
buffer_load_dwordx4 a[144:147], v155, s[8:11], s98 offen offset:2048 sc1
ds_read_b64_tr_b16 a[0:1], v216 offset:0
v_mfma_f32_16x16x32_bf16 v[100:103], a[4:7], a[216:219], v[100:103]
ds_read_b64_tr_b16 a[2:3], v216 offset:4096
v_mfma_f32_16x16x32_bf16 v[100:103], a[36:39], a[220:223], v[100:103]
ds_read_b64_tr_b16 a[32:33], v216 offset:8192
v_mfma_f32_16x16x32_bf16 v[68:71], a[36:39], a[188:191], v[68:71]
ds_read_b64_tr_b16 a[34:35], v216 offset:12288
v_mfma_f32_16x16x32_bf16 v[68:71], a[4:7], a[184:187], v[68:71]
v_mfma_f32_16x16x32_bf16 v[36:39], a[4:7], a[152:155], v[36:39]
buffer_load_dwordx4 a[148:151], v155, s[8:11], s98 offen offset:3072 sc1
v_mfma_f32_16x16x32_bf16 v[36:39], a[36:39], a[156:159], v[36:39]
v_mfma_f32_16x16x32_bf16 v[4:7], a[36:39], a[84:87], v[4:7]
v_mfma_f32_16x16x32_bf16 v[4:7], a[4:7], a[80:83], v[4:7]
ds_read_b64_tr_b16 a[4:5], v217 offset:0
v_mfma_f32_16x16x32_bf16 v[8:11], a[8:11], a[80:83], v[8:11]
buffer_load_dwordx4 a[176:179], v155, s[8:11], s99 offen offset:2048 sc1
ds_read_b64_tr_b16 a[6:7], v217 offset:4096
v_mfma_f32_16x16x32_bf16 v[8:11], a[40:43], a[84:87], v[8:11]
ds_read_b64_tr_b16 a[36:37], v217 offset:8192
v_mfma_f32_16x16x32_bf16 v[40:43], a[40:43], a[156:159], v[40:43]
ds_read_b64_tr_b16 a[38:39], v217 offset:12288
v_mfma_f32_16x16x32_bf16 v[40:43], a[8:11], a[152:155], v[40:43]
v_mfma_f32_16x16x32_bf16 v[72:75], a[8:11], a[184:187], v[72:75]
v_mfma_f32_16x16x32_bf16 v[72:75], a[40:43], a[188:191], v[72:75]
buffer_load_dwordx4 a[180:183], v155, s[8:11], s99 offen offset:3072 sc1
v_mfma_f32_16x16x32_bf16 v[104:107], a[40:43], a[220:223], v[104:107]
v_mfma_f32_16x16x32_bf16 v[104:107], a[8:11], a[216:219], v[104:107]
ds_read_b64_tr_b16 a[8:9], v218 offset:0
v_mfma_f32_16x16x32_bf16 v[108:111], a[12:15], a[216:219], v[108:111]
ds_read_b64_tr_b16 a[10:11], v218 offset:4096
v_mfma_f32_16x16x32_bf16 v[108:111], a[44:47], a[220:223], v[108:111]
buffer_load_dwordx4 a[208:211], v155, s[8:11], s60 offen offset:2048 sc1
ds_read_b64_tr_b16 a[40:41], v218 offset:8192
v_mfma_f32_16x16x32_bf16 v[76:79], a[44:47], a[188:191], v[76:79]
ds_read_b64_tr_b16 a[42:43], v218 offset:12288
v_mfma_f32_16x16x32_bf16 v[76:79], a[12:15], a[184:187], v[76:79]
v_mfma_f32_16x16x32_bf16 v[44:47], a[12:15], a[152:155], v[44:47]
v_mfma_f32_16x16x32_bf16 v[44:47], a[44:47], a[156:159], v[44:47]
v_mfma_f32_16x16x32_bf16 v[12:15], a[44:47], a[84:87], v[12:15]
buffer_load_dwordx4 a[212:215], v155, s[8:11], s60 offen offset:3072 sc1
v_mfma_f32_16x16x32_bf16 v[12:15], a[12:15], a[80:83], v[12:15]
s_waitcnt lgkmcnt(4)
ds_read_b64_tr_b16 a[12:13], v219 offset:0
v_mfma_f32_16x16x32_bf16 v[16:19], a[16:19], a[80:83], v[16:19]
ds_read_b64_tr_b16 a[14:15], v219 offset:4096
v_mfma_f32_16x16x32_bf16 v[16:19], a[48:51], a[84:87], v[16:19]
ds_read_b64_tr_b16 a[44:45], v219 offset:8192
v_mfma_f32_16x16x32_bf16 v[48:51], a[48:51], a[156:159], v[48:51]
buffer_load_dword v190, v191, s[8:11], s40 offen sc1
ds_read_b64_tr_b16 a[46:47], v219 offset:12288
v_mfma_f32_16x16x32_bf16 v[48:51], a[16:19], a[152:155], v[48:51]
v_mfma_f32_16x16x32_bf16 v[80:83], a[16:19], a[184:187], v[80:83]
v_mfma_f32_16x16x32_bf16 v[80:83], a[48:51], a[188:191], v[80:83]
v_mfma_f32_16x16x32_bf16 v[112:115], a[48:51], a[220:223], v[112:115]
v_mfma_f32_16x16x32_bf16 v[112:115], a[16:19], a[216:219], v[112:115]
buffer_load_dwordx4 v244, s[12:15], 0 offen offset:0 lds
ds_read_b64_tr_b16 a[16:17], v220 offset:0
v_add_u32 v244, 0x40000, v244
v_mfma_f32_16x16x32_bf16 v[116:119], a[20:23], a[216:219], v[116:119]
ds_read_b64_tr_b16 a[18:19], v220 offset:4096
v_mfma_f32_16x16x32_bf16 v[116:119], a[52:55], a[220:223], v[116:119]
ds_read_b64_tr_b16 a[48:49], v220 offset:8192
v_mfma_f32_16x16x32_bf16 v[84:87], a[52:55], a[188:191], v[84:87]
ds_read_b64_tr_b16 a[50:51], v220 offset:12288
v_mfma_f32_16x16x32_bf16 v[84:87], a[20:23], a[184:187], v[84:87]
buffer_load_dwordx4 v245, s[12:15], 0 offen offset:1024 lds
v_add_u32 v245, 0x40000, v245
v_mfma_f32_16x16x32_bf16 v[52:55], a[20:23], a[152:155], v[52:55]
v_mfma_f32_16x16x32_bf16 v[52:55], a[52:55], a[156:159], v[52:55]
v_mfma_f32_16x16x32_bf16 v[20:23], a[52:55], a[84:87], v[20:23]
v_mfma_f32_16x16x32_bf16 v[20:23], a[20:23], a[80:83], v[20:23]
ds_read_b64_tr_b16 a[20:21], v221 offset:0
v_mfma_f32_16x16x32_bf16 v[24:27], a[24:27], a[80:83], v[24:27]
buffer_load_dwordx4 v246, s[12:15], 0 offen offset:2048 lds
ds_read_b64_tr_b16 a[22:23], v221 offset:4096
v_add_u32 v246, 0x40000, v246
v_mfma_f32_16x16x32_bf16 v[24:27], a[56:59], a[84:87], v[24:27]
ds_read_b64_tr_b16 a[52:53], v221 offset:8192
v_mfma_f32_16x16x32_bf16 v[56:59], a[56:59], a[156:159], v[56:59]
ds_read_b64_tr_b16 a[54:55], v221 offset:12288
v_mfma_f32_16x16x32_bf16 v[56:59], a[24:27], a[152:155], v[56:59]
v_mfma_f32_16x16x32_bf16 v[88:91], a[24:27], a[184:187], v[88:91]
buffer_load_dwordx4 v247, s[12:15], 0 offen offset:3072 lds
v_add_u32 v247, 0x40000, v247
v_mfma_f32_16x16x32_bf16 v[88:91], a[56:59], a[188:191], v[88:91]
s_add_u32 m0, s24, 0x14000
v_mfma_f32_16x16x32_bf16 v[120:123], a[56:59], a[220:223], v[120:123]
v_mfma_f32_16x16x32_bf16 v[120:123], a[24:27], a[216:219], v[120:123]
ds_read_b64_tr_b16 a[24:25], v222 offset:0
v_mfma_f32_16x16x32_bf16 v[124:127], a[28:31], a[216:219], v[124:127]
ds_read_b64_tr_b16 a[26:27], v222 offset:4096
v_mfma_f32_16x16x32_bf16 v[124:127], a[60:63], a[220:223], v[124:127]
buffer_load_dwordx4 a[216:219], v156, s[8:11], s60 offen offset:1024 sc1
ds_read_b64_tr_b16 a[56:57], v222 offset:8192
v_mfma_f32_16x16x32_bf16 v[92:95], a[60:63], a[188:191], v[92:95]
ds_read_b64_tr_b16 a[58:59], v222 offset:12288
v_mfma_f32_16x16x32_bf16 v[92:95], a[28:31], a[184:187], v[92:95]
v_mfma_f32_16x16x32_bf16 v[60:63], a[28:31], a[152:155], v[60:63]
v_mfma_f32_16x16x32_bf16 v[60:63], a[60:63], a[156:159], v[60:63]
buffer_load_dwordx4 a[152:155], v156, s[8:11], s98 offen offset:1024 sc1
v_mfma_f32_16x16x32_bf16 v[28:31], a[60:63], a[84:87], v[28:31]
v_mfma_f32_16x16x32_bf16 v[28:31], a[28:31], a[80:83], v[28:31]
s_waitcnt vmcnt(25)
ds_read_b64_tr_b16 a[28:29], v223 offset:0
v_mfma_f32_16x16x32_bf16 v[0:3], a[0:3], a[88:91], v[0:3]
ds_read_b64_tr_b16 a[30:31], v223 offset:4096
v_mfma_f32_16x16x32_bf16 v[0:3], a[32:35], a[92:95], v[0:3]
ds_read_b64_tr_b16 a[60:61], v223 offset:8192
v_mfma_f32_16x16x32_bf16 v[32:35], a[32:35], a[164:167], v[32:35]
buffer_load_dwordx4 a[156:159], v156, s[8:11], s98 offen offset:2048 sc1
ds_read_b64_tr_b16 a[62:63], v223 offset:12288
v_mfma_f32_16x16x32_bf16 v[32:35], a[0:3], a[160:163], v[32:35]
s_waitcnt vmcnt(25)
v_mfma_f32_16x16x32_bf16 v[64:67], a[0:3], a[192:195], v[64:67]
s_waitcnt vmcnt(24)
v_mfma_f32_16x16x32_bf16 v[64:67], a[32:35], a[196:199], v[64:67]
s_waitcnt vmcnt(22)
v_mfma_f32_16x16x32_bf16 v[96:99], a[32:35], a[228:231], v[96:99]
buffer_load_dwordx4 a[184:187], v156, s[8:11], s99 offen offset:1024 sc1
v_mfma_f32_16x16x32_bf16 v[96:99], a[0:3], a[224:227], v[96:99]
s_barrier
ds_read_b64_tr_b16 a[0:1], v216 offset:16384
v_mfma_f32_16x16x32_bf16 v[100:103], a[4:7], a[224:227], v[100:103]
ds_read_b64_tr_b16 a[2:3], v216 offset:20480
v_mfma_f32_16x16x32_bf16 v[100:103], a[36:39], a[228:231], v[100:103]
ds_read_b64_tr_b16 a[32:33], v216 offset:24576
v_mfma_f32_16x16x32_bf16 v[68:71], a[36:39], a[196:199], v[68:71]
ds_read_b64_tr_b16 a[34:35], v216 offset:28672
v_mfma_f32_16x16x32_bf16 v[68:71], a[4:7], a[192:195], v[68:71]
buffer_load_dwordx4 a[188:191], v156, s[8:11], s99 offen offset:2048 sc1
v_mfma_f32_16x16x32_bf16 v[36:39], a[4:7], a[160:163], v[36:39]
v_mfma_f32_16x16x32_bf16 v[36:39], a[36:39], a[164:167], v[36:39]
v_mfma_f32_16x16x32_bf16 v[4:7], a[36:39], a[92:95], v[4:7]
v_mfma_f32_16x16x32_bf16 v[4:7], a[4:7], a[88:91], v[4:7]
s_waitcnt lgkmcnt(4)
buffer_load_dwordx4 a[220:223], v156, s[8:11], s60 offen offset:2048 sc1
ds_read_b64_tr_b16 a[4:5], v217 offset:16384
v_mfma_f32_16x16x32_bf16 v[8:11], a[8:11], a[88:91], v[8:11]
ds_read_b64_tr_b16 a[6:7], v217 offset:20480
v_mfma_f32_16x16x32_bf16 v[8:11], a[40:43], a[92:95], v[8:11]
ds_read_b64_tr_b16 a[36:37], v217 offset:24576
v_mfma_f32_16x16x32_bf16 v[40:43], a[40:43], a[164:167], v[40:43]
ds_read_b64_tr_b16 a[38:39], v217 offset:28672
v_mfma_f32_16x16x32_bf16 v[40:43], a[8:11], a[160:163], v[40:43]
v_mfma_f32_16x16x32_bf16 v[72:75], a[8:11], a[192:195], v[72:75]
buffer_load_dwordx4 v244, s[12:15], 0 offen offset:0 lds
v_add_u32 v244, 0xffe90000, v244
v_mfma_f32_16x16x32_bf16 v[72:75], a[40:43], a[196:199], v[72:75]
v_mfma_f32_16x16x32_bf16 v[104:107], a[40:43], a[228:231], v[104:107]
v_mfma_f32_16x16x32_bf16 v[104:107], a[8:11], a[224:227], v[104:107]
ds_read_b64_tr_b16 a[8:9], v218 offset:16384
v_mfma_f32_16x16x32_bf16 v[108:111], a[12:15], a[224:227], v[108:111]
buffer_load_dwordx4 v245, s[12:15], 0 offen offset:1024 lds
ds_read_b64_tr_b16 a[10:11], v218 offset:20480
v_add_u32 v245, 0xffe90000, v245
v_mfma_f32_16x16x32_bf16 v[108:111], a[44:47], a[228:231], v[108:111]
ds_read_b64_tr_b16 a[40:41], v218 offset:24576
v_mfma_f32_16x16x32_bf16 v[76:79], a[44:47], a[196:199], v[76:79]
ds_read_b64_tr_b16 a[42:43], v218 offset:28672
v_mfma_f32_16x16x32_bf16 v[76:79], a[12:15], a[192:195], v[76:79]
v_mfma_f32_16x16x32_bf16 v[44:47], a[12:15], a[160:163], v[44:47]
v_mfma_f32_16x16x32_bf16 v[44:47], a[44:47], a[164:167], v[44:47]
buffer_load_dwordx4 v246, s[12:15], 0 offen offset:2048 lds
v_add_u32 v246, 0xffe90000, v246
v_mfma_f32_16x16x32_bf16 v[12:15], a[44:47], a[92:95], v[12:15]
v_mfma_f32_16x16x32_bf16 v[12:15], a[12:15], a[88:91], v[12:15]
ds_read_b64_tr_b16 a[12:13], v219 offset:16384
v_mfma_f32_16x16x32_bf16 v[16:19], a[16:19], a[88:91], v[16:19]
ds_read_b64_tr_b16 a[14:15], v219 offset:20480
v_mfma_f32_16x16x32_bf16 v[16:19], a[48:51], a[92:95], v[16:19]
buffer_load_dwordx4 v247, s[12:15], 0 offen offset:3072 lds
ds_read_b64_tr_b16 a[44:45], v219 offset:24576
v_add_u32 v247, 0xffe90000, v247
v_mfma_f32_16x16x32_bf16 v[48:51], a[48:51], a[164:167], v[48:51]
s_add_u32 m0, s24, 0x18000
ds_read_b64_tr_b16 a[46:47], v219 offset:28672
v_mfma_f32_16x16x32_bf16 v[48:51], a[16:19], a[160:163], v[48:51]
v_mfma_f32_16x16x32_bf16 v[80:83], a[16:19], a[192:195], v[80:83]
v_mfma_f32_16x16x32_bf16 v[80:83], a[48:51], a[196:199], v[80:83]
v_mfma_f32_16x16x32_bf16 v[112:115], a[48:51], a[228:231], v[112:115]
s_waitcnt vmcnt(14)
v_cmp_ne_u32 s[46:47], s58, v190
s_nop 4
s_cmp_eq_u64 s[46:47], 0
s_cbranch_scc1 L_k4l_go
s_mov_b32 s56, 0x100000
L_k4l_poll:
buffer_load_dword v190, v191, s[8:11], s40 offen sc1
s_waitcnt vmcnt(0)
v_cmp_ne_u32 s[46:47], s58, v190
s_nop 4
s_cmp_eq_u64 s[46:47], 0
s_cbranch_scc1 L_k4l_go
s_sleep 1
s_sub_u32 s56, s56, 1
s_cbranch_scc0 L_k4l_poll
L_k4l_go:
buffer_load_dwordx4 v244, s[12:15], 0 offen offset:0 lds
v_add_u32 v244, 0x70000, v244
v_mfma_f32_16x16x32_bf16 v[112:115], a[16:19], a[224:227], v[112:115]
ds_read_b64_tr_b16 a[16:17], v220 offset:16384
v_mfma_f32_16x16x32_bf16 v[116:119], a[20:23], a[224:227], v[116:119]
ds_read_b64_tr_b16 a[18:19], v220 offset:20480
v_mfma_f32_16x16x32_bf16 v[116:119], a[52:55], a[228:231], v[116:119]
ds_read_b64_tr_b16 a[48:49], v220 offset:24576
v_mfma_f32_16x16x32_bf16 v[84:87], a[52:55], a[196:199], v[84:87]
buffer_load_dwordx4 v245, s[12:15], 0 offen offset:1024 lds
ds_read_b64_tr_b16 a[50:51], v220 offset:28672
v_add_u32 v245, 0x70000, v245
v_mfma_f32_16x16x32_bf16 v[84:87], a[20:23], a[192:195], v[84:87]
v_mfma_f32_16x16x32_bf16 v[52:55], a[20:23], a[160:163], v[52:55]
v_mfma_f32_16x16x32_bf16 v[52:55], a[52:55], a[164:167], v[52:55]
v_mfma_f32_16x16x32_bf16 v[20:23], a[52:55], a[92:95], v[20:23]
v_mfma_f32_16x16x32_bf16 v[20:23], a[20:23], a[88:91], v[20:23]
buffer_load_dwordx4 v246, s[12:15], 0 offen offset:2048 lds
ds_read_b64_tr_b16 a[20:21], v221 offset:16384
v_add_u32 v246, 0x70000, v246
v_mfma_f32_16x16x32_bf16 v[24:27], a[24:27], a[88:91], v[24:27]
ds_read_b64_tr_b16 a[22:23], v221 offset:20480
v_mfma_f32_16x16x32_bf16 v[24:27], a[56:59], a[92:95], v[24:27]
ds_read_b64_tr_b16 a[52:53], v221 offset:24576
v_mfma_f32_16x16x32_bf16 v[56:59], a[56:59], a[164:167], v[56:59]
ds_read_b64_tr_b16 a[54:55], v221 offset:28672
v_mfma_f32_16x16x32_bf16 v[56:59], a[24:27], a[160:163], v[56:59]
buffer_load_dwordx4 v247, s[12:15], 0 offen offset:3072 lds
v_add_u32 v247, 0x70000, v247
v_mfma_f32_16x16x32_bf16 v[88:91], a[24:27], a[192:195], v[88:91]
s_add_u32 m0, s24, 0x8000
v_mfma_f32_16x16x32_bf16 v[88:91], a[56:59], a[196:199], v[88:91]
v_mfma_f32_16x16x32_bf16 v[120:123], a[56:59], a[228:231], v[120:123]
v_mfma_f32_16x16x32_bf16 v[120:123], a[24:27], a[224:227], v[120:123]
ds_read_b64_tr_b16 a[24:25], v222 offset:16384
v_mfma_f32_16x16x32_bf16 v[124:127], a[28:31], a[224:227], v[124:127]
buffer_load_dwordx4 a[224:227], v157, s[8:11], s60 offen offset:1024 sc1
ds_read_b64_tr_b16 a[26:27], v222 offset:20480
v_mfma_f32_16x16x32_bf16 v[124:127], a[60:63], a[228:231], v[124:127]
ds_read_b64_tr_b16 a[56:57], v222 offset:24576
v_mfma_f32_16x16x32_bf16 v[92:95], a[60:63], a[196:199], v[92:95]
ds_read_b64_tr_b16 a[58:59], v222 offset:28672
v_mfma_f32_16x16x32_bf16 v[92:95], a[28:31], a[192:195], v[92:95]
v_mfma_f32_16x16x32_bf16 v[60:63], a[28:31], a[160:163], v[60:63]
buffer_load_dwordx4 a[160:163], v157, s[8:11], s98 offen offset:1024 sc1
v_mfma_f32_16x16x32_bf16 v[60:63], a[60:63], a[164:167], v[60:63]
v_mfma_f32_16x16x32_bf16 v[28:31], a[60:63], a[92:95], v[28:31]
v_mfma_f32_16x16x32_bf16 v[28:31], a[28:31], a[88:91], v[28:31]
s_waitcnt lgkmcnt(4)
ds_read_b64_tr_b16 a[28:29], v223 offset:16384
v_mfma_f32_16x16x32_bf16 v[0:3], a[0:3], a[96:99], v[0:3]
ds_read_b64_tr_b16 a[30:31], v223 offset:20480
v_mfma_f32_16x16x32_bf16 v[0:3], a[32:35], a[100:103], v[0:3]
buffer_load_dwordx4 a[164:167], v157, s[8:11], s98 offen offset:2048 sc1
ds_read_b64_tr_b16 a[60:61], v223 offset:24576
v_mfma_f32_16x16x32_bf16 v[32:35], a[32:35], a[140:143], v[32:35]
ds_read_b64_tr_b16 a[62:63], v223 offset:28672
v_mfma_f32_16x16x32_bf16 v[32:35], a[0:3], a[136:139], v[32:35]
v_mfma_f32_16x16x32_bf16 v[64:67], a[0:3], a[168:171], v[64:67]
v_mfma_f32_16x16x32_bf16 v[64:67], a[32:35], a[172:175], v[64:67]
buffer_load_dwordx4 a[192:195], v157, s[8:11], s99 offen offset:1024 sc1
v_mfma_f32_16x16x32_bf16 v[96:99], a[32:35], a[204:207], v[96:99]
v_mfma_f32_16x16x32_bf16 v[96:99], a[0:3], a[200:203], v[96:99]
s_barrier
ds_read_b64_tr_b16 a[0:1], v200 offset:49152
v_mfma_f32_16x16x32_bf16 v[100:103], a[4:7], a[200:203], v[100:103]
ds_read_b64_tr_b16 a[2:3], v200 offset:53248
v_mfma_f32_16x16x32_bf16 v[100:103], a[36:39], a[204:207], v[100:103]
ds_read_b64_tr_b16 a[32:33], v200 offset:57344
v_mfma_f32_16x16x32_bf16 v[68:71], a[36:39], a[172:175], v[68:71]
buffer_load_dwordx4 a[196:199], v157, s[8:11], s99 offen offset:2048 sc1
ds_read_b64_tr_b16 a[34:35], v200 offset:61440
v_mfma_f32_16x16x32_bf16 v[68:71], a[4:7], a[168:171], v[68:71]
v_mfma_f32_16x16x32_bf16 v[36:39], a[4:7], a[136:139], v[36:39]
v_mfma_f32_16x16x32_bf16 v[36:39], a[36:39], a[140:143], v[36:39]
v_mfma_f32_16x16x32_bf16 v[4:7], a[36:39], a[100:103], v[4:7]
buffer_load_dwordx4 a[228:231], v157, s[8:11], s60 offen offset:2048 sc1
v_mfma_f32_16x16x32_bf16 v[4:7], a[4:7], a[96:99], v[4:7]
ds_read_b64_tr_b16 a[4:5], v201 offset:49152
v_mfma_f32_16x16x32_bf16 v[8:11], a[8:11], a[96:99], v[8:11]
ds_read_b64_tr_b16 a[6:7], v201 offset:53248
v_mfma_f32_16x16x32_bf16 v[8:11], a[40:43], a[100:103], v[8:11]
ds_read_b64_tr_b16 a[36:37], v201 offset:57344
v_mfma_f32_16x16x32_bf16 v[40:43], a[40:43], a[140:143], v[40:43]
ds_read_b64_tr_b16 a[38:39], v201 offset:61440
v_mfma_f32_16x16x32_bf16 v[40:43], a[8:11], a[136:139], v[40:43]
buffer_load_dwordx4 v244, s[12:15], 0 offen offset:0 lds
v_add_u32 v244, 0x70000, v244
v_mfma_f32_16x16x32_bf16 v[72:75], a[8:11], a[168:171], v[72:75]
v_mfma_f32_16x16x32_bf16 v[72:75], a[40:43], a[172:175], v[72:75]
v_mfma_f32_16x16x32_bf16 v[104:107], a[40:43], a[204:207], v[104:107]
v_mfma_f32_16x16x32_bf16 v[104:107], a[8:11], a[200:203], v[104:107]
buffer_load_dwordx4 v245, s[12:15], 0 offen offset:1024 lds
ds_read_b64_tr_b16 a[8:9], v202 offset:49152
v_add_u32 v245, 0x70000, v245
v_mfma_f32_16x16x32_bf16 v[108:111], a[12:15], a[200:203], v[108:111]
ds_read_b64_tr_b16 a[10:11], v202 offset:53248
v_mfma_f32_16x16x32_bf16 v[108:111], a[44:47], a[204:207], v[108:111]
ds_read_b64_tr_b16 a[40:41], v202 offset:57344
v_mfma_f32_16x16x32_bf16 v[76:79], a[44:47], a[172:175], v[76:79]
ds_read_b64_tr_b16 a[42:43], v202 offset:61440
v_mfma_f32_16x16x32_bf16 v[76:79], a[12:15], a[168:171], v[76:79]
v_mfma_f32_16x16x32_bf16 v[44:47], a[12:15], a[136:139], v[44:47]
buffer_load_dwordx4 v246, s[12:15], 0 offen offset:2048 lds
v_add_u32 v246, 0x70000, v246
v_mfma_f32_16x16x32_bf16 v[44:47], a[44:47], a[140:143], v[44:47]
v_mfma_f32_16x16x32_bf16 v[12:15], a[44:47], a[100:103], v[12:15]
v_mfma_f32_16x16x32_bf16 v[12:15], a[12:15], a[96:99], v[12:15]
ds_read_b64_tr_b16 a[12:13], v203 offset:49152
v_mfma_f32_16x16x32_bf16 v[16:19], a[16:19], a[96:99], v[16:19]
buffer_load_dwordx4 v247, s[12:15], 0 offen offset:3072 lds
ds_read_b64_tr_b16 a[14:15], v203 offset:53248
v_add_u32 v247, 0x70000, v247
v_mfma_f32_16x16x32_bf16 v[16:19], a[48:51], a[100:103], v[16:19]
s_add_u32 m0, s24, 0x0
ds_read_b64_tr_b16 a[44:45], v203 offset:57344
v_mfma_f32_16x16x32_bf16 v[48:51], a[48:51], a[140:143], v[48:51]
ds_read_b64_tr_b16 a[46:47], v203 offset:61440
v_mfma_f32_16x16x32_bf16 v[48:51], a[16:19], a[136:139], v[48:51]
v_mfma_f32_16x16x32_bf16 v[80:83], a[16:19], a[168:171], v[80:83]
v_mfma_f32_16x16x32_bf16 v[80:83], a[48:51], a[172:175], v[80:83]
buffer_load_dwordx4 v[128:131], v172, s[8:11], s93 offen offset:0 sc1
v_mfma_f32_16x16x32_bf16 v[112:115], a[48:51], a[204:207], v[112:115]
v_mfma_f32_16x16x32_bf16 v[112:115], a[16:19], a[200:203], v[112:115]
ds_read_b64_tr_b16 a[16:17], v204 offset:49152
v_mfma_f32_16x16x32_bf16 v[116:119], a[20:23], a[200:203], v[116:119]
ds_read_b64_tr_b16 a[18:19], v204 offset:53248
v_mfma_f32_16x16x32_bf16 v[116:119], a[52:55], a[204:207], v[116:119]
buffer_load_dwordx4 v[132:135], v172, s[8:11], s93 offen offset:1024 sc1
ds_read_b64_tr_b16 a[48:49], v204 offset:57344
v_mfma_f32_16x16x32_bf16 v[84:87], a[52:55], a[172:175], v[84:87]
ds_read_b64_tr_b16 a[50:51], v204 offset:61440
v_mfma_f32_16x16x32_bf16 v[84:87], a[20:23], a[168:171], v[84:87]
v_mfma_f32_16x16x32_bf16 v[52:55], a[20:23], a[136:139], v[52:55]
v_mfma_f32_16x16x32_bf16 v[52:55], a[52:55], a[140:143], v[52:55]
v_mfma_f32_16x16x32_bf16 v[20:23], a[52:55], a[100:103], v[20:23]
buffer_load_dwordx4 v[136:139], v172, s[8:11], s93 offen offset:2048 sc1
v_mfma_f32_16x16x32_bf16 v[20:23], a[20:23], a[96:99], v[20:23]
s_waitcnt lgkmcnt(4)
ds_read_b64_tr_b16 a[20:21], v205 offset:49152
v_mfma_f32_16x16x32_bf16 v[24:27], a[24:27], a[96:99], v[24:27]
ds_read_b64_tr_b16 a[22:23], v205 offset:53248
v_mfma_f32_16x16x32_bf16 v[24:27], a[56:59], a[100:103], v[24:27]
ds_read_b64_tr_b16 a[52:53], v205 offset:57344
v_mfma_f32_16x16x32_bf16 v[56:59], a[56:59], a[140:143], v[56:59]
buffer_load_dwordx4 v[140:143], v172, s[8:11], s93 offen offset:3072 sc1
ds_read_b64_tr_b16 a[54:55], v205 offset:61440
v_mfma_f32_16x16x32_bf16 v[56:59], a[24:27], a[136:139], v[56:59]
v_mfma_f32_16x16x32_bf16 v[88:91], a[24:27], a[168:171], v[88:91]
v_mfma_f32_16x16x32_bf16 v[88:91], a[56:59], a[172:175], v[88:91]
v_mfma_f32_16x16x32_bf16 v[120:123], a[56:59], a[204:207], v[120:123]
v_mfma_f32_16x16x32_bf16 v[120:123], a[24:27], a[200:203], v[120:123]
buffer_load_dwordx4 v244, s[12:15], 0 offen offset:0 lds
ds_read_b64_tr_b16 a[24:25], v206 offset:49152
v_add_u32 v244, 0x70000, v244
v_mfma_f32_16x16x32_bf16 v[124:127], a[28:31], a[200:203], v[124:127]
ds_read_b64_tr_b16 a[26:27], v206 offset:53248
v_mfma_f32_16x16x32_bf16 v[124:127], a[60:63], a[204:207], v[124:127]
ds_read_b64_tr_b16 a[56:57], v206 offset:57344
v_mfma_f32_16x16x32_bf16 v[92:95], a[60:63], a[172:175], v[92:95]
ds_read_b64_tr_b16 a[58:59], v206 offset:61440
v_mfma_f32_16x16x32_bf16 v[92:95], a[28:31], a[168:171], v[92:95]
buffer_load_dwordx4 a[168:171], v172, s[8:11], s99 offen offset:2048 sc1
v_mfma_f32_16x16x32_bf16 v[60:63], a[28:31], a[136:139], v[60:63]
v_mfma_f32_16x16x32_bf16 v[60:63], a[60:63], a[140:143], v[60:63]
v_mfma_f32_16x16x32_bf16 v[28:31], a[60:63], a[100:103], v[28:31]
v_mfma_f32_16x16x32_bf16 v[28:31], a[28:31], a[96:99], v[28:31]
ds_read_b64_tr_b16 a[28:29], v207 offset:49152
v_mfma_f32_16x16x32_bf16 v[32:35], a[0:3], a[144:147], v[32:35]
buffer_load_dwordx4 a[136:139], v172, s[8:11], s98 offen offset:2048 sc1
ds_read_b64_tr_b16 a[30:31], v207 offset:53248
v_mfma_f32_16x16x32_bf16 v[32:35], a[32:35], a[148:151], v[32:35]
ds_read_b64_tr_b16 a[60:61], v207 offset:57344
v_mfma_f32_16x16x32_bf16 v[64:67], a[32:35], a[180:183], v[64:67]
ds_read_b64_tr_b16 a[62:63], v207 offset:61440
v_mfma_f32_16x16x32_bf16 v[64:67], a[0:3], a[176:179], v[64:67]
v_mfma_f32_16x16x32_bf16 v[96:99], a[0:3], a[208:211], v[96:99]
buffer_load_dwordx4 a[140:143], v172, s[8:11], s98 offen offset:3072 sc1
v_mfma_f32_16x16x32_bf16 v[96:99], a[32:35], a[212:215], v[96:99]
s_waitcnt vmcnt(32)
s_barrier
ds_read_b64_tr_b16 a[0:1], v208 offset:0
v_mfma_f32_16x16x32_bf16 v[100:103], a[36:39], a[212:215], v[100:103]
ds_read_b64_tr_b16 a[2:3], v208 offset:4096
v_mfma_f32_16x16x32_bf16 v[100:103], a[4:7], a[208:211], v[100:103]
ds_read_b64_tr_b16 a[32:33], v208 offset:8192
v_mfma_f32_16x16x32_bf16 v[68:71], a[4:7], a[176:179], v[68:71]
ds_read_b64_tr_b16 a[34:35], v208 offset:12288
v_mfma_f32_16x16x32_bf16 v[68:71], a[36:39], a[180:183], v[68:71]
buffer_load_dwordx4 a[172:175], v172, s[8:11], s99 offen offset:3072 sc1
v_mfma_f32_16x16x32_bf16 v[36:39], a[36:39], a[148:151], v[36:39]
v_mfma_f32_16x16x32_bf16 v[36:39], a[4:7], a[144:147], v[36:39]
ds_read_b64_tr_b16 a[4:5], v209 offset:0
v_mfma_f32_16x16x32_bf16 v[40:43], a[8:11], a[144:147], v[40:43]
ds_read_b64_tr_b16 a[6:7], v209 offset:4096
v_mfma_f32_16x16x32_bf16 v[40:43], a[40:43], a[148:151], v[40:43]
buffer_load_dwordx4 a[200:203], v172, s[8:11], s60 offen offset:2048 sc1
ds_read_b64_tr_b16 a[36:37], v209 offset:8192
v_mfma_f32_16x16x32_bf16 v[72:75], a[40:43], a[180:183], v[72:75]
ds_read_b64_tr_b16 a[38:39], v209 offset:12288
v_mfma_f32_16x16x32_bf16 v[72:75], a[8:11], a[176:179], v[72:75]
v_mfma_f32_16x16x32_bf16 v[104:107], a[8:11], a[208:211], v[104:107]
v_mfma_f32_16x16x32_bf16 v[104:107], a[40:43], a[212:215], v[104:107]
ds_read_b64_tr_b16 a[8:9], v210 offset:0
v_mfma_f32_16x16x32_bf16 v[108:111], a[44:47], a[212:215], v[108:111]
buffer_load_dwordx4 a[204:207], v172, s[8:11], s60 offen offset:3072 sc1
ds_read_b64_tr_b16 a[10:11], v210 offset:4096
v_mfma_f32_16x16x32_bf16 v[108:111], a[12:15], a[208:211], v[108:111]
ds_read_b64_tr_b16 a[40:41], v210 offset:8192
v_mfma_f32_16x16x32_bf16 v[76:79], a[12:15], a[176:179], v[76:79]
ds_read_b64_tr_b16 a[42:43], v210 offset:12288
v_mfma_f32_16x16x32_bf16 v[76:79], a[44:47], a[180:183], v[76:79]
v_mfma_f32_16x16x32_bf16 v[44:47], a[44:47], a[148:151], v[44:47]
buffer_load_dwordx4 v245, s[12:15], 0 offen offset:1024 lds
v_add_u32 v245, 0x70000, v245
v_mfma_f32_16x16x32_bf16 v[44:47], a[12:15], a[144:147], v[44:47]
s_waitcnt lgkmcnt(5)
ds_read_b64_tr_b16 a[12:13], v211 offset:0
v_mfma_f32_16x16x32_bf16 v[48:51], a[16:19], a[144:147], v[48:51]
ds_read_b64_tr_b16 a[14:15], v211 offset:4096
v_mfma_f32_16x16x32_bf16 v[48:51], a[48:51], a[148:151], v[48:51]
ds_read_b64_tr_b16 a[44:45], v211 offset:8192
v_mfma_f32_16x16x32_bf16 v[80:83], a[48:51], a[180:183], v[80:83]
ds_read_b64_tr_b16 a[46:47], v211 offset:12288
v_mfma_f32_16x16x32_bf16 v[80:83], a[16:19], a[176:179], v[80:83]
buffer_load_dwordx4 v246, s[12:15], 0 offen offset:2048 lds
v_add_u32 v246, 0x70000, v246
v_mfma_f32_16x16x32_bf16 v[112:115], a[16:19], a[208:211], v[112:115]
v_mfma_f32_16x16x32_bf16 v[112:115], a[48:51], a[212:215], v[112:115]
ds_read_b64_tr_b16 a[16:17], v212 offset:0
v_mfma_f32_16x16x32_bf16 v[116:119], a[52:55], a[212:215], v[116:119]
ds_read_b64_tr_b16 a[18:19], v212 offset:4096
v_mfma_f32_16x16x32_bf16 v[116:119], a[20:23], a[208:211], v[116:119]
buffer_load_dwordx4 v247, s[12:15], 0 offen offset:3072 lds
ds_read_b64_tr_b16 a[48:49], v212 offset:8192
v_add_u32 v247, 0x70000, v247
v_mfma_f32_16x16x32_bf16 v[84:87], a[20:23], a[176:179], v[84:87]
s_add_u32 m0, s24, 0x4000
ds_read_b64_tr_b16 a[50:51], v212 offset:12288
v_mfma_f32_16x16x32_bf16 v[84:87], a[52:55], a[180:183], v[84:87]
v_mfma_f32_16x16x32_bf16 v[52:55], a[52:55], a[148:151], v[52:55]
v_mfma_f32_16x16x32_bf16 v[52:55], a[20:23], a[144:147], v[52:55]
ds_read_b64_tr_b16 a[20:21], v213 offset:0
v_mfma_f32_16x16x32_bf16 v[56:59], a[24:27], a[144:147], v[56:59]
buffer_load_dwordx4 v244, s[12:15], 0 offen offset:0 lds
ds_read_b64_tr_b16 a[22:23], v213 offset:4096
v_add_u32 v244, s3, v244
v_mfma_f32_16x16x32_bf16 v[56:59], a[56:59], a[148:151], v[56:59]
ds_read_b64_tr_b16 a[52:53], v213 offset:8192
v_mfma_f32_16x16x32_bf16 v[88:91], a[56:59], a[180:183], v[88:91]
ds_read_b64_tr_b16 a[54:55], v213 offset:12288
v_mfma_f32_16x16x32_bf16 v[88:91], a[24:27], a[176:179], v[88:91]
v_mfma_f32_16x16x32_bf16 v[120:123], a[24:27], a[208:211], v[120:123]
buffer_load_dwordx4 v245, s[12:15], 0 offen offset:1024 lds
v_add_u32 v245, s3, v245
v_mfma_f32_16x16x32_bf16 v[120:123], a[56:59], a[212:215], v[120:123]
ds_read_b64_tr_b16 a[24:25], v214 offset:0
v_mfma_f32_16x16x32_bf16 v[124:127], a[60:63], a[212:215], v[124:127]
ds_read_b64_tr_b16 a[26:27], v214 offset:4096
v_mfma_f32_16x16x32_bf16 v[124:127], a[28:31], a[208:211], v[124:127]
ds_read_b64_tr_b16 a[56:57], v214 offset:8192
v_mfma_f32_16x16x32_bf16 v[92:95], a[28:31], a[176:179], v[92:95]
ds_read_b64_tr_b16 a[58:59], v214 offset:12288
v_mfma_f32_16x16x32_bf16 v[92:95], a[60:63], a[180:183], v[92:95]
buffer_load_dwordx4 a[176:179], v153, s[8:11], s99 offen offset:1024 sc1
v_mfma_f32_16x16x32_bf16 v[60:63], a[60:63], a[148:151], v[60:63]
v_mfma_f32_16x16x32_bf16 v[60:63], a[28:31], a[144:147], v[60:63]
s_waitcnt vmcnt(27)
ds_read_b64_tr_b16 a[28:29], v215 offset:0
v_mfma_f32_16x16x32_bf16 v[32:35], a[0:3], a[152:155], v[32:35]
ds_read_b64_tr_b16 a[30:31], v215 offset:4096
v_mfma_f32_16x16x32_bf16 v[32:35], a[32:35], a[156:159], v[32:35]
buffer_load_dwordx4 a[144:147], v153, s[8:11], s98 offen offset:1024 sc1
ds_read_b64_tr_b16 a[60:61], v215 offset:8192
v_mfma_f32_16x16x32_bf16 v[64:67], a[32:35], a[188:191], v[64:67]
ds_read_b64_tr_b16 a[62:63], v215 offset:12288
v_mfma_f32_16x16x32_bf16 v[64:67], a[0:3], a[184:187], v[64:67]
v_mfma_f32_16x16x32_bf16 v[96:99], a[0:3], a[216:219], v[96:99]
v_mfma_f32_16x16x32_bf16 v[96:99], a[32:35], a[220:223], v[96:99]
s_barrier
s_waitcnt lgkmcnt(5)
ds_read_b64_tr_b16 a[0:1], v208 offset:16384
v_mfma_f32_16x16x32_bf16 v[100:103], a[36:39], a[220:223], v[100:103]
buffer_load_dwordx4 a[148:151], v153, s[8:11], s98 offen offset:2048 sc1
ds_read_b64_tr_b16 a[2:3], v208 offset:20480
v_mfma_f32_16x16x32_bf16 v[100:103], a[4:7], a[216:219], v[100:103]
ds_read_b64_tr_b16 a[32:33], v208 offset:24576
v_mfma_f32_16x16x32_bf16 v[68:71], a[4:7], a[184:187], v[68:71]
ds_read_b64_tr_b16 a[34:35], v208 offset:28672
v_mfma_f32_16x16x32_bf16 v[68:71], a[36:39], a[188:191], v[68:71]
v_mfma_f32_16x16x32_bf16 v[36:39], a[36:39], a[156:159], v[36:39]
buffer_load_dwordx4 a[180:183], v153, s[8:11], s99 offen offset:2048 sc1
v_mfma_f32_16x16x32_bf16 v[36:39], a[4:7], a[152:155], v[36:39]
ds_read_b64_tr_b16 a[4:5], v209 offset:16384
v_mfma_f32_16x16x32_bf16 v[40:43], a[8:11], a[152:155], v[40:43]
ds_read_b64_tr_b16 a[6:7], v209 offset:20480
v_mfma_f32_16x16x32_bf16 v[40:43], a[40:43], a[156:159], v[40:43]
ds_read_b64_tr_b16 a[36:37], v209 offset:24576
v_mfma_f32_16x16x32_bf16 v[72:75], a[40:43], a[188:191], v[72:75]
ds_read_b64_tr_b16 a[38:39], v209 offset:28672
v_mfma_f32_16x16x32_bf16 v[72:75], a[8:11], a[184:187], v[72:75]
buffer_load_dwordx4 a[208:211], v153, s[8:11], s60 offen offset:1024 sc1
v_mfma_f32_16x16x32_bf16 v[104:107], a[8:11], a[216:219], v[104:107]
v_mfma_f32_16x16x32_bf16 v[104:107], a[40:43], a[220:223], v[104:107]
ds_read_b64_tr_b16 a[8:9], v210 offset:16384
v_mfma_f32_16x16x32_bf16 v[108:111], a[44:47], a[220:223], v[108:111]
ds_read_b64_tr_b16 a[10:11], v210 offset:20480
v_mfma_f32_16x16x32_bf16 v[108:111], a[12:15], a[216:219], v[108:111]
buffer_load_dwordx4 a[212:215], v153, s[8:11], s60 offen offset:2048 sc1
ds_read_b64_tr_b16 a[40:41], v210 offset:24576
v_mfma_f32_16x16x32_bf16 v[76:79], a[12:15], a[184:187], v[76:79]
ds_read_b64_tr_b16 a[42:43], v210 offset:28672
v_mfma_f32_16x16x32_bf16 v[76:79], a[44:47], a[188:191], v[76:79]
v_mfma_f32_16x16x32_bf16 v[44:47], a[44:47], a[156:159], v[44:47]
v_mfma_f32_16x16x32_bf16 v[44:47], a[12:15], a[152:155], v[44:47]
ds_read_b64_tr_b16 a[12:13], v211 offset:16384
v_mfma_f32_16x16x32_bf16 v[48:51], a[16:19], a[152:155], v[48:51]
buffer_load_dwordx4 v246, s[12:15], 0 offen offset:2048 lds
ds_read_b64_tr_b16 a[14:15], v211 offset:20480
v_add_u32 v246, s3, v246
v_mfma_f32_16x16x32_bf16 v[48:51], a[48:51], a[156:159], v[48:51]
ds_read_b64_tr_b16 a[44:45], v211 offset:24576
v_mfma_f32_16x16x32_bf16 v[80:83], a[48:51], a[188:191], v[80:83]
ds_read_b64_tr_b16 a[46:47], v211 offset:28672
v_mfma_f32_16x16x32_bf16 v[80:83], a[16:19], a[184:187], v[80:83]
v_mfma_f32_16x16x32_bf16 v[112:115], a[16:19], a[216:219], v[112:115]
buffer_load_dwordx4 v247, s[12:15], 0 offen offset:3072 lds
v_add_u32 v247, s3, v247
v_mfma_f32_16x16x32_bf16 v[112:115], a[48:51], a[220:223], v[112:115]
s_add_u32 m0, s24, 0x1c000
ds_read_b64_tr_b16 a[16:17], v212 offset:16384
v_mfma_f32_16x16x32_bf16 v[116:119], a[52:55], a[220:223], v[116:119]
ds_read_b64_tr_b16 a[18:19], v212 offset:20480
v_mfma_f32_16x16x32_bf16 v[116:119], a[20:23], a[216:219], v[116:119]
ds_read_b64_tr_b16 a[48:49], v212 offset:24576
v_mfma_f32_16x16x32_bf16 v[84:87], a[20:23], a[184:187], v[84:87]
ds_read_b64_tr_b16 a[50:51], v212 offset:28672
v_mfma_f32_16x16x32_bf16 v[84:87], a[52:55], a[188:191], v[84:87]
buffer_load_dwordx4 v244, s[12:15], 0 offen offset:0 lds
v_add_u32 v244, 0xe0000, v244
v_mfma_f32_16x16x32_bf16 v[52:55], a[52:55], a[156:159], v[52:55]
v_mfma_f32_16x16x32_bf16 v[52:55], a[20:23], a[152:155], v[52:55]
s_waitcnt lgkmcnt(5)
ds_read_b64_tr_b16 a[20:21], v213 offset:16384
v_mfma_f32_16x16x32_bf16 v[56:59], a[24:27], a[152:155], v[56:59]
ds_read_b64_tr_b16 a[22:23], v213 offset:20480
v_mfma_f32_16x16x32_bf16 v[56:59], a[56:59], a[156:159], v[56:59]
buffer_load_dwordx4 v245, s[12:15], 0 offen offset:1024 lds
ds_read_b64_tr_b16 a[52:53], v213 offset:24576
v_add_u32 v245, 0xe0000, v245
v_mfma_f32_16x16x32_bf16 v[88:91], a[56:59], a[188:191], v[88:91]
ds_read_b64_tr_b16 a[54:55], v213 offset:28672
v_mfma_f32_16x16x32_bf16 v[88:91], a[24:27], a[184:187], v[88:91]
v_mfma_f32_16x16x32_bf16 v[120:123], a[24:27], a[216:219], v[120:123]
v_mfma_f32_16x16x32_bf16 v[120:123], a[56:59], a[220:223], v[120:123]
ds_read_b64_tr_b16 a[24:25], v214 offset:16384
v_mfma_f32_16x16x32_bf16 v[124:127], a[60:63], a[220:223], v[124:127]
buffer_load_dwordx4 v246, s[12:15], 0 offen offset:2048 lds
ds_read_b64_tr_b16 a[26:27], v214 offset:20480
v_add_u32 v246, 0xe0000, v246
v_mfma_f32_16x16x32_bf16 v[124:127], a[28:31], a[216:219], v[124:127]
ds_read_b64_tr_b16 a[56:57], v214 offset:24576
v_mfma_f32_16x16x32_bf16 v[92:95], a[28:31], a[184:187], v[92:95]
ds_read_b64_tr_b16 a[58:59], v214 offset:28672
v_mfma_f32_16x16x32_bf16 v[92:95], a[60:63], a[188:191], v[92:95]
v_mfma_f32_16x16x32_bf16 v[60:63], a[60:63], a[156:159], v[60:63]
buffer_load_dwordx4 a[184:187], v155, s[8:11], s99 offen offset:0 sc1
v_mfma_f32_16x16x32_bf16 v[60:63], a[28:31], a[152:155], v[60:63]
s_waitcnt vmcnt(27)
ds_read_b64_tr_b16 a[28:29], v215 offset:16384
v_mfma_f32_16x16x32_bf16 v[32:35], a[0:3], a[160:163], v[32:35]
ds_read_b64_tr_b16 a[30:31], v215 offset:20480
v_mfma_f32_16x16x32_bf16 v[32:35], a[32:35], a[164:167], v[32:35]
ds_read_b64_tr_b16 a[60:61], v215 offset:24576
v_mfma_f32_16x16x32_bf16 v[64:67], a[32:35], a[196:199], v[64:67]
ds_read_b64_tr_b16 a[62:63], v215 offset:28672
v_mfma_f32_16x16x32_bf16 v[64:67], a[0:3], a[192:195], v[64:67]
buffer_load_dwordx4 a[152:155], v155, s[8:11], s98 offen offset:0 sc1
v_mfma_f32_16x16x32_bf16 v[96:99], a[0:3], a[224:227], v[96:99]
v_mfma_f32_16x16x32_bf16 v[96:99], a[32:35], a[228:231], v[96:99]
s_barrier
ds_read_b64_tr_b16 a[0:1], v208 offset:32768
v_mfma_f32_16x16x32_bf16 v[100:103], a[36:39], a[228:231], v[100:103]
ds_read_b64_tr_b16 a[2:3], v208 offset:36864
v_mfma_f32_16x16x32_bf16 v[100:103], a[4:7], a[224:227], v[100:103]
buffer_load_dwordx4 a[156:159], v155, s[8:11], s98 offen offset:1024 sc1
ds_read_b64_tr_b16 a[32:33], v208 offset:40960
v_mfma_f32_16x16x32_bf16 v[68:71], a[4:7], a[192:195], v[68:71]
ds_read_b64_tr_b16 a[34:35], v208 offset:45056
v_mfma_f32_16x16x32_bf16 v[68:71], a[36:39], a[196:199], v[68:71]
v_mfma_f32_16x16x32_bf16 v[36:39], a[36:39], a[164:167], v[36:39]
v_mfma_f32_16x16x32_bf16 v[36:39], a[4:7], a[160:163], v[36:39]
ds_read_b64_tr_b16 a[4:5], v209 offset:32768
v_mfma_f32_16x16x32_bf16 v[40:43], a[8:11], a[160:163], v[40:43]
buffer_load_dwordx4 a[188:191], v155, s[8:11], s99 offen offset:1024 sc1
ds_read_b64_tr_b16 a[6:7], v209 offset:36864
v_mfma_f32_16x16x32_bf16 v[40:43], a[40:43], a[164:167], v[40:43]
ds_read_b64_tr_b16 a[36:37], v209 offset:40960
v_mfma_f32_16x16x32_bf16 v[72:75], a[40:43], a[196:199], v[72:75]
ds_read_b64_tr_b16 a[38:39], v209 offset:45056
v_mfma_f32_16x16x32_bf16 v[72:75], a[8:11], a[192:195], v[72:75]
v_mfma_f32_16x16x32_bf16 v[104:107], a[8:11], a[224:227], v[104:107]
buffer_load_dwordx4 a[216:219], v155, s[8:11], s60 offen offset:0 sc1
v_mfma_f32_16x16x32_bf16 v[104:107], a[40:43], a[228:231], v[104:107]
s_waitcnt lgkmcnt(5)
ds_read_b64_tr_b16 a[8:9], v210 offset:32768
v_mfma_f32_16x16x32_bf16 v[108:111], a[44:47], a[228:231], v[108:111]
ds_read_b64_tr_b16 a[10:11], v210 offset:36864
v_mfma_f32_16x16x32_bf16 v[108:111], a[12:15], a[224:227], v[108:111]
ds_read_b64_tr_b16 a[40:41], v210 offset:40960
v_mfma_f32_16x16x32_bf16 v[76:79], a[12:15], a[192:195], v[76:79]
ds_read_b64_tr_b16 a[42:43], v210 offset:45056
v_mfma_f32_16x16x32_bf16 v[76:79], a[44:47], a[196:199], v[76:79]
buffer_load_dwordx4 a[220:223], v155, s[8:11], s60 offen offset:1024 sc1
v_mfma_f32_16x16x32_bf16 v[44:47], a[44:47], a[164:167], v[44:47]
v_mfma_f32_16x16x32_bf16 v[44:47], a[12:15], a[160:163], v[44:47]
ds_read_b64_tr_b16 a[12:13], v211 offset:32768
v_mfma_f32_16x16x32_bf16 v[48:51], a[16:19], a[160:163], v[48:51]
ds_read_b64_tr_b16 a[14:15], v211 offset:36864
v_mfma_f32_16x16x32_bf16 v[48:51], a[48:51], a[164:167], v[48:51]
buffer_load_dwordx4 v247, s[12:15], 0 offen offset:3072 lds
ds_read_b64_tr_b16 a[44:45], v211 offset:40960
v_add_u32 v247, 0xe0000, v247
v_mfma_f32_16x16x32_bf16 v[80:83], a[48:51], a[196:199], v[80:83]
s_add_u32 m0, s24, 0x20000
ds_read_b64_tr_b16 a[46:47], v211 offset:45056
v_mfma_f32_16x16x32_bf16 v[80:83], a[16:19], a[192:195], v[80:83]
v_mfma_f32_16x16x32_bf16 v[112:115], a[16:19], a[224:227], v[112:115]
v_mfma_f32_16x16x32_bf16 v[112:115], a[48:51], a[228:231], v[112:115]
ds_read_b64_tr_b16 a[16:17], v212 offset:32768
v_mfma_f32_16x16x32_bf16 v[116:119], a[52:55], a[228:231], v[116:119]
buffer_load_dwordx4 v244, s[12:15], 0 offen offset:0 lds
ds_read_b64_tr_b16 a[18:19], v212 offset:36864
v_mfma_f32_16x16x32_bf16 v[116:119], a[20:23], a[224:227], v[116:119]
ds_read_b64_tr_b16 a[48:49], v212 offset:40960
v_mfma_f32_16x16x32_bf16 v[84:87], a[20:23], a[192:195], v[84:87]
ds_read_b64_tr_b16 a[50:51], v212 offset:45056
v_mfma_f32_16x16x32_bf16 v[84:87], a[52:55], a[196:199], v[84:87]
v_mfma_f32_16x16x32_bf16 v[52:55], a[52:55], a[164:167], v[52:55]
buffer_load_dwordx4 v245, s[12:15], 0 offen offset:1024 lds
v_mfma_f32_16x16x32_bf16 v[52:55], a[20:23], a[160:163], v[52:55]
ds_read_b64_tr_b16 a[20:21], v213 offset:32768
v_mfma_f32_16x16x32_bf16 v[56:59], a[24:27], a[160:163], v[56:59]
ds_read_b64_tr_b16 a[22:23], v213 offset:36864
v_mfma_f32_16x16x32_bf16 v[56:59], a[56:59], a[164:167], v[56:59]
ds_read_b64_tr_b16 a[52:53], v213 offset:40960
v_mfma_f32_16x16x32_bf16 v[88:91], a[56:59], a[196:199], v[88:91]
ds_read_b64_tr_b16 a[54:55], v213 offset:45056
v_mfma_f32_16x16x32_bf16 v[88:91], a[24:27], a[192:195], v[88:91]
buffer_load_dwordx4 v246, s[12:15], 0 offen offset:2048 lds
v_mfma_f32_16x16x32_bf16 v[120:123], a[24:27], a[224:227], v[120:123]
v_mfma_f32_16x16x32_bf16 v[120:123], a[56:59], a[228:231], v[120:123]
ds_read_b64_tr_b16 a[24:25], v214 offset:32768
v_mfma_f32_16x16x32_bf16 v[124:127], a[60:63], a[228:231], v[124:127]
ds_read_b64_tr_b16 a[26:27], v214 offset:36864
v_mfma_f32_16x16x32_bf16 v[124:127], a[28:31], a[224:227], v[124:127]
buffer_load_dwordx4 a[224:227], v156, s[8:11], s60 offen offset:3072 sc1
ds_read_b64_tr_b16 a[56:57], v214 offset:40960
v_mfma_f32_16x16x32_bf16 v[92:95], a[28:31], a[192:195], v[92:95]
ds_read_b64_tr_b16 a[58:59], v214 offset:45056
v_mfma_f32_16x16x32_bf16 v[92:95], a[60:63], a[196:199], v[92:95]
v_mfma_f32_16x16x32_bf16 v[60:63], a[60:63], a[164:167], v[60:63]
v_mfma_f32_16x16x32_bf16 v[60:63], a[28:31], a[160:163], v[60:63]
s_waitcnt vmcnt(26) lgkmcnt(5)
ds_read_b64_tr_b16 a[28:29], v215 offset:32768
v_mfma_f32_16x16x32_bf16 v[32:35], a[0:3], a[136:139], v[32:35]
buffer_load_dwordx4 a[160:163], v156, s[8:11], s98 offen offset:3072 sc1
ds_read_b64_tr_b16 a[30:31], v215 offset:36864
v_mfma_f32_16x16x32_bf16 v[32:35], a[32:35], a[140:143], v[32:35]
ds_read_b64_tr_b16 a[60:61], v215 offset:40960
v_mfma_f32_16x16x32_bf16 v[64:67], a[32:35], a[172:175], v[64:67]
ds_read_b64_tr_b16 a[62:63], v215 offset:45056
v_mfma_f32_16x16x32_bf16 v[64:67], a[0:3], a[168:171], v[64:67]
v_mfma_f32_16x16x32_bf16 v[96:99], a[0:3], a[200:203], v[96:99]
buffer_load_dwordx4 a[164:167], v157, s[8:11], s98 offen offset:0 sc1
v_mfma_f32_16x16x32_bf16 v[96:99], a[32:35], a[204:207], v[96:99]
s_barrier
ds_read_b64_tr_b16 a[0:1], v200 offset:32768
v_mfma_f32_16x16x32_bf16 v[100:103], a[36:39], a[204:207], v[100:103]
ds_read_b64_tr_b16 a[2:3], v200 offset:36864
v_mfma_f32_16x16x32_bf16 v[100:103], a[4:7], a[200:203], v[100:103]
ds_read_b64_tr_b16 a[32:33], v200 offset:40960
v_mfma_f32_16x16x32_bf16 v[68:71], a[4:7], a[168:171], v[68:71]
ds_read_b64_tr_b16 a[34:35], v200 offset:45056
v_mfma_f32_16x16x32_bf16 v[68:71], a[36:39], a[172:175], v[68:71]
buffer_load_dwordx4 a[192:195], v156, s[8:11], s99 offen offset:3072 sc1
v_mfma_f32_16x16x32_bf16 v[36:39], a[36:39], a[140:143], v[36:39]
v_mfma_f32_16x16x32_bf16 v[36:39], a[4:7], a[136:139], v[36:39]
ds_read_b64_tr_b16 a[4:5], v201 offset:32768
v_mfma_f32_16x16x32_bf16 v[40:43], a[8:11], a[136:139], v[40:43]
ds_read_b64_tr_b16 a[6:7], v201 offset:36864
v_mfma_f32_16x16x32_bf16 v[40:43], a[40:43], a[140:143], v[40:43]
buffer_load_dwordx4 a[196:199], v157, s[8:11], s99 offen offset:0 sc1
ds_read_b64_tr_b16 a[36:37], v201 offset:40960
v_mfma_f32_16x16x32_bf16 v[72:75], a[40:43], a[172:175], v[72:75]
ds_read_b64_tr_b16 a[38:39], v201 offset:45056
v_mfma_f32_16x16x32_bf16 v[72:75], a[8:11], a[168:171], v[72:75]
v_mfma_f32_16x16x32_bf16 v[104:107], a[8:11], a[200:203], v[104:107]
v_mfma_f32_16x16x32_bf16 v[104:107], a[40:43], a[204:207], v[104:107]
ds_read_b64_tr_b16 a[8:9], v202 offset:32768
v_mfma_f32_16x16x32_bf16 v[108:111], a[44:47], a[204:207], v[108:111]
buffer_load_dwordx4 a[228:231], v157, s[8:11], s60 offen offset:0 sc1
ds_read_b64_tr_b16 a[10:11], v202 offset:36864
v_mfma_f32_16x16x32_bf16 v[108:111], a[12:15], a[200:203], v[108:111]
ds_read_b64_tr_b16 a[40:41], v202 offset:40960
v_mfma_f32_16x16x32_bf16 v[76:79], a[12:15], a[168:171], v[76:79]
ds_read_b64_tr_b16 a[42:43], v202 offset:45056
v_mfma_f32_16x16x32_bf16 v[76:79], a[44:47], a[172:175], v[76:79]
v_mfma_f32_16x16x32_bf16 v[44:47], a[44:47], a[140:143], v[44:47]
buffer_load_dwordx4 v247, s[12:15], 0 offen offset:3072 lds
v_mfma_f32_16x16x32_bf16 v[44:47], a[12:15], a[136:139], v[44:47]
ds_read_b64_tr_b16 a[12:13], v203 offset:32768
v_mfma_f32_16x16x32_bf16 v[48:51], a[16:19], a[136:139], v[48:51]
ds_read_b64_tr_b16 a[14:15], v203 offset:36864
v_mfma_f32_16x16x32_bf16 v[48:51], a[48:51], a[140:143], v[48:51]
ds_read_b64_tr_b16 a[44:45], v203 offset:40960
v_mfma_f32_16x16x32_bf16 v[80:83], a[48:51], a[172:175], v[80:83]
ds_read_b64_tr_b16 a[46:47], v203 offset:45056
v_mfma_f32_16x16x32_bf16 v[80:83], a[16:19], a[168:171], v[80:83]
buffer_load_dwordx4 a[104:107], v155, s[8:11], s23 offen offset:2048 sc1
v_mfma_f32_16x16x32_bf16 v[112:115], a[16:19], a[200:203], v[112:115]
v_mfma_f32_16x16x32_bf16 v[112:115], a[48:51], a[204:207], v[112:115]
s_waitcnt lgkmcnt(5)
ds_read_b64_tr_b16 a[16:17], v204 offset:32768
v_mfma_f32_16x16x32_bf16 v[116:119], a[52:55], a[204:207], v[116:119]
ds_read_b64_tr_b16 a[18:19], v204 offset:36864
v_mfma_f32_16x16x32_bf16 v[116:119], a[20:23], a[200:203], v[116:119]
buffer_load_dwordx4 a[108:111], v155, s[8:11], s23 offen offset:3072 sc1
ds_read_b64_tr_b16 a[48:49], v204 offset:40960
v_mfma_f32_16x16x32_bf16 v[84:87], a[20:23], a[168:171], v[84:87]
ds_read_b64_tr_b16 a[50:51], v204 offset:45056
v_mfma_f32_16x16x32_bf16 v[84:87], a[52:55], a[172:175], v[84:87]
v_mfma_f32_16x16x32_bf16 v[52:55], a[52:55], a[140:143], v[52:55]
v_mfma_f32_16x16x32_bf16 v[52:55], a[20:23], a[136:139], v[52:55]
ds_read_b64_tr_b16 a[20:21], v205 offset:32768
v_mfma_f32_16x16x32_bf16 v[56:59], a[24:27], a[136:139], v[56:59]
buffer_load_dwordx4 a[112:115], v156, s[8:11], s23 offen offset:1024 sc1
ds_read_b64_tr_b16 a[22:23], v205 offset:36864
v_mfma_f32_16x16x32_bf16 v[56:59], a[56:59], a[140:143], v[56:59]
ds_read_b64_tr_b16 a[52:53], v205 offset:40960
v_mfma_f32_16x16x32_bf16 v[88:91], a[56:59], a[172:175], v[88:91]
ds_read_b64_tr_b16 a[54:55], v205 offset:45056
v_mfma_f32_16x16x32_bf16 v[88:91], a[24:27], a[168:171], v[88:91]
v_mfma_f32_16x16x32_bf16 v[120:123], a[24:27], a[200:203], v[120:123]
buffer_load_dwordx4 a[116:119], v156, s[8:11], s23 offen offset:2048 sc1
v_mfma_f32_16x16x32_bf16 v[120:123], a[56:59], a[204:207], v[120:123]
ds_read_b64_tr_b16 a[24:25], v206 offset:32768
v_mfma_f32_16x16x32_bf16 v[124:127], a[60:63], a[204:207], v[124:127]
ds_read_b64_tr_b16 a[26:27], v206 offset:36864
v_mfma_f32_16x16x32_bf16 v[124:127], a[28:31], a[200:203], v[124:127]
ds_read_b64_tr_b16 a[56:57], v206 offset:40960
v_mfma_f32_16x16x32_bf16 v[92:95], a[28:31], a[168:171], v[92:95]
ds_read_b64_tr_b16 a[58:59], v206 offset:45056
v_mfma_f32_16x16x32_bf16 v[92:95], a[60:63], a[172:175], v[92:95]
buffer_load_dwordx4 a[168:171], v152, s[8:11], s99 offen offset:2048 sc1
v_mfma_f32_16x16x32_bf16 v[60:63], a[60:63], a[140:143], v[60:63]
v_mfma_f32_16x16x32_bf16 v[60:63], a[28:31], a[136:139], v[60:63]
s_waitcnt vmcnt(27)
ds_read_b64_tr_b16 a[28:29], v207 offset:32768
v_mfma_f32_16x16x32_bf16 v[32:35], a[0:3], a[144:147], v[32:35]
ds_read_b64_tr_b16 a[30:31], v207 offset:36864
v_mfma_f32_16x16x32_bf16 v[32:35], a[32:35], a[148:151], v[32:35]
buffer_load_dwordx4 a[136:139], v152, s[8:11], s98 offen offset:2048 sc1
ds_read_b64_tr_b16 a[60:61], v207 offset:40960
v_mfma_f32_16x16x32_bf16 v[64:67], a[32:35], a[180:183], v[64:67]
ds_read_b64_tr_b16 a[62:63], v207 offset:45056
v_mfma_f32_16x16x32_bf16 v[64:67], a[0:3], a[176:179], v[64:67]
v_mfma_f32_16x16x32_bf16 v[96:99], a[0:3], a[208:211], v[96:99]
v_mfma_f32_16x16x32_bf16 v[96:99], a[32:35], a[212:215], v[96:99]
s_barrier
ds_read_b64_tr_b16 a[0:1], v200 offset:0
v_mfma_f32_16x16x32_bf16 v[100:103], a[36:39], a[212:215], v[100:103]
buffer_load_dwordx4 a[140:143], v154, s[8:11], s98 offen offset:1024 sc1
ds_read_b64_tr_b16 a[2:3], v200 offset:4096
v_mfma_f32_16x16x32_bf16 v[100:103], a[4:7], a[208:211], v[100:103]
ds_read_b64_tr_b16 a[32:33], v200 offset:8192
v_mfma_f32_16x16x32_bf16 v[68:71], a[4:7], a[176:179], v[68:71]
ds_read_b64_tr_b16 a[34:35], v200 offset:12288
v_mfma_f32_16x16x32_bf16 v[68:71], a[36:39], a[180:183], v[68:71]
v_mfma_f32_16x16x32_bf16 v[36:39], a[36:39], a[148:151], v[36:39]
buffer_load_dwordx4 a[172:175], v154, s[8:11], s99 offen offset:1024 sc1
v_mfma_f32_16x16x32_bf16 v[36:39], a[4:7], a[144:147], v[36:39]
s_waitcnt lgkmcnt(5)
ds_read_b64_tr_b16 a[4:5], v201 offset:0
v_mfma_f32_16x16x32_bf16 v[40:43], a[8:11], a[144:147], v[40:43]
ds_read_b64_tr_b16 a[6:7], v201 offset:4096
v_mfma_f32_16x16x32_bf16 v[40:43], a[40:43], a[148:151], v[40:43]
ds_read_b64_tr_b16 a[36:37], v201 offset:8192
v_mfma_f32_16x16x32_bf16 v[72:75], a[40:43], a[180:183], v[72:75]
ds_read_b64_tr_b16 a[38:39], v201 offset:12288
v_mfma_f32_16x16x32_bf16 v[72:75], a[8:11], a[176:179], v[72:75]
buffer_load_dwordx4 a[200:203], v152, s[8:11], s60 offen offset:2048 sc1
v_mfma_f32_16x16x32_bf16 v[104:107], a[8:11], a[208:211], v[104:107]
v_mfma_f32_16x16x32_bf16 v[104:107], a[40:43], a[212:215], v[104:107]
ds_read_b64_tr_b16 a[8:9], v202 offset:0
v_mfma_f32_16x16x32_bf16 v[108:111], a[44:47], a[212:215], v[108:111]
ds_read_b64_tr_b16 a[10:11], v202 offset:4096
v_mfma_f32_16x16x32_bf16 v[108:111], a[12:15], a[208:211], v[108:111]
buffer_load_dwordx4 a[204:207], v154, s[8:11], s60 offen offset:1024 sc1
ds_read_b64_tr_b16 a[40:41], v202 offset:8192
v_mfma_f32_16x16x32_bf16 v[76:79], a[12:15], a[176:179], v[76:79]
ds_read_b64_tr_b16 a[42:43], v202 offset:12288
v_mfma_f32_16x16x32_bf16 v[76:79], a[44:47], a[180:183], v[76:79]
v_mfma_f32_16x16x32_bf16 v[44:47], a[44:47], a[148:151], v[44:47]
v_mfma_f32_16x16x32_bf16 v[44:47], a[12:15], a[144:147], v[44:47]
ds_read_b64_tr_b16 a[12:13], v203 offset:0
v_mfma_f32_16x16x32_bf16 v[48:51], a[16:19], a[144:147], v[48:51]
buffer_load_dwordx4 a[120:123], v157, s[8:11], s23 offen offset:1024 sc1
ds_read_b64_tr_b16 a[14:15], v203 offset:4096
v_mfma_f32_16x16x32_bf16 v[48:51], a[48:51], a[148:151], v[48:51]
ds_read_b64_tr_b16 a[44:45], v203 offset:8192
v_mfma_f32_16x16x32_bf16 v[80:83], a[48:51], a[180:183], v[80:83]
ds_read_b64_tr_b16 a[46:47], v203 offset:12288
v_mfma_f32_16x16x32_bf16 v[80:83], a[16:19], a[176:179], v[80:83]
v_mfma_f32_16x16x32_bf16 v[112:115], a[16:19], a[208:211], v[112:115]
buffer_load_dwordx4 a[124:127], v157, s[8:11], s23 offen offset:2048 sc1
v_mfma_f32_16x16x32_bf16 v[112:115], a[48:51], a[212:215], v[112:115]
ds_read_b64_tr_b16 a[16:17], v204 offset:0
v_mfma_f32_16x16x32_bf16 v[116:119], a[52:55], a[212:215], v[116:119]
ds_read_b64_tr_b16 a[18:19], v204 offset:4096
v_mfma_f32_16x16x32_bf16 v[116:119], a[20:23], a[208:211], v[116:119]
ds_read_b64_tr_b16 a[48:49], v204 offset:8192
v_mfma_f32_16x16x32_bf16 v[84:87], a[20:23], a[176:179], v[84:87]
ds_read_b64_tr_b16 a[50:51], v204 offset:12288
v_mfma_f32_16x16x32_bf16 v[84:87], a[52:55], a[180:183], v[84:87]
buffer_load_dwordx4 a[128:131], v172, s[8:11], s23 offen offset:2048 sc1
v_mfma_f32_16x16x32_bf16 v[52:55], a[52:55], a[148:151], v[52:55]
v_mfma_f32_16x16x32_bf16 v[52:55], a[20:23], a[144:147], v[52:55]
ds_read_b64_tr_b16 a[20:21], v205 offset:0
v_mfma_f32_16x16x32_bf16 v[56:59], a[24:27], a[144:147], v[56:59]
ds_read_b64_tr_b16 a[22:23], v205 offset:4096
v_mfma_f32_16x16x32_bf16 v[56:59], a[56:59], a[148:151], v[56:59]
buffer_load_dwordx4 a[132:135], v172, s[8:11], s23 offen offset:3072 sc1
ds_read_b64_tr_b16 a[52:53], v205 offset:8192
v_mfma_f32_16x16x32_bf16 v[88:91], a[56:59], a[180:183], v[88:91]
ds_read_b64_tr_b16 a[54:55], v205 offset:12288
v_mfma_f32_16x16x32_bf16 v[88:91], a[24:27], a[176:179], v[88:91]
v_mfma_f32_16x16x32_bf16 v[120:123], a[24:27], a[208:211], v[120:123]
v_mfma_f32_16x16x32_bf16 v[120:123], a[56:59], a[212:215], v[120:123]
s_waitcnt lgkmcnt(5)
ds_read_b64_tr_b16 a[24:25], v206 offset:0
v_mfma_f32_16x16x32_bf16 v[124:127], a[60:63], a[212:215], v[124:127]
buffer_load_dwordx4 a[64:67], v153, s[8:11], s23 offen offset:1024 sc1
ds_read_b64_tr_b16 a[26:27], v206 offset:4096
v_mfma_f32_16x16x32_bf16 v[124:127], a[28:31], a[208:211], v[124:127]
ds_read_b64_tr_b16 a[56:57], v206 offset:8192
v_mfma_f32_16x16x32_bf16 v[92:95], a[28:31], a[176:179], v[92:95]
ds_read_b64_tr_b16 a[58:59], v206 offset:12288
v_mfma_f32_16x16x32_bf16 v[92:95], a[60:63], a[180:183], v[92:95]
v_mfma_f32_16x16x32_bf16 v[60:63], a[60:63], a[148:151], v[60:63]
buffer_load_dwordx4 a[176:179], v156, s[8:11], s99 offen offset:0 sc1
v_mfma_f32_16x16x32_bf16 v[60:63], a[28:31], a[144:147], v[60:63]
s_waitcnt vmcnt(27)
ds_read_b64_tr_b16 a[28:29], v207 offset:0
v_mfma_f32_16x16x32_bf16 v[32:35], a[0:3], a[152:155], v[32:35]
ds_read_b64_tr_b16 a[30:31], v207 offset:4096
v_mfma_f32_16x16x32_bf16 v[32:35], a[32:35], a[156:159], v[32:35]
ds_read_b64_tr_b16 a[60:61], v207 offset:8192
v_mfma_f32_16x16x32_bf16 v[64:67], a[32:35], a[188:191], v[64:67]
ds_read_b64_tr_b16 a[62:63], v207 offset:12288
v_mfma_f32_16x16x32_bf16 v[64:67], a[0:3], a[184:187], v[64:67]
buffer_load_dwordx4 a[144:147], v156, s[8:11], s98 offen offset:0 sc1
v_mfma_f32_16x16x32_bf16 v[96:99], a[0:3], a[216:219], v[96:99]
v_mfma_f32_16x16x32_bf16 v[96:99], a[32:35], a[220:223], v[96:99]
s_barrier
ds_read_b64_tr_b16 a[0:1], v200 offset:16384
v_mfma_f32_16x16x32_bf16 v[100:103], a[36:39], a[220:223], v[100:103]
ds_read_b64_tr_b16 a[2:3], v200 offset:20480
v_mfma_f32_16x16x32_bf16 v[100:103], a[4:7], a[216:219], v[100:103]
buffer_load_dwordx4 a[148:151], v157, s[8:11], s98 offen offset:3072 sc1
ds_read_b64_tr_b16 a[32:33], v200 offset:24576
v_mfma_f32_16x16x32_bf16 v[68:71], a[4:7], a[184:187], v[68:71]
ds_read_b64_tr_b16 a[34:35], v200 offset:28672
v_mfma_f32_16x16x32_bf16 v[68:71], a[36:39], a[188:191], v[68:71]
v_mfma_f32_16x16x32_bf16 v[36:39], a[36:39], a[156:159], v[36:39]
v_mfma_f32_16x16x32_bf16 v[36:39], a[4:7], a[152:155], v[36:39]
ds_read_b64_tr_b16 a[4:5], v201 offset:16384
v_mfma_f32_16x16x32_bf16 v[40:43], a[8:11], a[152:155], v[40:43]
buffer_load_dwordx4 a[180:183], v157, s[8:11], s99 offen offset:3072 sc1
ds_read_b64_tr_b16 a[6:7], v201 offset:20480
v_mfma_f32_16x16x32_bf16 v[40:43], a[40:43], a[156:159], v[40:43]
ds_read_b64_tr_b16 a[36:37], v201 offset:24576
v_mfma_f32_16x16x32_bf16 v[72:75], a[40:43], a[188:191], v[72:75]
ds_read_b64_tr_b16 a[38:39], v201 offset:28672
v_mfma_f32_16x16x32_bf16 v[72:75], a[8:11], a[184:187], v[72:75]
v_mfma_f32_16x16x32_bf16 v[104:107], a[8:11], a[216:219], v[104:107]
buffer_load_dwordx4 a[208:211], v156, s[8:11], s60 offen offset:0 sc1
v_mfma_f32_16x16x32_bf16 v[104:107], a[40:43], a[220:223], v[104:107]
ds_read_b64_tr_b16 a[8:9], v202 offset:16384
v_mfma_f32_16x16x32_bf16 v[108:111], a[44:47], a[220:223], v[108:111]
ds_read_b64_tr_b16 a[10:11], v202 offset:20480
v_mfma_f32_16x16x32_bf16 v[108:111], a[12:15], a[216:219], v[108:111]
ds_read_b64_tr_b16 a[40:41], v202 offset:24576
v_mfma_f32_16x16x32_bf16 v[76:79], a[12:15], a[184:187], v[76:79]
ds_read_b64_tr_b16 a[42:43], v202 offset:28672
v_mfma_f32_16x16x32_bf16 v[76:79], a[44:47], a[188:191], v[76:79]
buffer_load_dwordx4 a[212:215], v157, s[8:11], s60 offen offset:3072 sc1
v_mfma_f32_16x16x32_bf16 v[44:47], a[44:47], a[156:159], v[44:47]
v_mfma_f32_16x16x32_bf16 v[44:47], a[12:15], a[152:155], v[44:47]
s_waitcnt lgkmcnt(5)
ds_read_b64_tr_b16 a[12:13], v203 offset:16384
v_mfma_f32_16x16x32_bf16 v[48:51], a[16:19], a[152:155], v[48:51]
ds_read_b64_tr_b16 a[14:15], v203 offset:20480
v_mfma_f32_16x16x32_bf16 v[48:51], a[48:51], a[156:159], v[48:51]
buffer_load_dwordx4 a[68:71], v153, s[8:11], s23 offen offset:2048 sc1
ds_read_b64_tr_b16 a[44:45], v203 offset:24576
v_mfma_f32_16x16x32_bf16 v[80:83], a[48:51], a[188:191], v[80:83]
ds_read_b64_tr_b16 a[46:47], v203 offset:28672
v_mfma_f32_16x16x32_bf16 v[80:83], a[16:19], a[184:187], v[80:83]
v_mfma_f32_16x16x32_bf16 v[112:115], a[16:19], a[216:219], v[112:115]
v_mfma_f32_16x16x32_bf16 v[112:115], a[48:51], a[220:223], v[112:115]
ds_read_b64_tr_b16 a[16:17], v204 offset:16384
v_mfma_f32_16x16x32_bf16 v[116:119], a[52:55], a[220:223], v[116:119]
buffer_load_dwordx4 a[72:75], v155, s[8:11], s23 offen offset:0 sc1
ds_read_b64_tr_b16 a[18:19], v204 offset:20480
v_mfma_f32_16x16x32_bf16 v[116:119], a[20:23], a[216:219], v[116:119]
ds_read_b64_tr_b16 a[48:49], v204 offset:24576
v_mfma_f32_16x16x32_bf16 v[84:87], a[20:23], a[184:187], v[84:87]
ds_read_b64_tr_b16 a[50:51], v204 offset:28672
v_mfma_f32_16x16x32_bf16 v[84:87], a[52:55], a[188:191], v[84:87]
v_mfma_f32_16x16x32_bf16 v[52:55], a[52:55], a[156:159], v[52:55]
buffer_load_dwordx4 a[76:79], v155, s[8:11], s23 offen offset:1024 sc1
v_mfma_f32_16x16x32_bf16 v[52:55], a[20:23], a[152:155], v[52:55]
ds_read_b64_tr_b16 a[20:21], v205 offset:16384
v_mfma_f32_16x16x32_bf16 v[56:59], a[24:27], a[152:155], v[56:59]
ds_read_b64_tr_b16 a[22:23], v205 offset:20480
v_mfma_f32_16x16x32_bf16 v[56:59], a[56:59], a[156:159], v[56:59]
ds_read_b64_tr_b16 a[52:53], v205 offset:24576
v_mfma_f32_16x16x32_bf16 v[88:91], a[56:59], a[188:191], v[88:91]
ds_read_b64_tr_b16 a[54:55], v205 offset:28672
v_mfma_f32_16x16x32_bf16 v[88:91], a[24:27], a[184:187], v[88:91]
buffer_load_dwordx4 a[80:83], v156, s[8:11], s23 offen offset:3072 sc1
v_mfma_f32_16x16x32_bf16 v[120:123], a[24:27], a[216:219], v[120:123]
v_mfma_f32_16x16x32_bf16 v[120:123], a[56:59], a[220:223], v[120:123]
ds_read_b64_tr_b16 a[24:25], v206 offset:16384
v_mfma_f32_16x16x32_bf16 v[124:127], a[60:63], a[220:223], v[124:127]
ds_read_b64_tr_b16 a[26:27], v206 offset:20480
v_mfma_f32_16x16x32_bf16 v[124:127], a[28:31], a[216:219], v[124:127]
buffer_load_dwordx4 a[84:87], v157, s[8:11], s23 offen offset:0 sc1
ds_read_b64_tr_b16 a[56:57], v206 offset:24576
v_mfma_f32_16x16x32_bf16 v[92:95], a[28:31], a[184:187], v[92:95]
ds_read_b64_tr_b16 a[58:59], v206 offset:28672
v_mfma_f32_16x16x32_bf16 v[92:95], a[60:63], a[188:191], v[92:95]
v_mfma_f32_16x16x32_bf16 v[60:63], a[60:63], a[156:159], v[60:63]
v_mfma_f32_16x16x32_bf16 v[60:63], a[28:31], a[152:155], v[60:63]
s_waitcnt vmcnt(26)
ds_read_b64_tr_b16 a[28:29], v207 offset:16384
v_mfma_f32_16x16x32_bf16 v[32:35], a[0:3], a[160:163], v[32:35]
buffer_load_dwordx4 a[88:91], v152, s[8:11], s23 offen offset:2048 sc1
ds_read_b64_tr_b16 a[30:31], v207 offset:20480
v_mfma_f32_16x16x32_bf16 v[32:35], a[32:35], a[164:167], v[32:35]
ds_read_b64_tr_b16 a[60:61], v207 offset:24576
v_mfma_f32_16x16x32_bf16 v[64:67], a[32:35], a[196:199], v[64:67]
ds_read_b64_tr_b16 a[62:63], v207 offset:28672
v_mfma_f32_16x16x32_bf16 v[64:67], a[0:3], a[192:195], v[64:67]
v_mfma_f32_16x16x32_bf16 v[96:99], a[0:3], a[224:227], v[96:99]
buffer_load_dwordx4 a[92:95], v154, s[8:11], s23 offen offset:1024 sc1
v_mfma_f32_16x16x32_bf16 v[96:99], a[32:35], a[228:231], v[96:99]
s_barrier
s_waitcnt lgkmcnt(5)
ds_read_b64_tr_b16 a[0:1], v208 offset:49152
v_mfma_f32_16x16x32_bf16 v[100:103], a[36:39], a[228:231], v[100:103]
ds_read_b64_tr_b16 a[2:3], v208 offset:53248
v_mfma_f32_16x16x32_bf16 v[100:103], a[4:7], a[224:227], v[100:103]
ds_read_b64_tr_b16 a[32:33], v208 offset:57344
v_mfma_f32_16x16x32_bf16 v[68:71], a[4:7], a[192:195], v[68:71]
ds_read_b64_tr_b16 a[34:35], v208 offset:61440
v_mfma_f32_16x16x32_bf16 v[68:71], a[36:39], a[196:199], v[68:71]
buffer_load_dwordx4 a[96:99], v156, s[8:11], s23 offen offset:0 sc1
v_mfma_f32_16x16x32_bf16 v[36:39], a[36:39], a[164:167], v[36:39]
v_mfma_f32_16x16x32_bf16 v[36:39], a[4:7], a[160:163], v[36:39]
ds_read_b64_tr_b16 a[4:5], v209 offset:49152
v_mfma_f32_16x16x32_bf16 v[40:43], a[8:11], a[160:163], v[40:43]
ds_read_b64_tr_b16 a[6:7], v209 offset:53248
v_mfma_f32_16x16x32_bf16 v[40:43], a[40:43], a[164:167], v[40:43]
buffer_load_dwordx4 a[100:103], v157, s[8:11], s23 offen offset:3072 sc1
ds_read_b64_tr_b16 a[36:37], v209 offset:57344
v_mfma_f32_16x16x32_bf16 v[72:75], a[40:43], a[196:199], v[72:75]
ds_read_b64_tr_b16 a[38:39], v209 offset:61440
v_mfma_f32_16x16x32_bf16 v[72:75], a[8:11], a[192:195], v[72:75]
v_mfma_f32_16x16x32_bf16 v[104:107], a[8:11], a[224:227], v[104:107]
v_mfma_f32_16x16x32_bf16 v[104:107], a[40:43], a[228:231], v[104:107]
ds_read_b64_tr_b16 a[8:9], v210 offset:49152
v_mfma_f32_16x16x32_bf16 v[108:111], a[44:47], a[228:231], v[108:111]
ds_read_b64_tr_b16 a[10:11], v210 offset:53248
v_mfma_f32_16x16x32_bf16 v[108:111], a[12:15], a[224:227], v[108:111]
ds_read_b64_tr_b16 a[40:41], v210 offset:57344
v_mfma_f32_16x16x32_bf16 v[76:79], a[12:15], a[192:195], v[76:79]
ds_read_b64_tr_b16 a[42:43], v210 offset:61440
v_mfma_f32_16x16x32_bf16 v[76:79], a[44:47], a[196:199], v[76:79]
v_mfma_f32_16x16x32_bf16 v[44:47], a[44:47], a[164:167], v[44:47]
v_mfma_f32_16x16x32_bf16 v[44:47], a[12:15], a[160:163], v[44:47]
ds_read_b64_tr_b16 a[12:13], v211 offset:49152
v_mfma_f32_16x16x32_bf16 v[48:51], a[16:19], a[160:163], v[48:51]
ds_read_b64_tr_b16 a[14:15], v211 offset:53248
v_mfma_f32_16x16x32_bf16 v[48:51], a[48:51], a[164:167], v[48:51]
ds_read_b64_tr_b16 a[44:45], v211 offset:57344
v_mfma_f32_16x16x32_bf16 v[80:83], a[48:51], a[196:199], v[80:83]
ds_read_b64_tr_b16 a[46:47], v211 offset:61440
v_mfma_f32_16x16x32_bf16 v[80:83], a[16:19], a[192:195], v[80:83]
v_mfma_f32_16x16x32_bf16 v[112:115], a[16:19], a[224:227], v[112:115]
v_mfma_f32_16x16x32_bf16 v[112:115], a[48:51], a[228:231], v[112:115]
ds_read_b64_tr_b16 a[16:17], v212 offset:49152
v_mfma_f32_16x16x32_bf16 v[116:119], a[52:55], a[228:231], v[116:119]
ds_read_b64_tr_b16 a[18:19], v212 offset:53248
v_mfma_f32_16x16x32_bf16 v[116:119], a[20:23], a[224:227], v[116:119]
ds_read_b64_tr_b16 a[48:49], v212 offset:57344
v_mfma_f32_16x16x32_bf16 v[84:87], a[20:23], a[192:195], v[84:87]
ds_read_b64_tr_b16 a[50:51], v212 offset:61440
v_mfma_f32_16x16x32_bf16 v[84:87], a[52:55], a[196:199], v[84:87]
v_mfma_f32_16x16x32_bf16 v[52:55], a[52:55], a[164:167], v[52:55]
v_mfma_f32_16x16x32_bf16 v[52:55], a[20:23], a[160:163], v[52:55]
s_waitcnt lgkmcnt(5)
ds_read_b64_tr_b16 a[20:21], v213 offset:49152
v_mfma_f32_16x16x32_bf16 v[56:59], a[24:27], a[160:163], v[56:59]
ds_read_b64_tr_b16 a[22:23], v213 offset:53248
v_mfma_f32_16x16x32_bf16 v[56:59], a[56:59], a[164:167], v[56:59]
ds_read_b64_tr_b16 a[52:53], v213 offset:57344
v_mfma_f32_16x16x32_bf16 v[88:91], a[56:59], a[196:199], v[88:91]
ds_read_b64_tr_b16 a[54:55], v213 offset:61440
v_mfma_f32_16x16x32_bf16 v[88:91], a[24:27], a[192:195], v[88:91]
v_mfma_f32_16x16x32_bf16 v[120:123], a[24:27], a[224:227], v[120:123]
v_mfma_f32_16x16x32_bf16 v[120:123], a[56:59], a[228:231], v[120:123]
ds_read_b64_tr_b16 a[24:25], v214 offset:49152
v_mfma_f32_16x16x32_bf16 v[124:127], a[60:63], a[228:231], v[124:127]
ds_read_b64_tr_b16 a[26:27], v214 offset:53248
v_mfma_f32_16x16x32_bf16 v[124:127], a[28:31], a[224:227], v[124:127]
ds_read_b64_tr_b16 a[56:57], v214 offset:57344
v_mfma_f32_16x16x32_bf16 v[92:95], a[28:31], a[192:195], v[92:95]
ds_read_b64_tr_b16 a[58:59], v214 offset:61440
v_mfma_f32_16x16x32_bf16 v[92:95], a[60:63], a[196:199], v[92:95]
v_mfma_f32_16x16x32_bf16 v[60:63], a[60:63], a[164:167], v[60:63]
v_mfma_f32_16x16x32_bf16 v[60:63], a[28:31], a[160:163], v[60:63]
s_waitcnt vmcnt(20)
ds_read_b64_tr_b16 a[28:29], v215 offset:49152
v_mfma_f32_16x16x32_bf16 v[32:35], a[0:3], a[136:139], v[32:35]
ds_read_b64_tr_b16 a[30:31], v215 offset:53248
v_mfma_f32_16x16x32_bf16 v[32:35], a[32:35], a[140:143], v[32:35]
ds_read_b64_tr_b16 a[60:61], v215 offset:57344
v_mfma_f32_16x16x32_bf16 v[64:67], a[32:35], a[172:175], v[64:67]
ds_read_b64_tr_b16 a[62:63], v215 offset:61440
v_mfma_f32_16x16x32_bf16 v[64:67], a[0:3], a[168:171], v[64:67]
v_mfma_f32_16x16x32_bf16 v[96:99], a[0:3], a[200:203], v[96:99]
v_mfma_f32_16x16x32_bf16 v[96:99], a[32:35], a[204:207], v[96:99]
s_barrier
ds_read_b64_tr_b16 a[0:1], v216 offset:0
v_mfma_f32_16x16x32_bf16 v[100:103], a[36:39], a[204:207], v[100:103]
ds_read_b64_tr_b16 a[2:3], v216 offset:4096
v_mfma_f32_16x16x32_bf16 v[100:103], a[4:7], a[200:203], v[100:103]
ds_read_b64_tr_b16 a[32:33], v216 offset:8192
v_mfma_f32_16x16x32_bf16 v[68:71], a[4:7], a[168:171], v[68:71]
ds_read_b64_tr_b16 a[34:35], v216 offset:12288
v_mfma_f32_16x16x32_bf16 v[68:71], a[36:39], a[172:175], v[68:71]
v_mfma_f32_16x16x32_bf16 v[36:39], a[36:39], a[140:143], v[36:39]
v_mfma_f32_16x16x32_bf16 v[36:39], a[4:7], a[136:139], v[36:39]
ds_read_b64_tr_b16 a[4:5], v217 offset:0
v_mfma_f32_16x16x32_bf16 v[40:43], a[8:11], a[136:139], v[40:43]
ds_read_b64_tr_b16 a[6:7], v217 offset:4096
v_mfma_f32_16x16x32_bf16 v[40:43], a[40:43], a[140:143], v[40:43]
ds_read_b64_tr_b16 a[36:37], v217 offset:8192
v_mfma_f32_16x16x32_bf16 v[72:75], a[40:43], a[172:175], v[72:75]
ds_read_b64_tr_b16 a[38:39], v217 offset:12288
v_mfma_f32_16x16x32_bf16 v[72:75], a[8:11], a[168:171], v[72:75]
v_mfma_f32_16x16x32_bf16 v[104:107], a[8:11], a[200:203], v[104:107]
v_mfma_f32_16x16x32_bf16 v[104:107], a[40:43], a[204:207], v[104:107]
s_waitcnt lgkmcnt(5)
ds_read_b64_tr_b16 a[8:9], v218 offset:0
v_mfma_f32_16x16x32_bf16 v[108:111], a[44:47], a[204:207], v[108:111]
ds_read_b64_tr_b16 a[10:11], v218 offset:4096
v_mfma_f32_16x16x32_bf16 v[108:111], a[12:15], a[200:203], v[108:111]
ds_read_b64_tr_b16 a[40:41], v218 offset:8192
v_mfma_f32_16x16x32_bf16 v[76:79], a[12:15], a[168:171], v[76:79]
ds_read_b64_tr_b16 a[42:43], v218 offset:12288
v_mfma_f32_16x16x32_bf16 v[76:79], a[44:47], a[172:175], v[76:79]
v_mfma_f32_16x16x32_bf16 v[44:47], a[44:47], a[140:143], v[44:47]
v_mfma_f32_16x16x32_bf16 v[44:47], a[12:15], a[136:139], v[44:47]
ds_read_b64_tr_b16 a[12:13], v219 offset:0
v_mfma_f32_16x16x32_bf16 v[48:51], a[16:19], a[136:139], v[48:51]
ds_read_b64_tr_b16 a[14:15], v219 offset:4096
v_mfma_f32_16x16x32_bf16 v[48:51], a[48:51], a[140:143], v[48:51]
ds_read_b64_tr_b16 a[44:45], v219 offset:8192
v_mfma_f32_16x16x32_bf16 v[80:83], a[48:51], a[172:175], v[80:83]
ds_read_b64_tr_b16 a[46:47], v219 offset:12288
v_mfma_f32_16x16x32_bf16 v[80:83], a[16:19], a[168:171], v[80:83]
v_mfma_f32_16x16x32_bf16 v[112:115], a[16:19], a[200:203], v[112:115]
v_mfma_f32_16x16x32_bf16 v[112:115], a[48:51], a[204:207], v[112:115]
ds_read_b64_tr_b16 a[16:17], v220 offset:0
v_mfma_f32_16x16x32_bf16 v[116:119], a[52:55], a[204:207], v[116:119]
ds_read_b64_tr_b16 a[18:19], v220 offset:4096
v_mfma_f32_16x16x32_bf16 v[116:119], a[20:23], a[200:203], v[116:119]
ds_read_b64_tr_b16 a[48:49], v220 offset:8192
v_mfma_f32_16x16x32_bf16 v[84:87], a[20:23], a[168:171], v[84:87]
ds_read_b64_tr_b16 a[50:51], v220 offset:12288
v_mfma_f32_16x16x32_bf16 v[84:87], a[52:55], a[172:175], v[84:87]
v_mfma_f32_16x16x32_bf16 v[52:55], a[52:55], a[140:143], v[52:55]
v_mfma_f32_16x16x32_bf16 v[52:55], a[20:23], a[136:139], v[52:55]
ds_read_b64_tr_b16 a[20:21], v221 offset:0
v_mfma_f32_16x16x32_bf16 v[56:59], a[24:27], a[136:139], v[56:59]
ds_read_b64_tr_b16 a[22:23], v221 offset:4096
v_mfma_f32_16x16x32_bf16 v[56:59], a[56:59], a[140:143], v[56:59]
ds_read_b64_tr_b16 a[52:53], v221 offset:8192
v_mfma_f32_16x16x32_bf16 v[88:91], a[56:59], a[172:175], v[88:91]
ds_read_b64_tr_b16 a[54:55], v221 offset:12288
v_mfma_f32_16x16x32_bf16 v[88:91], a[24:27], a[168:171], v[88:91]
v_mfma_f32_16x16x32_bf16 v[120:123], a[24:27], a[200:203], v[120:123]
v_mfma_f32_16x16x32_bf16 v[120:123], a[56:59], a[204:207], v[120:123]
ds_read_b64_tr_b16 a[24:25], v222 offset:0
v_mfma_f32_16x16x32_bf16 v[124:127], a[60:63], a[204:207], v[124:127]
ds_read_b64_tr_b16 a[26:27], v222 offset:4096
v_mfma_f32_16x16x32_bf16 v[124:127], a[28:31], a[200:203], v[124:127]
ds_read_b64_tr_b16 a[56:57], v222 offset:8192
v_mfma_f32_16x16x32_bf16 v[92:95], a[28:31], a[168:171], v[92:95]
ds_read_b64_tr_b16 a[58:59], v222 offset:12288
v_mfma_f32_16x16x32_bf16 v[92:95], a[60:63], a[172:175], v[92:95]
v_mfma_f32_16x16x32_bf16 v[60:63], a[60:63], a[140:143], v[60:63]
v_mfma_f32_16x16x32_bf16 v[60:63], a[28:31], a[136:139], v[60:63]
s_waitcnt vmcnt(9) lgkmcnt(5)
ds_read_b64_tr_b16 a[28:29], v223 offset:0
v_mfma_f32_16x16x32_bf16 v[32:35], a[0:3], a[144:147], v[32:35]
ds_read_b64_tr_b16 a[30:31], v223 offset:4096
v_mfma_f32_16x16x32_bf16 v[32:35], a[32:35], a[148:151], v[32:35]
ds_read_b64_tr_b16 a[60:61], v223 offset:8192
v_mfma_f32_16x16x32_bf16 v[64:67], a[32:35], a[180:183], v[64:67]
ds_read_b64_tr_b16 a[62:63], v223 offset:12288
v_mfma_f32_16x16x32_bf16 v[64:67], a[0:3], a[176:179], v[64:67]
v_mfma_f32_16x16x32_bf16 v[96:99], a[0:3], a[208:211], v[96:99]
v_mfma_f32_16x16x32_bf16 v[96:99], a[32:35], a[212:215], v[96:99]
ds_read_b64_tr_b16 a[0:1], v200 offset:49152
v_mfma_f32_16x16x32_bf16 v[100:103], a[36:39], a[212:215], v[100:103]
ds_read_b64_tr_b16 a[2:3], v200 offset:53248
v_mfma_f32_16x16x32_bf16 v[100:103], a[4:7], a[208:211], v[100:103]
ds_read_b64_tr_b16 a[32:33], v200 offset:57344
v_mfma_f32_16x16x32_bf16 v[68:71], a[4:7], a[176:179], v[68:71]
ds_read_b64_tr_b16 a[34:35], v200 offset:61440
v_mfma_f32_16x16x32_bf16 v[68:71], a[36:39], a[180:183], v[68:71]
v_mfma_f32_16x16x32_bf16 v[36:39], a[36:39], a[148:151], v[36:39]
s_waitcnt vmcnt(0)
v_mfma_f32_16x16x32_bf16 v[36:39], a[4:7], a[144:147], v[36:39]
ds_read_b64_tr_b16 a[4:5], v201 offset:49152
v_cvt_pk_bf16_f32 v96, v96, v97
v_mfma_f32_16x16x32_bf16 v[40:43], a[8:11], a[144:147], v[40:43]
ds_read_b64_tr_b16 a[6:7], v201 offset:53248
v_cvt_pk_bf16_f32 v97, v98, v99
v_mfma_f32_16x16x32_bf16 v[40:43], a[40:43], a[148:151], v[40:43]
ds_read_b64_tr_b16 a[36:37], v201 offset:57344
v_cvt_pk_bf16_f32 v98, v100, v101
v_mfma_f32_16x16x32_bf16 v[72:75], a[40:43], a[180:183], v[72:75]
ds_read_b64_tr_b16 a[38:39], v201 offset:61440
v_cvt_pk_bf16_f32 v99, v102, v103
v_mfma_f32_16x16x32_bf16 v[72:75], a[8:11], a[176:179], v[72:75]
buffer_store_dwordx4 v[96:99], v172, s[8:11], s39 offen offset:0 sc1
v_cvt_pk_bf16_f32 v64, v64, v65
v_mfma_f32_16x16x32_bf16 v[104:107], a[8:11], a[208:211], v[104:107]
v_cvt_pk_bf16_f32 v65, v66, v67
v_cvt_pk_bf16_f32 v66, v68, v69
v_mfma_f32_16x16x32_bf16 v[104:107], a[40:43], a[212:215], v[104:107]
ds_read_b64_tr_b16 a[8:9], v202 offset:49152
v_cvt_pk_bf16_f32 v67, v70, v71
v_mfma_f32_16x16x32_bf16 v[108:111], a[44:47], a[212:215], v[108:111]
ds_read_b64_tr_b16 a[10:11], v202 offset:53248
buffer_store_dwordx4 v[64:67], v172, s[8:11], s38 offen offset:0 sc1
v_mfma_f32_16x16x32_bf16 v[108:111], a[12:15], a[208:211], v[108:111]
ds_read_b64_tr_b16 a[40:41], v202 offset:57344
v_cvt_pk_bf16_f32 v32, v32, v33
v_mfma_f32_16x16x32_bf16 v[76:79], a[12:15], a[176:179], v[76:79]
ds_read_b64_tr_b16 a[42:43], v202 offset:61440
v_cvt_pk_bf16_f32 v33, v34, v35
v_mfma_f32_16x16x32_bf16 v[76:79], a[44:47], a[180:183], v[76:79]
v_cvt_pk_bf16_f32 v34, v36, v37
v_cvt_pk_bf16_f32 v35, v38, v39
v_mfma_f32_16x16x32_bf16 v[44:47], a[44:47], a[148:151], v[44:47]
buffer_store_dwordx4 v[32:35], v172, s[8:11], s37 offen offset:0 sc1
v_mfma_f32_16x16x32_bf16 v[44:47], a[12:15], a[144:147], v[44:47]
ds_read_b64_tr_b16 a[12:13], v203 offset:49152
v_cvt_pk_bf16_f32 v104, v104, v105
v_mfma_f32_16x16x32_bf16 v[48:51], a[16:19], a[144:147], v[48:51]
ds_read_b64_tr_b16 a[14:15], v203 offset:53248
v_cvt_pk_bf16_f32 v105, v106, v107
v_mfma_f32_16x16x32_bf16 v[48:51], a[48:51], a[148:151], v[48:51]
ds_read_b64_tr_b16 a[44:45], v203 offset:57344
v_cvt_pk_bf16_f32 v106, v108, v109
v_mfma_f32_16x16x32_bf16 v[80:83], a[48:51], a[180:183], v[80:83]
ds_read_b64_tr_b16 a[46:47], v203 offset:61440
v_cvt_pk_bf16_f32 v107, v110, v111
v_mfma_f32_16x16x32_bf16 v[80:83], a[16:19], a[176:179], v[80:83]
buffer_store_dwordx4 v[104:107], v172, s[8:11], s39 offen offset:1024 sc1
v_cvt_pk_bf16_f32 v72, v72, v73
v_mfma_f32_16x16x32_bf16 v[112:115], a[16:19], a[208:211], v[112:115]
v_cvt_pk_bf16_f32 v73, v74, v75
v_cvt_pk_bf16_f32 v74, v76, v77
v_mfma_f32_16x16x32_bf16 v[112:115], a[48:51], a[212:215], v[112:115]
s_waitcnt lgkmcnt(5)
ds_read_b64_tr_b16 a[16:17], v204 offset:49152
v_cvt_pk_bf16_f32 v75, v78, v79
v_mfma_f32_16x16x32_bf16 v[116:119], a[52:55], a[212:215], v[116:119]
ds_read_b64_tr_b16 a[18:19], v204 offset:53248
buffer_store_dwordx4 v[72:75], v172, s[8:11], s38 offen offset:1024 sc1
v_mfma_f32_16x16x32_bf16 v[116:119], a[20:23], a[208:211], v[116:119]
ds_read_b64_tr_b16 a[48:49], v204 offset:57344
v_cvt_pk_bf16_f32 v40, v40, v41
v_mfma_f32_16x16x32_bf16 v[84:87], a[20:23], a[176:179], v[84:87]
ds_read_b64_tr_b16 a[50:51], v204 offset:61440
v_cvt_pk_bf16_f32 v41, v42, v43
v_mfma_f32_16x16x32_bf16 v[84:87], a[52:55], a[180:183], v[84:87]
v_cvt_pk_bf16_f32 v42, v44, v45
v_cvt_pk_bf16_f32 v43, v46, v47
v_mfma_f32_16x16x32_bf16 v[52:55], a[52:55], a[148:151], v[52:55]
buffer_store_dwordx4 v[40:43], v172, s[8:11], s37 offen offset:1024 sc1
v_mfma_f32_16x16x32_bf16 v[52:55], a[20:23], a[144:147], v[52:55]
ds_read_b64_tr_b16 a[20:21], v205 offset:49152
v_cvt_pk_bf16_f32 v112, v112, v113
v_mfma_f32_16x16x32_bf16 v[56:59], a[24:27], a[144:147], v[56:59]
ds_read_b64_tr_b16 a[22:23], v205 offset:53248
v_cvt_pk_bf16_f32 v113, v114, v115
v_mfma_f32_16x16x32_bf16 v[56:59], a[56:59], a[148:151], v[56:59]
ds_read_b64_tr_b16 a[52:53], v205 offset:57344
v_cvt_pk_bf16_f32 v114, v116, v117
v_mfma_f32_16x16x32_bf16 v[88:91], a[56:59], a[180:183], v[88:91]
ds_read_b64_tr_b16 a[54:55], v205 offset:61440
v_cvt_pk_bf16_f32 v115, v118, v119
v_mfma_f32_16x16x32_bf16 v[88:91], a[24:27], a[176:179], v[88:91]
buffer_store_dwordx4 v[112:115], v172, s[8:11], s39 offen offset:2048 sc1
v_cvt_pk_bf16_f32 v80, v80, v81
v_mfma_f32_16x16x32_bf16 v[120:123], a[24:27], a[208:211], v[120:123]
v_cvt_pk_bf16_f32 v81, v82, v83
v_cvt_pk_bf16_f32 v82, v84, v85
v_mfma_f32_16x16x32_bf16 v[120:123], a[56:59], a[212:215], v[120:123]
ds_read_b64_tr_b16 a[24:25], v206 offset:49152
v_cvt_pk_bf16_f32 v83, v86, v87
v_mfma_f32_16x16x32_bf16 v[124:127], a[60:63], a[212:215], v[124:127]
ds_read_b64_tr_b16 a[26:27], v206 offset:53248
buffer_store_dwordx4 v[80:83], v172, s[8:11], s38 offen offset:2048 sc1
v_mfma_f32_16x16x32_bf16 v[124:127], a[28:31], a[208:211], v[124:127]
ds_read_b64_tr_b16 a[56:57], v206 offset:57344
v_cvt_pk_bf16_f32 v48, v48, v49
v_mfma_f32_16x16x32_bf16 v[92:95], a[28:31], a[176:179], v[92:95]
ds_read_b64_tr_b16 a[58:59], v206 offset:61440
v_cvt_pk_bf16_f32 v49, v50, v51
v_mfma_f32_16x16x32_bf16 v[92:95], a[60:63], a[180:183], v[92:95]
v_cvt_pk_bf16_f32 v50, v52, v53
v_cvt_pk_bf16_f32 v51, v54, v55
v_mfma_f32_16x16x32_bf16 v[60:63], a[60:63], a[148:151], v[60:63]
buffer_store_dwordx4 v[48:51], v172, s[8:11], s37 offen offset:2048 sc1
v_mfma_f32_16x16x32_bf16 v[60:63], a[28:31], a[144:147], v[60:63]
ds_read_b64_tr_b16 a[28:29], v207 offset:49152
v_cvt_pk_bf16_f32 v120, v120, v121
v_mfma_f32_16x16x32_bf16 v[0:3], a[0:3], a[104:107], v[0:3]
ds_read_b64_tr_b16 a[30:31], v207 offset:53248
v_cvt_pk_bf16_f32 v121, v122, v123
v_mfma_f32_16x16x32_bf16 v[0:3], a[32:35], a[108:111], v[0:3]
ds_read_b64_tr_b16 a[60:61], v207 offset:57344
v_cvt_pk_bf16_f32 v122, v124, v125
v_mfma_f32_16x16x32_bf16 v[4:7], a[36:39], a[108:111], v[4:7]
ds_read_b64_tr_b16 a[62:63], v207 offset:61440
ds_read_b64_tr_b16 a[0:1], v208 offset:0
v_mfma_f32_16x16x32_bf16 v[4:7], a[4:7], a[104:107], v[4:7]
s_waitcnt lgkmcnt(8)
ds_read_b64_tr_b16 a[2:3], v208 offset:4096
v_cvt_pk_bf16_f32 v123, v126, v127
v_mfma_f32_16x16x32_bf16 v[8:11], a[8:11], a[104:107], v[8:11]
ds_read_b64_tr_b16 a[32:33], v208 offset:8192
ds_read_b64_tr_b16 a[34:35], v208 offset:12288
v_mfma_f32_16x16x32_bf16 v[8:11], a[40:43], a[108:111], v[8:11]
ds_read_b64_tr_b16 a[4:5], v209 offset:0
buffer_store_dwordx4 v[120:123], v172, s[8:11], s39 offen offset:3072 sc1
v_mfma_f32_16x16x32_bf16 v[12:15], a[44:47], a[108:111], v[12:15]
ds_read_b64_tr_b16 a[6:7], v209 offset:4096
ds_read_b64_tr_b16 a[36:37], v209 offset:8192
v_mfma_f32_16x16x32_bf16 v[12:15], a[12:15], a[104:107], v[12:15]
ds_read_b64_tr_b16 a[38:39], v209 offset:12288
ds_read_b64_tr_b16 a[8:9], v210 offset:0
v_mfma_f32_16x16x32_bf16 v[16:19], a[16:19], a[104:107], v[16:19]
ds_read_b64_tr_b16 a[10:11], v210 offset:4096
ds_read_b64_tr_b16 a[40:41], v210 offset:8192
v_mfma_f32_16x16x32_bf16 v[16:19], a[48:51], a[108:111], v[16:19]
ds_read_b64_tr_b16 a[42:43], v210 offset:12288
ds_read_b64_tr_b16 a[12:13], v211 offset:0
v_cvt_pk_bf16_f32 v88, v88, v89
v_mfma_f32_16x16x32_bf16 v[20:23], a[52:55], a[108:111], v[20:23]
ds_read_b64_tr_b16 a[14:15], v211 offset:4096
ds_read_b64_tr_b16 a[44:45], v211 offset:8192
v_cvt_pk_bf16_f32 v89, v90, v91
v_mfma_f32_16x16x32_bf16 v[20:23], a[20:23], a[104:107], v[20:23]
s_waitcnt lgkmcnt(15)
ds_read_b64_tr_b16 a[46:47], v211 offset:12288
ds_read_b64_tr_b16 a[16:17], v212 offset:0
v_cvt_pk_bf16_f32 v90, v92, v93
v_mfma_f32_16x16x32_bf16 v[24:27], a[24:27], a[104:107], v[24:27]
ds_read_b64_tr_b16 a[18:19], v212 offset:4096
ds_read_b64_tr_b16 a[48:49], v212 offset:8192
v_mfma_f32_16x16x32_bf16 v[24:27], a[56:59], a[108:111], v[24:27]
ds_read_b64_tr_b16 a[50:51], v212 offset:12288
ds_read_b64_tr_b16 a[20:21], v213 offset:0
v_mfma_f32_16x16x32_bf16 v[28:31], a[60:63], a[108:111], v[28:31]
ds_read_b64_tr_b16 a[22:23], v213 offset:4096
ds_read_b64_tr_b16 a[52:53], v213 offset:8192
v_mfma_f32_16x16x32_bf16 v[28:31], a[28:31], a[104:107], v[28:31]
s_waitcnt lgkmcnt(15)
ds_read_b64_tr_b16 a[54:55], v213 offset:12288
ds_read_b64_tr_b16 a[24:25], v214 offset:0
v_mfma_f32_16x16x32_bf16 v[0:3], a[0:3], a[112:115], v[0:3]
ds_read_b64_tr_b16 a[26:27], v214 offset:4096
ds_read_b64_tr_b16 a[56:57], v214 offset:8192
v_mfma_f32_16x16x32_bf16 v[0:3], a[32:35], a[116:119], v[0:3]
ds_read_b64_tr_b16 a[58:59], v214 offset:12288
ds_read_b64_tr_b16 a[28:29], v215 offset:0
v_mfma_f32_16x16x32_bf16 v[4:7], a[36:39], a[116:119], v[4:7]
ds_read_b64_tr_b16 a[30:31], v215 offset:4096
ds_read_b64_tr_b16 a[60:61], v215 offset:8192
v_mfma_f32_16x16x32_bf16 v[4:7], a[4:7], a[112:115], v[4:7]
s_waitcnt lgkmcnt(15)
ds_read_b64_tr_b16 a[62:63], v215 offset:12288
ds_read_b64_tr_b16 a[0:1], v208 offset:16384
v_mfma_f32_16x16x32_bf16 v[8:11], a[8:11], a[112:115], v[8:11]
ds_read_b64_tr_b16 a[2:3], v208 offset:20480
ds_read_b64_tr_b16 a[32:33], v208 offset:24576
v_mfma_f32_16x16x32_bf16 v[8:11], a[40:43], a[116:119], v[8:11]
ds_read_b64_tr_b16 a[34:35], v208 offset:28672
ds_read_b64_tr_b16 a[4:5], v209 offset:16384
v_mfma_f32_16x16x32_bf16 v[12:15], a[44:47], a[116:119], v[12:15]
ds_read_b64_tr_b16 a[6:7], v209 offset:20480
ds_read_b64_tr_b16 a[36:37], v209 offset:24576
v_mfma_f32_16x16x32_bf16 v[12:15], a[12:15], a[112:115], v[12:15]
s_waitcnt lgkmcnt(15)
ds_read_b64_tr_b16 a[38:39], v209 offset:28672
ds_read_b64_tr_b16 a[8:9], v210 offset:16384
v_mfma_f32_16x16x32_bf16 v[16:19], a[16:19], a[112:115], v[16:19]
ds_read_b64_tr_b16 a[10:11], v210 offset:20480
ds_read_b64_tr_b16 a[40:41], v210 offset:24576
v_mfma_f32_16x16x32_bf16 v[16:19], a[48:51], a[116:119], v[16:19]
ds_read_b64_tr_b16 a[42:43], v210 offset:28672
ds_read_b64_tr_b16 a[12:13], v211 offset:16384
v_mfma_f32_16x16x32_bf16 v[20:23], a[52:55], a[116:119], v[20:23]
ds_read_b64_tr_b16 a[14:15], v211 offset:20480
ds_read_b64_tr_b16 a[44:45], v211 offset:24576
v_mfma_f32_16x16x32_bf16 v[20:23], a[20:23], a[112:115], v[20:23]
s_waitcnt lgkmcnt(15)
ds_read_b64_tr_b16 a[46:47], v211 offset:28672
ds_read_b64_tr_b16 a[16:17], v212 offset:16384
v_mfma_f32_16x16x32_bf16 v[24:27], a[24:27], a[112:115], v[24:27]
ds_read_b64_tr_b16 a[18:19], v212 offset:20480
ds_read_b64_tr_b16 a[48:49], v212 offset:24576
v_mfma_f32_16x16x32_bf16 v[24:27], a[56:59], a[116:119], v[24:27]
ds_read_b64_tr_b16 a[50:51], v212 offset:28672
ds_read_b64_tr_b16 a[20:21], v213 offset:16384
v_mfma_f32_16x16x32_bf16 v[28:31], a[60:63], a[116:119], v[28:31]
ds_read_b64_tr_b16 a[22:23], v213 offset:20480
ds_read_b64_tr_b16 a[52:53], v213 offset:24576
v_mfma_f32_16x16x32_bf16 v[28:31], a[28:31], a[112:115], v[28:31]
s_waitcnt lgkmcnt(15)
ds_read_b64_tr_b16 a[54:55], v213 offset:28672
ds_read_b64_tr_b16 a[24:25], v214 offset:16384
v_mfma_f32_16x16x32_bf16 v[0:3], a[0:3], a[120:123], v[0:3]
ds_read_b64_tr_b16 a[26:27], v214 offset:20480
ds_read_b64_tr_b16 a[56:57], v214 offset:24576
v_mfma_f32_16x16x32_bf16 v[0:3], a[32:35], a[124:127], v[0:3]
ds_read_b64_tr_b16 a[58:59], v214 offset:28672
ds_read_b64_tr_b16 a[28:29], v215 offset:16384
v_mfma_f32_16x16x32_bf16 v[4:7], a[36:39], a[124:127], v[4:7]
ds_read_b64_tr_b16 a[30:31], v215 offset:20480
ds_read_b64_tr_b16 a[60:61], v215 offset:24576
v_mfma_f32_16x16x32_bf16 v[4:7], a[4:7], a[120:123], v[4:7]
s_waitcnt lgkmcnt(15)
ds_read_b64_tr_b16 a[62:63], v215 offset:28672
ds_read_b64_tr_b16 a[0:1], v208 offset:32768
v_mfma_f32_16x16x32_bf16 v[8:11], a[8:11], a[120:123], v[8:11]
ds_read_b64_tr_b16 a[2:3], v208 offset:36864
ds_read_b64_tr_b16 a[32:33], v208 offset:40960
v_mfma_f32_16x16x32_bf16 v[8:11], a[40:43], a[124:127], v[8:11]
ds_read_b64_tr_b16 a[34:35], v208 offset:45056
ds_read_b64_tr_b16 a[4:5], v209 offset:32768
v_mfma_f32_16x16x32_bf16 v[12:15], a[44:47], a[124:127], v[12:15]
ds_read_b64_tr_b16 a[6:7], v209 offset:36864
ds_read_b64_tr_b16 a[36:37], v209 offset:40960
v_mfma_f32_16x16x32_bf16 v[12:15], a[12:15], a[120:123], v[12:15]
s_waitcnt lgkmcnt(15)
ds_read_b64_tr_b16 a[38:39], v209 offset:45056
ds_read_b64_tr_b16 a[8:9], v210 offset:32768
v_mfma_f32_16x16x32_bf16 v[16:19], a[16:19], a[120:123], v[16:19]
ds_read_b64_tr_b16 a[10:11], v210 offset:36864
ds_read_b64_tr_b16 a[40:41], v210 offset:40960
v_mfma_f32_16x16x32_bf16 v[16:19], a[48:51], a[124:127], v[16:19]
ds_read_b64_tr_b16 a[42:43], v210 offset:45056
ds_read_b64_tr_b16 a[12:13], v211 offset:32768
v_mfma_f32_16x16x32_bf16 v[20:23], a[52:55], a[124:127], v[20:23]
ds_read_b64_tr_b16 a[14:15], v211 offset:36864
ds_read_b64_tr_b16 a[44:45], v211 offset:40960
v_mfma_f32_16x16x32_bf16 v[20:23], a[20:23], a[120:123], v[20:23]
s_waitcnt lgkmcnt(15)
ds_read_b64_tr_b16 a[46:47], v211 offset:45056
ds_read_b64_tr_b16 a[16:17], v212 offset:32768
v_mfma_f32_16x16x32_bf16 v[24:27], a[24:27], a[120:123], v[24:27]
ds_read_b64_tr_b16 a[18:19], v212 offset:36864
ds_read_b64_tr_b16 a[48:49], v212 offset:40960
v_mfma_f32_16x16x32_bf16 v[24:27], a[56:59], a[124:127], v[24:27]
ds_read_b64_tr_b16 a[50:51], v212 offset:45056
ds_read_b64_tr_b16 a[20:21], v213 offset:32768
v_mfma_f32_16x16x32_bf16 v[28:31], a[60:63], a[124:127], v[28:31]
ds_read_b64_tr_b16 a[22:23], v213 offset:36864
ds_read_b64_tr_b16 a[52:53], v213 offset:40960
v_mfma_f32_16x16x32_bf16 v[28:31], a[28:31], a[120:123], v[28:31]
s_waitcnt lgkmcnt(15)
ds_read_b64_tr_b16 a[54:55], v213 offset:45056
ds_read_b64_tr_b16 a[24:25], v214 offset:32768
v_mfma_f32_16x16x32_bf16 v[0:3], a[0:3], a[128:131], v[0:3]
ds_read_b64_tr_b16 a[26:27], v214 offset:36864
ds_read_b64_tr_b16 a[56:57], v214 offset:40960
v_mfma_f32_16x16x32_bf16 v[0:3], a[32:35], a[132:135], v[0:3]
ds_read_b64_tr_b16 a[58:59], v214 offset:45056
ds_read_b64_tr_b16 a[28:29], v215 offset:32768
v_mfma_f32_16x16x32_bf16 v[4:7], a[36:39], a[132:135], v[4:7]
ds_read_b64_tr_b16 a[30:31], v215 offset:36864
ds_read_b64_tr_b16 a[60:61], v215 offset:40960
v_mfma_f32_16x16x32_bf16 v[4:7], a[4:7], a[128:131], v[4:7]
s_waitcnt lgkmcnt(15)
ds_read_b64_tr_b16 a[62:63], v215 offset:45056
ds_read_b64_tr_b16 a[0:1], v200 offset:32768
v_mfma_f32_16x16x32_bf16 v[8:11], a[8:11], a[128:131], v[8:11]
ds_read_b64_tr_b16 a[2:3], v200 offset:36864
ds_read_b64_tr_b16 a[32:33], v200 offset:40960
v_mfma_f32_16x16x32_bf16 v[8:11], a[40:43], a[132:135], v[8:11]
ds_read_b64_tr_b16 a[34:35], v200 offset:45056
ds_read_b64_tr_b16 a[4:5], v201 offset:32768
v_mfma_f32_16x16x32_bf16 v[12:15], a[44:47], a[132:135], v[12:15]
ds_read_b64_tr_b16 a[6:7], v201 offset:36864
ds_read_b64_tr_b16 a[36:37], v201 offset:40960
v_mfma_f32_16x16x32_bf16 v[12:15], a[12:15], a[128:131], v[12:15]
s_waitcnt lgkmcnt(15)
ds_read_b64_tr_b16 a[38:39], v201 offset:45056
ds_read_b64_tr_b16 a[8:9], v202 offset:32768
v_mfma_f32_16x16x32_bf16 v[16:19], a[16:19], a[128:131], v[16:19]
ds_read_b64_tr_b16 a[10:11], v202 offset:36864
ds_read_b64_tr_b16 a[40:41], v202 offset:40960
v_mfma_f32_16x16x32_bf16 v[16:19], a[48:51], a[132:135], v[16:19]
ds_read_b64_tr_b16 a[42:43], v202 offset:45056
ds_read_b64_tr_b16 a[12:13], v203 offset:32768
v_mfma_f32_16x16x32_bf16 v[20:23], a[52:55], a[132:135], v[20:23]
ds_read_b64_tr_b16 a[14:15], v203 offset:36864
ds_read_b64_tr_b16 a[44:45], v203 offset:40960
v_mfma_f32_16x16x32_bf16 v[20:23], a[20:23], a[128:131], v[20:23]
s_waitcnt lgkmcnt(15)
ds_read_b64_tr_b16 a[46:47], v203 offset:45056
ds_read_b64_tr_b16 a[16:17], v204 offset:32768
v_mfma_f32_16x16x32_bf16 v[24:27], a[24:27], a[128:131], v[24:27]
ds_read_b64_tr_b16 a[18:19], v204 offset:36864
ds_read_b64_tr_b16 a[48:49], v204 offset:40960
v_mfma_f32_16x16x32_bf16 v[24:27], a[56:59], a[132:135], v[24:27]
ds_read_b64_tr_b16 a[50:51], v204 offset:45056
ds_read_b64_tr_b16 a[20:21], v205 offset:32768
v_mfma_f32_16x16x32_bf16 v[28:31], a[60:63], a[132:135], v[28:31]
ds_read_b64_tr_b16 a[22:23], v205 offset:36864
ds_read_b64_tr_b16 a[52:53], v205 offset:40960
v_mfma_f32_16x16x32_bf16 v[28:31], a[28:31], a[128:131], v[28:31]
s_waitcnt lgkmcnt(15)
ds_read_b64_tr_b16 a[54:55], v205 offset:45056
ds_read_b64_tr_b16 a[24:25], v206 offset:32768
v_mfma_f32_16x16x32_bf16 v[0:3], a[0:3], a[64:67], v[0:3]
ds_read_b64_tr_b16 a[26:27], v206 offset:36864
ds_read_b64_tr_b16 a[56:57], v206 offset:40960
v_mfma_f32_16x16x32_bf16 v[0:3], a[32:35], a[68:71], v[0:3]
ds_read_b64_tr_b16 a[58:59], v206 offset:45056
ds_read_b64_tr_b16 a[28:29], v207 offset:32768
v_mfma_f32_16x16x32_bf16 v[4:7], a[36:39], a[68:71], v[4:7]
ds_read_b64_tr_b16 a[30:31], v207 offset:36864
ds_read_b64_tr_b16 a[60:61], v207 offset:40960
v_mfma_f32_16x16x32_bf16 v[4:7], a[4:7], a[64:67], v[4:7]
s_waitcnt lgkmcnt(15)
ds_read_b64_tr_b16 a[62:63], v207 offset:45056
ds_read_b64_tr_b16 a[0:1], v200 offset:0
v_mfma_f32_16x16x32_bf16 v[8:11], a[8:11], a[64:67], v[8:11]
ds_read_b64_tr_b16 a[2:3], v200 offset:4096
ds_read_b64_tr_b16 a[32:33], v200 offset:8192
v_mfma_f32_16x16x32_bf16 v[8:11], a[40:43], a[68:71], v[8:11]
ds_read_b64_tr_b16 a[34:35], v200 offset:12288
ds_read_b64_tr_b16 a[4:5], v201 offset:0
v_mfma_f32_16x16x32_bf16 v[12:15], a[44:47], a[68:71], v[12:15]
ds_read_b64_tr_b16 a[6:7], v201 offset:4096
ds_read_b64_tr_b16 a[36:37], v201 offset:8192
v_mfma_f32_16x16x32_bf16 v[12:15], a[12:15], a[64:67], v[12:15]
s_waitcnt lgkmcnt(15)
ds_read_b64_tr_b16 a[38:39], v201 offset:12288
ds_read_b64_tr_b16 a[8:9], v202 offset:0
v_mfma_f32_16x16x32_bf16 v[16:19], a[16:19], a[64:67], v[16:19]
ds_read_b64_tr_b16 a[10:11], v202 offset:4096
ds_read_b64_tr_b16 a[40:41], v202 offset:8192
v_mfma_f32_16x16x32_bf16 v[16:19], a[48:51], a[68:71], v[16:19]
ds_read_b64_tr_b16 a[42:43], v202 offset:12288
ds_read_b64_tr_b16 a[12:13], v203 offset:0
v_mfma_f32_16x16x32_bf16 v[20:23], a[52:55], a[68:71], v[20:23]
ds_read_b64_tr_b16 a[14:15], v203 offset:4096
ds_read_b64_tr_b16 a[44:45], v203 offset:8192
v_mfma_f32_16x16x32_bf16 v[20:23], a[20:23], a[64:67], v[20:23]
s_waitcnt lgkmcnt(15)
ds_read_b64_tr_b16 a[46:47], v203 offset:12288
ds_read_b64_tr_b16 a[16:17], v204 offset:0
v_mfma_f32_16x16x32_bf16 v[24:27], a[24:27], a[64:67], v[24:27]
ds_read_b64_tr_b16 a[18:19], v204 offset:4096
ds_read_b64_tr_b16 a[48:49], v204 offset:8192
v_mfma_f32_16x16x32_bf16 v[24:27], a[56:59], a[68:71], v[24:27]
ds_read_b64_tr_b16 a[50:51], v204 offset:12288
ds_read_b64_tr_b16 a[20:21], v205 offset:0
v_mfma_f32_16x16x32_bf16 v[28:31], a[60:63], a[68:71], v[28:31]
ds_read_b64_tr_b16 a[22:23], v205 offset:4096
ds_read_b64_tr_b16 a[52:53], v205 offset:8192
v_mfma_f32_16x16x32_bf16 v[28:31], a[28:31], a[64:67], v[28:31]
s_waitcnt lgkmcnt(15)
ds_read_b64_tr_b16 a[54:55], v205 offset:12288
ds_read_b64_tr_b16 a[24:25], v206 offset:0
v_mfma_f32_16x16x32_bf16 v[0:3], a[0:3], a[72:75], v[0:3]
ds_read_b64_tr_b16 a[26:27], v206 offset:4096
ds_read_b64_tr_b16 a[56:57], v206 offset:8192
v_mfma_f32_16x16x32_bf16 v[0:3], a[32:35], a[76:79], v[0:3]
ds_read_b64_tr_b16 a[58:59], v206 offset:12288
ds_read_b64_tr_b16 a[28:29], v207 offset:0
v_mfma_f32_16x16x32_bf16 v[4:7], a[36:39], a[76:79], v[4:7]
ds_read_b64_tr_b16 a[30:31], v207 offset:4096
ds_read_b64_tr_b16 a[60:61], v207 offset:8192
v_mfma_f32_16x16x32_bf16 v[4:7], a[4:7], a[72:75], v[4:7]
s_waitcnt lgkmcnt(15)
ds_read_b64_tr_b16 a[62:63], v207 offset:12288
ds_read_b64_tr_b16 a[0:1], v200 offset:16384
v_mfma_f32_16x16x32_bf16 v[8:11], a[8:11], a[72:75], v[8:11]
ds_read_b64_tr_b16 a[2:3], v200 offset:20480
ds_read_b64_tr_b16 a[32:33], v200 offset:24576
v_mfma_f32_16x16x32_bf16 v[8:11], a[40:43], a[76:79], v[8:11]
ds_read_b64_tr_b16 a[34:35], v200 offset:28672
ds_read_b64_tr_b16 a[4:5], v201 offset:16384
v_mfma_f32_16x16x32_bf16 v[12:15], a[44:47], a[76:79], v[12:15]
ds_read_b64_tr_b16 a[6:7], v201 offset:20480
ds_read_b64_tr_b16 a[36:37], v201 offset:24576
v_mfma_f32_16x16x32_bf16 v[12:15], a[12:15], a[72:75], v[12:15]
s_waitcnt lgkmcnt(15)
ds_read_b64_tr_b16 a[38:39], v201 offset:28672
ds_read_b64_tr_b16 a[8:9], v202 offset:16384
v_mfma_f32_16x16x32_bf16 v[16:19], a[16:19], a[72:75], v[16:19]
ds_read_b64_tr_b16 a[10:11], v202 offset:20480
ds_read_b64_tr_b16 a[40:41], v202 offset:24576
v_mfma_f32_16x16x32_bf16 v[16:19], a[48:51], a[76:79], v[16:19]
ds_read_b64_tr_b16 a[42:43], v202 offset:28672
ds_read_b64_tr_b16 a[12:13], v203 offset:16384
v_mfma_f32_16x16x32_bf16 v[20:23], a[52:55], a[76:79], v[20:23]
ds_read_b64_tr_b16 a[14:15], v203 offset:20480
ds_read_b64_tr_b16 a[44:45], v203 offset:24576
v_mfma_f32_16x16x32_bf16 v[20:23], a[20:23], a[72:75], v[20:23]
s_waitcnt lgkmcnt(15)
ds_read_b64_tr_b16 a[46:47], v203 offset:28672
ds_read_b64_tr_b16 a[16:17], v204 offset:16384
v_mfma_f32_16x16x32_bf16 v[24:27], a[24:27], a[72:75], v[24:27]
ds_read_b64_tr_b16 a[18:19], v204 offset:20480
ds_read_b64_tr_b16 a[48:49], v204 offset:24576
v_mfma_f32_16x16x32_bf16 v[24:27], a[56:59], a[76:79], v[24:27]
ds_read_b64_tr_b16 a[50:51], v204 offset:28672
ds_read_b64_tr_b16 a[20:21], v205 offset:16384
v_mfma_f32_16x16x32_bf16 v[28:31], a[60:63], a[76:79], v[28:31]
ds_read_b64_tr_b16 a[22:23], v205 offset:20480
ds_read_b64_tr_b16 a[52:53], v205 offset:24576
v_mfma_f32_16x16x32_bf16 v[28:31], a[28:31], a[72:75], v[28:31]
s_waitcnt lgkmcnt(15)
ds_read_b64_tr_b16 a[54:55], v205 offset:28672
ds_read_b64_tr_b16 a[24:25], v206 offset:16384
v_mfma_f32_16x16x32_bf16 v[0:3], a[0:3], a[80:83], v[0:3]
ds_read_b64_tr_b16 a[26:27], v206 offset:20480
ds_read_b64_tr_b16 a[56:57], v206 offset:24576
v_mfma_f32_16x16x32_bf16 v[0:3], a[32:35], a[84:87], v[0:3]
ds_read_b64_tr_b16 a[58:59], v206 offset:28672
ds_read_b64_tr_b16 a[28:29], v207 offset:16384
v_mfma_f32_16x16x32_bf16 v[4:7], a[36:39], a[84:87], v[4:7]
ds_read_b64_tr_b16 a[30:31], v207 offset:20480
ds_read_b64_tr_b16 a[60:61], v207 offset:24576
v_mfma_f32_16x16x32_bf16 v[4:7], a[4:7], a[80:83], v[4:7]
s_waitcnt lgkmcnt(15)
ds_read_b64_tr_b16 a[62:63], v207 offset:28672
ds_read_b64_tr_b16 a[0:1], v208 offset:49152
v_mfma_f32_16x16x32_bf16 v[8:11], a[8:11], a[80:83], v[8:11]
ds_read_b64_tr_b16 a[2:3], v208 offset:53248
ds_read_b64_tr_b16 a[32:33], v208 offset:57344
v_mfma_f32_16x16x32_bf16 v[8:11], a[40:43], a[84:87], v[8:11]
ds_read_b64_tr_b16 a[34:35], v208 offset:61440
ds_read_b64_tr_b16 a[4:5], v209 offset:49152
v_mfma_f32_16x16x32_bf16 v[12:15], a[44:47], a[84:87], v[12:15]
ds_read_b64_tr_b16 a[6:7], v209 offset:53248
ds_read_b64_tr_b16 a[36:37], v209 offset:57344
v_mfma_f32_16x16x32_bf16 v[12:15], a[12:15], a[80:83], v[12:15]
s_waitcnt lgkmcnt(15)
ds_read_b64_tr_b16 a[38:39], v209 offset:61440
ds_read_b64_tr_b16 a[8:9], v210 offset:49152
v_mfma_f32_16x16x32_bf16 v[16:19], a[16:19], a[80:83], v[16:19]
ds_read_b64_tr_b16 a[10:11], v210 offset:53248
ds_read_b64_tr_b16 a[40:41], v210 offset:57344
v_mfma_f32_16x16x32_bf16 v[16:19], a[48:51], a[84:87], v[16:19]
ds_read_b64_tr_b16 a[42:43], v210 offset:61440
ds_read_b64_tr_b16 a[12:13], v211 offset:49152
v_mfma_f32_16x16x32_bf16 v[20:23], a[52:55], a[84:87], v[20:23]
ds_read_b64_tr_b16 a[14:15], v211 offset:53248
ds_read_b64_tr_b16 a[44:45], v211 offset:57344
v_mfma_f32_16x16x32_bf16 v[20:23], a[20:23], a[80:83], v[20:23]
s_waitcnt lgkmcnt(15)
ds_read_b64_tr_b16 a[46:47], v211 offset:61440
ds_read_b64_tr_b16 a[16:17], v212 offset:49152
v_mfma_f32_16x16x32_bf16 v[24:27], a[24:27], a[80:83], v[24:27]
ds_read_b64_tr_b16 a[18:19], v212 offset:53248
ds_read_b64_tr_b16 a[48:49], v212 offset:57344
v_mfma_f32_16x16x32_bf16 v[24:27], a[56:59], a[84:87], v[24:27]
ds_read_b64_tr_b16 a[50:51], v212 offset:61440
ds_read_b64_tr_b16 a[20:21], v213 offset:49152
v_mfma_f32_16x16x32_bf16 v[28:31], a[60:63], a[84:87], v[28:31]
ds_read_b64_tr_b16 a[22:23], v213 offset:53248
ds_read_b64_tr_b16 a[52:53], v213 offset:57344
v_mfma_f32_16x16x32_bf16 v[28:31], a[28:31], a[80:83], v[28:31]
s_waitcnt lgkmcnt(15)
ds_read_b64_tr_b16 a[54:55], v213 offset:61440
ds_read_b64_tr_b16 a[24:25], v214 offset:49152
v_mfma_f32_16x16x32_bf16 v[0:3], a[0:3], a[88:91], v[0:3]
ds_read_b64_tr_b16 a[26:27], v214 offset:53248
ds_read_b64_tr_b16 a[56:57], v214 offset:57344
v_mfma_f32_16x16x32_bf16 v[0:3], a[32:35], a[92:95], v[0:3]
ds_read_b64_tr_b16 a[58:59], v214 offset:61440
ds_read_b64_tr_b16 a[28:29], v215 offset:49152
v_mfma_f32_16x16x32_bf16 v[4:7], a[36:39], a[92:95], v[4:7]
ds_read_b64_tr_b16 a[30:31], v215 offset:53248
ds_read_b64_tr_b16 a[60:61], v215 offset:57344
v_mfma_f32_16x16x32_bf16 v[4:7], a[4:7], a[88:91], v[4:7]
s_waitcnt lgkmcnt(15)
ds_read_b64_tr_b16 a[62:63], v215 offset:61440
ds_read_b64_tr_b16 a[0:1], v216 offset:0
v_mfma_f32_16x16x32_bf16 v[8:11], a[8:11], a[88:91], v[8:11]
ds_read_b64_tr_b16 a[2:3], v216 offset:4096
ds_read_b64_tr_b16 a[32:33], v216 offset:8192
v_mfma_f32_16x16x32_bf16 v[8:11], a[40:43], a[92:95], v[8:11]
ds_read_b64_tr_b16 a[34:35], v216 offset:12288
ds_read_b64_tr_b16 a[4:5], v217 offset:0
v_mfma_f32_16x16x32_bf16 v[12:15], a[44:47], a[92:95], v[12:15]
ds_read_b64_tr_b16 a[6:7], v217 offset:4096
ds_read_b64_tr_b16 a[36:37], v217 offset:8192
v_mfma_f32_16x16x32_bf16 v[12:15], a[12:15], a[88:91], v[12:15]
v_cvt_pk_bf16_f32 v91, v94, v95
buffer_store_dwordx4 v[88:91], v172, s[8:11], s38 offen offset:3072 sc1
v_cvt_pk_bf16_f32 v56, v56, v57
v_cvt_pk_bf16_f32 v57, v58, v59
v_cvt_pk_bf16_f32 v58, v60, v61
v_cvt_pk_bf16_f32 v59, v62, v63
buffer_store_dwordx4 v[56:59], v172, s[8:11], s37 offen offset:3072 sc1
s_waitcnt vmcnt(0)
s_mov_b64 exec, 1
buffer_store_dword v173, off, s[8:11], s95 sc1
buffer_store_dword v173, off, s[8:11], s96 sc1
buffer_store_dword v173, off, s[8:11], s97 sc1
s_mov_b64 exec, -1
s_waitcnt lgkmcnt(15)
ds_read_b64_tr_b16 a[38:39], v217 offset:12288
v_mfma_f32_16x16x32_bf16 v[16:19], a[16:19], a[88:91], v[16:19]
ds_read_b64_tr_b16 a[8:9], v218 offset:0
ds_read_b64_tr_b16 a[10:11], v218 offset:4096
v_mfma_f32_16x16x32_bf16 v[16:19], a[48:51], a[92:95], v[16:19]
ds_read_b64_tr_b16 a[40:41], v218 offset:8192
ds_read_b64_tr_b16 a[42:43], v218 offset:12288
v_mfma_f32_16x16x32_bf16 v[20:23], a[52:55], a[92:95], v[20:23]
ds_read_b64_tr_b16 a[12:13], v219 offset:0
ds_read_b64_tr_b16 a[14:15], v219 offset:4096
v_mfma_f32_16x16x32_bf16 v[20:23], a[20:23], a[88:91], v[20:23]
s_waitcnt lgkmcnt(15)
ds_read_b64_tr_b16 a[44:45], v219 offset:8192
ds_read_b64_tr_b16 a[46:47], v219 offset:12288
v_mfma_f32_16x16x32_bf16 v[24:27], a[24:27], a[88:91], v[24:27]
ds_read_b64_tr_b16 a[16:17], v220 offset:0
ds_read_b64_tr_b16 a[18:19], v220 offset:4096
v_mfma_f32_16x16x32_bf16 v[24:27], a[56:59], a[92:95], v[24:27]
s_waitcnt lgkmcnt(15)
ds_read_b64_tr_b16 a[48:49], v220 offset:8192
ds_read_b64_tr_b16 a[50:51], v220 offset:12288
v_mfma_f32_16x16x32_bf16 v[28:31], a[60:63], a[92:95], v[28:31]
ds_read_b64_tr_b16 a[20:21], v221 offset:0
ds_read_b64_tr_b16 a[22:23], v221 offset:4096
v_mfma_f32_16x16x32_bf16 v[28:31], a[28:31], a[88:91], v[28:31]
s_waitcnt lgkmcnt(15)
ds_read_b64_tr_b16 a[52:53], v221 offset:8192
ds_read_b64_tr_b16 a[54:55], v221 offset:12288
v_mfma_f32_16x16x32_bf16 v[0:3], a[0:3], a[96:99], v[0:3]
ds_read_b64_tr_b16 a[24:25], v222 offset:0
ds_read_b64_tr_b16 a[26:27], v222 offset:4096
v_mfma_f32_16x16x32_bf16 v[0:3], a[32:35], a[100:103], v[0:3]
s_waitcnt lgkmcnt(15)
ds_read_b64_tr_b16 a[56:57], v222 offset:8192
ds_read_b64_tr_b16 a[58:59], v222 offset:12288
v_mfma_f32_16x16x32_bf16 v[4:7], a[36:39], a[100:103], v[4:7]
ds_read_b64_tr_b16 a[28:29], v223 offset:0
ds_read_b64_tr_b16 a[30:31], v223 offset:4096
v_mfma_f32_16x16x32_bf16 v[4:7], a[4:7], a[96:99], v[4:7]
s_waitcnt lgkmcnt(15)
ds_read_b64_tr_b16 a[60:61], v223 offset:8192
ds_read_b64_tr_b16 a[62:63], v223 offset:12288
v_mfma_f32_16x16x32_bf16 v[8:11], a[8:11], a[96:99], v[8:11]
v_mfma_f32_16x16x32_bf16 v[8:11], a[40:43], a[100:103], v[8:11]
s_waitcnt lgkmcnt(15)
v_mfma_f32_16x16x32_bf16 v[12:15], a[44:47], a[100:103], v[12:15]
v_mfma_f32_16x16x32_bf16 v[12:15], a[12:15], a[96:99], v[12:15]
s_waitcnt lgkmcnt(12)
v_mfma_f32_16x16x32_bf16 v[16:19], a[16:19], a[96:99], v[16:19]
v_mfma_f32_16x16x32_bf16 v[16:19], a[48:51], a[100:103], v[16:19]
s_waitcnt lgkmcnt(8)
v_mfma_f32_16x16x32_bf16 v[20:23], a[52:55], a[100:103], v[20:23]
v_mfma_f32_16x16x32_bf16 v[20:23], a[20:23], a[96:99], v[20:23]
s_waitcnt lgkmcnt(4)
v_mfma_f32_16x16x32_bf16 v[24:27], a[24:27], a[96:99], v[24:27]
v_mfma_f32_16x16x32_bf16 v[24:27], a[56:59], a[100:103], v[24:27]
s_waitcnt lgkmcnt(0)
v_mfma_f32_16x16x32_bf16 v[28:31], a[60:63], a[100:103], v[28:31]
v_mfma_f32_16x16x32_bf16 v[28:31], a[28:31], a[96:99], v[28:31]
v_min_u32 v177, 2, v168
v_lshlrev_b32 v177, 7, v177
s_barrier
s_add_u32 s26, s92, 0x0
s_lshl_b32 s27, s21, 11
s_lshr_b32 s28, s22, 1
s_lshl_b32 s28, s28, 9
s_add_u32 s27, s27, s28
s_and_b32 s28, s22, 1
s_lshl_b32 s28, s28, 4
s_add_u32 s27, s27, s28
s_add_u32 s27, s27, 0x1a00000
v_and_b32 v184, 15, v168
v_lshlrev_b32 v184, 5, v184
v_lshlrev_b32 v180, 16, v128
v_and_b32 v181, 0xffff0000, v128
v_pk_fma_f32 v[0:1], v[0:1], v[174:175], v[180:181] op_sel_hi:[1,0,1]
v_lshlrev_b32 v182, 16, v129
v_and_b32 v183, 0xffff0000, v129
v_pk_fma_f32 v[2:3], v[2:3], v[174:175], v[182:183] op_sel_hi:[1,0,1]
v_lshlrev_b32 v180, 16, v130
v_and_b32 v181, 0xffff0000, v130
v_pk_fma_f32 v[4:5], v[4:5], v[174:175], v[180:181] op_sel_hi:[1,0,1]
v_lshlrev_b32 v182, 16, v131
v_and_b32 v183, 0xffff0000, v131
v_pk_fma_f32 v[6:7], v[6:7], v[174:175], v[182:183] op_sel_hi:[1,0,1]
v_lshlrev_b32 v180, 16, v132
v_and_b32 v181, 0xffff0000, v132
v_pk_fma_f32 v[8:9], v[8:9], v[174:175], v[180:181] op_sel_hi:[1,0,1]
v_lshlrev_b32 v182, 16, v133
v_and_b32 v183, 0xffff0000, v133
v_pk_fma_f32 v[10:11], v[10:11], v[174:175], v[182:183] op_sel_hi:[1,0,1]
v_lshlrev_b32 v180, 16, v134
v_and_b32 v181, 0xffff0000, v134
v_pk_fma_f32 v[12:13], v[12:13], v[174:175], v[180:181] op_sel_hi:[1,0,1]
v_lshlrev_b32 v182, 16, v135
v_and_b32 v183, 0xffff0000, v135
v_pk_fma_f32 v[14:15], v[14:15], v[174:175], v[182:183] op_sel_hi:[1,0,1]
v_lshlrev_b32 v180, 16, v136
v_and_b32 v181, 0xffff0000, v136
v_pk_fma_f32 v[16:17], v[16:17], v[174:175], v[180:181] op_sel_hi:[1,0,1]
v_lshlrev_b32 v182, 16, v137
v_and_b32 v183, 0xffff0000, v137
v_pk_fma_f32 v[18:19], v[18:19], v[174:175], v[182:183] op_sel_hi:[1,0,1]
v_lshlrev_b32 v180, 16, v138
v_and_b32 v181, 0xffff0000, v138
v_pk_fma_f32 v[20:21], v[20:21], v[174:175], v[180:181] op_sel_hi:[1,0,1]
v_lshlrev_b32 v182, 16, v139
v_and_b32 v183, 0xffff0000, v139
v_pk_fma_f32 v[22:23], v[22:23], v[174:175], v[182:183] op_sel_hi:[1,0,1]
v_lshlrev_b32 v180, 16, v140
v_and_b32 v181, 0xffff0000, v140
v_pk_fma_f32 v[24:25], v[24:25], v[174:175], v[180:181] op_sel_hi:[1,0,1]
v_lshlrev_b32 v182, 16, v141
v_and_b32 v183, 0xffff0000, v141
v_pk_fma_f32 v[26:27], v[26:27], v[174:175], v[182:183] op_sel_hi:[1,0,1]
v_lshlrev_b32 v180, 16, v142
v_and_b32 v181, 0xffff0000, v142
v_pk_fma_f32 v[28:29], v[28:29], v[174:175], v[180:181] op_sel_hi:[1,0,1]
v_lshlrev_b32 v182, 16, v143
v_and_b32 v183, 0xffff0000, v143
v_pk_fma_f32 v[30:31], v[30:31], v[174:175], v[182:183] op_sel_hi:[1,0,1]
s_mov_b32 s56, 0x100000
L_k4x_poll:
buffer_load_dword v176, v177, s[8:11], s94 offen sc1
s_waitcnt vmcnt(0)
v_cmp_ne_u32 s[46:47], s58, v176
s_nop 4
s_cmp_eq_u64 s[46:47], 0
s_cbranch_scc1 L_k4x_go
s_sub_u32 s56, s56, 1
s_cbranch_scc0 L_k4x_poll
L_k4x_go:
buffer_load_dwordx4 v[192:195], v172, s[8:11], s36 offen offset:0 sc1
buffer_load_dwordx4 v[196:199], v172, s[8:11], s36 offen offset:1024 sc1
buffer_load_dwordx4 v[200:203], v172, s[8:11], s36 offen offset:2048 sc1
buffer_load_dwordx4 v[204:207], v172, s[8:11], s36 offen offset:3072 sc1
buffer_load_dwordx4 v[208:211], v172, s[8:11], s61 offen offset:0 sc1
buffer_load_dwordx4 v[212:215], v172, s[8:11], s61 offen offset:1024 sc1
buffer_load_dwordx4 v[216:219], v172, s[8:11], s61 offen offset:2048 sc1
buffer_load_dwordx4 v[220:223], v172, s[8:11], s61 offen offset:3072 sc1
buffer_load_dwordx4 v[128:131], v172, s[8:11], s62 offen offset:0 sc1
buffer_load_dwordx4 v[132:135], v172, s[8:11], s62 offen offset:1024 sc1
buffer_load_dwordx4 v[136:139], v172, s[8:11], s62 offen offset:2048 sc1
buffer_load_dwordx4 v[140:143], v172, s[8:11], s62 offen offset:3072 sc1
s_waitcnt vmcnt(8)
v_lshlrev_b32 v180, 16, v192
v_and_b32 v181, 0xffff0000, v192
v_pk_fma_f32 v[0:1], v[180:181], v[174:175], v[0:1] op_sel_hi:[1,0,1]
v_lshlrev_b32 v182, 16, v193
v_and_b32 v183, 0xffff0000, v193
v_pk_fma_f32 v[2:3], v[182:183], v[174:175], v[2:3] op_sel_hi:[1,0,1]
v_lshlrev_b32 v180, 16, v194
v_and_b32 v181, 0xffff0000, v194
v_pk_fma_f32 v[4:5], v[180:181], v[174:175], v[4:5] op_sel_hi:[1,0,1]
v_lshlrev_b32 v182, 16, v195
v_and_b32 v183, 0xffff0000, v195
v_pk_fma_f32 v[6:7], v[182:183], v[174:175], v[6:7] op_sel_hi:[1,0,1]
v_lshlrev_b32 v180, 16, v196
v_and_b32 v181, 0xffff0000, v196
v_pk_fma_f32 v[8:9], v[180:181], v[174:175], v[8:9] op_sel_hi:[1,0,1]
v_lshlrev_b32 v182, 16, v197
v_and_b32 v183, 0xffff0000, v197
v_pk_fma_f32 v[10:11], v[182:183], v[174:175], v[10:11] op_sel_hi:[1,0,1]
v_lshlrev_b32 v180, 16, v198
v_and_b32 v181, 0xffff0000, v198
v_pk_fma_f32 v[12:13], v[180:181], v[174:175], v[12:13] op_sel_hi:[1,0,1]
v_lshlrev_b32 v182, 16, v199
v_and_b32 v183, 0xffff0000, v199
v_pk_fma_f32 v[14:15], v[182:183], v[174:175], v[14:15] op_sel_hi:[1,0,1]
v_lshlrev_b32 v180, 16, v200
v_and_b32 v181, 0xffff0000, v200
v_pk_fma_f32 v[16:17], v[180:181], v[174:175], v[16:17] op_sel_hi:[1,0,1]
v_lshlrev_b32 v182, 16, v201
v_and_b32 v183, 0xffff0000, v201
v_pk_fma_f32 v[18:19], v[182:183], v[174:175], v[18:19] op_sel_hi:[1,0,1]
v_lshlrev_b32 v180, 16, v202
v_and_b32 v181, 0xffff0000, v202
v_pk_fma_f32 v[20:21], v[180:181], v[174:175], v[20:21] op_sel_hi:[1,0,1]
v_lshlrev_b32 v182, 16, v203
v_and_b32 v183, 0xffff0000, v203
v_pk_fma_f32 v[22:23], v[182:183], v[174:175], v[22:23] op_sel_hi:[1,0,1]
v_lshlrev_b32 v180, 16, v204
v_and_b32 v181, 0xffff0000, v204
v_pk_fma_f32 v[24:25], v[180:181], v[174:175], v[24:25] op_sel_hi:[1,0,1]
v_lshlrev_b32 v182, 16, v205
v_and_b32 v183, 0xffff0000, v205
v_pk_fma_f32 v[26:27], v[182:183], v[174:175], v[26:27] op_sel_hi:[1,0,1]
v_lshlrev_b32 v180, 16, v206
v_and_b32 v181, 0xffff0000, v206
v_pk_fma_f32 v[28:29], v[180:181], v[174:175], v[28:29] op_sel_hi:[1,0,1]
v_lshlrev_b32 v182, 16, v207
v_and_b32 v183, 0xffff0000, v207
v_pk_fma_f32 v[30:31], v[182:183], v[174:175], v[30:31] op_sel_hi:[1,0,1]
s_waitcnt vmcnt(4)
v_lshlrev_b32 v180, 16, v208
v_and_b32 v181, 0xffff0000, v208
v_pk_fma_f32 v[0:1], v[180:181], v[174:175], v[0:1] op_sel_hi:[1,0,1]
v_lshlrev_b32 v182, 16, v209
v_and_b32 v183, 0xffff0000, v209
v_pk_fma_f32 v[2:3], v[182:183], v[174:175], v[2:3] op_sel_hi:[1,0,1]
v_lshlrev_b32 v180, 16, v210
v_and_b32 v181, 0xffff0000, v210
v_pk_fma_f32 v[4:5], v[180:181], v[174:175], v[4:5] op_sel_hi:[1,0,1]
v_lshlrev_b32 v182, 16, v211
v_and_b32 v183, 0xffff0000, v211
v_pk_fma_f32 v[6:7], v[182:183], v[174:175], v[6:7] op_sel_hi:[1,0,1]
v_lshlrev_b32 v180, 16, v212
v_and_b32 v181, 0xffff0000, v212
v_pk_fma_f32 v[8:9], v[180:181], v[174:175], v[8:9] op_sel_hi:[1,0,1]
v_lshlrev_b32 v182, 16, v213
v_and_b32 v183, 0xffff0000, v213
v_pk_fma_f32 v[10:11], v[182:183], v[174:175], v[10:11] op_sel_hi:[1,0,1]
v_lshlrev_b32 v180, 16, v214
v_and_b32 v181, 0xffff0000, v214
v_pk_fma_f32 v[12:13], v[180:181], v[174:175], v[12:13] op_sel_hi:[1,0,1]
v_lshlrev_b32 v182, 16, v215
v_and_b32 v183, 0xffff0000, v215
v_pk_fma_f32 v[14:15], v[182:183], v[174:175], v[14:15] op_sel_hi:[1,0,1]
v_lshlrev_b32 v180, 16, v216
v_and_b32 v181, 0xffff0000, v216
v_pk_fma_f32 v[16:17], v[180:181], v[174:175], v[16:17] op_sel_hi:[1,0,1]
v_lshlrev_b32 v182, 16, v217
v_and_b32 v183, 0xffff0000, v217
v_pk_fma_f32 v[18:19], v[182:183], v[174:175], v[18:19] op_sel_hi:[1,0,1]
v_lshlrev_b32 v180, 16, v218
v_and_b32 v181, 0xffff0000, v218
v_pk_fma_f32 v[20:21], v[180:181], v[174:175], v[20:21] op_sel_hi:[1,0,1]
v_lshlrev_b32 v182, 16, v219
v_and_b32 v183, 0xffff0000, v219
v_pk_fma_f32 v[22:23], v[182:183], v[174:175], v[22:23] op_sel_hi:[1,0,1]
v_lshlrev_b32 v180, 16, v220
v_and_b32 v181, 0xffff0000, v220
v_pk_fma_f32 v[24:25], v[180:181], v[174:175], v[24:25] op_sel_hi:[1,0,1]
v_lshlrev_b32 v182, 16, v221
v_and_b32 v183, 0xffff0000, v221
v_pk_fma_f32 v[26:27], v[182:183], v[174:175], v[26:27] op_sel_hi:[1,0,1]
v_lshlrev_b32 v180, 16, v222
v_and_b32 v181, 0xffff0000, v222
v_pk_fma_f32 v[28:29], v[180:181], v[174:175], v[28:29] op_sel_hi:[1,0,1]
v_lshlrev_b32 v182, 16, v223
v_and_b32 v183, 0xffff0000, v223
v_pk_fma_f32 v[30:31], v[182:183], v[174:175], v[30:31] op_sel_hi:[1,0,1]
s_waitcnt vmcnt(0)
v_lshlrev_b32 v180, 16, v128
v_and_b32 v181, 0xffff0000, v128
v_pk_fma_f32 v[0:1], v[180:181], v[174:175], v[0:1] op_sel_hi:[1,0,1]
v_cvt_pk_bf16_f32 v128, v0, v1
v_lshlrev_b32 v182, 16, v129
v_and_b32 v183, 0xffff0000, v129
v_pk_fma_f32 v[2:3], v[182:183], v[174:175], v[2:3] op_sel_hi:[1,0,1]
v_cvt_pk_bf16_f32 v129, v2, v3
v_lshlrev_b32 v180, 16, v130
v_and_b32 v181, 0xffff0000, v130
v_pk_fma_f32 v[4:5], v[180:181], v[174:175], v[4:5] op_sel_hi:[1,0,1]
v_cvt_pk_bf16_f32 v130, v4, v5
v_lshlrev_b32 v182, 16, v131
v_and_b32 v183, 0xffff0000, v131
v_pk_fma_f32 v[6:7], v[182:183], v[174:175], v[6:7] op_sel_hi:[1,0,1]
v_cvt_pk_bf16_f32 v131, v6, v7
v_lshlrev_b32 v180, 16, v132
v_and_b32 v181, 0xffff0000, v132
v_pk_fma_f32 v[8:9], v[180:181], v[174:175], v[8:9] op_sel_hi:[1,0,1]
v_cvt_pk_bf16_f32 v132, v8, v9
v_lshlrev_b32 v182, 16, v133
v_and_b32 v183, 0xffff0000, v133
v_pk_fma_f32 v[10:11], v[182:183], v[174:175], v[10:11] op_sel_hi:[1,0,1]
v_cvt_pk_bf16_f32 v133, v10, v11
v_lshlrev_b32 v180, 16, v134
v_and_b32 v181, 0xffff0000, v134
v_pk_fma_f32 v[12:13], v[180:181], v[174:175], v[12:13] op_sel_hi:[1,0,1]
v_cvt_pk_bf16_f32 v134, v12, v13
v_lshlrev_b32 v182, 16, v135
v_and_b32 v183, 0xffff0000, v135
v_pk_fma_f32 v[14:15], v[182:183], v[174:175], v[14:15] op_sel_hi:[1,0,1]
v_cvt_pk_bf16_f32 v135, v14, v15
v_lshlrev_b32 v180, 16, v136
v_and_b32 v181, 0xffff0000, v136
v_pk_fma_f32 v[16:17], v[180:181], v[174:175], v[16:17] op_sel_hi:[1,0,1]
v_cvt_pk_bf16_f32 v136, v16, v17
v_lshlrev_b32 v182, 16, v137
v_and_b32 v183, 0xffff0000, v137
v_pk_fma_f32 v[18:19], v[182:183], v[174:175], v[18:19] op_sel_hi:[1,0,1]
v_cvt_pk_bf16_f32 v137, v18, v19
v_lshlrev_b32 v180, 16, v138
v_and_b32 v181, 0xffff0000, v138
v_pk_fma_f32 v[20:21], v[180:181], v[174:175], v[20:21] op_sel_hi:[1,0,1]
v_cvt_pk_bf16_f32 v138, v20, v21
v_lshlrev_b32 v182, 16, v139
v_and_b32 v183, 0xffff0000, v139
v_pk_fma_f32 v[22:23], v[182:183], v[174:175], v[22:23] op_sel_hi:[1,0,1]
v_cvt_pk_bf16_f32 v139, v22, v23
v_lshlrev_b32 v180, 16, v140
v_and_b32 v181, 0xffff0000, v140
v_pk_fma_f32 v[24:25], v[180:181], v[174:175], v[24:25] op_sel_hi:[1,0,1]
v_cvt_pk_bf16_f32 v140, v24, v25
v_lshlrev_b32 v182, 16, v141
v_and_b32 v183, 0xffff0000, v141
v_pk_fma_f32 v[26:27], v[182:183], v[174:175], v[26:27] op_sel_hi:[1,0,1]
v_cvt_pk_bf16_f32 v141, v26, v27
v_lshlrev_b32 v180, 16, v142
v_and_b32 v181, 0xffff0000, v142
v_pk_fma_f32 v[28:29], v[180:181], v[174:175], v[28:29] op_sel_hi:[1,0,1]
v_cvt_pk_bf16_f32 v142, v28, v29
v_lshlrev_b32 v182, 16, v143
v_and_b32 v183, 0xffff0000, v143
v_pk_fma_f32 v[30:31], v[182:183], v[174:175], v[30:31] op_sel_hi:[1,0,1]
v_cvt_pk_bf16_f32 v143, v30, v31
s_cmp_lg_u32 s30, 0
s_cbranch_scc1 L_k4_final
buffer_store_dwordx4 v[128:131], v172, s[8:11], s26 offen offset:0 sc1
buffer_store_dwordx4 v[132:135], v172, s[8:11], s26 offen offset:1024 sc1
buffer_store_dwordx4 v[136:139], v172, s[8:11], s26 offen offset:2048 sc1
buffer_store_dwordx4 v[140:143], v172, s[8:11], s26 offen offset:3072 sc1
v_lshlrev_b32 v0, 16, v128
v_lshlrev_b32 v16, 16, v136
v_and_b32 v1, 0xffff0000, v128
v_and_b32 v17, 0xffff0000, v136
v_lshlrev_b32 v2, 16, v129
v_lshlrev_b32 v18, 16, v137
v_and_b32 v3, 0xffff0000, v129
v_and_b32 v19, 0xffff0000, v137
v_lshlrev_b32 v4, 16, v130
v_lshlrev_b32 v20, 16, v138
v_and_b32 v5, 0xffff0000, v130
v_and_b32 v21, 0xffff0000, v138
v_lshlrev_b32 v6, 16, v131
v_lshlrev_b32 v22, 16, v139
v_and_b32 v7, 0xffff0000, v131
v_and_b32 v23, 0xffff0000, v139
v_lshlrev_b32 v8, 16, v132
v_lshlrev_b32 v24, 16, v140
v_and_b32 v9, 0xffff0000, v132
v_and_b32 v25, 0xffff0000, v140
v_lshlrev_b32 v10, 16, v133
v_lshlrev_b32 v26, 16, v141
v_and_b32 v11, 0xffff0000, v133
v_and_b32 v27, 0xffff0000, v141
v_lshlrev_b32 v12, 16, v134
v_lshlrev_b32 v28, 16, v142
v_and_b32 v13, 0xffff0000, v134
v_and_b32 v29, 0xffff0000, v142
v_lshlrev_b32 v14, 16, v135
v_lshlrev_b32 v30, 16, v143
v_and_b32 v15, 0xffff0000, v135
v_and_b32 v31, 0xffff0000, v143
v_pk_add_f32 v[176:177], v[0:1], v[2:3]
v_pk_add_f32 v[178:179], v[16:17], v[18:19]
v_pk_add_f32 v[176:177], v[176:177], v[4:5]
v_pk_add_f32 v[178:179], v[178:179], v[20:21]
v_pk_add_f32 v[176:177], v[176:177], v[6:7]
v_pk_add_f32 v[178:179], v[178:179], v[22:23]
v_pk_add_f32 v[176:177], v[176:177], v[8:9]
v_pk_add_f32 v[178:179], v[178:179], v[24:25]
v_pk_add_f32 v[176:177], v[176:177], v[10:11]
v_pk_add_f32 v[178:179], v[178:179], v[26:27]
v_pk_add_f32 v[176:177], v[176:177], v[12:13]
v_pk_add_f32 v[178:179], v[178:179], v[28:29]
v_pk_add_f32 v[176:177], v[176:177], v[14:15]
v_pk_add_f32 v[178:179], v[178:179], v[30:31]
v_add_f32 v176, v176, v177
v_add_f32 v178, v178, v179
v_mov_b32 v180, v176
v_mov_b32 v181, v178
s_nop 0
v_permlane16_swap_b32 v176, v180
v_permlane16_swap_b32 v178, v181
v_add_f32 v176, v176, v180
v_add_f32 v178, v178, v181
v_mov_b32 v180, v176
v_mov_b32 v181, v178
s_nop 0
v_permlane32_swap_b32 v176, v180
v_permlane32_swap_b32 v178, v181
v_add_f32 v176, v176, v180
v_add_f32 v178, v178, v181
v_mul_f32 v177, 0x3c800000, v176
v_mul_f32 v179, 0x3c800000, v178
v_pk_add_f32 v[0:1], v[0:1], v[176:177] op_sel:[0,1] op_sel_hi:[1,1] neg_lo:[0,1] neg_hi:[0,1]
v_pk_add_f32 v[16:17], v[16:17], v[178:179] op_sel:[0,1] op_sel_hi:[1,1] neg_lo:[0,1] neg_hi:[0,1]
v_pk_add_f32 v[2:3], v[2:3], v[176:177] op_sel:[0,1] op_sel_hi:[1,1] neg_lo:[0,1] neg_hi:[0,1]
v_pk_add_f32 v[18:19], v[18:19], v[178:179] op_sel:[0,1] op_sel_hi:[1,1] neg_lo:[0,1] neg_hi:[0,1]
v_pk_add_f32 v[4:5], v[4:5], v[176:177] op_sel:[0,1] op_sel_hi:[1,1] neg_lo:[0,1] neg_hi:[0,1]
v_pk_add_f32 v[20:21], v[20:21], v[178:179] op_sel:[0,1] op_sel_hi:[1,1] neg_lo:[0,1] neg_hi:[0,1]
v_pk_add_f32 v[6:7], v[6:7], v[176:177] op_sel:[0,1] op_sel_hi:[1,1] neg_lo:[0,1] neg_hi:[0,1]
v_pk_add_f32 v[22:23], v[22:23], v[178:179] op_sel:[0,1] op_sel_hi:[1,1] neg_lo:[0,1] neg_hi:[0,1]
v_pk_add_f32 v[8:9], v[8:9], v[176:177] op_sel:[0,1] op_sel_hi:[1,1] neg_lo:[0,1] neg_hi:[0,1]
v_pk_add_f32 v[24:25], v[24:25], v[178:179] op_sel:[0,1] op_sel_hi:[1,1] neg_lo:[0,1] neg_hi:[0,1]
v_pk_add_f32 v[10:11], v[10:11], v[176:177] op_sel:[0,1] op_sel_hi:[1,1] neg_lo:[0,1] neg_hi:[0,1]
v_pk_add_f32 v[26:27], v[26:27], v[178:179] op_sel:[0,1] op_sel_hi:[1,1] neg_lo:[0,1] neg_hi:[0,1]
v_pk_add_f32 v[12:13], v[12:13], v[176:177] op_sel:[0,1] op_sel_hi:[1,1] neg_lo:[0,1] neg_hi:[0,1]
v_pk_add_f32 v[28:29], v[28:29], v[178:179] op_sel:[0,1] op_sel_hi:[1,1] neg_lo:[0,1] neg_hi:[0,1]
v_pk_add_f32 v[14:15], v[14:15], v[176:177] op_sel:[0,1] op_sel_hi:[1,1] neg_lo:[0,1] neg_hi:[0,1]
v_pk_add_f32 v[30:31], v[30:31], v[178:179] op_sel:[0,1] op_sel_hi:[1,1] neg_lo:[0,1] neg_hi:[0,1]
v_pk_mul_f32 v[0:1], v[0:1], v[0:1]
v_pk_mul_f32 v[16:17], v[16:17], v[16:17]
v_pk_fma_f32 v[0:1], v[2:3], v[2:3], v[0:1]
v_pk_fma_f32 v[16:17], v[18:19], v[18:19], v[16:17]
v_pk_fma_f32 v[0:1], v[4:5], v[4:5], v[0:1]
v_pk_fma_f32 v[16:17], v[20:21], v[20:21], v[16:17]
v_pk_fma_f32 v[0:1], v[6:7], v[6:7], v[0:1]
v_pk_fma_f32 v[16:17], v[22:23], v[22:23], v[16:17]
v_pk_fma_f32 v[0:1], v[8:9], v[8:9], v[0:1]
v_pk_fma_f32 v[16:17], v[24:25], v[24:25], v[16:17]
v_pk_fma_f32 v[0:1], v[10:11], v[10:11], v[0:1]
v_pk_fma_f32 v[16:17], v[26:27], v[26:27], v[16:17]
v_pk_fma_f32 v[0:1], v[12:13], v[12:13], v[0:1]
v_pk_fma_f32 v[16:17], v[28:29], v[28:29], v[16:17]
v_pk_fma_f32 v[0:1], v[14:15], v[14:15], v[0:1]
v_pk_fma_f32 v[16:17], v[30:31], v[30:31], v[16:17]
v_add_f32 v177, v0, v1
v_add_f32 v179, v16, v17
v_mov_b32 v180, v177
v_mov_b32 v181, v179
s_nop 0
v_permlane16_swap_b32 v177, v180
v_permlane16_swap_b32 v179, v181
v_add_f32 v177, v177, v180
v_add_f32 v179, v179, v181
v_mov_b32 v180, v177
v_mov_b32 v181, v179
s_nop 0
v_permlane32_swap_b32 v177, v180
v_permlane32_swap_b32 v179, v181
v_add_f32 v177, v177, v180
v_add_f32 v179, v179, v181
buffer_store_dwordx2 v[176:177], v184, s[8:11], s27 offen offset:0 sc1
buffer_store_dwordx2 v[178:179], v184, s[8:11], s27 offen offset:8 sc1
s_mov_b32 s30, 1
s_mov_b32 s57, 0x100000
s_nop 7
s_branch L_layer
L_k4_final:
s_load_dwordx2 s[4:5], s[0:1], 64
v_lshlrev_b32 v176, 6, v184
v_lshrrev_b32 v177, 4, v168
v_lshl_add_u32 v176, v177, 4, v176
s_lshl_b32 s26, s21, 15
s_lshl_b32 s27, s22, 8
s_add_u32 s26, s26, s27
v_permlane32_swap_b32 v128, v130
v_permlane32_swap_b32 v129, v131
v_permlane32_swap_b32 v132, v134
v_permlane32_swap_b32 v133, v135
v_permlane32_swap_b32 v136, v138
v_permlane32_swap_b32 v137, v139
v_permlane32_swap_b32 v140, v142
v_permlane32_swap_b32 v141, v143
v_permlane16_swap_b32 v128, v130
v_permlane16_swap_b32 v129, v131
v_permlane16_swap_b32 v132, v134
v_permlane16_swap_b32 v133, v135
v_permlane16_swap_b32 v136, v138
v_permlane16_swap_b32 v137, v139
v_permlane16_swap_b32 v140, v142
v_permlane16_swap_b32 v141, v143
s_nop 1
buffer_store_dwordx4 v[128:131], v176, s[16:19], s26 offen offset:0
buffer_store_dwordx4 v[132:135], v176, s[16:19], s26 offen offset:64
buffer_store_dwordx4 v[136:139], v176, s[16:19], s26 offen offset:128
buffer_store_dwordx4 v[140:143], v176, s[16:19], s26 offen offset:192
s_add_u32 s26, s2, s20
s_cmp_lg_u32 s26, 0
s_cbranch_scc1 L_k4_nz
v_mov_b32 v0, 0
s_waitcnt lgkmcnt(0)
s_mov_b64 exec, 1
global_store_dword v0, v0, s[4:5]
s_mov_b64 exec, -1
L_k4_nz:
L_main_end:
s_endpgm
.section .rodata,"a"
.p2align 6
.amdhsa_kernel interleave_layers__linear_attn_block__glu_gated_bilinear__prompt_kernel
  .amdhsa_next_free_vgpr 512
  .amdhsa_next_free_sgpr 102
  .amdhsa_accum_offset 256
  .amdhsa_group_segment_fixed_size 0
  .amdhsa_kernarg_size 80
  .amdhsa_user_sgpr_count 2
  .amdhsa_user_sgpr_kernarg_segment_ptr 1
  .amdhsa_system_sgpr_workgroup_id_x 1
  .amdhsa_float_denorm_mode_32 3
.end_amdhsa_kernel
.text
```
